```python
import torch

def _softmax(x, axis=-1):
    return torch.softmax(x, dim=axis)
def _gelu(x):
    return torch.nn.functional.gelu(x, approximate="tanh")
def _silu(x):
    return torch.nn.functional.silu(x)
def _sigmoid(x):
    return torch.sigmoid(x)
def _layernorm(x, axis=-1, eps=1e-5):
    m = x.mean(dim=axis, keepdim=True)
    v = x.var(dim=axis, keepdim=True, unbiased=False)
    return (x - m) / torch.sqrt(v + eps)
def _scatter_add(tgt, idx, src, axis=0):
    return tgt.clone().index_add_(axis, idx, src)
def _segment_sum(src, seg, n):
    out = torch.zeros((n,) + src.shape[1:], dtype=src.dtype)
    return out.index_add_(0, seg, src)
def _pad(x, pw):
    flat = tuple(v for pair in reversed(pw) for v in pair)
    return torch.nn.functional.pad(x, flat)

kernel_name = 'concat_heads__mha_block_cached__mha_block_cached__near_ridge'

def setup_inputs():

    _w = (lambda a: (lambda t: t.to(torch.bfloat16) if t.is_floating_point() else t)(torch.as_tensor(a)))
    def _A_setup():
        B, Sq, D = 16, 112, 512
        H, Sk, Dh = 32, 512, 128
        return {
            "x": _w((lambda *s: torch.randn(*s, dtype=torch.bfloat16) * 0.8)(B, Sq, D)),
            "k_cache": _w((lambda *s: torch.randn(*s, dtype=torch.bfloat16) * 0.8)(B, H, Sk, Dh)),
            "v_cache": _w((lambda *s: torch.randn(*s, dtype=torch.bfloat16) * 0.05)(B, H, Sk, Dh)),
            "wq": _w((lambda *s: torch.randn(*s, dtype=torch.bfloat16) * 0.8)(D, H * Dh) * (D ** -0.5)),
            "wo": _w((lambda *s: torch.randn(*s, dtype=torch.bfloat16) * 0.05)(H * Dh, D) * ((H * Dh) ** -0.5)),
        }
    _A_in = _A_setup()

    def _B_setup():
        B, Sq, D = 16, 112, 512
        H, Sk, Dh = 32, 512, 128
        return {
            "x": _w((lambda *s: torch.randn(*s, dtype=torch.bfloat16) * 0.8)(B, Sq, D)),
            "k_cache": _w((lambda *s: torch.randn(*s, dtype=torch.bfloat16) * 0.8)(B, H, Sk, Dh)),
            "v_cache": _w((lambda *s: torch.randn(*s, dtype=torch.bfloat16) * 0.05)(B, H, Sk, Dh)),
            "wq": _w((lambda *s: torch.randn(*s, dtype=torch.bfloat16) * 0.8)(D, H * Dh) * (D ** -0.5)),
            "wo": _w((lambda *s: torch.randn(*s, dtype=torch.bfloat16) * 0.05)(H * Dh, D) * ((H * Dh) ** -0.5)),
        }
    _B_in = _B_setup()

    return {
        "A_x": _A_in["x"],
        "A_k_cache": _A_in["k_cache"],
        "A_v_cache": _A_in["v_cache"],
        "A_wq": _A_in["wq"],
        "A_wo": _A_in["wo"],
        "B_x": _B_in["x"],
        "B_k_cache": _B_in["k_cache"],
        "B_v_cache": _B_in["v_cache"],
        "B_wq": _B_in["wq"],
        "B_wo": _B_in["wo"],
    }

def reference(A_x, A_k_cache, A_v_cache, A_wq, A_wo, B_x, B_k_cache, B_v_cache, B_wq, B_wo):
    def _A_ref(x, k_cache, v_cache, wq, wo):
        B, Sq, D = x.shape
        H, Dh = 32, 128
        q = (lambda x, *d: x.permute(*d))((x @ wq).reshape(B, Sq, H, Dh), 0, 2, 1, 3)
        scores = torch.einsum("bhqd,bhkd->bhqk", q, k_cache) * (Dh ** -0.5)
        p = _softmax(scores, axis=-1)
        o = torch.einsum("bhqk,bhkd->bhqd", p, v_cache)
        return (lambda x, *d: x.permute(*d))(o, 0, 2, 1, 3).reshape(B, Sq, H * Dh) @ wo

    def _B_ref(x, k_cache, v_cache, wq, wo):
        B, Sq, D = x.shape
        H, Dh = 32, 128
        q = (lambda x, *d: x.permute(*d))((x @ wq).reshape(B, Sq, H, Dh), 0, 2, 1, 3)
        scores = torch.einsum("bhqd,bhkd->bhqk", q, k_cache) * (Dh ** -0.5)
        p = _softmax(scores, axis=-1)
        o = torch.einsum("bhqk,bhkd->bhqd", p, v_cache)
        return (lambda x, *d: x.permute(*d))(o, 0, 2, 1, 3).reshape(B, Sq, H * Dh) @ wo

    a = _A_ref(A_x, A_k_cache, A_v_cache, A_wq, A_wo)
    b = _B_ref(B_x, B_k_cache, B_v_cache, B_wq, B_wo)
    return torch.concatenate([a, b], axis=-1)
```

```asm
; @launch grid=(256,1,1) block=(512,1,1) lds=163840
.amdgcn_target "amdgcn-amd-amdhsa--gfx950"
.text
.globl concat_heads__mha_block_cached__mha_block_cached__near_ridge_kernel
.p2align 8
.type concat_heads__mha_block_cached__mha_block_cached__near_ridge_kernel,@function
concat_heads__mha_block_cached__mha_block_cached__near_ridge_kernel:
    s_cmp_ge_u32 s2, 256
    s_cbranch_scc1 L_end
    s_load_dwordx16 s[4:19], s[0:1], 0
    s_load_dwordx4 s[20:23], s[0:1], 64
    s_load_dwordx2 s[24:25], s[0:1], 96
    s_load_dwordx4 s[32:35], s[0:1], 80
    v_lshrrev_b32 v1, 6, v0
    v_and_b32 v0, 63, v0
    v_readfirstlane_b32 s29, v1
    s_lshr_b32 s89, s2, 4
    s_bfe_u32 s90, s2, 0x10002
    s_cmp_eq_u32 s29, 7
    s_cbranch_scc1 L_codepf
    v_lshrrev_b32 v2, 4, v0
    v_and_b32 v3, 15, v0
    v_xor_b32 v3, v3, v2
    v_lshl_add_u32 v1, v1, 4, v2
    v_lshlrev_b32 v1, 10, v1
    v_lshl_add_u32 v8, v3, 4, v1
    v_xor_b32 v9, 64, v8
    v_add_u32 v9, 3072, v9
    v_xor_b32 v10, 128, v8
    v_add_u32 v10, 6144, v10
    v_xor_b32 v11, 192, v8
    v_add_u32 v11, 9216, v11
    s_lshl_b32 s26, s29, 12
    s_add_u32 m0, s26, 131072
    s_waitcnt lgkmcnt(0)
    s_cmp_lg_u32 s90, 0
    s_cselect_b32 s36, s14, s4
    s_cselect_b32 s37, s15, s5
    s_mul_i32 s73, s89, 114688
    s_add_u32 s36, s36, s73
    s_addc_u32 s37, s37, 0
    s_mov_b32 s38, 114688
    s_mov_b32 s39, 0x20000
    buffer_load_dwordx4 v8, s[36:39], 0 offen offset:0  lds
    buffer_load_dwordx4 v9, s[36:39], 0 offen offset:1024  lds
    buffer_load_dwordx4 v10, s[36:39], 0 offen offset:2048  lds
    buffer_load_dwordx4 v11, s[36:39], 0 offen offset:3072  lds
L_ids:
    s_and_b32 s26, s2, 3
    s_lshl_b32 s26, s26, 1
    s_bfe_u32 s27, s2, 0x10003
    s_or_b32 s80, s26, s27
    s_lshl_b32 s91, s90, 4
    s_add_u32 s91, s91, s89
    s_and_b32 s72, s29, 3
    s_lshl_b32 s79, s72, 12
    s_lshl_b32 s85, s72, 13
    s_lshr_b32 s3, s2, 2
    s_lshr_b32 s28, s2, 5
    s_xor_b32 s3, s3, s28
    s_and_b32 s3, s3, 7
    s_lshl_b32 s3, s3, 14
    s_lshr_b32 s95, s2, 1
    s_and_b32 s95, s95, 3
    s_lshl_b32 s28, s95, 17
    s_or_b32 s3, s3, s28
    s_lshl_b32 s95, s95, 8
    s_mov_b32 s78, s95
    s_cmp_eq_u32 s29, 7
    s_cbranch_scc1 L_B1
    s_cmp_ge_u32 s29, 4
    s_cbranch_scc1 L_B2
    v_lshrrev_b32 v84, 4, v0
    v_and_b32 v85, 15, v0
    v_lshlrev_b32 v86, 1, v84
    v_xor_b32 v86, v86, v85
    v_xor_b32 v87, 8, v86
    s_lshl_b32 s73, s72, 17
    v_lshl_add_u32 v88, v84, 13, s73
    v_lshl_add_u32 v72, v86, 4, v88
    v_lshl_add_u32 v73, v87, 4, v88
    v_add_u32 v73, 31744, v73
    v_lshl_add_u32 v74, v86, 4, v88
    v_add_u32 v74, 63488, v74
    v_lshl_add_u32 v75, v87, 4, v88
    v_add_u32 v75, 95232, v75
    s_cmp_lg_u32 s90, 0
    s_cselect_b32 s48, s20, s10
    s_cselect_b32 s49, s21, s11
    s_lshl_b32 s73, s80, 10
    s_sub_u32 s50, 0x400000, s73
    s_add_u32 s48, s48, s73
    s_addc_u32 s49, s49, 0
    s_mov_b32 s51, 0x20000
    s_add_u32 m0, s79, 65536
    s_nop 0
    buffer_load_dwordx4 v72, s[48:51], s78 offen offset:0  lds
    buffer_load_dwordx4 v73, s[48:51], s78 offen offset:1024  lds
    buffer_load_dwordx4 v74, s[48:51], s78 offen offset:2048  lds
    buffer_load_dwordx4 v75, s[48:51], s78 offen offset:3072  lds
    s_xor_b32 s78, s95, 524288
    s_add_u32 m0, s79, 81920
    s_nop 0
    buffer_load_dwordx4 v72, s[48:51], s78 offen offset:0  lds
    buffer_load_dwordx4 v73, s[48:51], s78 offen offset:1024  lds
    buffer_load_dwordx4 v74, s[48:51], s78 offen offset:2048  lds
    buffer_load_dwordx4 v75, s[48:51], s78 offen offset:3072  lds
    s_xor_b32 s78, s95, 1048576
    s_cmp_eq_u32 s29, 3
    s_cbranch_scc1 L_P1
    s_branch L_P2
L_codepf:
    s_getpc_b64 s[30:31]
L_code_ref:
    s_sub_u32 s30, s30, L_code_ref-concat_heads__mha_block_cached__mha_block_cached__near_ridge_kernel
    s_subb_u32 s31, s31, 0
    s_lshr_b32 s26, s2, 3
    s_mul_i32 s26, s26, 22
    v_and_b32 v1, 31, v0
    v_add_u32 v1, s26, v1
    v_lshlrev_b32 v1, 7, v1
    v_min_u32 v1, L_end-concat_heads__mha_block_cached__mha_block_cached__near_ridge_kernel, v1
    global_load_dword v192, v1, s[30:31]
    s_waitcnt lgkmcnt(0)
    s_cmp_lg_u32 s90, 0
    s_cselect_b32 s36, s14, s4
    s_cselect_b32 s37, s15, s5
    s_mul_i32 s73, s89, 114688
    s_add_u32 s36, s36, s73
    s_addc_u32 s37, s37, 0
    s_mov_b32 s38, 114688
    s_mov_b32 s39, 0x20000
    s_branch L_ids
L_P2:
    v_lshrrev_b32 v84, 4, v0
    v_and_b32 v85, 15, v0
    v_lshlrev_b32 v86, 1, v84
    v_xor_b32 v86, v86, v85
    v_xor_b32 v87, 8, v86
    s_lshl_b32 s73, s72, 15
    v_lshl_add_u32 v88, v84, 10, s73
    v_add_u32 v89, 0, v84
    v_xor_b32 v89, v89, v85
    v_lshl_add_u32 v64, v89, 4, v88
    v_add_u32 v68, 16384, v64
    v_add_u32 v89, 4, v84
    v_xor_b32 v89, v89, v85
    v_lshl_add_u32 v65, v89, 4, v88
    v_add_u32 v65, 3072, v65
    v_add_u32 v69, 16384, v65
    v_add_u32 v89, 8, v84
    v_xor_b32 v89, v89, v85
    v_lshl_add_u32 v66, v89, 4, v88
    v_add_u32 v66, 6144, v66
    v_add_u32 v70, 16384, v66
    v_add_u32 v89, 12, v84
    v_xor_b32 v89, v89, v85
    v_lshl_add_u32 v67, v89, 4, v88
    v_add_u32 v67, 9216, v67
    v_add_u32 v71, 16384, v67
    s_add_u32 m0, s85, 0
    s_mov_b32 s74, 256
    buffer_load_dwordx4 v64, s[36:39], s74 offen offset:0  lds
    buffer_load_dwordx4 v65, s[36:39], s74 offen offset:1024  lds
    buffer_load_dwordx4 v66, s[36:39], s74 offen offset:2048  lds
    buffer_load_dwordx4 v67, s[36:39], s74 offen offset:3072  lds
    s_cmp_lg_u32 s90, 0
    s_cselect_b32 s40, s16, s6
    s_cselect_b32 s41, s17, s7
    s_cselect_b32 s44, s18, s8
    s_cselect_b32 s45, s19, s9
    s_cselect_b32 s52, s22, s12
    s_cselect_b32 s53, s23, s13
    s_lshl_b32 s73, s89, 3
    s_add_u32 s73, s73, s80
    s_lshl_b32 s73, s73, 19
    s_add_u32 s40, s40, s73
    s_addc_u32 s41, s41, 0
    s_mov_b32 s42, 524288
    s_mov_b32 s43, 0x20000
    s_lshl_b32 s73, s89, 3
    s_add_u32 s73, s73, s80
    s_lshl_b32 s73, s73, 19
    s_add_u32 s44, s44, s73
    s_addc_u32 s45, s45, 0
    s_mov_b32 s46, 524288
    s_mov_b32 s47, 0x20000
    s_lshl_b32 s73, s80, 19
    s_add_u32 s52, s52, s73
    s_addc_u32 s53, s53, 0
    s_mov_b32 s54, 524288
    s_mov_b32 s55, 0x20000
    s_lshl_b32 s73, s91, 20
    s_add_u32 s56, s24, s73
    s_addc_u32 s57, s25, 0
    s_mov_b32 s58, 1048576
    s_mov_b32 s59, 0x20000
    s_lshl_b32 s73, s91, 10
    s_add_u32 s73, s73, 33554432
    s_add_u32 s60, s24, s73
    s_addc_u32 s61, s25, 0
    s_mov_b32 s62, 1024
    s_mov_b32 s63, 0x20000
    s_lshl_b32 s73, s91, 2
    s_add_u32 s64, s34, s73
    s_addc_u32 s65, s35, 0
    s_mov_b32 s66, 4
    s_mov_b32 s67, 0x20000
    s_waitcnt vmcnt(8)
    s_barrier
    s_add_u32 m0, s85, 4096
    s_mov_b32 s74, 256
    buffer_load_dwordx4 v68, s[36:39], s74 offen offset:0  lds
    buffer_load_dwordx4 v69, s[36:39], s74 offen offset:1024  lds
    buffer_load_dwordx4 v70, s[36:39], s74 offen offset:2048  lds
    buffer_load_dwordx4 v71, s[36:39], s74 offen offset:3072  lds
    s_add_u32 m0, s79, 98304
    s_nop 0
    buffer_load_dwordx4 v72, s[48:51], s78 offen offset:0  lds
    buffer_load_dwordx4 v73, s[48:51], s78 offen offset:1024  lds
    buffer_load_dwordx4 v74, s[48:51], s78 offen offset:2048  lds
    buffer_load_dwordx4 v75, s[48:51], s78 offen offset:3072  lds
    s_xor_b32 s78, s95, 1572864
    s_waitcnt vmcnt(12)
    s_barrier
    s_add_u32 m0, s79, 114688
    s_nop 0
    buffer_load_dwordx4 v72, s[48:51], s78 offen offset:0  lds
    buffer_load_dwordx4 v73, s[48:51], s78 offen offset:1024  lds
    buffer_load_dwordx4 v74, s[48:51], s78 offen offset:2048  lds
    buffer_load_dwordx4 v75, s[48:51], s78 offen offset:3072  lds
    s_xor_b32 s78, s95, 2097152
    s_add_u32 m0, s85, 32768
    s_mov_b32 s74, 512
    buffer_load_dwordx4 v64, s[36:39], s74 offen offset:0  lds
    buffer_load_dwordx4 v65, s[36:39], s74 offen offset:1024  lds
    buffer_load_dwordx4 v66, s[36:39], s74 offen offset:2048  lds
    buffer_load_dwordx4 v67, s[36:39], s74 offen offset:3072  lds
    v_lshrrev_b32 v84, 4, v0
    v_and_b32 v85, 15, v0
    v_lshlrev_b32 v86, 1, v84
    v_xor_b32 v86, v86, v85
    v_xor_b32 v87, 8, v86
    s_lshl_b32 s73, s72, 12
    v_lshl_add_u32 v88, v84, 8, s73
    v_add_u32 v89, 0, v84
    v_xor_b32 v89, v89, v85
    v_lshl_add_u32 v76, v89, 4, v88
    v_add_u32 v89, 4, v84
    v_xor_b32 v89, v89, v85
    v_lshl_add_u32 v77, v89, 4, v88
    v_add_u32 v89, 8, v84
    v_xor_b32 v89, v89, v85
    v_lshl_add_u32 v78, v89, 4, v88
    v_add_u32 v89, 12, v84
    v_xor_b32 v89, v89, v85
    v_lshl_add_u32 v79, v89, 4, v88
    v_lshl_add_u32 v80, v86, 4, v88
    v_lshl_add_u32 v81, v87, 4, v88
    s_waitcnt vmcnt(8)
    s_barrier
    s_add_u32 m0, s85, 36864
    s_mov_b32 s74, 512
    s_waitcnt vmcnt(7)
    buffer_load_dwordx4 v68, s[36:39], s74 offen offset:0  lds
    s_waitcnt vmcnt(7)
    buffer_load_dwordx4 v69, s[36:39], s74 offen offset:1024  lds
    s_waitcnt vmcnt(7)
    buffer_load_dwordx4 v70, s[36:39], s74 offen offset:2048  lds
    s_waitcnt vmcnt(7)
    buffer_load_dwordx4 v71, s[36:39], s74 offen offset:3072  lds
    s_add_u32 m0, s79, 65536
    s_nop 0
    s_waitcnt vmcnt(7)
    buffer_load_dwordx4 v72, s[48:51], s78 offen offset:0  lds
    s_waitcnt vmcnt(7)
    buffer_load_dwordx4 v73, s[48:51], s78 offen offset:1024  lds
    s_waitcnt vmcnt(7)
    buffer_load_dwordx4 v74, s[48:51], s78 offen offset:2048  lds
    s_waitcnt vmcnt(7)
    buffer_load_dwordx4 v75, s[48:51], s78 offen offset:3072  lds
    s_xor_b32 s78, s95, 2621440
    v_and_b32 v1, 15, v0
    v_lshrrev_b32 v2, 4, v0
    v_xor_b32 v2, v2, v1
    v_lshlrev_b32 v2, 4, v2
    v_lshl_add_u32 v1, v1, 8, v2
    v_xor_b32 v8, 0x0, v1
    v_xor_b32 v9, 0x40, v1
    v_xor_b32 v10, 0x80, v1
    v_xor_b32 v11, 0xc0, v1
    s_waitcnt vmcnt(12)
    s_barrier
    s_add_u32 m0, s79, 81920
    s_nop 0
    s_waitcnt vmcnt(7)
    buffer_load_dwordx4 v72, s[48:51], s78 offen offset:0  lds
    s_waitcnt vmcnt(7)
    buffer_load_dwordx4 v73, s[48:51], s78 offen offset:1024  lds
    s_waitcnt vmcnt(7)
    buffer_load_dwordx4 v74, s[48:51], s78 offen offset:2048  lds
    s_waitcnt vmcnt(7)
    buffer_load_dwordx4 v75, s[48:51], s78 offen offset:3072  lds
    s_xor_b32 s78, s95, 3145728
    s_add_u32 m0, s85, 131072
    s_mov_b32 s74, 768
    s_waitcnt vmcnt(7)
    buffer_load_dwordx4 v64, s[36:39], s74 offen offset:0  lds
    s_waitcnt vmcnt(7)
    buffer_load_dwordx4 v65, s[36:39], s74 offen offset:1024  lds
    s_waitcnt vmcnt(7)
    buffer_load_dwordx4 v66, s[36:39], s74 offen offset:2048  lds
    s_waitcnt vmcnt(7)
    buffer_load_dwordx4 v67, s[36:39], s74 offen offset:3072  lds
    v_lshrrev_b32 v1, 2, v0
    v_and_b32 v2, 7, v1
    v_lshlrev_b32 v1, 8, v1
    v_lshl_add_u32 v1, v2, 5, v1
    v_and_b32 v2, 3, v0
    v_lshl_add_u32 v1, v2, 3, v1
    v_xor_b32 v12, 0x0, v1
    v_xor_b32 v13, 0x20, v1
    v_xor_b32 v14, 0x40, v1
    v_xor_b32 v15, 0x60, v1
    v_xor_b32 v16, 0x80, v1
    v_xor_b32 v17, 0xa0, v1
    v_xor_b32 v18, 0xc0, v1
    v_xor_b32 v19, 0xe0, v1
    s_waitcnt vmcnt(8)
    s_barrier
    s_add_u32 m0, s85, 135168
    s_mov_b32 s74, 768
    s_waitcnt vmcnt(7)
    buffer_load_dwordx4 v68, s[36:39], s74 offen offset:0  lds
    s_waitcnt vmcnt(7)
    buffer_load_dwordx4 v69, s[36:39], s74 offen offset:1024  lds
    s_waitcnt vmcnt(7)
    buffer_load_dwordx4 v70, s[36:39], s74 offen offset:2048  lds
    s_waitcnt vmcnt(7)
    buffer_load_dwordx4 v71, s[36:39], s74 offen offset:3072  lds
    s_add_u32 m0, s79, 98304
    s_nop 0
    s_waitcnt vmcnt(7)
    buffer_load_dwordx4 v72, s[48:51], s78 offen offset:0  lds
    s_waitcnt vmcnt(7)
    buffer_load_dwordx4 v73, s[48:51], s78 offen offset:1024  lds
    s_waitcnt vmcnt(7)
    buffer_load_dwordx4 v74, s[48:51], s78 offen offset:2048  lds
    s_waitcnt vmcnt(7)
    buffer_load_dwordx4 v75, s[48:51], s78 offen offset:3072  lds
    s_xor_b32 s78, s95, 3670016
    s_add_u32 s73, s85, 131072
    v_lshl_add_u32 v4, v0, 4, s73
    v_mov_b32 v28, 0x3f803f80
    v_mov_b32 v29, 0x3f803f80
    v_mov_b32 v30, 0x3f803f80
    v_mov_b32 v31, 0x3f803f80
    s_mov_b32 s87, 0x46800000
    s_mov_b32 s82, 0
    s_waitcnt vmcnt(12)
    s_barrier
    s_add_u32 m0, s79, 114688
    s_nop 0
    s_waitcnt vmcnt(7)
    buffer_load_dwordx4 v72, s[48:51], s78 offen offset:0  lds
    s_waitcnt vmcnt(7)
    buffer_load_dwordx4 v73, s[48:51], s78 offen offset:1024  lds
    s_waitcnt vmcnt(7)
    buffer_load_dwordx4 v74, s[48:51], s78 offen offset:2048  lds
    s_waitcnt vmcnt(7)
    buffer_load_dwordx4 v75, s[48:51], s78 offen offset:3072  lds
    s_xor_b32 s78, s95, 256
    s_add_u32 m0, s79, 0
    s_nop 0
    s_waitcnt vmcnt(7)
    buffer_load_dwordx4 v76, s[40:43], s3 offen offset:0 nt lds
    s_waitcnt vmcnt(7)
    buffer_load_dwordx4 v77, s[40:43], s3 offen offset:1024 nt lds
    s_waitcnt vmcnt(7)
    buffer_load_dwordx4 v78, s[40:43], s3 offen offset:2048 nt lds
    s_waitcnt vmcnt(7)
    buffer_load_dwordx4 v79, s[40:43], s3 offen offset:3072 nt lds
    s_waitcnt vmcnt(8)
    s_barrier
    s_add_u32 m0, s79, 65536
    s_nop 0
    s_waitcnt vmcnt(7)
    buffer_load_dwordx4 v72, s[48:51], s78 offen offset:0  lds
    s_waitcnt vmcnt(7)
    buffer_load_dwordx4 v73, s[48:51], s78 offen offset:1024  lds
    s_waitcnt vmcnt(7)
    buffer_load_dwordx4 v74, s[48:51], s78 offen offset:2048  lds
    s_waitcnt vmcnt(7)
    buffer_load_dwordx4 v75, s[48:51], s78 offen offset:3072  lds
    s_xor_b32 s78, s95, 524288
    s_waitcnt vmcnt(8)
    s_barrier
    s_add_u32 m0, s79, 16384
    s_nop 0
    s_waitcnt vmcnt(7)
    buffer_load_dwordx4 v80, s[44:47], s3 offen offset:0 nt lds
    s_waitcnt vmcnt(7)
    buffer_load_dwordx4 v81, s[44:47], s3 offen offset:1024 nt lds
    s_waitcnt vmcnt(7)
    buffer_load_dwordx4 v80, s[44:47], s3 offen offset:2048 nt lds
    s_waitcnt vmcnt(7)
    buffer_load_dwordx4 v81, s[44:47], s3 offen offset:3072 nt lds
    s_waitcnt vmcnt(4)
L_A2:
    s_barrier
    ds_read_b128 v[128:131], v4 offset:0
    ds_read_b128 v[144:147], v4 offset:4096
    ds_read_b128 v[32:35], v8 offset:0
    ds_read_b128 v[36:39], v8 offset:4096
    ds_read_b128 v[40:43], v8 offset:8192
    ds_read_b128 v[44:47], v8 offset:12288
    ds_read_b128 v[132:135], v4 offset:1024
    ds_read_b128 v[148:151], v4 offset:5120
    ds_read_b128 v[48:51], v9 offset:0
    ds_read_b128 v[52:55], v9 offset:4096
    ds_read_b128 v[56:59], v9 offset:8192
    s_waitcnt lgkmcnt(8)
    v_mfma_f32_16x16x32_bf16 v[160:163], v[32:35], v[128:131], 0
    ds_read_b128 v[60:63], v9 offset:12288
    v_mfma_f32_16x16x32_bf16 v[176:179], v[32:35], v[144:147], 0
    s_waitcnt lgkmcnt(7)
    v_mfma_f32_16x16x32_bf16 v[180:183], v[36:39], v[144:147], 0
    ds_read_b128 v[136:139], v4 offset:2048
    ds_read_b128 v[152:155], v4 offset:6144
    v_mfma_f32_16x16x32_bf16 v[164:167], v[36:39], v[128:131], 0
    ds_read_b128 v[32:35], v10 offset:0
    v_mfma_f32_16x16x32_bf16 v[168:171], v[40:43], v[128:131], 0
    ds_read_b128 v[36:39], v10 offset:4096
    v_mfma_f32_16x16x32_bf16 v[184:187], v[40:43], v[144:147], 0
    s_waitcnt lgkmcnt(7)
    v_mfma_f32_16x16x32_bf16 v[188:191], v[44:47], v[144:147], 0
    ds_read_b128 v[40:43], v10 offset:8192
    v_mfma_f32_16x16x32_bf16 v[172:175], v[44:47], v[128:131], 0
    v_mfma_f32_16x16x32_bf16 v[160:163], v[48:51], v[132:135], v[160:163]
    ds_read_b128 v[44:47], v10 offset:12288
    v_mfma_f32_16x16x32_bf16 v[176:179], v[48:51], v[148:151], v[176:179]
    s_waitcnt lgkmcnt(7)
    v_mfma_f32_16x16x32_bf16 v[180:183], v[52:55], v[148:151], v[180:183]
    ds_read_b128 v[140:143], v4 offset:3072
    ds_read_b128 v[156:159], v4 offset:7168
    v_mfma_f32_16x16x32_bf16 v[164:167], v[52:55], v[132:135], v[164:167]
    ds_read_b128 v[48:51], v11 offset:0
    v_mfma_f32_16x16x32_bf16 v[168:171], v[56:59], v[132:135], v[168:171]
    ds_read_b128 v[52:55], v11 offset:4096
    v_mfma_f32_16x16x32_bf16 v[184:187], v[56:59], v[148:151], v[184:187]
    s_waitcnt lgkmcnt(7)
    v_mfma_f32_16x16x32_bf16 v[188:191], v[60:63], v[148:151], v[188:191]
    ds_read_b128 v[56:59], v11 offset:8192
    v_mfma_f32_16x16x32_bf16 v[172:175], v[60:63], v[132:135], v[172:175]
    v_mfma_f32_16x16x32_bf16 v[160:163], v[32:35], v[136:139], v[160:163]
    ds_read_b128 v[60:63], v11 offset:12288
    v_mfma_f32_16x16x32_bf16 v[176:179], v[32:35], v[152:155], v[176:179]
    s_waitcnt lgkmcnt(7)
    v_mfma_f32_16x16x32_bf16 v[180:183], v[36:39], v[152:155], v[180:183]
    v_mfma_f32_16x16x32_bf16 v[164:167], v[36:39], v[136:139], v[164:167]
    v_mfma_f32_16x16x32_bf16 v[168:171], v[40:43], v[136:139], v[168:171]
    v_mfma_f32_16x16x32_bf16 v[184:187], v[40:43], v[152:155], v[184:187]
    s_waitcnt lgkmcnt(3)
    v_mfma_f32_16x16x32_bf16 v[188:191], v[44:47], v[152:155], v[188:191]
    v_mfma_f32_16x16x32_bf16 v[172:175], v[44:47], v[136:139], v[172:175]
    v_mfma_f32_16x16x32_bf16 v[160:163], v[48:51], v[140:143], v[160:163]
    v_mfma_f32_16x16x32_bf16 v[176:179], v[48:51], v[156:159], v[176:179]
    s_waitcnt lgkmcnt(1)
    v_mfma_f32_16x16x32_bf16 v[180:183], v[52:55], v[156:159], v[180:183]
    v_mfma_f32_16x16x32_bf16 v[164:167], v[52:55], v[140:143], v[164:167]
    v_mfma_f32_16x16x32_bf16 v[168:171], v[56:59], v[140:143], v[168:171]
    v_mfma_f32_16x16x32_bf16 v[184:187], v[56:59], v[156:159], v[184:187]
    s_waitcnt lgkmcnt(0)
    v_mfma_f32_16x16x32_bf16 v[188:191], v[60:63], v[156:159], v[188:191]
    v_mfma_f32_16x16x32_bf16 v[172:175], v[60:63], v[140:143], v[172:175]
    s_mov_b32 s81, 4
    s_nop 5
    s_branch L_A2_go
L_A2_item:
    s_barrier
    v_rcp_f32 v20, v2
    v_rcp_f32 v24, v3
    s_cmp_eq_u32 s82, 4
    s_cbranch_scc1 L_A2_tail
    ds_read_b128 v[128:131], v4 offset:0
    ds_read_b128 v[144:147], v4 offset:4096
    ds_read_b128 v[32:35], v8 offset:0
    ds_read_b128 v[36:39], v8 offset:4096
    ds_read_b128 v[40:43], v8 offset:8192
    ds_read_b128 v[44:47], v8 offset:12288
    ds_read_b128 v[132:135], v4 offset:1024
    ds_read_b128 v[148:151], v4 offset:5120
    ds_read_b128 v[48:51], v9 offset:0
    ds_read_b128 v[52:55], v9 offset:4096
    ds_read_b128 v[56:59], v9 offset:8192
    s_waitcnt lgkmcnt(8)
    v_mfma_f32_16x16x32_bf16 v[160:163], v[32:35], v[128:131], 0
    ds_read_b128 v[60:63], v9 offset:12288
    v_mfma_f32_16x16x32_bf16 v[176:179], v[32:35], v[144:147], 0
    v_mul_f32 v192, v20, v192
    v_mul_f32 v193, v20, v193
    v_mul_f32 v224, v24, v224
    v_mul_f32 v225, v24, v225
    s_waitcnt lgkmcnt(7)
    v_mfma_f32_16x16x32_bf16 v[180:183], v[36:39], v[144:147], 0
    ds_read_b128 v[136:139], v4 offset:2048
    ds_read_b128 v[152:155], v4 offset:6144
    v_mfma_f32_16x16x32_bf16 v[164:167], v[36:39], v[128:131], 0
    ds_read_b128 v[32:35], v10 offset:0
    v_mul_f32 v194, v20, v194
    v_mul_f32 v195, v20, v195
    v_mul_f32 v226, v24, v226
    v_mul_f32 v227, v24, v227
    v_mfma_f32_16x16x32_bf16 v[168:171], v[40:43], v[128:131], 0
    ds_read_b128 v[36:39], v10 offset:4096
    v_mfma_f32_16x16x32_bf16 v[184:187], v[40:43], v[144:147], 0
    v_mul_f32 v196, v20, v196
    v_mul_f32 v197, v20, v197
    v_mul_f32 v228, v24, v228
    v_mul_f32 v229, v24, v229
    s_waitcnt lgkmcnt(7)
    v_mfma_f32_16x16x32_bf16 v[188:191], v[44:47], v[144:147], 0
    ds_read_b128 v[40:43], v10 offset:8192
    v_mfma_f32_16x16x32_bf16 v[172:175], v[44:47], v[128:131], 0
    v_mul_f32 v198, v20, v198
    v_mul_f32 v199, v20, v199
    v_mul_f32 v230, v24, v230
    v_mul_f32 v231, v24, v231
    v_mfma_f32_16x16x32_bf16 v[160:163], v[48:51], v[132:135], v[160:163]
    ds_read_b128 v[44:47], v10 offset:12288
    v_mfma_f32_16x16x32_bf16 v[176:179], v[48:51], v[148:151], v[176:179]
    v_mul_f32 v200, v20, v200
    v_mul_f32 v201, v20, v201
    v_mul_f32 v232, v24, v232
    v_mul_f32 v233, v24, v233
    s_waitcnt lgkmcnt(7)
    v_mfma_f32_16x16x32_bf16 v[180:183], v[52:55], v[148:151], v[180:183]
    ds_read_b128 v[140:143], v4 offset:3072
    ds_read_b128 v[156:159], v4 offset:7168
    v_mfma_f32_16x16x32_bf16 v[164:167], v[52:55], v[132:135], v[164:167]
    ds_read_b128 v[48:51], v11 offset:0
    v_mul_f32 v202, v20, v202
    v_mul_f32 v203, v20, v203
    v_mul_f32 v234, v24, v234
    v_mul_f32 v235, v24, v235
    v_mfma_f32_16x16x32_bf16 v[168:171], v[56:59], v[132:135], v[168:171]
    ds_read_b128 v[52:55], v11 offset:4096
    v_mfma_f32_16x16x32_bf16 v[184:187], v[56:59], v[148:151], v[184:187]
    v_mul_f32 v204, v20, v204
    v_mul_f32 v205, v20, v205
    v_mul_f32 v236, v24, v236
    v_mul_f32 v237, v24, v237
    s_waitcnt lgkmcnt(7)
    v_mfma_f32_16x16x32_bf16 v[188:191], v[60:63], v[148:151], v[188:191]
    ds_read_b128 v[56:59], v11 offset:8192
    v_mfma_f32_16x16x32_bf16 v[172:175], v[60:63], v[132:135], v[172:175]
    v_mul_f32 v206, v20, v206
    v_mul_f32 v207, v20, v207
    v_mul_f32 v238, v24, v238
    v_mul_f32 v239, v24, v239
    v_mfma_f32_16x16x32_bf16 v[160:163], v[32:35], v[136:139], v[160:163]
    ds_read_b128 v[60:63], v11 offset:12288
    v_mfma_f32_16x16x32_bf16 v[176:179], v[32:35], v[152:155], v[176:179]
    v_mul_f32 v208, v20, v208
    v_mul_f32 v209, v20, v209
    v_mul_f32 v240, v24, v240
    v_mul_f32 v241, v24, v241
    s_waitcnt lgkmcnt(7)
    v_mfma_f32_16x16x32_bf16 v[180:183], v[36:39], v[152:155], v[180:183]
    v_mfma_f32_16x16x32_bf16 v[164:167], v[36:39], v[136:139], v[164:167]
    v_mul_f32 v210, v20, v210
    v_mul_f32 v211, v20, v211
    v_mul_f32 v242, v24, v242
    v_mul_f32 v243, v24, v243
    v_mfma_f32_16x16x32_bf16 v[168:171], v[40:43], v[136:139], v[168:171]
    v_mfma_f32_16x16x32_bf16 v[184:187], v[40:43], v[152:155], v[184:187]
    v_mul_f32 v212, v20, v212
    v_mul_f32 v213, v20, v213
    v_mul_f32 v244, v24, v244
    v_mul_f32 v245, v24, v245
    s_waitcnt lgkmcnt(3)
    v_mfma_f32_16x16x32_bf16 v[188:191], v[44:47], v[152:155], v[188:191]
    v_mfma_f32_16x16x32_bf16 v[172:175], v[44:47], v[136:139], v[172:175]
    v_mul_f32 v214, v20, v214
    v_mul_f32 v215, v20, v215
    v_mul_f32 v246, v24, v246
    v_mul_f32 v247, v24, v247
    v_mfma_f32_16x16x32_bf16 v[160:163], v[48:51], v[140:143], v[160:163]
    v_mfma_f32_16x16x32_bf16 v[176:179], v[48:51], v[156:159], v[176:179]
    v_mul_f32 v216, v20, v216
    v_mul_f32 v217, v20, v217
    v_mul_f32 v248, v24, v248
    v_mul_f32 v249, v24, v249
    s_waitcnt lgkmcnt(1)
    v_mfma_f32_16x16x32_bf16 v[180:183], v[52:55], v[156:159], v[180:183]
    v_mfma_f32_16x16x32_bf16 v[164:167], v[52:55], v[140:143], v[164:167]
    v_mul_f32 v218, v20, v218
    v_mul_f32 v219, v20, v219
    v_mul_f32 v250, v24, v250
    v_mul_f32 v251, v24, v251
    v_mfma_f32_16x16x32_bf16 v[168:171], v[56:59], v[140:143], v[168:171]
    v_mfma_f32_16x16x32_bf16 v[184:187], v[56:59], v[156:159], v[184:187]
    v_mul_f32 v220, v20, v220
    v_mul_f32 v221, v20, v221
    v_mul_f32 v252, v24, v252
    v_mul_f32 v253, v24, v253
    s_waitcnt lgkmcnt(0)
    v_mfma_f32_16x16x32_bf16 v[188:191], v[60:63], v[156:159], v[188:191]
    v_mfma_f32_16x16x32_bf16 v[172:175], v[60:63], v[140:143], v[172:175]
    v_mul_f32 v222, v20, v222
    v_mul_f32 v223, v20, v223
    v_mul_f32 v254, v24, v254
    v_mul_f32 v255, v24, v255
    s_mov_b32 s81, 4
    s_cmp_eq_u32 s82, 1
    s_cbranch_scc1 L_A2_save0
    s_cmp_eq_u32 s82, 2
    s_cbranch_scc1 L_A2_save1
    s_cmp_eq_u32 s82, 3
    s_cbranch_scc1 L_A2_save2
    s_nop 3
L_A2_go:
    v_max3_f32 v20, v160, v161, v162
    v_max3_f32 v24, v176, v177, v178
    v_max3_f32 v20, v20, v163, v164
    v_max3_f32 v24, v24, v179, v180
    v_max3_f32 v20, v20, v165, v166
    v_max3_f32 v24, v24, v181, v182
    v_max3_f32 v20, v20, v167, v168
    v_max3_f32 v24, v24, v183, v184
    v_max3_f32 v20, v20, v169, v170
    v_max3_f32 v24, v24, v185, v186
    v_max3_f32 v20, v20, v171, v172
    v_max3_f32 v24, v24, v187, v188
    v_max3_f32 v20, v20, v173, v174
    v_max3_f32 v24, v24, v189, v190
    v_max_f32 v20, v20, v175
    v_max_f32 v24, v24, v191
    v_mov_b32 v22, v20
    v_mov_b32 v26, v24
    s_nop 0
    v_permlane32_swap_b32 v20, v22
    v_permlane32_swap_b32 v24, v26
    s_nop 0
    v_max_f32 v20, v20, v22
    v_max_f32 v24, v24, v26
    v_mov_b32 v22, v20
    v_mov_b32 v26, v24
    s_nop 0
    v_permlane16_swap_b32 v20, v22
    v_permlane16_swap_b32 v24, v26
    s_nop 0
    v_max_f32 v20, v20, v22
    v_max_f32 v24, v24, v26
    v_sub_f32 v160, v160, v20
    v_sub_f32 v161, v161, v20
    v_sub_f32 v162, v162, v20
    v_sub_f32 v163, v163, v20
    v_sub_f32 v164, v164, v20
    v_sub_f32 v165, v165, v20
    v_sub_f32 v166, v166, v20
    v_sub_f32 v167, v167, v20
    v_sub_f32 v168, v168, v20
    v_sub_f32 v169, v169, v20
    v_sub_f32 v170, v170, v20
    v_sub_f32 v171, v171, v20
    v_sub_f32 v172, v172, v20
    v_sub_f32 v173, v173, v20
    v_sub_f32 v174, v174, v20
    v_sub_f32 v175, v175, v20
    v_sub_f32 v21, 0, v20
    v_sub_f32 v22, 0, v20
    v_sub_f32 v23, 0, v20
    v_sub_f32 v20, 0, v20
    v_sub_f32 v176, v176, v24
    v_sub_f32 v177, v177, v24
    v_sub_f32 v178, v178, v24
    v_sub_f32 v179, v179, v24
    v_sub_f32 v180, v180, v24
    v_sub_f32 v181, v181, v24
    v_sub_f32 v182, v182, v24
    v_sub_f32 v183, v183, v24
    v_sub_f32 v184, v184, v24
    v_sub_f32 v185, v185, v24
    v_sub_f32 v186, v186, v24
    v_sub_f32 v187, v187, v24
    v_sub_f32 v188, v188, v24
    v_sub_f32 v189, v189, v24
    v_sub_f32 v190, v190, v24
    v_sub_f32 v191, v191, v24
    v_sub_f32 v25, 0, v24
    v_sub_f32 v26, 0, v24
    v_sub_f32 v27, 0, v24
    v_sub_f32 v24, 0, v24
    s_waitcnt lgkmcnt(0)
    v_exp_f32 v160, v160
    v_exp_f32 v161, v161
    v_exp_f32 v162, v162
    v_cvt_pk_bf16_f32 v160, v160, v161
    v_exp_f32 v163, v163
    v_exp_f32 v164, v164
    v_cvt_pk_bf16_f32 v161, v162, v163
    v_exp_f32 v165, v165
    v_exp_f32 v166, v166
    v_cvt_pk_bf16_f32 v162, v164, v165
    v_exp_f32 v167, v167
    v_exp_f32 v176, v176
    v_cvt_pk_bf16_f32 v163, v166, v167
    v_exp_f32 v177, v177
    v_exp_f32 v178, v178
    v_cvt_pk_bf16_f32 v176, v176, v177
    v_exp_f32 v179, v179
    v_exp_f32 v180, v180
    v_cvt_pk_bf16_f32 v177, v178, v179
    v_exp_f32 v181, v181
    v_exp_f32 v182, v182
    v_cvt_pk_bf16_f32 v178, v180, v181
    v_exp_f32 v183, v183
    v_exp_f32 v168, v168
    v_cvt_pk_bf16_f32 v179, v182, v183
    v_exp_f32 v169, v169
    v_exp_f32 v170, v170
    v_cvt_pk_bf16_f32 v164, v168, v169
    v_exp_f32 v171, v171
    v_exp_f32 v172, v172
    v_cvt_pk_bf16_f32 v165, v170, v171
    v_exp_f32 v173, v173
    v_exp_f32 v174, v174
    v_cvt_pk_bf16_f32 v166, v172, v173
    v_exp_f32 v175, v175
    v_exp_f32 v184, v184
    v_cvt_pk_bf16_f32 v167, v174, v175
    v_exp_f32 v185, v185
    v_exp_f32 v186, v186
    v_cvt_pk_bf16_f32 v180, v184, v185
    v_exp_f32 v187, v187
    v_exp_f32 v188, v188
    v_cvt_pk_bf16_f32 v181, v186, v187
    v_exp_f32 v189, v189
    v_exp_f32 v190, v190
    v_cvt_pk_bf16_f32 v182, v188, v189
    v_exp_f32 v191, v191
    s_nop 0
    v_cvt_pk_bf16_f32 v183, v190, v191
    v_mfma_f32_16x16x32_bf16 v[32:35], v[28:31], v[160:163], 0
    v_mfma_f32_16x16x32_bf16 v[36:39], v[28:31], v[176:179], 0
    v_mfma_f32_16x16x32_bf16 v[32:35], v[28:31], v[164:167], v[32:35]
    v_mfma_f32_16x16x32_bf16 v[36:39], v[28:31], v[180:183], v[36:39]
    s_nop 7
    v_mov_b32 v2, v32
    v_mov_b32 v3, v36
    s_waitcnt vmcnt(0)
    s_barrier
    ds_read_b64_tr_b16 v[32:33], v12 offset:16384
    ds_read_b64_tr_b16 v[34:35], v12 offset:20480
    ds_read_b64_tr_b16 v[36:37], v13 offset:16384
    ds_read_b64_tr_b16 v[38:39], v13 offset:20480
    ds_read_b64_tr_b16 v[40:41], v14 offset:16384
    ds_read_b64_tr_b16 v[42:43], v14 offset:20480
    ds_read_b64_tr_b16 v[44:45], v15 offset:16384
    ds_read_b64_tr_b16 v[46:47], v15 offset:20480
    ds_read_b64_tr_b16 v[48:49], v16 offset:16384
    ds_read_b64_tr_b16 v[50:51], v16 offset:20480
    ds_read_b64_tr_b16 v[52:53], v17 offset:16384
    ds_read_b64_tr_b16 v[54:55], v17 offset:20480
    ds_read_b64_tr_b16 v[56:57], v18 offset:16384
    ds_read_b64_tr_b16 v[58:59], v18 offset:20480
    s_waitcnt lgkmcnt(12)
    v_mfma_f32_16x16x32_bf16 v[192:195], v[32:35], v[160:163], 0
    ds_read_b64_tr_b16 v[60:61], v19 offset:16384
    v_mfma_f32_16x16x32_bf16 v[224:227], v[32:35], v[176:179], 0
    ds_read_b64_tr_b16 v[62:63], v19 offset:20480
    s_waitcnt lgkmcnt(10)
    v_mfma_f32_16x16x32_bf16 v[228:231], v[36:39], v[176:179], 0
    ds_read_b64_tr_b16 v[32:33], v12 offset:24576
    v_mfma_f32_16x16x32_bf16 v[196:199], v[36:39], v[160:163], 0
    ds_read_b64_tr_b16 v[34:35], v12 offset:28672
    v_mfma_f32_16x16x32_bf16 v[200:203], v[40:43], v[160:163], 0
    ds_read_b64_tr_b16 v[36:37], v13 offset:24576
    v_mfma_f32_16x16x32_bf16 v[232:235], v[40:43], v[176:179], 0
    ds_read_b64_tr_b16 v[38:39], v13 offset:28672
    s_waitcnt lgkmcnt(10)
    v_mfma_f32_16x16x32_bf16 v[236:239], v[44:47], v[176:179], 0
    ds_read_b64_tr_b16 v[40:41], v14 offset:24576
    v_mfma_f32_16x16x32_bf16 v[204:207], v[44:47], v[160:163], 0
    ds_read_b64_tr_b16 v[42:43], v14 offset:28672
    v_mfma_f32_16x16x32_bf16 v[208:211], v[48:51], v[160:163], 0
    ds_read_b64_tr_b16 v[44:45], v15 offset:24576
    v_mfma_f32_16x16x32_bf16 v[240:243], v[48:51], v[176:179], 0
    ds_read_b64_tr_b16 v[46:47], v15 offset:28672
    s_waitcnt lgkmcnt(10)
    v_mfma_f32_16x16x32_bf16 v[244:247], v[52:55], v[176:179], 0
    ds_read_b64_tr_b16 v[48:49], v16 offset:24576
    v_mfma_f32_16x16x32_bf16 v[212:215], v[52:55], v[160:163], 0
    ds_read_b64_tr_b16 v[50:51], v16 offset:28672
    v_mfma_f32_16x16x32_bf16 v[216:219], v[56:59], v[160:163], 0
    ds_read_b64_tr_b16 v[52:53], v17 offset:24576
    v_mfma_f32_16x16x32_bf16 v[248:251], v[56:59], v[176:179], 0
    ds_read_b64_tr_b16 v[54:55], v17 offset:28672
    s_waitcnt lgkmcnt(10)
    v_mfma_f32_16x16x32_bf16 v[252:255], v[60:63], v[176:179], 0
    ds_read_b64_tr_b16 v[56:57], v18 offset:24576
    v_mfma_f32_16x16x32_bf16 v[220:223], v[60:63], v[160:163], 0
    ds_read_b64_tr_b16 v[58:59], v18 offset:28672
    v_mfma_f32_16x16x32_bf16 v[192:195], v[32:35], v[164:167], v[192:195]
    ds_read_b64_tr_b16 v[60:61], v19 offset:24576
    v_mfma_f32_16x16x32_bf16 v[224:227], v[32:35], v[180:183], v[224:227]
    ds_read_b64_tr_b16 v[62:63], v19 offset:28672
    s_waitcnt lgkmcnt(10)
    v_mfma_f32_16x16x32_bf16 v[228:231], v[36:39], v[180:183], v[228:231]
    v_mfma_f32_16x16x32_bf16 v[196:199], v[36:39], v[164:167], v[196:199]
    v_mfma_f32_16x16x32_bf16 v[200:203], v[40:43], v[164:167], v[200:203]
    v_mfma_f32_16x16x32_bf16 v[232:235], v[40:43], v[180:183], v[232:235]
    s_waitcnt lgkmcnt(6)
    v_mfma_f32_16x16x32_bf16 v[236:239], v[44:47], v[180:183], v[236:239]
    v_mfma_f32_16x16x32_bf16 v[204:207], v[44:47], v[164:167], v[204:207]
    v_mfma_f32_16x16x32_bf16 v[208:211], v[48:51], v[164:167], v[208:211]
    v_mfma_f32_16x16x32_bf16 v[240:243], v[48:51], v[180:183], v[240:243]
    s_waitcnt lgkmcnt(2)
    v_mfma_f32_16x16x32_bf16 v[244:247], v[52:55], v[180:183], v[244:247]
    v_mfma_f32_16x16x32_bf16 v[212:215], v[52:55], v[164:167], v[212:215]
    v_mfma_f32_16x16x32_bf16 v[216:219], v[56:59], v[164:167], v[216:219]
    v_mfma_f32_16x16x32_bf16 v[248:251], v[56:59], v[180:183], v[248:251]
    s_waitcnt lgkmcnt(0)
    v_mfma_f32_16x16x32_bf16 v[252:255], v[60:63], v[180:183], v[252:255]
    v_mfma_f32_16x16x32_bf16 v[220:223], v[60:63], v[164:167], v[220:223]
    s_branch L_A2_mid
L_A2_save0:
    v_cvt_pk_bf16_f32 v64, v192, v193
    v_cvt_pk_bf16_f32 v65, v194, v195
    v_cvt_pk_bf16_f32 v66, v196, v197
    v_cvt_pk_bf16_f32 v67, v198, v199
    v_cvt_pk_bf16_f32 v68, v200, v201
    v_cvt_pk_bf16_f32 v69, v202, v203
    v_cvt_pk_bf16_f32 v70, v204, v205
    v_cvt_pk_bf16_f32 v71, v206, v207
    v_cvt_pk_bf16_f32 v72, v208, v209
    v_cvt_pk_bf16_f32 v73, v210, v211
    v_cvt_pk_bf16_f32 v74, v212, v213
    v_cvt_pk_bf16_f32 v75, v214, v215
    v_cvt_pk_bf16_f32 v76, v216, v217
    v_cvt_pk_bf16_f32 v77, v218, v219
    v_cvt_pk_bf16_f32 v78, v220, v221
    v_cvt_pk_bf16_f32 v79, v222, v223
    v_cvt_pk_bf16_f32 v80, v224, v225
    v_cvt_pk_bf16_f32 v81, v226, v227
    v_cvt_pk_bf16_f32 v82, v228, v229
    v_cvt_pk_bf16_f32 v83, v230, v231
    v_cvt_pk_bf16_f32 v84, v232, v233
    v_cvt_pk_bf16_f32 v85, v234, v235
    v_cvt_pk_bf16_f32 v86, v236, v237
    v_cvt_pk_bf16_f32 v87, v238, v239
    v_cvt_pk_bf16_f32 v88, v240, v241
    v_cvt_pk_bf16_f32 v89, v242, v243
    v_cvt_pk_bf16_f32 v90, v244, v245
    v_cvt_pk_bf16_f32 v91, v246, v247
    v_cvt_pk_bf16_f32 v92, v248, v249
    v_cvt_pk_bf16_f32 v93, v250, v251
    v_cvt_pk_bf16_f32 v94, v252, v253
    v_cvt_pk_bf16_f32 v95, v254, v255
    s_branch L_A2_go
L_A2_save1:
    v_cvt_pk_bf16_f32 v96, v192, v193
    v_cvt_pk_bf16_f32 v97, v194, v195
    v_cvt_pk_bf16_f32 v98, v196, v197
    v_cvt_pk_bf16_f32 v99, v198, v199
    v_cvt_pk_bf16_f32 v100, v200, v201
    v_cvt_pk_bf16_f32 v101, v202, v203
    v_cvt_pk_bf16_f32 v102, v204, v205
    v_cvt_pk_bf16_f32 v103, v206, v207
    v_cvt_pk_bf16_f32 v104, v208, v209
    v_cvt_pk_bf16_f32 v105, v210, v211
    v_cvt_pk_bf16_f32 v106, v212, v213
    v_cvt_pk_bf16_f32 v107, v214, v215
    v_cvt_pk_bf16_f32 v108, v216, v217
    v_cvt_pk_bf16_f32 v109, v218, v219
    v_cvt_pk_bf16_f32 v110, v220, v221
    v_cvt_pk_bf16_f32 v111, v222, v223
    v_cvt_pk_bf16_f32 v112, v224, v225
    v_cvt_pk_bf16_f32 v113, v226, v227
    v_cvt_pk_bf16_f32 v114, v228, v229
    v_cvt_pk_bf16_f32 v115, v230, v231
    v_cvt_pk_bf16_f32 v116, v232, v233
    v_cvt_pk_bf16_f32 v117, v234, v235
    v_cvt_pk_bf16_f32 v118, v236, v237
    v_cvt_pk_bf16_f32 v119, v238, v239
    v_cvt_pk_bf16_f32 v120, v240, v241
    v_cvt_pk_bf16_f32 v121, v242, v243
    v_cvt_pk_bf16_f32 v122, v244, v245
    v_cvt_pk_bf16_f32 v123, v246, v247
    v_cvt_pk_bf16_f32 v124, v248, v249
    v_cvt_pk_bf16_f32 v125, v250, v251
    v_cvt_pk_bf16_f32 v126, v252, v253
    v_cvt_pk_bf16_f32 v127, v254, v255
    s_branch L_A2_go
L_A2_save2:
    v_cvt_pk_bf16_f32 v32, v192, v193
    v_cvt_pk_bf16_f32 v33, v194, v195
    v_cvt_pk_bf16_f32 v34, v196, v197
    v_cvt_pk_bf16_f32 v35, v198, v199
    v_cvt_pk_bf16_f32 v36, v200, v201
    v_cvt_pk_bf16_f32 v37, v202, v203
    v_cvt_pk_bf16_f32 v38, v204, v205
    v_cvt_pk_bf16_f32 v39, v206, v207
    v_cvt_pk_bf16_f32 v40, v208, v209
    v_cvt_pk_bf16_f32 v41, v210, v211
    v_cvt_pk_bf16_f32 v42, v212, v213
    v_cvt_pk_bf16_f32 v43, v214, v215
    v_cvt_pk_bf16_f32 v44, v216, v217
    v_cvt_pk_bf16_f32 v45, v218, v219
    v_cvt_pk_bf16_f32 v46, v220, v221
    v_cvt_pk_bf16_f32 v47, v222, v223
    v_cvt_pk_bf16_f32 v48, v224, v225
    v_cvt_pk_bf16_f32 v49, v226, v227
    v_cvt_pk_bf16_f32 v50, v228, v229
    v_cvt_pk_bf16_f32 v51, v230, v231
    v_cvt_pk_bf16_f32 v52, v232, v233
    v_cvt_pk_bf16_f32 v53, v234, v235
    v_cvt_pk_bf16_f32 v54, v236, v237
    v_cvt_pk_bf16_f32 v55, v238, v239
    v_cvt_pk_bf16_f32 v56, v240, v241
    v_cvt_pk_bf16_f32 v57, v242, v243
    v_cvt_pk_bf16_f32 v58, v244, v245
    v_cvt_pk_bf16_f32 v59, v246, v247
    v_cvt_pk_bf16_f32 v60, v248, v249
    v_cvt_pk_bf16_f32 v61, v250, v251
    v_cvt_pk_bf16_f32 v62, v252, v253
    v_cvt_pk_bf16_f32 v63, v254, v255
    ds_write_b128 v4, v[32:35] offset:0
    ds_write_b128 v4, v[36:39] offset:1024
    ds_write_b128 v4, v[40:43] offset:2048
    ds_write_b128 v4, v[44:47] offset:3072
    ds_write_b128 v4, v[48:51] offset:4096
    ds_write_b128 v4, v[52:55] offset:5120
    ds_write_b128 v4, v[56:59] offset:6144
    ds_write_b128 v4, v[60:63] offset:7168
    s_branch L_A2_go
.p2align 3
L_A2_loop:
    s_barrier
    ds_read_b128 v[32:35], v8 offset:0
    ds_read_b128 v[36:39], v8 offset:4096
    ds_read_b128 v[40:43], v8 offset:8192
    ds_read_b128 v[44:47], v8 offset:12288
    ds_read_b128 v[48:51], v9 offset:0
    ds_read_b128 v[52:55], v9 offset:4096
    ds_read_b128 v[56:59], v9 offset:8192
    s_waitcnt lgkmcnt(6)
    v_mfma_f32_16x16x32_bf16 v[160:163], v[32:35], v[128:131], v[20:23]
    ds_read_b128 v[60:63], v9 offset:12288
    v_mfma_f32_16x16x32_bf16 v[176:179], v[32:35], v[144:147], v[24:27]
    s_waitcnt lgkmcnt(5)
    v_mfma_f32_16x16x32_bf16 v[180:183], v[36:39], v[144:147], v[24:27]
    ds_read_b128 v[32:35], v10 offset:0
    v_mfma_f32_16x16x32_bf16 v[164:167], v[36:39], v[128:131], v[20:23]
    v_mfma_f32_16x16x32_bf16 v[168:171], v[40:43], v[128:131], v[20:23]
    ds_read_b128 v[36:39], v10 offset:4096
    v_mfma_f32_16x16x32_bf16 v[184:187], v[40:43], v[144:147], v[24:27]
    s_waitcnt lgkmcnt(5)
    v_mfma_f32_16x16x32_bf16 v[188:191], v[44:47], v[144:147], v[24:27]
    ds_read_b128 v[40:43], v10 offset:8192
    v_mfma_f32_16x16x32_bf16 v[172:175], v[44:47], v[128:131], v[20:23]
    v_mfma_f32_16x16x32_bf16 v[160:163], v[48:51], v[132:135], v[160:163]
    ds_read_b128 v[44:47], v10 offset:12288
    v_mfma_f32_16x16x32_bf16 v[176:179], v[48:51], v[148:151], v[176:179]
    s_waitcnt lgkmcnt(5)
    v_mfma_f32_16x16x32_bf16 v[180:183], v[52:55], v[148:151], v[180:183]
    ds_read_b128 v[48:51], v11 offset:0
    v_mfma_f32_16x16x32_bf16 v[164:167], v[52:55], v[132:135], v[164:167]
    v_mfma_f32_16x16x32_bf16 v[168:171], v[56:59], v[132:135], v[168:171]
    ds_read_b128 v[52:55], v11 offset:4096
    v_mfma_f32_16x16x32_bf16 v[184:187], v[56:59], v[148:151], v[184:187]
    s_waitcnt lgkmcnt(5)
    v_mfma_f32_16x16x32_bf16 v[188:191], v[60:63], v[148:151], v[188:191]
    ds_read_b128 v[56:59], v11 offset:8192
    v_mfma_f32_16x16x32_bf16 v[172:175], v[60:63], v[132:135], v[172:175]
    v_mfma_f32_16x16x32_bf16 v[160:163], v[32:35], v[136:139], v[160:163]
    ds_read_b128 v[60:63], v11 offset:12288
    v_mfma_f32_16x16x32_bf16 v[176:179], v[32:35], v[152:155], v[176:179]
    s_waitcnt lgkmcnt(5)
    v_mfma_f32_16x16x32_bf16 v[180:183], v[36:39], v[152:155], v[180:183]
    v_mfma_f32_16x16x32_bf16 v[164:167], v[36:39], v[136:139], v[164:167]
    v_mfma_f32_16x16x32_bf16 v[168:171], v[40:43], v[136:139], v[168:171]
    v_mfma_f32_16x16x32_bf16 v[184:187], v[40:43], v[152:155], v[184:187]
    s_waitcnt lgkmcnt(3)
    v_mfma_f32_16x16x32_bf16 v[188:191], v[44:47], v[152:155], v[188:191]
    v_mfma_f32_16x16x32_bf16 v[172:175], v[44:47], v[136:139], v[172:175]
    v_mfma_f32_16x16x32_bf16 v[160:163], v[48:51], v[140:143], v[160:163]
    v_mfma_f32_16x16x32_bf16 v[176:179], v[48:51], v[156:159], v[176:179]
    s_waitcnt lgkmcnt(1)
    v_mfma_f32_16x16x32_bf16 v[180:183], v[52:55], v[156:159], v[180:183]
    v_mfma_f32_16x16x32_bf16 v[164:167], v[52:55], v[140:143], v[164:167]
    v_mfma_f32_16x16x32_bf16 v[168:171], v[56:59], v[140:143], v[168:171]
    v_mfma_f32_16x16x32_bf16 v[184:187], v[56:59], v[156:159], v[184:187]
    s_waitcnt lgkmcnt(0)
    v_mfma_f32_16x16x32_bf16 v[188:191], v[60:63], v[156:159], v[188:191]
    v_mfma_f32_16x16x32_bf16 v[172:175], v[60:63], v[140:143], v[172:175]
    s_nop 1
L_A2_exp0:
    v_exp_f32 v160, v160
    v_exp_f32 v161, v161
    v_exp_f32 v162, v162
    v_cvt_pk_bf16_f32 v160, v160, v161
    v_exp_f32 v163, v163
    v_exp_f32 v164, v164
    v_cvt_pk_bf16_f32 v161, v162, v163
    v_exp_f32 v165, v165
    v_exp_f32 v166, v166
    v_cvt_pk_bf16_f32 v162, v164, v165
    v_exp_f32 v167, v167
    v_exp_f32 v176, v176
    v_cvt_pk_bf16_f32 v163, v166, v167
    v_exp_f32 v177, v177
    v_exp_f32 v178, v178
    v_cvt_pk_bf16_f32 v176, v176, v177
    v_exp_f32 v179, v179
    v_exp_f32 v180, v180
    v_cvt_pk_bf16_f32 v177, v178, v179
    v_exp_f32 v181, v181
    v_exp_f32 v182, v182
    v_cvt_pk_bf16_f32 v178, v180, v181
    v_exp_f32 v183, v183
    v_exp_f32 v168, v168
    v_cvt_pk_bf16_f32 v179, v182, v183
    v_exp_f32 v169, v169
    v_exp_f32 v170, v170
    v_cvt_pk_bf16_f32 v164, v168, v169
    v_exp_f32 v171, v171
    v_exp_f32 v172, v172
    v_cvt_pk_bf16_f32 v165, v170, v171
    v_exp_f32 v173, v173
    v_exp_f32 v174, v174
    v_cvt_pk_bf16_f32 v166, v172, v173
    v_exp_f32 v175, v175
    v_exp_f32 v184, v184
    v_cvt_pk_bf16_f32 v167, v174, v175
    v_exp_f32 v185, v185
    v_exp_f32 v186, v186
    v_cvt_pk_bf16_f32 v180, v184, v185
    v_exp_f32 v187, v187
    v_exp_f32 v188, v188
    v_cvt_pk_bf16_f32 v181, v186, v187
    v_exp_f32 v189, v189
    v_exp_f32 v190, v190
    v_cvt_pk_bf16_f32 v182, v188, v189
    v_exp_f32 v191, v191
    s_nop 0
    v_cvt_pk_bf16_f32 v183, v190, v191
    v_mfma_f32_16x16x32_bf16 v[32:35], v[28:31], v[160:163], 0
    v_mfma_f32_16x16x32_bf16 v[36:39], v[28:31], v[176:179], 0
    v_mfma_f32_16x16x32_bf16 v[32:35], v[28:31], v[164:167], v[32:35]
    v_mfma_f32_16x16x32_bf16 v[36:39], v[28:31], v[180:183], v[36:39]
    s_nop 7
    v_max_f32 v1, v32, v36
    v_cmp_lt_f32 vcc, s87, v1
    s_cbranch_vccnz L_A2_slow0
    v_add_f32 v2, v2, v32
    v_add_f32 v3, v3, v36
    s_barrier
    ds_read_b64_tr_b16 v[32:33], v12 offset:16384
    ds_read_b64_tr_b16 v[34:35], v12 offset:20480
    ds_read_b64_tr_b16 v[36:37], v13 offset:16384
    ds_read_b64_tr_b16 v[38:39], v13 offset:20480
    ds_read_b64_tr_b16 v[40:41], v14 offset:16384
    ds_read_b64_tr_b16 v[42:43], v14 offset:20480
    ds_read_b64_tr_b16 v[44:45], v15 offset:16384
    ds_read_b64_tr_b16 v[46:47], v15 offset:20480
    ds_read_b64_tr_b16 v[48:49], v16 offset:16384
    ds_read_b64_tr_b16 v[50:51], v16 offset:20480
    ds_read_b64_tr_b16 v[52:53], v17 offset:16384
    ds_read_b64_tr_b16 v[54:55], v17 offset:20480
    ds_read_b64_tr_b16 v[56:57], v18 offset:16384
    ds_read_b64_tr_b16 v[58:59], v18 offset:20480
    s_waitcnt lgkmcnt(12)
    v_mfma_f32_16x16x32_bf16 v[192:195], v[32:35], v[160:163], v[192:195]
    ds_read_b64_tr_b16 v[60:61], v19 offset:16384
    v_mfma_f32_16x16x32_bf16 v[224:227], v[32:35], v[176:179], v[224:227]
    ds_read_b64_tr_b16 v[62:63], v19 offset:20480
    s_waitcnt lgkmcnt(10)
    v_mfma_f32_16x16x32_bf16 v[228:231], v[36:39], v[176:179], v[228:231]
    ds_read_b64_tr_b16 v[32:33], v12 offset:24576
    v_mfma_f32_16x16x32_bf16 v[196:199], v[36:39], v[160:163], v[196:199]
    ds_read_b64_tr_b16 v[34:35], v12 offset:28672
    v_mfma_f32_16x16x32_bf16 v[200:203], v[40:43], v[160:163], v[200:203]
    ds_read_b64_tr_b16 v[36:37], v13 offset:24576
    v_mfma_f32_16x16x32_bf16 v[232:235], v[40:43], v[176:179], v[232:235]
    ds_read_b64_tr_b16 v[38:39], v13 offset:28672
    s_waitcnt lgkmcnt(10)
    v_mfma_f32_16x16x32_bf16 v[236:239], v[44:47], v[176:179], v[236:239]
    ds_read_b64_tr_b16 v[40:41], v14 offset:24576
    v_mfma_f32_16x16x32_bf16 v[204:207], v[44:47], v[160:163], v[204:207]
    ds_read_b64_tr_b16 v[42:43], v14 offset:28672
    v_mfma_f32_16x16x32_bf16 v[208:211], v[48:51], v[160:163], v[208:211]
    ds_read_b64_tr_b16 v[44:45], v15 offset:24576
    v_mfma_f32_16x16x32_bf16 v[240:243], v[48:51], v[176:179], v[240:243]
    ds_read_b64_tr_b16 v[46:47], v15 offset:28672
    s_waitcnt lgkmcnt(10)
    v_mfma_f32_16x16x32_bf16 v[244:247], v[52:55], v[176:179], v[244:247]
    ds_read_b64_tr_b16 v[48:49], v16 offset:24576
    v_mfma_f32_16x16x32_bf16 v[212:215], v[52:55], v[160:163], v[212:215]
    ds_read_b64_tr_b16 v[50:51], v16 offset:28672
    v_mfma_f32_16x16x32_bf16 v[216:219], v[56:59], v[160:163], v[216:219]
    ds_read_b64_tr_b16 v[52:53], v17 offset:24576
    v_mfma_f32_16x16x32_bf16 v[248:251], v[56:59], v[176:179], v[248:251]
    ds_read_b64_tr_b16 v[54:55], v17 offset:28672
    s_waitcnt lgkmcnt(10)
    v_mfma_f32_16x16x32_bf16 v[252:255], v[60:63], v[176:179], v[252:255]
    ds_read_b64_tr_b16 v[56:57], v18 offset:24576
    v_mfma_f32_16x16x32_bf16 v[220:223], v[60:63], v[160:163], v[220:223]
    ds_read_b64_tr_b16 v[58:59], v18 offset:28672
    v_mfma_f32_16x16x32_bf16 v[192:195], v[32:35], v[164:167], v[192:195]
    ds_read_b64_tr_b16 v[60:61], v19 offset:24576
    v_mfma_f32_16x16x32_bf16 v[224:227], v[32:35], v[180:183], v[224:227]
    ds_read_b64_tr_b16 v[62:63], v19 offset:28672
    s_waitcnt lgkmcnt(10)
    v_mfma_f32_16x16x32_bf16 v[228:231], v[36:39], v[180:183], v[228:231]
    v_mfma_f32_16x16x32_bf16 v[196:199], v[36:39], v[164:167], v[196:199]
    v_mfma_f32_16x16x32_bf16 v[200:203], v[40:43], v[164:167], v[200:203]
    v_mfma_f32_16x16x32_bf16 v[232:235], v[40:43], v[180:183], v[232:235]
    s_waitcnt lgkmcnt(6)
    v_mfma_f32_16x16x32_bf16 v[236:239], v[44:47], v[180:183], v[236:239]
    v_mfma_f32_16x16x32_bf16 v[204:207], v[44:47], v[164:167], v[204:207]
    v_mfma_f32_16x16x32_bf16 v[208:211], v[48:51], v[164:167], v[208:211]
    v_mfma_f32_16x16x32_bf16 v[240:243], v[48:51], v[180:183], v[240:243]
    s_waitcnt lgkmcnt(2)
    v_mfma_f32_16x16x32_bf16 v[244:247], v[52:55], v[180:183], v[244:247]
    v_mfma_f32_16x16x32_bf16 v[212:215], v[52:55], v[164:167], v[212:215]
    v_mfma_f32_16x16x32_bf16 v[216:219], v[56:59], v[164:167], v[216:219]
    v_mfma_f32_16x16x32_bf16 v[248:251], v[56:59], v[180:183], v[248:251]
    s_waitcnt lgkmcnt(0)
    v_mfma_f32_16x16x32_bf16 v[252:255], v[60:63], v[180:183], v[252:255]
    v_mfma_f32_16x16x32_bf16 v[220:223], v[60:63], v[164:167], v[220:223]
L_A2_mid:
    s_barrier
    ds_read_b128 v[32:35], v8 offset:32768
    ds_read_b128 v[36:39], v8 offset:36864
    ds_read_b128 v[40:43], v8 offset:40960
    ds_read_b128 v[44:47], v8 offset:45056
    ds_read_b128 v[48:51], v9 offset:32768
    ds_read_b128 v[52:55], v9 offset:36864
    ds_read_b128 v[56:59], v9 offset:40960
    s_waitcnt lgkmcnt(6)
    v_mfma_f32_16x16x32_bf16 v[160:163], v[32:35], v[128:131], v[20:23]
    ds_read_b128 v[60:63], v9 offset:45056
    v_mfma_f32_16x16x32_bf16 v[176:179], v[32:35], v[144:147], v[24:27]
    s_waitcnt lgkmcnt(5)
    v_mfma_f32_16x16x32_bf16 v[180:183], v[36:39], v[144:147], v[24:27]
    ds_read_b128 v[32:35], v10 offset:32768
    v_mfma_f32_16x16x32_bf16 v[164:167], v[36:39], v[128:131], v[20:23]
    v_mfma_f32_16x16x32_bf16 v[168:171], v[40:43], v[128:131], v[20:23]
    ds_read_b128 v[36:39], v10 offset:36864
    v_mfma_f32_16x16x32_bf16 v[184:187], v[40:43], v[144:147], v[24:27]
    s_waitcnt lgkmcnt(5)
    v_mfma_f32_16x16x32_bf16 v[188:191], v[44:47], v[144:147], v[24:27]
    ds_read_b128 v[40:43], v10 offset:40960
    v_mfma_f32_16x16x32_bf16 v[172:175], v[44:47], v[128:131], v[20:23]
    v_mfma_f32_16x16x32_bf16 v[160:163], v[48:51], v[132:135], v[160:163]
    ds_read_b128 v[44:47], v10 offset:45056
    v_mfma_f32_16x16x32_bf16 v[176:179], v[48:51], v[148:151], v[176:179]
    s_waitcnt lgkmcnt(5)
    v_mfma_f32_16x16x32_bf16 v[180:183], v[52:55], v[148:151], v[180:183]
    ds_read_b128 v[48:51], v11 offset:32768
    v_mfma_f32_16x16x32_bf16 v[164:167], v[52:55], v[132:135], v[164:167]
    v_mfma_f32_16x16x32_bf16 v[168:171], v[56:59], v[132:135], v[168:171]
    ds_read_b128 v[52:55], v11 offset:36864
    v_mfma_f32_16x16x32_bf16 v[184:187], v[56:59], v[148:151], v[184:187]
    s_waitcnt lgkmcnt(5)
    v_mfma_f32_16x16x32_bf16 v[188:191], v[60:63], v[148:151], v[188:191]
    ds_read_b128 v[56:59], v11 offset:40960
    v_mfma_f32_16x16x32_bf16 v[172:175], v[60:63], v[132:135], v[172:175]
    v_mfma_f32_16x16x32_bf16 v[160:163], v[32:35], v[136:139], v[160:163]
    ds_read_b128 v[60:63], v11 offset:45056
    v_mfma_f32_16x16x32_bf16 v[176:179], v[32:35], v[152:155], v[176:179]
    s_waitcnt lgkmcnt(5)
    v_mfma_f32_16x16x32_bf16 v[180:183], v[36:39], v[152:155], v[180:183]
    v_mfma_f32_16x16x32_bf16 v[164:167], v[36:39], v[136:139], v[164:167]
    v_mfma_f32_16x16x32_bf16 v[168:171], v[40:43], v[136:139], v[168:171]
    v_mfma_f32_16x16x32_bf16 v[184:187], v[40:43], v[152:155], v[184:187]
    s_waitcnt lgkmcnt(3)
    v_mfma_f32_16x16x32_bf16 v[188:191], v[44:47], v[152:155], v[188:191]
    v_mfma_f32_16x16x32_bf16 v[172:175], v[44:47], v[136:139], v[172:175]
    v_mfma_f32_16x16x32_bf16 v[160:163], v[48:51], v[140:143], v[160:163]
    v_mfma_f32_16x16x32_bf16 v[176:179], v[48:51], v[156:159], v[176:179]
    s_waitcnt lgkmcnt(1)
    v_mfma_f32_16x16x32_bf16 v[180:183], v[52:55], v[156:159], v[180:183]
    v_mfma_f32_16x16x32_bf16 v[164:167], v[52:55], v[140:143], v[164:167]
    v_mfma_f32_16x16x32_bf16 v[168:171], v[56:59], v[140:143], v[168:171]
    v_mfma_f32_16x16x32_bf16 v[184:187], v[56:59], v[156:159], v[184:187]
    s_waitcnt lgkmcnt(0)
    v_mfma_f32_16x16x32_bf16 v[188:191], v[60:63], v[156:159], v[188:191]
    v_mfma_f32_16x16x32_bf16 v[172:175], v[60:63], v[140:143], v[172:175]
    s_nop 1
L_A2_exp1:
    v_exp_f32 v160, v160
    v_exp_f32 v161, v161
    v_exp_f32 v162, v162
    v_cvt_pk_bf16_f32 v160, v160, v161
    v_exp_f32 v163, v163
    v_exp_f32 v164, v164
    v_cvt_pk_bf16_f32 v161, v162, v163
    v_exp_f32 v165, v165
    v_exp_f32 v166, v166
    v_cvt_pk_bf16_f32 v162, v164, v165
    v_exp_f32 v167, v167
    v_exp_f32 v176, v176
    v_cvt_pk_bf16_f32 v163, v166, v167
    v_exp_f32 v177, v177
    v_exp_f32 v178, v178
    v_cvt_pk_bf16_f32 v176, v176, v177
    v_exp_f32 v179, v179
    v_exp_f32 v180, v180
    v_cvt_pk_bf16_f32 v177, v178, v179
    v_exp_f32 v181, v181
    v_exp_f32 v182, v182
    v_cvt_pk_bf16_f32 v178, v180, v181
    v_exp_f32 v183, v183
    v_exp_f32 v168, v168
    v_cvt_pk_bf16_f32 v179, v182, v183
    v_exp_f32 v169, v169
    v_exp_f32 v170, v170
    v_cvt_pk_bf16_f32 v164, v168, v169
    v_exp_f32 v171, v171
    v_exp_f32 v172, v172
    v_cvt_pk_bf16_f32 v165, v170, v171
    v_exp_f32 v173, v173
    v_exp_f32 v174, v174
    v_cvt_pk_bf16_f32 v166, v172, v173
    v_exp_f32 v175, v175
    v_exp_f32 v184, v184
    v_cvt_pk_bf16_f32 v167, v174, v175
    v_exp_f32 v185, v185
    v_exp_f32 v186, v186
    v_cvt_pk_bf16_f32 v180, v184, v185
    v_exp_f32 v187, v187
    v_exp_f32 v188, v188
    v_cvt_pk_bf16_f32 v181, v186, v187
    v_exp_f32 v189, v189
    v_exp_f32 v190, v190
    v_cvt_pk_bf16_f32 v182, v188, v189
    v_exp_f32 v191, v191
    s_nop 0
    v_cvt_pk_bf16_f32 v183, v190, v191
    v_mfma_f32_16x16x32_bf16 v[32:35], v[28:31], v[160:163], 0
    v_mfma_f32_16x16x32_bf16 v[36:39], v[28:31], v[176:179], 0
    v_mfma_f32_16x16x32_bf16 v[32:35], v[28:31], v[164:167], v[32:35]
    v_mfma_f32_16x16x32_bf16 v[36:39], v[28:31], v[180:183], v[36:39]
    s_nop 7
    v_max_f32 v1, v32, v36
    v_cmp_lt_f32 vcc, s87, v1
    s_cbranch_vccnz L_A2_slow1
    v_add_f32 v2, v2, v32
    v_add_f32 v3, v3, v36
    s_barrier
    ds_read_b64_tr_b16 v[32:33], v12 offset:49152
    ds_read_b64_tr_b16 v[34:35], v12 offset:53248
    ds_read_b64_tr_b16 v[36:37], v13 offset:49152
    ds_read_b64_tr_b16 v[38:39], v13 offset:53248
    ds_read_b64_tr_b16 v[40:41], v14 offset:49152
    ds_read_b64_tr_b16 v[42:43], v14 offset:53248
    ds_read_b64_tr_b16 v[44:45], v15 offset:49152
    ds_read_b64_tr_b16 v[46:47], v15 offset:53248
    ds_read_b64_tr_b16 v[48:49], v16 offset:49152
    ds_read_b64_tr_b16 v[50:51], v16 offset:53248
    ds_read_b64_tr_b16 v[52:53], v17 offset:49152
    ds_read_b64_tr_b16 v[54:55], v17 offset:53248
    ds_read_b64_tr_b16 v[56:57], v18 offset:49152
    ds_read_b64_tr_b16 v[58:59], v18 offset:53248
    s_waitcnt lgkmcnt(12)
    v_mfma_f32_16x16x32_bf16 v[192:195], v[32:35], v[160:163], v[192:195]
    ds_read_b64_tr_b16 v[60:61], v19 offset:49152
    v_mfma_f32_16x16x32_bf16 v[224:227], v[32:35], v[176:179], v[224:227]
    ds_read_b64_tr_b16 v[62:63], v19 offset:53248
    s_waitcnt lgkmcnt(10)
    v_mfma_f32_16x16x32_bf16 v[228:231], v[36:39], v[176:179], v[228:231]
    ds_read_b64_tr_b16 v[32:33], v12 offset:57344
    v_mfma_f32_16x16x32_bf16 v[196:199], v[36:39], v[160:163], v[196:199]
    ds_read_b64_tr_b16 v[34:35], v12 offset:61440
    v_mfma_f32_16x16x32_bf16 v[200:203], v[40:43], v[160:163], v[200:203]
    ds_read_b64_tr_b16 v[36:37], v13 offset:57344
    v_mfma_f32_16x16x32_bf16 v[232:235], v[40:43], v[176:179], v[232:235]
    ds_read_b64_tr_b16 v[38:39], v13 offset:61440
    s_waitcnt lgkmcnt(10)
    v_mfma_f32_16x16x32_bf16 v[236:239], v[44:47], v[176:179], v[236:239]
    ds_read_b64_tr_b16 v[40:41], v14 offset:57344
    v_mfma_f32_16x16x32_bf16 v[204:207], v[44:47], v[160:163], v[204:207]
    ds_read_b64_tr_b16 v[42:43], v14 offset:61440
    v_mfma_f32_16x16x32_bf16 v[208:211], v[48:51], v[160:163], v[208:211]
    ds_read_b64_tr_b16 v[44:45], v15 offset:57344
    v_mfma_f32_16x16x32_bf16 v[240:243], v[48:51], v[176:179], v[240:243]
    ds_read_b64_tr_b16 v[46:47], v15 offset:61440
    s_waitcnt lgkmcnt(10)
    v_mfma_f32_16x16x32_bf16 v[244:247], v[52:55], v[176:179], v[244:247]
    ds_read_b64_tr_b16 v[48:49], v16 offset:57344
    v_mfma_f32_16x16x32_bf16 v[212:215], v[52:55], v[160:163], v[212:215]
    ds_read_b64_tr_b16 v[50:51], v16 offset:61440
    v_mfma_f32_16x16x32_bf16 v[216:219], v[56:59], v[160:163], v[216:219]
    ds_read_b64_tr_b16 v[52:53], v17 offset:57344
    v_mfma_f32_16x16x32_bf16 v[248:251], v[56:59], v[176:179], v[248:251]
    ds_read_b64_tr_b16 v[54:55], v17 offset:61440
    s_waitcnt lgkmcnt(10)
    v_mfma_f32_16x16x32_bf16 v[252:255], v[60:63], v[176:179], v[252:255]
    ds_read_b64_tr_b16 v[56:57], v18 offset:57344
    v_mfma_f32_16x16x32_bf16 v[220:223], v[60:63], v[160:163], v[220:223]
    ds_read_b64_tr_b16 v[58:59], v18 offset:61440
    v_mfma_f32_16x16x32_bf16 v[192:195], v[32:35], v[164:167], v[192:195]
    ds_read_b64_tr_b16 v[60:61], v19 offset:57344
    v_mfma_f32_16x16x32_bf16 v[224:227], v[32:35], v[180:183], v[224:227]
    ds_read_b64_tr_b16 v[62:63], v19 offset:61440
    s_waitcnt lgkmcnt(10)
    v_mfma_f32_16x16x32_bf16 v[228:231], v[36:39], v[180:183], v[228:231]
    v_mfma_f32_16x16x32_bf16 v[196:199], v[36:39], v[164:167], v[196:199]
    v_mfma_f32_16x16x32_bf16 v[200:203], v[40:43], v[164:167], v[200:203]
    v_mfma_f32_16x16x32_bf16 v[232:235], v[40:43], v[180:183], v[232:235]
    s_waitcnt lgkmcnt(6)
    v_mfma_f32_16x16x32_bf16 v[236:239], v[44:47], v[180:183], v[236:239]
    v_mfma_f32_16x16x32_bf16 v[204:207], v[44:47], v[164:167], v[204:207]
    v_mfma_f32_16x16x32_bf16 v[208:211], v[48:51], v[164:167], v[208:211]
    v_mfma_f32_16x16x32_bf16 v[240:243], v[48:51], v[180:183], v[240:243]
    s_waitcnt lgkmcnt(2)
    v_mfma_f32_16x16x32_bf16 v[244:247], v[52:55], v[180:183], v[244:247]
    v_mfma_f32_16x16x32_bf16 v[212:215], v[52:55], v[164:167], v[212:215]
    v_mfma_f32_16x16x32_bf16 v[216:219], v[56:59], v[164:167], v[216:219]
    v_mfma_f32_16x16x32_bf16 v[248:251], v[56:59], v[180:183], v[248:251]
    s_waitcnt lgkmcnt(0)
    v_mfma_f32_16x16x32_bf16 v[252:255], v[60:63], v[180:183], v[252:255]
    v_mfma_f32_16x16x32_bf16 v[220:223], v[60:63], v[164:167], v[220:223]
    s_sub_u32 s81, s81, 1
    s_cmp_lg_u32 s81, 0
    s_cbranch_scc1 L_A2_loop
    s_add_u32 s82, s82, 1
    s_branch L_A2_item
L_A2_slow0:
    ds_read_b128 v[32:35], v8 offset:0
    ds_read_b128 v[36:39], v8 offset:4096
    ds_read_b128 v[40:43], v8 offset:8192
    ds_read_b128 v[44:47], v8 offset:12288
    ds_read_b128 v[48:51], v9 offset:0
    ds_read_b128 v[52:55], v9 offset:4096
    ds_read_b128 v[56:59], v9 offset:8192
    s_waitcnt lgkmcnt(6)
    v_mfma_f32_16x16x32_bf16 v[160:163], v[32:35], v[128:131], v[20:23]
    ds_read_b128 v[60:63], v9 offset:12288
    v_mfma_f32_16x16x32_bf16 v[176:179], v[32:35], v[144:147], v[24:27]
    s_waitcnt lgkmcnt(5)
    v_mfma_f32_16x16x32_bf16 v[180:183], v[36:39], v[144:147], v[24:27]
    ds_read_b128 v[32:35], v10 offset:0
    v_mfma_f32_16x16x32_bf16 v[164:167], v[36:39], v[128:131], v[20:23]
    v_mfma_f32_16x16x32_bf16 v[168:171], v[40:43], v[128:131], v[20:23]
    ds_read_b128 v[36:39], v10 offset:4096
    v_mfma_f32_16x16x32_bf16 v[184:187], v[40:43], v[144:147], v[24:27]
    s_waitcnt lgkmcnt(5)
    v_mfma_f32_16x16x32_bf16 v[188:191], v[44:47], v[144:147], v[24:27]
    ds_read_b128 v[40:43], v10 offset:8192
    v_mfma_f32_16x16x32_bf16 v[172:175], v[44:47], v[128:131], v[20:23]
    v_mfma_f32_16x16x32_bf16 v[160:163], v[48:51], v[132:135], v[160:163]
    ds_read_b128 v[44:47], v10 offset:12288
    v_mfma_f32_16x16x32_bf16 v[176:179], v[48:51], v[148:151], v[176:179]
    s_waitcnt lgkmcnt(5)
    v_mfma_f32_16x16x32_bf16 v[180:183], v[52:55], v[148:151], v[180:183]
    ds_read_b128 v[48:51], v11 offset:0
    v_mfma_f32_16x16x32_bf16 v[164:167], v[52:55], v[132:135], v[164:167]
    v_mfma_f32_16x16x32_bf16 v[168:171], v[56:59], v[132:135], v[168:171]
    ds_read_b128 v[52:55], v11 offset:4096
    v_mfma_f32_16x16x32_bf16 v[184:187], v[56:59], v[148:151], v[184:187]
    s_waitcnt lgkmcnt(5)
    v_mfma_f32_16x16x32_bf16 v[188:191], v[60:63], v[148:151], v[188:191]
    ds_read_b128 v[56:59], v11 offset:8192
    v_mfma_f32_16x16x32_bf16 v[172:175], v[60:63], v[132:135], v[172:175]
    v_mfma_f32_16x16x32_bf16 v[160:163], v[32:35], v[136:139], v[160:163]
    ds_read_b128 v[60:63], v11 offset:12288
    v_mfma_f32_16x16x32_bf16 v[176:179], v[32:35], v[152:155], v[176:179]
    s_waitcnt lgkmcnt(5)
    v_mfma_f32_16x16x32_bf16 v[180:183], v[36:39], v[152:155], v[180:183]
    v_mfma_f32_16x16x32_bf16 v[164:167], v[36:39], v[136:139], v[164:167]
    v_mfma_f32_16x16x32_bf16 v[168:171], v[40:43], v[136:139], v[168:171]
    v_mfma_f32_16x16x32_bf16 v[184:187], v[40:43], v[152:155], v[184:187]
    s_waitcnt lgkmcnt(3)
    v_mfma_f32_16x16x32_bf16 v[188:191], v[44:47], v[152:155], v[188:191]
    v_mfma_f32_16x16x32_bf16 v[172:175], v[44:47], v[136:139], v[172:175]
    v_mfma_f32_16x16x32_bf16 v[160:163], v[48:51], v[140:143], v[160:163]
    v_mfma_f32_16x16x32_bf16 v[176:179], v[48:51], v[156:159], v[176:179]
    s_waitcnt lgkmcnt(1)
    v_mfma_f32_16x16x32_bf16 v[180:183], v[52:55], v[156:159], v[180:183]
    v_mfma_f32_16x16x32_bf16 v[164:167], v[52:55], v[140:143], v[164:167]
    v_mfma_f32_16x16x32_bf16 v[168:171], v[56:59], v[140:143], v[168:171]
    v_mfma_f32_16x16x32_bf16 v[184:187], v[56:59], v[156:159], v[184:187]
    s_waitcnt lgkmcnt(0)
    v_mfma_f32_16x16x32_bf16 v[188:191], v[60:63], v[156:159], v[188:191]
    v_mfma_f32_16x16x32_bf16 v[172:175], v[60:63], v[140:143], v[172:175]
    s_nop 7
    v_max3_f32 v32, v160, v161, v162
    v_max3_f32 v32, v32, v163, v164
    v_max3_f32 v32, v32, v165, v166
    v_max3_f32 v32, v32, v167, v168
    v_max3_f32 v32, v32, v169, v170
    v_max3_f32 v32, v32, v171, v172
    v_max3_f32 v32, v32, v173, v174
    v_max3_f32 v32, v32, v175, 0
    v_mov_b32 v33, v32
    s_nop 1
    v_permlane32_swap_b32 v32, v33
    s_nop 1
    v_max_f32 v32, v32, v33
    v_mov_b32 v33, v32
    s_nop 1
    v_permlane16_swap_b32 v32, v33
    s_nop 1
    v_max_f32 v32, v32, v33
    v_exp_f32 v33, -v32
    v_sub_f32 v20, v20, v32
    v_sub_f32 v21, v21, v32
    v_sub_f32 v22, v22, v32
    v_sub_f32 v23, v23, v32
    v_sub_f32 v160, v160, v32
    v_sub_f32 v161, v161, v32
    v_sub_f32 v162, v162, v32
    v_sub_f32 v163, v163, v32
    v_sub_f32 v164, v164, v32
    v_sub_f32 v165, v165, v32
    v_sub_f32 v166, v166, v32
    v_sub_f32 v167, v167, v32
    v_sub_f32 v168, v168, v32
    v_sub_f32 v169, v169, v32
    v_sub_f32 v170, v170, v32
    v_sub_f32 v171, v171, v32
    v_sub_f32 v172, v172, v32
    v_sub_f32 v173, v173, v32
    v_sub_f32 v174, v174, v32
    v_sub_f32 v175, v175, v32
    v_mul_f32 v2, v33, v2
    v_mul_f32 v192, v33, v192
    v_mul_f32 v193, v33, v193
    v_mul_f32 v194, v33, v194
    v_mul_f32 v195, v33, v195
    v_mul_f32 v196, v33, v196
    v_mul_f32 v197, v33, v197
    v_mul_f32 v198, v33, v198
    v_mul_f32 v199, v33, v199
    v_mul_f32 v200, v33, v200
    v_mul_f32 v201, v33, v201
    v_mul_f32 v202, v33, v202
    v_mul_f32 v203, v33, v203
    v_mul_f32 v204, v33, v204
    v_mul_f32 v205, v33, v205
    v_mul_f32 v206, v33, v206
    v_mul_f32 v207, v33, v207
    v_mul_f32 v208, v33, v208
    v_mul_f32 v209, v33, v209
    v_mul_f32 v210, v33, v210
    v_mul_f32 v211, v33, v211
    v_mul_f32 v212, v33, v212
    v_mul_f32 v213, v33, v213
    v_mul_f32 v214, v33, v214
    v_mul_f32 v215, v33, v215
    v_mul_f32 v216, v33, v216
    v_mul_f32 v217, v33, v217
    v_mul_f32 v218, v33, v218
    v_mul_f32 v219, v33, v219
    v_mul_f32 v220, v33, v220
    v_mul_f32 v221, v33, v221
    v_mul_f32 v222, v33, v222
    v_mul_f32 v223, v33, v223
    v_max3_f32 v36, v176, v177, v178
    v_max3_f32 v36, v36, v179, v180
    v_max3_f32 v36, v36, v181, v182
    v_max3_f32 v36, v36, v183, v184
    v_max3_f32 v36, v36, v185, v186
    v_max3_f32 v36, v36, v187, v188
    v_max3_f32 v36, v36, v189, v190
    v_max3_f32 v36, v36, v191, 0
    v_mov_b32 v37, v36
    s_nop 1
    v_permlane32_swap_b32 v36, v37
    s_nop 1
    v_max_f32 v36, v36, v37
    v_mov_b32 v37, v36
    s_nop 1
    v_permlane16_swap_b32 v36, v37
    s_nop 1
    v_max_f32 v36, v36, v37
    v_exp_f32 v37, -v36
    v_sub_f32 v24, v24, v36
    v_sub_f32 v25, v25, v36
    v_sub_f32 v26, v26, v36
    v_sub_f32 v27, v27, v36
    v_sub_f32 v176, v176, v36
    v_sub_f32 v177, v177, v36
    v_sub_f32 v178, v178, v36
    v_sub_f32 v179, v179, v36
    v_sub_f32 v180, v180, v36
    v_sub_f32 v181, v181, v36
    v_sub_f32 v182, v182, v36
    v_sub_f32 v183, v183, v36
    v_sub_f32 v184, v184, v36
    v_sub_f32 v185, v185, v36
    v_sub_f32 v186, v186, v36
    v_sub_f32 v187, v187, v36
    v_sub_f32 v188, v188, v36
    v_sub_f32 v189, v189, v36
    v_sub_f32 v190, v190, v36
    v_sub_f32 v191, v191, v36
    v_mul_f32 v3, v37, v3
    v_mul_f32 v224, v37, v224
    v_mul_f32 v225, v37, v225
    v_mul_f32 v226, v37, v226
    v_mul_f32 v227, v37, v227
    v_mul_f32 v228, v37, v228
    v_mul_f32 v229, v37, v229
    v_mul_f32 v230, v37, v230
    v_mul_f32 v231, v37, v231
    v_mul_f32 v232, v37, v232
    v_mul_f32 v233, v37, v233
    v_mul_f32 v234, v37, v234
    v_mul_f32 v235, v37, v235
    v_mul_f32 v236, v37, v236
    v_mul_f32 v237, v37, v237
    v_mul_f32 v238, v37, v238
    v_mul_f32 v239, v37, v239
    v_mul_f32 v240, v37, v240
    v_mul_f32 v241, v37, v241
    v_mul_f32 v242, v37, v242
    v_mul_f32 v243, v37, v243
    v_mul_f32 v244, v37, v244
    v_mul_f32 v245, v37, v245
    v_mul_f32 v246, v37, v246
    v_mul_f32 v247, v37, v247
    v_mul_f32 v248, v37, v248
    v_mul_f32 v249, v37, v249
    v_mul_f32 v250, v37, v250
    v_mul_f32 v251, v37, v251
    v_mul_f32 v252, v37, v252
    v_mul_f32 v253, v37, v253
    v_mul_f32 v254, v37, v254
    v_mul_f32 v255, v37, v255
    s_branch L_A2_exp0
L_A2_slow1:
    ds_read_b128 v[32:35], v8 offset:32768
    ds_read_b128 v[36:39], v8 offset:36864
    ds_read_b128 v[40:43], v8 offset:40960
    ds_read_b128 v[44:47], v8 offset:45056
    ds_read_b128 v[48:51], v9 offset:32768
    ds_read_b128 v[52:55], v9 offset:36864
    ds_read_b128 v[56:59], v9 offset:40960
    s_waitcnt lgkmcnt(6)
    v_mfma_f32_16x16x32_bf16 v[160:163], v[32:35], v[128:131], v[20:23]
    ds_read_b128 v[60:63], v9 offset:45056
    v_mfma_f32_16x16x32_bf16 v[176:179], v[32:35], v[144:147], v[24:27]
    s_waitcnt lgkmcnt(5)
    v_mfma_f32_16x16x32_bf16 v[180:183], v[36:39], v[144:147], v[24:27]
    ds_read_b128 v[32:35], v10 offset:32768
    v_mfma_f32_16x16x32_bf16 v[164:167], v[36:39], v[128:131], v[20:23]
    v_mfma_f32_16x16x32_bf16 v[168:171], v[40:43], v[128:131], v[20:23]
    ds_read_b128 v[36:39], v10 offset:36864
    v_mfma_f32_16x16x32_bf16 v[184:187], v[40:43], v[144:147], v[24:27]
    s_waitcnt lgkmcnt(5)
    v_mfma_f32_16x16x32_bf16 v[188:191], v[44:47], v[144:147], v[24:27]
    ds_read_b128 v[40:43], v10 offset:40960
    v_mfma_f32_16x16x32_bf16 v[172:175], v[44:47], v[128:131], v[20:23]
    v_mfma_f32_16x16x32_bf16 v[160:163], v[48:51], v[132:135], v[160:163]
    ds_read_b128 v[44:47], v10 offset:45056
    v_mfma_f32_16x16x32_bf16 v[176:179], v[48:51], v[148:151], v[176:179]
    s_waitcnt lgkmcnt(5)
    v_mfma_f32_16x16x32_bf16 v[180:183], v[52:55], v[148:151], v[180:183]
    ds_read_b128 v[48:51], v11 offset:32768
    v_mfma_f32_16x16x32_bf16 v[164:167], v[52:55], v[132:135], v[164:167]
    v_mfma_f32_16x16x32_bf16 v[168:171], v[56:59], v[132:135], v[168:171]
    ds_read_b128 v[52:55], v11 offset:36864
    v_mfma_f32_16x16x32_bf16 v[184:187], v[56:59], v[148:151], v[184:187]
    s_waitcnt lgkmcnt(5)
    v_mfma_f32_16x16x32_bf16 v[188:191], v[60:63], v[148:151], v[188:191]
    ds_read_b128 v[56:59], v11 offset:40960
    v_mfma_f32_16x16x32_bf16 v[172:175], v[60:63], v[132:135], v[172:175]
    v_mfma_f32_16x16x32_bf16 v[160:163], v[32:35], v[136:139], v[160:163]
    ds_read_b128 v[60:63], v11 offset:45056
    v_mfma_f32_16x16x32_bf16 v[176:179], v[32:35], v[152:155], v[176:179]
    s_waitcnt lgkmcnt(5)
    v_mfma_f32_16x16x32_bf16 v[180:183], v[36:39], v[152:155], v[180:183]
    v_mfma_f32_16x16x32_bf16 v[164:167], v[36:39], v[136:139], v[164:167]
    v_mfma_f32_16x16x32_bf16 v[168:171], v[40:43], v[136:139], v[168:171]
    v_mfma_f32_16x16x32_bf16 v[184:187], v[40:43], v[152:155], v[184:187]
    s_waitcnt lgkmcnt(3)
    v_mfma_f32_16x16x32_bf16 v[188:191], v[44:47], v[152:155], v[188:191]
    v_mfma_f32_16x16x32_bf16 v[172:175], v[44:47], v[136:139], v[172:175]
    v_mfma_f32_16x16x32_bf16 v[160:163], v[48:51], v[140:143], v[160:163]
    v_mfma_f32_16x16x32_bf16 v[176:179], v[48:51], v[156:159], v[176:179]
    s_waitcnt lgkmcnt(1)
    v_mfma_f32_16x16x32_bf16 v[180:183], v[52:55], v[156:159], v[180:183]
    v_mfma_f32_16x16x32_bf16 v[164:167], v[52:55], v[140:143], v[164:167]
    v_mfma_f32_16x16x32_bf16 v[168:171], v[56:59], v[140:143], v[168:171]
    v_mfma_f32_16x16x32_bf16 v[184:187], v[56:59], v[156:159], v[184:187]
    s_waitcnt lgkmcnt(0)
    v_mfma_f32_16x16x32_bf16 v[188:191], v[60:63], v[156:159], v[188:191]
    v_mfma_f32_16x16x32_bf16 v[172:175], v[60:63], v[140:143], v[172:175]
    s_nop 7
    v_max3_f32 v32, v160, v161, v162
    v_max3_f32 v32, v32, v163, v164
    v_max3_f32 v32, v32, v165, v166
    v_max3_f32 v32, v32, v167, v168
    v_max3_f32 v32, v32, v169, v170
    v_max3_f32 v32, v32, v171, v172
    v_max3_f32 v32, v32, v173, v174
    v_max3_f32 v32, v32, v175, 0
    v_mov_b32 v33, v32
    s_nop 1
    v_permlane32_swap_b32 v32, v33
    s_nop 1
    v_max_f32 v32, v32, v33
    v_mov_b32 v33, v32
    s_nop 1
    v_permlane16_swap_b32 v32, v33
    s_nop 1
    v_max_f32 v32, v32, v33
    v_exp_f32 v33, -v32
    v_sub_f32 v20, v20, v32
    v_sub_f32 v21, v21, v32
    v_sub_f32 v22, v22, v32
    v_sub_f32 v23, v23, v32
    v_sub_f32 v160, v160, v32
    v_sub_f32 v161, v161, v32
    v_sub_f32 v162, v162, v32
    v_sub_f32 v163, v163, v32
    v_sub_f32 v164, v164, v32
    v_sub_f32 v165, v165, v32
    v_sub_f32 v166, v166, v32
    v_sub_f32 v167, v167, v32
    v_sub_f32 v168, v168, v32
    v_sub_f32 v169, v169, v32
    v_sub_f32 v170, v170, v32
    v_sub_f32 v171, v171, v32
    v_sub_f32 v172, v172, v32
    v_sub_f32 v173, v173, v32
    v_sub_f32 v174, v174, v32
    v_sub_f32 v175, v175, v32
    v_mul_f32 v2, v33, v2
    v_mul_f32 v192, v33, v192
    v_mul_f32 v193, v33, v193
    v_mul_f32 v194, v33, v194
    v_mul_f32 v195, v33, v195
    v_mul_f32 v196, v33, v196
    v_mul_f32 v197, v33, v197
    v_mul_f32 v198, v33, v198
    v_mul_f32 v199, v33, v199
    v_mul_f32 v200, v33, v200
    v_mul_f32 v201, v33, v201
    v_mul_f32 v202, v33, v202
    v_mul_f32 v203, v33, v203
    v_mul_f32 v204, v33, v204
    v_mul_f32 v205, v33, v205
    v_mul_f32 v206, v33, v206
    v_mul_f32 v207, v33, v207
    v_mul_f32 v208, v33, v208
    v_mul_f32 v209, v33, v209
    v_mul_f32 v210, v33, v210
    v_mul_f32 v211, v33, v211
    v_mul_f32 v212, v33, v212
    v_mul_f32 v213, v33, v213
    v_mul_f32 v214, v33, v214
    v_mul_f32 v215, v33, v215
    v_mul_f32 v216, v33, v216
    v_mul_f32 v217, v33, v217
    v_mul_f32 v218, v33, v218
    v_mul_f32 v219, v33, v219
    v_mul_f32 v220, v33, v220
    v_mul_f32 v221, v33, v221
    v_mul_f32 v222, v33, v222
    v_mul_f32 v223, v33, v223
    v_max3_f32 v36, v176, v177, v178
    v_max3_f32 v36, v36, v179, v180
    v_max3_f32 v36, v36, v181, v182
    v_max3_f32 v36, v36, v183, v184
    v_max3_f32 v36, v36, v185, v186
    v_max3_f32 v36, v36, v187, v188
    v_max3_f32 v36, v36, v189, v190
    v_max3_f32 v36, v36, v191, 0
    v_mov_b32 v37, v36
    s_nop 1
    v_permlane32_swap_b32 v36, v37
    s_nop 1
    v_max_f32 v36, v36, v37
    v_mov_b32 v37, v36
    s_nop 1
    v_permlane16_swap_b32 v36, v37
    s_nop 1
    v_max_f32 v36, v36, v37
    v_exp_f32 v37, -v36
    v_sub_f32 v24, v24, v36
    v_sub_f32 v25, v25, v36
    v_sub_f32 v26, v26, v36
    v_sub_f32 v27, v27, v36
    v_sub_f32 v176, v176, v36
    v_sub_f32 v177, v177, v36
    v_sub_f32 v178, v178, v36
    v_sub_f32 v179, v179, v36
    v_sub_f32 v180, v180, v36
    v_sub_f32 v181, v181, v36
    v_sub_f32 v182, v182, v36
    v_sub_f32 v183, v183, v36
    v_sub_f32 v184, v184, v36
    v_sub_f32 v185, v185, v36
    v_sub_f32 v186, v186, v36
    v_sub_f32 v187, v187, v36
    v_sub_f32 v188, v188, v36
    v_sub_f32 v189, v189, v36
    v_sub_f32 v190, v190, v36
    v_sub_f32 v191, v191, v36
    v_mul_f32 v3, v37, v3
    v_mul_f32 v224, v37, v224
    v_mul_f32 v225, v37, v225
    v_mul_f32 v226, v37, v226
    v_mul_f32 v227, v37, v227
    v_mul_f32 v228, v37, v228
    v_mul_f32 v229, v37, v229
    v_mul_f32 v230, v37, v230
    v_mul_f32 v231, v37, v231
    v_mul_f32 v232, v37, v232
    v_mul_f32 v233, v37, v233
    v_mul_f32 v234, v37, v234
    v_mul_f32 v235, v37, v235
    v_mul_f32 v236, v37, v236
    v_mul_f32 v237, v37, v237
    v_mul_f32 v238, v37, v238
    v_mul_f32 v239, v37, v239
    v_mul_f32 v240, v37, v240
    v_mul_f32 v241, v37, v241
    v_mul_f32 v242, v37, v242
    v_mul_f32 v243, v37, v243
    v_mul_f32 v244, v37, v244
    v_mul_f32 v245, v37, v245
    v_mul_f32 v246, v37, v246
    v_mul_f32 v247, v37, v247
    v_mul_f32 v248, v37, v248
    v_mul_f32 v249, v37, v249
    v_mul_f32 v250, v37, v250
    v_mul_f32 v251, v37, v251
    v_mul_f32 v252, v37, v252
    v_mul_f32 v253, v37, v253
    v_mul_f32 v254, v37, v254
    v_mul_f32 v255, v37, v255
    s_branch L_A2_exp1
L_A2_tail:
    ds_read_b128 v[128:131], v4 offset:0
    ds_read_b128 v[132:135], v4 offset:1024
    ds_read_b128 v[136:139], v4 offset:2048
    ds_read_b128 v[140:143], v4 offset:3072
    ds_read_b128 v[144:147], v4 offset:4096
    ds_read_b128 v[148:151], v4 offset:5120
    ds_read_b128 v[152:155], v4 offset:6144
    ds_read_b128 v[156:159], v4 offset:7168
    v_pk_mul_f32 v[192:193], v[20:21], v[192:193] op_sel_hi:[0,1]
    v_pk_mul_f32 v[194:195], v[20:21], v[194:195] op_sel_hi:[0,1]
    v_pk_mul_f32 v[196:197], v[20:21], v[196:197] op_sel_hi:[0,1]
    v_pk_mul_f32 v[198:199], v[20:21], v[198:199] op_sel_hi:[0,1]
    v_pk_mul_f32 v[200:201], v[20:21], v[200:201] op_sel_hi:[0,1]
    v_pk_mul_f32 v[202:203], v[20:21], v[202:203] op_sel_hi:[0,1]
    v_pk_mul_f32 v[204:205], v[20:21], v[204:205] op_sel_hi:[0,1]
    v_pk_mul_f32 v[206:207], v[20:21], v[206:207] op_sel_hi:[0,1]
    v_pk_mul_f32 v[208:209], v[20:21], v[208:209] op_sel_hi:[0,1]
    v_pk_mul_f32 v[210:211], v[20:21], v[210:211] op_sel_hi:[0,1]
    v_pk_mul_f32 v[212:213], v[20:21], v[212:213] op_sel_hi:[0,1]
    v_pk_mul_f32 v[214:215], v[20:21], v[214:215] op_sel_hi:[0,1]
    v_pk_mul_f32 v[216:217], v[20:21], v[216:217] op_sel_hi:[0,1]
    v_pk_mul_f32 v[218:219], v[20:21], v[218:219] op_sel_hi:[0,1]
    v_pk_mul_f32 v[220:221], v[20:21], v[220:221] op_sel_hi:[0,1]
    v_pk_mul_f32 v[222:223], v[20:21], v[222:223] op_sel_hi:[0,1]
    v_pk_mul_f32 v[224:225], v[24:25], v[224:225] op_sel_hi:[0,1]
    v_pk_mul_f32 v[226:227], v[24:25], v[226:227] op_sel_hi:[0,1]
    v_pk_mul_f32 v[228:229], v[24:25], v[228:229] op_sel_hi:[0,1]
    v_pk_mul_f32 v[230:231], v[24:25], v[230:231] op_sel_hi:[0,1]
    v_pk_mul_f32 v[232:233], v[24:25], v[232:233] op_sel_hi:[0,1]
    v_pk_mul_f32 v[234:235], v[24:25], v[234:235] op_sel_hi:[0,1]
    v_pk_mul_f32 v[236:237], v[24:25], v[236:237] op_sel_hi:[0,1]
    v_pk_mul_f32 v[238:239], v[24:25], v[238:239] op_sel_hi:[0,1]
    v_pk_mul_f32 v[240:241], v[24:25], v[240:241] op_sel_hi:[0,1]
    v_pk_mul_f32 v[242:243], v[24:25], v[242:243] op_sel_hi:[0,1]
    v_pk_mul_f32 v[244:245], v[24:25], v[244:245] op_sel_hi:[0,1]
    v_pk_mul_f32 v[246:247], v[24:25], v[246:247] op_sel_hi:[0,1]
    v_pk_mul_f32 v[248:249], v[24:25], v[248:249] op_sel_hi:[0,1]
    v_pk_mul_f32 v[250:251], v[24:25], v[250:251] op_sel_hi:[0,1]
    v_pk_mul_f32 v[252:253], v[24:25], v[252:253] op_sel_hi:[0,1]
    v_pk_mul_f32 v[254:255], v[24:25], v[254:255] op_sel_hi:[0,1]
    v_add_u32 v20, 0x10000, v12
    v_add_u32 v21, 0x10000, v13
    v_add_u32 v22, 0x10000, v14
    v_add_u32 v23, 0x10000, v15
    v_add_u32 v24, 0x10000, v16
    v_add_u32 v25, 0x10000, v17
    v_add_u32 v26, 0x10000, v18
    v_add_u32 v27, 0x10000, v19
    s_waitcnt lgkmcnt(0)
    s_setprio 2
    ds_read_b64_tr_b16 v[32:33], v20 offset:0
    ds_read_b64_tr_b16 v[34:35], v20 offset:4096
    ds_read_b64_tr_b16 v[36:37], v21 offset:0
    ds_read_b64_tr_b16 v[38:39], v21 offset:4096
    ds_read_b64_tr_b16 v[40:41], v22 offset:0
    ds_read_b64_tr_b16 v[42:43], v22 offset:4096
    ds_read_b64_tr_b16 v[44:45], v23 offset:0
    ds_read_b64_tr_b16 v[46:47], v23 offset:4096
    ds_read_b64_tr_b16 v[48:49], v20 offset:8192
    ds_read_b64_tr_b16 v[50:51], v20 offset:12288
    ds_read_b64_tr_b16 v[52:53], v21 offset:8192
    ds_read_b64_tr_b16 v[54:55], v21 offset:12288
    ds_read_b64_tr_b16 v[56:57], v22 offset:8192
    ds_read_b64_tr_b16 v[58:59], v22 offset:12288
    v_cvt_pk_bf16_f32 v160, v192, v193
    v_cvt_pk_bf16_f32 v161, v194, v195
    v_cvt_pk_bf16_f32 v162, v196, v197
    v_cvt_pk_bf16_f32 v163, v198, v199
    v_cvt_pk_bf16_f32 v164, v200, v201
    v_cvt_pk_bf16_f32 v165, v202, v203
    v_cvt_pk_bf16_f32 v166, v204, v205
    v_cvt_pk_bf16_f32 v167, v206, v207
    v_cvt_pk_bf16_f32 v168, v208, v209
    v_cvt_pk_bf16_f32 v169, v210, v211
    v_cvt_pk_bf16_f32 v170, v212, v213
    v_cvt_pk_bf16_f32 v171, v214, v215
    v_cvt_pk_bf16_f32 v172, v216, v217
    v_cvt_pk_bf16_f32 v173, v218, v219
    v_cvt_pk_bf16_f32 v174, v220, v221
    v_cvt_pk_bf16_f32 v175, v222, v223
    v_cvt_pk_bf16_f32 v176, v224, v225
    v_cvt_pk_bf16_f32 v177, v226, v227
    v_cvt_pk_bf16_f32 v178, v228, v229
    v_cvt_pk_bf16_f32 v179, v230, v231
    v_cvt_pk_bf16_f32 v180, v232, v233
    v_cvt_pk_bf16_f32 v181, v234, v235
    v_cvt_pk_bf16_f32 v182, v236, v237
    v_cvt_pk_bf16_f32 v183, v238, v239
    v_cvt_pk_bf16_f32 v184, v240, v241
    v_cvt_pk_bf16_f32 v185, v242, v243
    v_cvt_pk_bf16_f32 v186, v244, v245
    v_cvt_pk_bf16_f32 v187, v246, v247
    v_cvt_pk_bf16_f32 v188, v248, v249
    v_cvt_pk_bf16_f32 v189, v250, v251
    v_cvt_pk_bf16_f32 v190, v252, v253
    v_cvt_pk_bf16_f32 v191, v254, v255
    v_lshl_add_u32 v2, v0, 4, s79
    v_mov_b32 v3, 0x80000000
    s_mov_b32 s84, s80
    s_lshl_b32 s75, s80, 14
    s_mov_b32 s83, 0
    s_mov_b32 s88, 0
    s_mov_b32 s81, 4
.p2align 3
L_A2_op:
    s_waitcnt lgkmcnt(12)
    v_mfma_f32_16x16x32_bf16 v[192:195], v[32:35], v[64:67], 0
    ds_read_b64_tr_b16 v[60:61], v23 offset:8192
    v_mfma_f32_16x16x32_bf16 v[208:211], v[32:35], v[80:83], 0
    ds_read_b64_tr_b16 v[62:63], v23 offset:12288
    s_waitcnt lgkmcnt(10)
    v_mfma_f32_16x16x32_bf16 v[212:215], v[36:39], v[80:83], 0
    ds_read_b64_tr_b16 v[32:33], v24 offset:0
    v_mfma_f32_16x16x32_bf16 v[196:199], v[36:39], v[64:67], 0
    ds_read_b64_tr_b16 v[34:35], v24 offset:4096
    v_mfma_f32_16x16x32_bf16 v[200:203], v[40:43], v[64:67], 0
    ds_read_b64_tr_b16 v[36:37], v25 offset:0
    v_mfma_f32_16x16x32_bf16 v[216:219], v[40:43], v[80:83], 0
    ds_read_b64_tr_b16 v[38:39], v25 offset:4096
    s_waitcnt lgkmcnt(10)
    v_mfma_f32_16x16x32_bf16 v[220:223], v[44:47], v[80:83], 0
    ds_read_b64_tr_b16 v[40:41], v26 offset:0
    v_mfma_f32_16x16x32_bf16 v[204:207], v[44:47], v[64:67], 0
    ds_read_b64_tr_b16 v[42:43], v26 offset:4096
    v_cvt_pk_bf16_f32 v10, v224, v225
    v_cvt_pk_bf16_f32 v11, v226, v227
    v_mfma_f32_16x16x32_bf16 v[192:195], v[48:51], v[68:71], v[192:195]
    ds_read_b64_tr_b16 v[44:45], v27 offset:0
    v_mfma_f32_16x16x32_bf16 v[208:211], v[48:51], v[84:87], v[208:211]
    ds_read_b64_tr_b16 v[46:47], v27 offset:4096
    v_cvt_pk_bf16_f32 v8, v228, v229
    v_cvt_pk_bf16_f32 v9, v230, v231
    s_waitcnt lgkmcnt(10)
    v_mfma_f32_16x16x32_bf16 v[212:215], v[52:55], v[84:87], v[212:215]
    ds_read_b64_tr_b16 v[48:49], v24 offset:8192
    v_mfma_f32_16x16x32_bf16 v[196:199], v[52:55], v[68:71], v[196:199]
    ds_read_b64_tr_b16 v[50:51], v24 offset:12288
    buffer_store_dwordx4 v[8:11], v3, s[56:59], s83 offen offset:0 sc1
    v_mfma_f32_16x16x32_bf16 v[200:203], v[56:59], v[68:71], v[200:203]
    ds_read_b64_tr_b16 v[52:53], v25 offset:8192
    v_mfma_f32_16x16x32_bf16 v[216:219], v[56:59], v[84:87], v[216:219]
    ds_read_b64_tr_b16 v[54:55], v25 offset:12288
    v_cvt_pk_bf16_f32 v30, v232, v233
    v_cvt_pk_bf16_f32 v31, v234, v235
    s_waitcnt lgkmcnt(10)
    v_mfma_f32_16x16x32_bf16 v[220:223], v[60:63], v[84:87], v[220:223]
    ds_read_b64_tr_b16 v[56:57], v26 offset:8192
    v_mfma_f32_16x16x32_bf16 v[204:207], v[60:63], v[68:71], v[204:207]
    ds_read_b64_tr_b16 v[58:59], v26 offset:12288
    v_cvt_pk_bf16_f32 v28, v236, v237
    v_cvt_pk_bf16_f32 v29, v238, v239
    v_mfma_f32_16x16x32_bf16 v[192:195], v[32:35], v[72:75], v[192:195]
    ds_read_b64_tr_b16 v[60:61], v27 offset:8192
    v_mfma_f32_16x16x32_bf16 v[208:211], v[32:35], v[88:91], v[208:211]
    ds_read_b64_tr_b16 v[62:63], v27 offset:12288
    buffer_store_dwordx4 v[28:31], v3, s[56:59], s83 offen offset:1024 sc1
    s_waitcnt lgkmcnt(10)
    v_mfma_f32_16x16x32_bf16 v[212:215], v[36:39], v[88:91], v[212:215]
    ds_read_b64_tr_b16 v[32:33], v20 offset:16384
    v_mfma_f32_16x16x32_bf16 v[196:199], v[36:39], v[72:75], v[196:199]
    ds_read_b64_tr_b16 v[34:35], v20 offset:20480
    v_cvt_pk_bf16_f32 v10, v240, v241
    v_cvt_pk_bf16_f32 v11, v242, v243
    v_mfma_f32_16x16x32_bf16 v[200:203], v[40:43], v[72:75], v[200:203]
    ds_read_b64_tr_b16 v[36:37], v21 offset:16384
    v_mfma_f32_16x16x32_bf16 v[216:219], v[40:43], v[88:91], v[216:219]
    ds_read_b64_tr_b16 v[38:39], v21 offset:20480
    v_cvt_pk_bf16_f32 v8, v244, v245
    v_cvt_pk_bf16_f32 v9, v246, v247
    s_waitcnt lgkmcnt(10)
    v_mfma_f32_16x16x32_bf16 v[220:223], v[44:47], v[88:91], v[220:223]
    ds_read_b64_tr_b16 v[40:41], v22 offset:16384
    v_mfma_f32_16x16x32_bf16 v[204:207], v[44:47], v[72:75], v[204:207]
    ds_read_b64_tr_b16 v[42:43], v22 offset:20480
    buffer_store_dwordx4 v[8:11], v3, s[56:59], s83 offen offset:2048 sc1
    v_mfma_f32_16x16x32_bf16 v[192:195], v[48:51], v[76:79], v[192:195]
    ds_read_b64_tr_b16 v[44:45], v23 offset:16384
    v_mfma_f32_16x16x32_bf16 v[208:211], v[48:51], v[92:95], v[208:211]
    ds_read_b64_tr_b16 v[46:47], v23 offset:20480
    v_cvt_pk_bf16_f32 v30, v248, v249
    v_cvt_pk_bf16_f32 v31, v250, v251
    s_waitcnt lgkmcnt(10)
    v_mfma_f32_16x16x32_bf16 v[212:215], v[52:55], v[92:95], v[212:215]
    ds_read_b64_tr_b16 v[48:49], v20 offset:24576
    v_mfma_f32_16x16x32_bf16 v[196:199], v[52:55], v[76:79], v[196:199]
    ds_read_b64_tr_b16 v[50:51], v20 offset:28672
    v_cvt_pk_bf16_f32 v28, v252, v253
    v_cvt_pk_bf16_f32 v29, v254, v255
    v_mfma_f32_16x16x32_bf16 v[200:203], v[56:59], v[76:79], v[200:203]
    ds_read_b64_tr_b16 v[52:53], v21 offset:24576
    v_mfma_f32_16x16x32_bf16 v[216:219], v[56:59], v[92:95], v[216:219]
    ds_read_b64_tr_b16 v[54:55], v21 offset:28672
    buffer_store_dwordx4 v[28:31], v3, s[56:59], s83 offen offset:3072 sc1
    s_waitcnt lgkmcnt(10)
    v_mfma_f32_16x16x32_bf16 v[220:223], v[60:63], v[92:95], v[220:223]
    ds_read_b64_tr_b16 v[56:57], v22 offset:24576
    v_mfma_f32_16x16x32_bf16 v[204:207], v[60:63], v[76:79], v[204:207]
    ds_read_b64_tr_b16 v[58:59], v22 offset:28672
    s_barrier
    v_mfma_f32_16x16x32_bf16 v[192:195], v[32:35], v[96:99], v[192:195]
    ds_read_b64_tr_b16 v[60:61], v23 offset:24576
    v_mfma_f32_16x16x32_bf16 v[208:211], v[32:35], v[112:115], v[208:211]
    ds_read_b64_tr_b16 v[62:63], v23 offset:28672
    s_waitcnt lgkmcnt(10)
    v_mfma_f32_16x16x32_bf16 v[212:215], v[36:39], v[112:115], v[212:215]
    ds_read_b64_tr_b16 v[32:33], v24 offset:16384
    v_mfma_f32_16x16x32_bf16 v[196:199], v[36:39], v[96:99], v[196:199]
    ds_read_b64_tr_b16 v[34:35], v24 offset:20480
    v_mfma_f32_16x16x32_bf16 v[200:203], v[40:43], v[96:99], v[200:203]
    ds_read_b64_tr_b16 v[36:37], v25 offset:16384
    v_mfma_f32_16x16x32_bf16 v[216:219], v[40:43], v[112:115], v[216:219]
    ds_read_b64_tr_b16 v[38:39], v25 offset:20480
    s_waitcnt lgkmcnt(10)
    v_mfma_f32_16x16x32_bf16 v[220:223], v[44:47], v[112:115], v[220:223]
    ds_read_b64_tr_b16 v[40:41], v26 offset:16384
    v_mfma_f32_16x16x32_bf16 v[204:207], v[44:47], v[96:99], v[204:207]
    ds_read_b64_tr_b16 v[42:43], v26 offset:20480
    v_mfma_f32_16x16x32_bf16 v[192:195], v[48:51], v[100:103], v[192:195]
    ds_read_b64_tr_b16 v[44:45], v27 offset:16384
    v_mfma_f32_16x16x32_bf16 v[208:211], v[48:51], v[116:119], v[208:211]
    ds_read_b64_tr_b16 v[46:47], v27 offset:20480
    s_add_u32 s84, s84, 1
    s_waitcnt lgkmcnt(10)
    v_mfma_f32_16x16x32_bf16 v[212:215], v[52:55], v[116:119], v[212:215]
    ds_read_b64_tr_b16 v[48:49], v24 offset:24576
    v_mfma_f32_16x16x32_bf16 v[196:199], v[52:55], v[100:103], v[196:199]
    ds_read_b64_tr_b16 v[50:51], v24 offset:28672
    s_and_b32 s84, s84, 7
    v_mfma_f32_16x16x32_bf16 v[200:203], v[56:59], v[100:103], v[200:203]
    ds_read_b64_tr_b16 v[52:53], v25 offset:24576
    v_mfma_f32_16x16x32_bf16 v[216:219], v[56:59], v[116:119], v[216:219]
    ds_read_b64_tr_b16 v[54:55], v25 offset:28672
    s_lshl_b32 s83, s84, 17
    s_waitcnt lgkmcnt(10)
    v_mfma_f32_16x16x32_bf16 v[220:223], v[60:63], v[116:119], v[220:223]
    ds_read_b64_tr_b16 v[56:57], v26 offset:24576
    v_mfma_f32_16x16x32_bf16 v[204:207], v[60:63], v[100:103], v[204:207]
    ds_read_b64_tr_b16 v[58:59], v26 offset:28672
    s_add_u32 s83, s83, s75
    v_mfma_f32_16x16x32_bf16 v[192:195], v[32:35], v[104:107], v[192:195]
    ds_read_b64_tr_b16 v[60:61], v27 offset:24576
    v_mfma_f32_16x16x32_bf16 v[208:211], v[32:35], v[120:123], v[208:211]
    ds_read_b64_tr_b16 v[62:63], v27 offset:28672
    s_waitcnt lgkmcnt(10)
    v_mfma_f32_16x16x32_bf16 v[212:215], v[36:39], v[120:123], v[212:215]
    ds_read_b64_tr_b16 v[32:33], v20 offset:32768
    v_mfma_f32_16x16x32_bf16 v[196:199], v[36:39], v[104:107], v[196:199]
    ds_read_b64_tr_b16 v[34:35], v20 offset:36864
    v_mfma_f32_16x16x32_bf16 v[200:203], v[40:43], v[104:107], v[200:203]
    ds_read_b64_tr_b16 v[36:37], v21 offset:32768
    v_mfma_f32_16x16x32_bf16 v[216:219], v[40:43], v[120:123], v[216:219]
    ds_read_b64_tr_b16 v[38:39], v21 offset:36864
    v_mov_b32 v3, v2
    s_waitcnt lgkmcnt(10)
    v_mfma_f32_16x16x32_bf16 v[220:223], v[44:47], v[120:123], v[220:223]
    ds_read_b64_tr_b16 v[40:41], v22 offset:32768
    v_mfma_f32_16x16x32_bf16 v[204:207], v[44:47], v[104:107], v[204:207]
    ds_read_b64_tr_b16 v[42:43], v22 offset:36864
    v_mfma_f32_16x16x32_bf16 v[192:195], v[48:51], v[108:111], v[192:195]
    ds_read_b64_tr_b16 v[44:45], v23 offset:32768
    v_mfma_f32_16x16x32_bf16 v[208:211], v[48:51], v[124:127], v[208:211]
    ds_read_b64_tr_b16 v[46:47], v23 offset:36864
    s_waitcnt lgkmcnt(10)
    v_mfma_f32_16x16x32_bf16 v[212:215], v[52:55], v[124:127], v[212:215]
    ds_read_b64_tr_b16 v[48:49], v20 offset:40960
    v_mfma_f32_16x16x32_bf16 v[196:199], v[52:55], v[108:111], v[196:199]
    ds_read_b64_tr_b16 v[50:51], v20 offset:45056
    v_mfma_f32_16x16x32_bf16 v[200:203], v[56:59], v[108:111], v[200:203]
    ds_read_b64_tr_b16 v[52:53], v21 offset:40960
    v_mfma_f32_16x16x32_bf16 v[216:219], v[56:59], v[124:127], v[216:219]
    ds_read_b64_tr_b16 v[54:55], v21 offset:45056
    s_waitcnt lgkmcnt(10)
    v_mfma_f32_16x16x32_bf16 v[220:223], v[60:63], v[124:127], v[220:223]
    ds_read_b64_tr_b16 v[56:57], v22 offset:40960
    v_mfma_f32_16x16x32_bf16 v[204:207], v[60:63], v[108:111], v[204:207]
    ds_read_b64_tr_b16 v[58:59], v22 offset:45056
    s_barrier
    v_mfma_f32_16x16x32_bf16 v[192:195], v[32:35], v[128:131], v[192:195]
    ds_read_b64_tr_b16 v[60:61], v23 offset:40960
    v_mfma_f32_16x16x32_bf16 v[208:211], v[32:35], v[144:147], v[208:211]
    ds_read_b64_tr_b16 v[62:63], v23 offset:45056
    s_waitcnt lgkmcnt(10)
    v_mfma_f32_16x16x32_bf16 v[212:215], v[36:39], v[144:147], v[212:215]
    ds_read_b64_tr_b16 v[32:33], v24 offset:32768
    v_mfma_f32_16x16x32_bf16 v[196:199], v[36:39], v[128:131], v[196:199]
    ds_read_b64_tr_b16 v[34:35], v24 offset:36864
    v_mfma_f32_16x16x32_bf16 v[200:203], v[40:43], v[128:131], v[200:203]
    ds_read_b64_tr_b16 v[36:37], v25 offset:32768
    v_mfma_f32_16x16x32_bf16 v[216:219], v[40:43], v[144:147], v[216:219]
    ds_read_b64_tr_b16 v[38:39], v25 offset:36864
    s_waitcnt lgkmcnt(10)
    v_mfma_f32_16x16x32_bf16 v[220:223], v[44:47], v[144:147], v[220:223]
    ds_read_b64_tr_b16 v[40:41], v26 offset:32768
    v_mfma_f32_16x16x32_bf16 v[204:207], v[44:47], v[128:131], v[204:207]
    ds_read_b64_tr_b16 v[42:43], v26 offset:36864
    v_mfma_f32_16x16x32_bf16 v[192:195], v[48:51], v[132:135], v[192:195]
    ds_read_b64_tr_b16 v[44:45], v27 offset:32768
    v_mfma_f32_16x16x32_bf16 v[208:211], v[48:51], v[148:151], v[208:211]
    ds_read_b64_tr_b16 v[46:47], v27 offset:36864
    s_waitcnt lgkmcnt(10)
    v_mfma_f32_16x16x32_bf16 v[212:215], v[52:55], v[148:151], v[212:215]
    ds_read_b64_tr_b16 v[48:49], v24 offset:40960
    v_mfma_f32_16x16x32_bf16 v[196:199], v[52:55], v[132:135], v[196:199]
    ds_read_b64_tr_b16 v[50:51], v24 offset:45056
    v_mfma_f32_16x16x32_bf16 v[200:203], v[56:59], v[132:135], v[200:203]
    ds_read_b64_tr_b16 v[52:53], v25 offset:40960
    v_mfma_f32_16x16x32_bf16 v[216:219], v[56:59], v[148:151], v[216:219]
    ds_read_b64_tr_b16 v[54:55], v25 offset:45056
    s_waitcnt lgkmcnt(10)
    v_mfma_f32_16x16x32_bf16 v[220:223], v[60:63], v[148:151], v[220:223]
    ds_read_b64_tr_b16 v[56:57], v26 offset:40960
    v_mfma_f32_16x16x32_bf16 v[204:207], v[60:63], v[132:135], v[204:207]
    ds_read_b64_tr_b16 v[58:59], v26 offset:45056
    v_mfma_f32_16x16x32_bf16 v[192:195], v[32:35], v[136:139], v[192:195]
    ds_read_b64_tr_b16 v[60:61], v27 offset:40960
    v_mfma_f32_16x16x32_bf16 v[208:211], v[32:35], v[152:155], v[208:211]
    ds_read_b64_tr_b16 v[62:63], v27 offset:45056
    s_waitcnt lgkmcnt(10)
    v_mfma_f32_16x16x32_bf16 v[212:215], v[36:39], v[152:155], v[212:215]
    ds_read_b64_tr_b16 v[32:33], v20 offset:49152
    v_mfma_f32_16x16x32_bf16 v[196:199], v[36:39], v[136:139], v[196:199]
    ds_read_b64_tr_b16 v[34:35], v20 offset:53248
    v_mfma_f32_16x16x32_bf16 v[200:203], v[40:43], v[136:139], v[200:203]
    ds_read_b64_tr_b16 v[36:37], v21 offset:49152
    v_mfma_f32_16x16x32_bf16 v[216:219], v[40:43], v[152:155], v[216:219]
    ds_read_b64_tr_b16 v[38:39], v21 offset:53248
    s_waitcnt lgkmcnt(10)
    v_mfma_f32_16x16x32_bf16 v[220:223], v[44:47], v[152:155], v[220:223]
    ds_read_b64_tr_b16 v[40:41], v22 offset:49152
    v_mfma_f32_16x16x32_bf16 v[204:207], v[44:47], v[136:139], v[204:207]
    ds_read_b64_tr_b16 v[42:43], v22 offset:53248
    v_mfma_f32_16x16x32_bf16 v[192:195], v[48:51], v[140:143], v[192:195]
    ds_read_b64_tr_b16 v[44:45], v23 offset:49152
    v_mfma_f32_16x16x32_bf16 v[208:211], v[48:51], v[156:159], v[208:211]
    ds_read_b64_tr_b16 v[46:47], v23 offset:53248
    s_waitcnt lgkmcnt(10)
    v_mfma_f32_16x16x32_bf16 v[212:215], v[52:55], v[156:159], v[212:215]
    ds_read_b64_tr_b16 v[48:49], v20 offset:57344
    v_mfma_f32_16x16x32_bf16 v[196:199], v[52:55], v[140:143], v[196:199]
    ds_read_b64_tr_b16 v[50:51], v20 offset:61440
    v_mfma_f32_16x16x32_bf16 v[200:203], v[56:59], v[140:143], v[200:203]
    ds_read_b64_tr_b16 v[52:53], v21 offset:57344
    v_mfma_f32_16x16x32_bf16 v[216:219], v[56:59], v[156:159], v[216:219]
    ds_read_b64_tr_b16 v[54:55], v21 offset:61440
    s_waitcnt lgkmcnt(10)
    v_mfma_f32_16x16x32_bf16 v[220:223], v[60:63], v[156:159], v[220:223]
    ds_read_b64_tr_b16 v[56:57], v22 offset:57344
    v_mfma_f32_16x16x32_bf16 v[204:207], v[60:63], v[140:143], v[204:207]
    ds_read_b64_tr_b16 v[58:59], v22 offset:61440
    s_waitcnt vmcnt(0)
    s_barrier
    v_mfma_f32_16x16x32_bf16 v[192:195], v[32:35], v[160:163], v[192:195]
    ds_read_b64_tr_b16 v[60:61], v23 offset:57344
    v_mfma_f32_16x16x32_bf16 v[208:211], v[32:35], v[176:179], v[208:211]
    ds_read_b64_tr_b16 v[62:63], v23 offset:61440
    s_waitcnt lgkmcnt(10)
    v_mfma_f32_16x16x32_bf16 v[212:215], v[36:39], v[176:179], v[212:215]
    ds_read_b64_tr_b16 v[32:33], v24 offset:49152
    v_mfma_f32_16x16x32_bf16 v[196:199], v[36:39], v[160:163], v[196:199]
    ds_read_b64_tr_b16 v[34:35], v24 offset:53248
    v_mfma_f32_16x16x32_bf16 v[200:203], v[40:43], v[160:163], v[200:203]
    ds_read_b64_tr_b16 v[36:37], v25 offset:49152
    v_mfma_f32_16x16x32_bf16 v[216:219], v[40:43], v[176:179], v[216:219]
    ds_read_b64_tr_b16 v[38:39], v25 offset:53248
    s_waitcnt lgkmcnt(10)
    v_mfma_f32_16x16x32_bf16 v[220:223], v[44:47], v[176:179], v[220:223]
    ds_read_b64_tr_b16 v[40:41], v26 offset:49152
    v_mfma_f32_16x16x32_bf16 v[204:207], v[44:47], v[160:163], v[204:207]
    ds_read_b64_tr_b16 v[42:43], v26 offset:53248
    v_mfma_f32_16x16x32_bf16 v[192:195], v[48:51], v[164:167], v[192:195]
    ds_read_b64_tr_b16 v[44:45], v27 offset:49152
    v_mfma_f32_16x16x32_bf16 v[208:211], v[48:51], v[180:183], v[208:211]
    ds_read_b64_tr_b16 v[46:47], v27 offset:53248
    s_waitcnt lgkmcnt(10)
    v_mfma_f32_16x16x32_bf16 v[212:215], v[52:55], v[180:183], v[212:215]
    ds_read_b64_tr_b16 v[48:49], v24 offset:57344
    v_mfma_f32_16x16x32_bf16 v[196:199], v[52:55], v[164:167], v[196:199]
    ds_read_b64_tr_b16 v[50:51], v24 offset:61440
    v_mfma_f32_16x16x32_bf16 v[200:203], v[56:59], v[164:167], v[200:203]
    ds_read_b64_tr_b16 v[52:53], v25 offset:57344
    v_mfma_f32_16x16x32_bf16 v[216:219], v[56:59], v[180:183], v[216:219]
    ds_read_b64_tr_b16 v[54:55], v25 offset:61440
    s_waitcnt lgkmcnt(10)
    v_mfma_f32_16x16x32_bf16 v[220:223], v[60:63], v[180:183], v[220:223]
    ds_read_b64_tr_b16 v[56:57], v26 offset:57344
    v_mfma_f32_16x16x32_bf16 v[204:207], v[60:63], v[164:167], v[204:207]
    ds_read_b64_tr_b16 v[58:59], v26 offset:61440
    v_mfma_f32_16x16x32_bf16 v[192:195], v[32:35], v[168:171], v[192:195]
    ds_read_b64_tr_b16 v[60:61], v27 offset:57344
    v_mfma_f32_16x16x32_bf16 v[208:211], v[32:35], v[184:187], v[208:211]
    ds_read_b64_tr_b16 v[62:63], v27 offset:61440
    s_waitcnt lgkmcnt(10)
    v_mfma_f32_16x16x32_bf16 v[212:215], v[36:39], v[184:187], v[212:215]
    ds_read_b64_tr_b16 v[32:33], v12 offset:0
    v_mfma_f32_16x16x32_bf16 v[196:199], v[36:39], v[168:171], v[196:199]
    ds_read_b64_tr_b16 v[34:35], v12 offset:4096
    v_mfma_f32_16x16x32_bf16 v[200:203], v[40:43], v[168:171], v[200:203]
    ds_read_b64_tr_b16 v[36:37], v13 offset:0
    v_mfma_f32_16x16x32_bf16 v[216:219], v[40:43], v[184:187], v[216:219]
    ds_read_b64_tr_b16 v[38:39], v13 offset:4096
    s_waitcnt lgkmcnt(10)
    v_mfma_f32_16x16x32_bf16 v[220:223], v[44:47], v[184:187], v[220:223]
    ds_read_b64_tr_b16 v[40:41], v14 offset:0
    v_mfma_f32_16x16x32_bf16 v[204:207], v[44:47], v[168:171], v[204:207]
    ds_read_b64_tr_b16 v[42:43], v14 offset:4096
    v_mfma_f32_16x16x32_bf16 v[192:195], v[48:51], v[172:175], v[192:195]
    ds_read_b64_tr_b16 v[44:45], v15 offset:0
    v_mfma_f32_16x16x32_bf16 v[208:211], v[48:51], v[188:191], v[208:211]
    ds_read_b64_tr_b16 v[46:47], v15 offset:4096
    s_waitcnt lgkmcnt(10)
    v_mfma_f32_16x16x32_bf16 v[212:215], v[52:55], v[188:191], v[212:215]
    ds_read_b64_tr_b16 v[48:49], v12 offset:8192
    v_mfma_f32_16x16x32_bf16 v[196:199], v[52:55], v[172:175], v[196:199]
    ds_read_b64_tr_b16 v[50:51], v12 offset:12288
    v_mfma_f32_16x16x32_bf16 v[200:203], v[56:59], v[172:175], v[200:203]
    ds_read_b64_tr_b16 v[52:53], v13 offset:8192
    v_mfma_f32_16x16x32_bf16 v[216:219], v[56:59], v[188:191], v[216:219]
    ds_read_b64_tr_b16 v[54:55], v13 offset:12288
    s_waitcnt lgkmcnt(10)
    v_mfma_f32_16x16x32_bf16 v[220:223], v[60:63], v[188:191], v[220:223]
    ds_read_b64_tr_b16 v[56:57], v14 offset:8192
    v_mfma_f32_16x16x32_bf16 v[204:207], v[60:63], v[172:175], v[204:207]
    ds_read_b64_tr_b16 v[58:59], v14 offset:12288
    s_barrier
    v_mfma_f32_16x16x32_bf16 v[224:227], v[32:35], v[64:67], 0
    ds_read_b64_tr_b16 v[60:61], v15 offset:8192
    v_mfma_f32_16x16x32_bf16 v[240:243], v[32:35], v[80:83], 0
    ds_read_b64_tr_b16 v[62:63], v15 offset:12288
    s_waitcnt lgkmcnt(10)
    v_mfma_f32_16x16x32_bf16 v[244:247], v[36:39], v[80:83], 0
    ds_read_b64_tr_b16 v[32:33], v16 offset:0
    v_mfma_f32_16x16x32_bf16 v[228:231], v[36:39], v[64:67], 0
    ds_read_b64_tr_b16 v[34:35], v16 offset:4096
    v_mfma_f32_16x16x32_bf16 v[232:235], v[40:43], v[64:67], 0
    ds_read_b64_tr_b16 v[36:37], v17 offset:0
    v_mfma_f32_16x16x32_bf16 v[248:251], v[40:43], v[80:83], 0
    ds_read_b64_tr_b16 v[38:39], v17 offset:4096
    s_waitcnt lgkmcnt(10)
    v_mfma_f32_16x16x32_bf16 v[252:255], v[44:47], v[80:83], 0
    ds_read_b64_tr_b16 v[40:41], v18 offset:0
    v_mfma_f32_16x16x32_bf16 v[236:239], v[44:47], v[64:67], 0
    ds_read_b64_tr_b16 v[42:43], v18 offset:4096
    v_cvt_pk_bf16_f32 v8, v192, v193
    v_cvt_pk_bf16_f32 v9, v194, v195
    v_mfma_f32_16x16x32_bf16 v[224:227], v[48:51], v[68:71], v[224:227]
    ds_read_b64_tr_b16 v[44:45], v19 offset:0
    v_mfma_f32_16x16x32_bf16 v[240:243], v[48:51], v[84:87], v[240:243]
    ds_read_b64_tr_b16 v[46:47], v19 offset:4096
    v_cvt_pk_bf16_f32 v10, v196, v197
    v_cvt_pk_bf16_f32 v11, v198, v199
    s_waitcnt lgkmcnt(10)
    v_mfma_f32_16x16x32_bf16 v[244:247], v[52:55], v[84:87], v[244:247]
    ds_read_b64_tr_b16 v[48:49], v16 offset:8192
    v_mfma_f32_16x16x32_bf16 v[228:231], v[52:55], v[68:71], v[228:231]
    ds_read_b64_tr_b16 v[50:51], v16 offset:12288
    buffer_store_dwordx4 v[8:11], v2, s[56:59], s83 offen offset:0 sc1
    v_mfma_f32_16x16x32_bf16 v[232:235], v[56:59], v[68:71], v[232:235]
    ds_read_b64_tr_b16 v[52:53], v17 offset:8192
    v_mfma_f32_16x16x32_bf16 v[248:251], v[56:59], v[84:87], v[248:251]
    ds_read_b64_tr_b16 v[54:55], v17 offset:12288
    v_cvt_pk_bf16_f32 v28, v200, v201
    v_cvt_pk_bf16_f32 v29, v202, v203
    s_waitcnt lgkmcnt(10)
    v_mfma_f32_16x16x32_bf16 v[252:255], v[60:63], v[84:87], v[252:255]
    ds_read_b64_tr_b16 v[56:57], v18 offset:8192
    v_mfma_f32_16x16x32_bf16 v[236:239], v[60:63], v[68:71], v[236:239]
    ds_read_b64_tr_b16 v[58:59], v18 offset:12288
    v_cvt_pk_bf16_f32 v30, v204, v205
    v_cvt_pk_bf16_f32 v31, v206, v207
    v_mfma_f32_16x16x32_bf16 v[224:227], v[32:35], v[72:75], v[224:227]
    ds_read_b64_tr_b16 v[60:61], v19 offset:8192
    v_mfma_f32_16x16x32_bf16 v[240:243], v[32:35], v[88:91], v[240:243]
    ds_read_b64_tr_b16 v[62:63], v19 offset:12288
    buffer_store_dwordx4 v[28:31], v2, s[56:59], s83 offen offset:1024 sc1
    s_waitcnt lgkmcnt(10)
    v_mfma_f32_16x16x32_bf16 v[244:247], v[36:39], v[88:91], v[244:247]
    ds_read_b64_tr_b16 v[32:33], v12 offset:16384
    v_mfma_f32_16x16x32_bf16 v[228:231], v[36:39], v[72:75], v[228:231]
    ds_read_b64_tr_b16 v[34:35], v12 offset:20480
    v_cvt_pk_bf16_f32 v8, v208, v209
    v_cvt_pk_bf16_f32 v9, v210, v211
    v_mfma_f32_16x16x32_bf16 v[232:235], v[40:43], v[72:75], v[232:235]
    ds_read_b64_tr_b16 v[36:37], v13 offset:16384
    v_mfma_f32_16x16x32_bf16 v[248:251], v[40:43], v[88:91], v[248:251]
    ds_read_b64_tr_b16 v[38:39], v13 offset:20480
    v_cvt_pk_bf16_f32 v10, v212, v213
    v_cvt_pk_bf16_f32 v11, v214, v215
    s_waitcnt lgkmcnt(10)
    v_mfma_f32_16x16x32_bf16 v[252:255], v[44:47], v[88:91], v[252:255]
    ds_read_b64_tr_b16 v[40:41], v14 offset:16384
    v_mfma_f32_16x16x32_bf16 v[236:239], v[44:47], v[72:75], v[236:239]
    ds_read_b64_tr_b16 v[42:43], v14 offset:20480
    buffer_store_dwordx4 v[8:11], v2, s[56:59], s83 offen offset:2048 sc1
    v_mfma_f32_16x16x32_bf16 v[224:227], v[48:51], v[76:79], v[224:227]
    ds_read_b64_tr_b16 v[44:45], v15 offset:16384
    v_mfma_f32_16x16x32_bf16 v[240:243], v[48:51], v[92:95], v[240:243]
    ds_read_b64_tr_b16 v[46:47], v15 offset:20480
    v_cvt_pk_bf16_f32 v28, v216, v217
    v_cvt_pk_bf16_f32 v29, v218, v219
    s_waitcnt lgkmcnt(10)
    v_mfma_f32_16x16x32_bf16 v[244:247], v[52:55], v[92:95], v[244:247]
    ds_read_b64_tr_b16 v[48:49], v12 offset:24576
    v_mfma_f32_16x16x32_bf16 v[228:231], v[52:55], v[76:79], v[228:231]
    ds_read_b64_tr_b16 v[50:51], v12 offset:28672
    v_cvt_pk_bf16_f32 v30, v220, v221
    v_cvt_pk_bf16_f32 v31, v222, v223
    v_mfma_f32_16x16x32_bf16 v[232:235], v[56:59], v[76:79], v[232:235]
    ds_read_b64_tr_b16 v[52:53], v13 offset:24576
    v_mfma_f32_16x16x32_bf16 v[248:251], v[56:59], v[92:95], v[248:251]
    ds_read_b64_tr_b16 v[54:55], v13 offset:28672
    buffer_store_dwordx4 v[28:31], v2, s[56:59], s83 offen offset:3072 sc1
    s_waitcnt lgkmcnt(10)
    v_mfma_f32_16x16x32_bf16 v[252:255], v[60:63], v[92:95], v[252:255]
    ds_read_b64_tr_b16 v[56:57], v14 offset:24576
    v_mfma_f32_16x16x32_bf16 v[236:239], v[60:63], v[76:79], v[236:239]
    ds_read_b64_tr_b16 v[58:59], v14 offset:28672
    s_barrier
    v_mfma_f32_16x16x32_bf16 v[224:227], v[32:35], v[96:99], v[224:227]
    ds_read_b64_tr_b16 v[60:61], v15 offset:24576
    v_mfma_f32_16x16x32_bf16 v[240:243], v[32:35], v[112:115], v[240:243]
    ds_read_b64_tr_b16 v[62:63], v15 offset:28672
    s_waitcnt lgkmcnt(10)
    v_mfma_f32_16x16x32_bf16 v[244:247], v[36:39], v[112:115], v[244:247]
    ds_read_b64_tr_b16 v[32:33], v16 offset:16384
    v_mfma_f32_16x16x32_bf16 v[228:231], v[36:39], v[96:99], v[228:231]
    ds_read_b64_tr_b16 v[34:35], v16 offset:20480
    v_mfma_f32_16x16x32_bf16 v[232:235], v[40:43], v[96:99], v[232:235]
    ds_read_b64_tr_b16 v[36:37], v17 offset:16384
    v_mfma_f32_16x16x32_bf16 v[248:251], v[40:43], v[112:115], v[248:251]
    ds_read_b64_tr_b16 v[38:39], v17 offset:20480
    s_waitcnt lgkmcnt(10)
    v_mfma_f32_16x16x32_bf16 v[252:255], v[44:47], v[112:115], v[252:255]
    ds_read_b64_tr_b16 v[40:41], v18 offset:16384
    v_mfma_f32_16x16x32_bf16 v[236:239], v[44:47], v[96:99], v[236:239]
    ds_read_b64_tr_b16 v[42:43], v18 offset:20480
    v_mfma_f32_16x16x32_bf16 v[224:227], v[48:51], v[100:103], v[224:227]
    ds_read_b64_tr_b16 v[44:45], v19 offset:16384
    v_mfma_f32_16x16x32_bf16 v[240:243], v[48:51], v[116:119], v[240:243]
    ds_read_b64_tr_b16 v[46:47], v19 offset:20480
    s_add_u32 s84, s84, 1
    s_waitcnt lgkmcnt(10)
    v_mfma_f32_16x16x32_bf16 v[244:247], v[52:55], v[116:119], v[244:247]
    ds_read_b64_tr_b16 v[48:49], v16 offset:24576
    v_mfma_f32_16x16x32_bf16 v[228:231], v[52:55], v[100:103], v[228:231]
    ds_read_b64_tr_b16 v[50:51], v16 offset:28672
    s_and_b32 s84, s84, 7
    v_mfma_f32_16x16x32_bf16 v[232:235], v[56:59], v[100:103], v[232:235]
    ds_read_b64_tr_b16 v[52:53], v17 offset:24576
    v_mfma_f32_16x16x32_bf16 v[248:251], v[56:59], v[116:119], v[248:251]
    ds_read_b64_tr_b16 v[54:55], v17 offset:28672
    s_lshl_b32 s83, s84, 17
    s_waitcnt lgkmcnt(10)
    v_mfma_f32_16x16x32_bf16 v[252:255], v[60:63], v[116:119], v[252:255]
    ds_read_b64_tr_b16 v[56:57], v18 offset:24576
    v_mfma_f32_16x16x32_bf16 v[236:239], v[60:63], v[100:103], v[236:239]
    ds_read_b64_tr_b16 v[58:59], v18 offset:28672
    s_add_u32 s83, s83, s75
    v_mfma_f32_16x16x32_bf16 v[224:227], v[32:35], v[104:107], v[224:227]
    ds_read_b64_tr_b16 v[60:61], v19 offset:24576
    v_mfma_f32_16x16x32_bf16 v[240:243], v[32:35], v[120:123], v[240:243]
    ds_read_b64_tr_b16 v[62:63], v19 offset:28672
    s_waitcnt lgkmcnt(10)
    v_mfma_f32_16x16x32_bf16 v[244:247], v[36:39], v[120:123], v[244:247]
    ds_read_b64_tr_b16 v[32:33], v12 offset:32768
    v_mfma_f32_16x16x32_bf16 v[228:231], v[36:39], v[104:107], v[228:231]
    ds_read_b64_tr_b16 v[34:35], v12 offset:36864
    v_mfma_f32_16x16x32_bf16 v[232:235], v[40:43], v[104:107], v[232:235]
    ds_read_b64_tr_b16 v[36:37], v13 offset:32768
    v_mfma_f32_16x16x32_bf16 v[248:251], v[40:43], v[120:123], v[248:251]
    ds_read_b64_tr_b16 v[38:39], v13 offset:36864
    s_waitcnt lgkmcnt(10)
    v_mfma_f32_16x16x32_bf16 v[252:255], v[44:47], v[120:123], v[252:255]
    ds_read_b64_tr_b16 v[40:41], v14 offset:32768
    v_mfma_f32_16x16x32_bf16 v[236:239], v[44:47], v[104:107], v[236:239]
    ds_read_b64_tr_b16 v[42:43], v14 offset:36864
    v_mfma_f32_16x16x32_bf16 v[224:227], v[48:51], v[108:111], v[224:227]
    ds_read_b64_tr_b16 v[44:45], v15 offset:32768
    v_mfma_f32_16x16x32_bf16 v[240:243], v[48:51], v[124:127], v[240:243]
    ds_read_b64_tr_b16 v[46:47], v15 offset:36864
    s_waitcnt lgkmcnt(10)
    v_mfma_f32_16x16x32_bf16 v[244:247], v[52:55], v[124:127], v[244:247]
    ds_read_b64_tr_b16 v[48:49], v12 offset:40960
    v_mfma_f32_16x16x32_bf16 v[228:231], v[52:55], v[108:111], v[228:231]
    ds_read_b64_tr_b16 v[50:51], v12 offset:45056
    v_mfma_f32_16x16x32_bf16 v[232:235], v[56:59], v[108:111], v[232:235]
    ds_read_b64_tr_b16 v[52:53], v13 offset:40960
    v_mfma_f32_16x16x32_bf16 v[248:251], v[56:59], v[124:127], v[248:251]
    ds_read_b64_tr_b16 v[54:55], v13 offset:45056
    s_waitcnt lgkmcnt(10)
    v_mfma_f32_16x16x32_bf16 v[252:255], v[60:63], v[124:127], v[252:255]
    ds_read_b64_tr_b16 v[56:57], v14 offset:40960
    v_mfma_f32_16x16x32_bf16 v[236:239], v[60:63], v[108:111], v[236:239]
    ds_read_b64_tr_b16 v[58:59], v14 offset:45056
    s_barrier
    v_mfma_f32_16x16x32_bf16 v[224:227], v[32:35], v[128:131], v[224:227]
    ds_read_b64_tr_b16 v[60:61], v15 offset:40960
    v_mfma_f32_16x16x32_bf16 v[240:243], v[32:35], v[144:147], v[240:243]
    ds_read_b64_tr_b16 v[62:63], v15 offset:45056
    s_waitcnt lgkmcnt(10)
    v_mfma_f32_16x16x32_bf16 v[244:247], v[36:39], v[144:147], v[244:247]
    ds_read_b64_tr_b16 v[32:33], v16 offset:32768
    v_mfma_f32_16x16x32_bf16 v[228:231], v[36:39], v[128:131], v[228:231]
    ds_read_b64_tr_b16 v[34:35], v16 offset:36864
    v_mfma_f32_16x16x32_bf16 v[232:235], v[40:43], v[128:131], v[232:235]
    ds_read_b64_tr_b16 v[36:37], v17 offset:32768
    v_mfma_f32_16x16x32_bf16 v[248:251], v[40:43], v[144:147], v[248:251]
    ds_read_b64_tr_b16 v[38:39], v17 offset:36864
    s_waitcnt lgkmcnt(10)
    v_mfma_f32_16x16x32_bf16 v[252:255], v[44:47], v[144:147], v[252:255]
    ds_read_b64_tr_b16 v[40:41], v18 offset:32768
    v_mfma_f32_16x16x32_bf16 v[236:239], v[44:47], v[128:131], v[236:239]
    ds_read_b64_tr_b16 v[42:43], v18 offset:36864
    v_mfma_f32_16x16x32_bf16 v[224:227], v[48:51], v[132:135], v[224:227]
    ds_read_b64_tr_b16 v[44:45], v19 offset:32768
    v_mfma_f32_16x16x32_bf16 v[240:243], v[48:51], v[148:151], v[240:243]
    ds_read_b64_tr_b16 v[46:47], v19 offset:36864
    s_waitcnt lgkmcnt(10)
    v_mfma_f32_16x16x32_bf16 v[244:247], v[52:55], v[148:151], v[244:247]
    ds_read_b64_tr_b16 v[48:49], v16 offset:40960
    v_mfma_f32_16x16x32_bf16 v[228:231], v[52:55], v[132:135], v[228:231]
    ds_read_b64_tr_b16 v[50:51], v16 offset:45056
    v_mfma_f32_16x16x32_bf16 v[232:235], v[56:59], v[132:135], v[232:235]
    ds_read_b64_tr_b16 v[52:53], v17 offset:40960
    v_mfma_f32_16x16x32_bf16 v[248:251], v[56:59], v[148:151], v[248:251]
    ds_read_b64_tr_b16 v[54:55], v17 offset:45056
    s_waitcnt lgkmcnt(10)
    v_mfma_f32_16x16x32_bf16 v[252:255], v[60:63], v[148:151], v[252:255]
    ds_read_b64_tr_b16 v[56:57], v18 offset:40960
    v_mfma_f32_16x16x32_bf16 v[236:239], v[60:63], v[132:135], v[236:239]
    ds_read_b64_tr_b16 v[58:59], v18 offset:45056
    v_mfma_f32_16x16x32_bf16 v[224:227], v[32:35], v[136:139], v[224:227]
    ds_read_b64_tr_b16 v[60:61], v19 offset:40960
    v_mfma_f32_16x16x32_bf16 v[240:243], v[32:35], v[152:155], v[240:243]
    ds_read_b64_tr_b16 v[62:63], v19 offset:45056
    s_waitcnt lgkmcnt(10)
    v_mfma_f32_16x16x32_bf16 v[244:247], v[36:39], v[152:155], v[244:247]
    ds_read_b64_tr_b16 v[32:33], v12 offset:49152
    v_mfma_f32_16x16x32_bf16 v[228:231], v[36:39], v[136:139], v[228:231]
    ds_read_b64_tr_b16 v[34:35], v12 offset:53248
    v_mfma_f32_16x16x32_bf16 v[232:235], v[40:43], v[136:139], v[232:235]
    ds_read_b64_tr_b16 v[36:37], v13 offset:49152
    v_mfma_f32_16x16x32_bf16 v[248:251], v[40:43], v[152:155], v[248:251]
    ds_read_b64_tr_b16 v[38:39], v13 offset:53248
    s_waitcnt lgkmcnt(10)
    v_mfma_f32_16x16x32_bf16 v[252:255], v[44:47], v[152:155], v[252:255]
    ds_read_b64_tr_b16 v[40:41], v14 offset:49152
    v_mfma_f32_16x16x32_bf16 v[236:239], v[44:47], v[136:139], v[236:239]
    ds_read_b64_tr_b16 v[42:43], v14 offset:53248
    v_mfma_f32_16x16x32_bf16 v[224:227], v[48:51], v[140:143], v[224:227]
    ds_read_b64_tr_b16 v[44:45], v15 offset:49152
    v_mfma_f32_16x16x32_bf16 v[240:243], v[48:51], v[156:159], v[240:243]
    ds_read_b64_tr_b16 v[46:47], v15 offset:53248
    s_waitcnt lgkmcnt(10)
    v_mfma_f32_16x16x32_bf16 v[244:247], v[52:55], v[156:159], v[244:247]
    ds_read_b64_tr_b16 v[48:49], v12 offset:57344
    v_mfma_f32_16x16x32_bf16 v[228:231], v[52:55], v[140:143], v[228:231]
    ds_read_b64_tr_b16 v[50:51], v12 offset:61440
    v_mfma_f32_16x16x32_bf16 v[232:235], v[56:59], v[140:143], v[232:235]
    ds_read_b64_tr_b16 v[52:53], v13 offset:57344
    v_mfma_f32_16x16x32_bf16 v[248:251], v[56:59], v[156:159], v[248:251]
    ds_read_b64_tr_b16 v[54:55], v13 offset:61440
    s_waitcnt lgkmcnt(10)
    v_mfma_f32_16x16x32_bf16 v[252:255], v[60:63], v[156:159], v[252:255]
    ds_read_b64_tr_b16 v[56:57], v14 offset:57344
    v_mfma_f32_16x16x32_bf16 v[236:239], v[60:63], v[140:143], v[236:239]
    ds_read_b64_tr_b16 v[58:59], v14 offset:61440
    s_waitcnt vmcnt(0)
    s_barrier
    v_mfma_f32_16x16x32_bf16 v[224:227], v[32:35], v[160:163], v[224:227]
    ds_read_b64_tr_b16 v[60:61], v15 offset:57344
    v_mfma_f32_16x16x32_bf16 v[240:243], v[32:35], v[176:179], v[240:243]
    ds_read_b64_tr_b16 v[62:63], v15 offset:61440
    s_waitcnt lgkmcnt(10)
    v_mfma_f32_16x16x32_bf16 v[244:247], v[36:39], v[176:179], v[244:247]
    ds_read_b64_tr_b16 v[32:33], v16 offset:49152
    v_mfma_f32_16x16x32_bf16 v[228:231], v[36:39], v[160:163], v[228:231]
    ds_read_b64_tr_b16 v[34:35], v16 offset:53248
    v_mfma_f32_16x16x32_bf16 v[232:235], v[40:43], v[160:163], v[232:235]
    ds_read_b64_tr_b16 v[36:37], v17 offset:49152
    v_mfma_f32_16x16x32_bf16 v[248:251], v[40:43], v[176:179], v[248:251]
    ds_read_b64_tr_b16 v[38:39], v17 offset:53248
    s_waitcnt lgkmcnt(10)
    v_mfma_f32_16x16x32_bf16 v[252:255], v[44:47], v[176:179], v[252:255]
    ds_read_b64_tr_b16 v[40:41], v18 offset:49152
    v_mfma_f32_16x16x32_bf16 v[236:239], v[44:47], v[160:163], v[236:239]
    ds_read_b64_tr_b16 v[42:43], v18 offset:53248
    v_mfma_f32_16x16x32_bf16 v[224:227], v[48:51], v[164:167], v[224:227]
    ds_read_b64_tr_b16 v[44:45], v19 offset:49152
    v_mfma_f32_16x16x32_bf16 v[240:243], v[48:51], v[180:183], v[240:243]
    ds_read_b64_tr_b16 v[46:47], v19 offset:53248
    s_waitcnt lgkmcnt(10)
    v_mfma_f32_16x16x32_bf16 v[244:247], v[52:55], v[180:183], v[244:247]
    ds_read_b64_tr_b16 v[48:49], v16 offset:57344
    v_mfma_f32_16x16x32_bf16 v[228:231], v[52:55], v[164:167], v[228:231]
    ds_read_b64_tr_b16 v[50:51], v16 offset:61440
    v_mfma_f32_16x16x32_bf16 v[232:235], v[56:59], v[164:167], v[232:235]
    ds_read_b64_tr_b16 v[52:53], v17 offset:57344
    v_mfma_f32_16x16x32_bf16 v[248:251], v[56:59], v[180:183], v[248:251]
    ds_read_b64_tr_b16 v[54:55], v17 offset:61440
    s_waitcnt lgkmcnt(10)
    v_mfma_f32_16x16x32_bf16 v[252:255], v[60:63], v[180:183], v[252:255]
    ds_read_b64_tr_b16 v[56:57], v18 offset:57344
    v_mfma_f32_16x16x32_bf16 v[236:239], v[60:63], v[164:167], v[236:239]
    ds_read_b64_tr_b16 v[58:59], v18 offset:61440
    v_mfma_f32_16x16x32_bf16 v[224:227], v[32:35], v[168:171], v[224:227]
    ds_read_b64_tr_b16 v[60:61], v19 offset:57344
    v_mfma_f32_16x16x32_bf16 v[240:243], v[32:35], v[184:187], v[240:243]
    ds_read_b64_tr_b16 v[62:63], v19 offset:61440
    s_waitcnt lgkmcnt(10)
    v_mfma_f32_16x16x32_bf16 v[244:247], v[36:39], v[184:187], v[244:247]
    ds_read_b64_tr_b16 v[32:33], v20 offset:0
    v_mfma_f32_16x16x32_bf16 v[228:231], v[36:39], v[168:171], v[228:231]
    ds_read_b64_tr_b16 v[34:35], v20 offset:4096
    v_mfma_f32_16x16x32_bf16 v[232:235], v[40:43], v[168:171], v[232:235]
    ds_read_b64_tr_b16 v[36:37], v21 offset:0
    v_mfma_f32_16x16x32_bf16 v[248:251], v[40:43], v[184:187], v[248:251]
    ds_read_b64_tr_b16 v[38:39], v21 offset:4096
    s_waitcnt lgkmcnt(10)
    v_mfma_f32_16x16x32_bf16 v[252:255], v[44:47], v[184:187], v[252:255]
    ds_read_b64_tr_b16 v[40:41], v22 offset:0
    v_mfma_f32_16x16x32_bf16 v[236:239], v[44:47], v[168:171], v[236:239]
    ds_read_b64_tr_b16 v[42:43], v22 offset:4096
    v_mfma_f32_16x16x32_bf16 v[224:227], v[48:51], v[172:175], v[224:227]
    ds_read_b64_tr_b16 v[44:45], v23 offset:0
    v_mfma_f32_16x16x32_bf16 v[240:243], v[48:51], v[188:191], v[240:243]
    ds_read_b64_tr_b16 v[46:47], v23 offset:4096
    s_sub_u32 s81, s81, 1
    s_waitcnt lgkmcnt(10)
    v_mfma_f32_16x16x32_bf16 v[244:247], v[52:55], v[188:191], v[244:247]
    ds_read_b64_tr_b16 v[48:49], v20 offset:8192
    v_mfma_f32_16x16x32_bf16 v[228:231], v[52:55], v[172:175], v[228:231]
    ds_read_b64_tr_b16 v[50:51], v20 offset:12288
    s_cmp_lg_u32 s81, 0
    v_mfma_f32_16x16x32_bf16 v[232:235], v[56:59], v[172:175], v[232:235]
    ds_read_b64_tr_b16 v[52:53], v21 offset:8192
    v_mfma_f32_16x16x32_bf16 v[248:251], v[56:59], v[188:191], v[248:251]
    ds_read_b64_tr_b16 v[54:55], v21 offset:12288
    s_waitcnt lgkmcnt(12)
    v_mfma_f32_16x16x32_bf16 v[252:255], v[60:63], v[188:191], v[252:255]
    ds_read_b64_tr_b16 v[56:57], v22 offset:8192
    v_mfma_f32_16x16x32_bf16 v[236:239], v[60:63], v[172:175], v[236:239]
    ds_read_b64_tr_b16 v[58:59], v22 offset:12288
    s_barrier
    s_cbranch_scc1 L_A2_op
    s_nop 7
    ds_write_b128 v4, v[224:227] offset:0
    ds_write_b128 v4, v[228:231] offset:1024
    ds_write_b128 v4, v[232:235] offset:2048
    ds_write_b128 v4, v[236:239] offset:3072
    ds_write_b128 v4, v[240:243] offset:4096
    ds_write_b128 v4, v[244:247] offset:5120
    ds_write_b128 v4, v[248:251] offset:6144
    ds_write_b128 v4, v[252:255] offset:7168
    s_waitcnt lgkmcnt(0)
    s_barrier
    s_endpgm
L_P1:
    v_lshrrev_b32 v84, 4, v0
    v_and_b32 v85, 15, v0
    v_lshlrev_b32 v86, 1, v84
    v_xor_b32 v86, v86, v85
    v_xor_b32 v87, 8, v86
    s_lshl_b32 s73, s72, 15
    v_lshl_add_u32 v88, v84, 10, s73
    v_add_u32 v89, 0, v84
    v_xor_b32 v89, v89, v85
    v_lshl_add_u32 v64, v89, 4, v88
    v_add_u32 v68, 16384, v64
    v_add_u32 v89, 4, v84
    v_xor_b32 v89, v89, v85
    v_lshl_add_u32 v65, v89, 4, v88
    v_add_u32 v65, 3072, v65
    v_add_u32 v69, 16384, v65
    v_add_u32 v89, 8, v84
    v_xor_b32 v89, v89, v85
    v_lshl_add_u32 v66, v89, 4, v88
    v_add_u32 v66, 6144, v66
    v_add_u32 v70, 16384, v66
    v_add_u32 v89, 12, v84
    v_xor_b32 v89, v89, v85
    v_lshl_add_u32 v67, v89, 4, v88
    v_add_u32 v67, 9216, v67
    v_add_u32 v71, 16384, v67
    s_add_u32 m0, s85, 0
    s_mov_b32 s74, 256
    buffer_load_dwordx4 v64, s[36:39], s74 offen offset:0  lds
    buffer_load_dwordx4 v65, s[36:39], s74 offen offset:1024  lds
    buffer_load_dwordx4 v66, s[36:39], s74 offen offset:2048  lds
    buffer_load_dwordx4 v67, s[36:39], s74 offen offset:3072  lds
    s_cmp_lg_u32 s90, 0
    s_cselect_b32 s40, s16, s6
    s_cselect_b32 s41, s17, s7
    s_cselect_b32 s44, s18, s8
    s_cselect_b32 s45, s19, s9
    s_cselect_b32 s52, s22, s12
    s_cselect_b32 s53, s23, s13
    s_lshl_b32 s73, s89, 3
    s_add_u32 s73, s73, s80
    s_lshl_b32 s73, s73, 19
    s_add_u32 s40, s40, s73
    s_addc_u32 s41, s41, 0
    s_mov_b32 s42, 524288
    s_mov_b32 s43, 0x20000
    s_lshl_b32 s73, s89, 3
    s_add_u32 s73, s73, s80
    s_lshl_b32 s73, s73, 19
    s_add_u32 s44, s44, s73
    s_addc_u32 s45, s45, 0
    s_mov_b32 s46, 524288
    s_mov_b32 s47, 0x20000
    s_lshl_b32 s73, s80, 19
    s_add_u32 s52, s52, s73
    s_addc_u32 s53, s53, 0
    s_mov_b32 s54, 524288
    s_mov_b32 s55, 0x20000
    s_lshl_b32 s73, s91, 20
    s_add_u32 s56, s24, s73
    s_addc_u32 s57, s25, 0
    s_mov_b32 s58, 1048576
    s_mov_b32 s59, 0x20000
    s_lshl_b32 s73, s91, 10
    s_add_u32 s73, s73, 33554432
    s_add_u32 s60, s24, s73
    s_addc_u32 s61, s25, 0
    s_mov_b32 s62, 1024
    s_mov_b32 s63, 0x20000
    s_lshl_b32 s73, s91, 2
    s_add_u32 s64, s34, s73
    s_addc_u32 s65, s35, 0
    s_mov_b32 s66, 4
    s_mov_b32 s67, 0x20000
    s_waitcnt vmcnt(8)
    s_barrier
    s_add_u32 m0, s79, 98304
    s_nop 0
    buffer_load_dwordx4 v72, s[48:51], s78 offen offset:0  lds
    buffer_load_dwordx4 v73, s[48:51], s78 offen offset:1024  lds
    buffer_load_dwordx4 v74, s[48:51], s78 offen offset:2048  lds
    buffer_load_dwordx4 v75, s[48:51], s78 offen offset:3072  lds
    s_xor_b32 s78, s95, 1572864
    s_waitcnt vmcnt(8)
    s_barrier
    s_add_u32 m0, s79, 114688
    s_nop 0
    buffer_load_dwordx4 v72, s[48:51], s78 offen offset:0  lds
    buffer_load_dwordx4 v73, s[48:51], s78 offen offset:1024  lds
    buffer_load_dwordx4 v74, s[48:51], s78 offen offset:2048  lds
    buffer_load_dwordx4 v75, s[48:51], s78 offen offset:3072  lds
    s_xor_b32 s78, s95, 2097152
    s_add_u32 m0, s85, 32768
    s_mov_b32 s74, 512
    buffer_load_dwordx4 v64, s[36:39], s74 offen offset:0  lds
    buffer_load_dwordx4 v65, s[36:39], s74 offen offset:1024  lds
    buffer_load_dwordx4 v66, s[36:39], s74 offen offset:2048  lds
    buffer_load_dwordx4 v67, s[36:39], s74 offen offset:3072  lds
    v_lshrrev_b32 v84, 4, v0
    v_and_b32 v85, 15, v0
    v_lshlrev_b32 v86, 1, v84
    v_xor_b32 v86, v86, v85
    v_xor_b32 v87, 8, v86
    s_lshl_b32 s73, s72, 12
    v_lshl_add_u32 v88, v84, 8, s73
    v_add_u32 v89, 0, v84
    v_xor_b32 v89, v89, v85
    v_lshl_add_u32 v76, v89, 4, v88
    v_add_u32 v89, 4, v84
    v_xor_b32 v89, v89, v85
    v_lshl_add_u32 v77, v89, 4, v88
    v_add_u32 v89, 8, v84
    v_xor_b32 v89, v89, v85
    v_lshl_add_u32 v78, v89, 4, v88
    v_add_u32 v89, 12, v84
    v_xor_b32 v89, v89, v85
    v_lshl_add_u32 v79, v89, 4, v88
    v_lshl_add_u32 v80, v86, 4, v88
    v_lshl_add_u32 v81, v87, 4, v88
    s_waitcnt vmcnt(8)
    s_barrier
    s_add_u32 m0, s79, 65536
    s_nop 0
    s_waitcnt vmcnt(7)
    buffer_load_dwordx4 v72, s[48:51], s78 offen offset:0  lds
    s_waitcnt vmcnt(7)
    buffer_load_dwordx4 v73, s[48:51], s78 offen offset:1024  lds
    s_waitcnt vmcnt(7)
    buffer_load_dwordx4 v74, s[48:51], s78 offen offset:2048  lds
    s_waitcnt vmcnt(7)
    buffer_load_dwordx4 v75, s[48:51], s78 offen offset:3072  lds
    s_xor_b32 s78, s95, 2621440
    v_and_b32 v1, 15, v0
    v_lshrrev_b32 v2, 4, v0
    v_xor_b32 v2, v2, v1
    v_lshlrev_b32 v2, 4, v2
    v_lshl_add_u32 v1, v1, 8, v2
    v_xor_b32 v8, 0x0, v1
    v_xor_b32 v9, 0x40, v1
    v_xor_b32 v10, 0x80, v1
    v_xor_b32 v11, 0xc0, v1
    s_waitcnt vmcnt(8)
    s_barrier
    s_add_u32 m0, s79, 81920
    s_nop 0
    s_waitcnt vmcnt(7)
    buffer_load_dwordx4 v72, s[48:51], s78 offen offset:0  lds
    s_waitcnt vmcnt(7)
    buffer_load_dwordx4 v73, s[48:51], s78 offen offset:1024  lds
    s_waitcnt vmcnt(7)
    buffer_load_dwordx4 v74, s[48:51], s78 offen offset:2048  lds
    s_waitcnt vmcnt(7)
    buffer_load_dwordx4 v75, s[48:51], s78 offen offset:3072  lds
    s_xor_b32 s78, s95, 3145728
    s_add_u32 m0, s85, 131072
    s_mov_b32 s74, 768
    s_waitcnt vmcnt(7)
    buffer_load_dwordx4 v64, s[36:39], s74 offen offset:0  lds
    s_waitcnt vmcnt(7)
    buffer_load_dwordx4 v65, s[36:39], s74 offen offset:1024  lds
    s_waitcnt vmcnt(7)
    buffer_load_dwordx4 v66, s[36:39], s74 offen offset:2048  lds
    s_waitcnt vmcnt(7)
    buffer_load_dwordx4 v67, s[36:39], s74 offen offset:3072  lds
    v_lshrrev_b32 v1, 2, v0
    v_and_b32 v2, 7, v1
    v_lshlrev_b32 v1, 8, v1
    v_lshl_add_u32 v1, v2, 5, v1
    v_and_b32 v2, 3, v0
    v_lshl_add_u32 v1, v2, 3, v1
    v_xor_b32 v12, 0x0, v1
    v_xor_b32 v13, 0x20, v1
    v_xor_b32 v14, 0x40, v1
    v_xor_b32 v15, 0x60, v1
    v_xor_b32 v16, 0x80, v1
    v_xor_b32 v17, 0xa0, v1
    v_xor_b32 v18, 0xc0, v1
    v_xor_b32 v19, 0xe0, v1
    s_waitcnt vmcnt(8)
    s_barrier
    s_add_u32 m0, s79, 98304
    s_nop 0
    s_waitcnt vmcnt(7)
    buffer_load_dwordx4 v72, s[48:51], s78 offen offset:0  lds
    s_waitcnt vmcnt(7)
    buffer_load_dwordx4 v73, s[48:51], s78 offen offset:1024  lds
    s_waitcnt vmcnt(7)
    buffer_load_dwordx4 v74, s[48:51], s78 offen offset:2048  lds
    s_waitcnt vmcnt(7)
    buffer_load_dwordx4 v75, s[48:51], s78 offen offset:3072  lds
    s_xor_b32 s78, s95, 3670016
    s_add_u32 s73, s85, 131072
    v_lshl_add_u32 v4, v0, 4, s73
    v_mov_b32 v28, 0x3f803f80
    v_mov_b32 v29, 0x3f803f80
    v_mov_b32 v30, 0x3f803f80
    v_mov_b32 v31, 0x3f803f80
    s_mov_b32 s87, 0x46800000
    s_mov_b32 s82, 0
    s_waitcnt vmcnt(8)
    s_barrier
    s_add_u32 m0, s79, 114688
    s_nop 0
    s_waitcnt vmcnt(7)
    buffer_load_dwordx4 v72, s[48:51], s78 offen offset:0  lds
    s_waitcnt vmcnt(7)
    buffer_load_dwordx4 v73, s[48:51], s78 offen offset:1024  lds
    s_waitcnt vmcnt(7)
    buffer_load_dwordx4 v74, s[48:51], s78 offen offset:2048  lds
    s_waitcnt vmcnt(7)
    buffer_load_dwordx4 v75, s[48:51], s78 offen offset:3072  lds
    s_xor_b32 s78, s95, 256
    s_add_u32 m0, s79, 0
    s_nop 0
    s_waitcnt vmcnt(7)
    buffer_load_dwordx4 v76, s[40:43], s3 offen offset:0 nt lds
    s_waitcnt vmcnt(7)
    buffer_load_dwordx4 v77, s[40:43], s3 offen offset:1024 nt lds
    s_waitcnt vmcnt(7)
    buffer_load_dwordx4 v78, s[40:43], s3 offen offset:2048 nt lds
    s_waitcnt vmcnt(7)
    buffer_load_dwordx4 v79, s[40:43], s3 offen offset:3072 nt lds
    s_waitcnt vmcnt(8)
    s_barrier
    s_add_u32 m0, s79, 65536
    s_nop 0
    s_waitcnt vmcnt(7)
    buffer_load_dwordx4 v72, s[48:51], s78 offen offset:0  lds
    s_waitcnt vmcnt(7)
    buffer_load_dwordx4 v73, s[48:51], s78 offen offset:1024  lds
    s_waitcnt vmcnt(7)
    buffer_load_dwordx4 v74, s[48:51], s78 offen offset:2048  lds
    s_waitcnt vmcnt(7)
    buffer_load_dwordx4 v75, s[48:51], s78 offen offset:3072  lds
    s_xor_b32 s78, s95, 524288
    s_waitcnt vmcnt(8)
    s_barrier
    s_add_u32 m0, s79, 16384
    s_nop 0
    s_waitcnt vmcnt(7)
    buffer_load_dwordx4 v80, s[44:47], s3 offen offset:0 nt lds
    s_waitcnt vmcnt(7)
    buffer_load_dwordx4 v81, s[44:47], s3 offen offset:1024 nt lds
    s_waitcnt vmcnt(7)
    buffer_load_dwordx4 v80, s[44:47], s3 offen offset:2048 nt lds
    s_waitcnt vmcnt(7)
    buffer_load_dwordx4 v81, s[44:47], s3 offen offset:3072 nt lds
    s_waitcnt vmcnt(4)
    s_lshl_b32 s73, s80, 7
    v_lshrrev_b32 v1, 5, v0
    v_lshlrev_b32 v1, 24, v1
    v_lshl_add_u32 v1, v0, 2, v1
    v_add_u32 v5, s73, v1
    v_mov_b32 v1, 0
    buffer_store_dword v1, v5, s[60:63], 0 offen sc1
    v_lshlrev_b32 v90, 24, v0
    v_mov_b32 v91, 1
    s_and_b32 s94, s89, 7
L_A1:
    s_barrier
    ds_read_b128 v[128:131], v4 offset:0
    ds_read_b128 v[32:35], v8 offset:0
    ds_read_b128 v[36:39], v8 offset:4096
    ds_read_b128 v[40:43], v8 offset:8192
    ds_read_b128 v[44:47], v8 offset:12288
    ds_read_b128 v[132:135], v4 offset:1024
    ds_read_b128 v[48:51], v9 offset:0
    ds_read_b128 v[52:55], v9 offset:4096
    ds_read_b128 v[56:59], v9 offset:8192
    s_waitcnt lgkmcnt(7)
    v_mfma_f32_16x16x32_bf16 v[160:163], v[32:35], v[128:131], 0
    ds_read_b128 v[60:63], v9 offset:12288
    s_waitcnt lgkmcnt(6)
    v_mfma_f32_16x16x32_bf16 v[164:167], v[36:39], v[128:131], 0
    ds_read_b128 v[136:139], v4 offset:2048
    ds_read_b128 v[32:35], v10 offset:0
    v_mfma_f32_16x16x32_bf16 v[168:171], v[40:43], v[128:131], 0
    ds_read_b128 v[36:39], v10 offset:4096
    s_waitcnt lgkmcnt(6)
    v_mfma_f32_16x16x32_bf16 v[172:175], v[44:47], v[128:131], 0
    ds_read_b128 v[40:43], v10 offset:8192
    v_mfma_f32_16x16x32_bf16 v[160:163], v[48:51], v[132:135], v[160:163]
    ds_read_b128 v[44:47], v10 offset:12288
    s_waitcnt lgkmcnt(6)
    v_mfma_f32_16x16x32_bf16 v[164:167], v[52:55], v[132:135], v[164:167]
    ds_read_b128 v[140:143], v4 offset:3072
    ds_read_b128 v[48:51], v11 offset:0
    v_mfma_f32_16x16x32_bf16 v[168:171], v[56:59], v[132:135], v[168:171]
    ds_read_b128 v[52:55], v11 offset:4096
    s_waitcnt lgkmcnt(6)
    v_mfma_f32_16x16x32_bf16 v[172:175], v[60:63], v[132:135], v[172:175]
    ds_read_b128 v[56:59], v11 offset:8192
    v_mfma_f32_16x16x32_bf16 v[160:163], v[32:35], v[136:139], v[160:163]
    ds_read_b128 v[60:63], v11 offset:12288
    s_waitcnt lgkmcnt(6)
    v_mfma_f32_16x16x32_bf16 v[164:167], v[36:39], v[136:139], v[164:167]
    v_mfma_f32_16x16x32_bf16 v[168:171], v[40:43], v[136:139], v[168:171]
    s_waitcnt lgkmcnt(3)
    v_mfma_f32_16x16x32_bf16 v[172:175], v[44:47], v[136:139], v[172:175]
    v_mfma_f32_16x16x32_bf16 v[160:163], v[48:51], v[140:143], v[160:163]
    s_waitcnt lgkmcnt(1)
    v_mfma_f32_16x16x32_bf16 v[164:167], v[52:55], v[140:143], v[164:167]
    v_mfma_f32_16x16x32_bf16 v[168:171], v[56:59], v[140:143], v[168:171]
    s_waitcnt lgkmcnt(0)
    v_mfma_f32_16x16x32_bf16 v[172:175], v[60:63], v[140:143], v[172:175]
    s_mov_b32 s81, 4
    s_nop 5
    s_branch L_A1_go
L_A1_item:
    s_barrier
    v_rcp_f32 v20, v2
    s_cmp_eq_u32 s82, 4
    s_cbranch_scc1 L_A1_tail
    ds_read_b128 v[128:131], v4 offset:0
    ds_read_b128 v[32:35], v8 offset:0
    ds_read_b128 v[36:39], v8 offset:4096
    ds_read_b128 v[40:43], v8 offset:8192
    ds_read_b128 v[44:47], v8 offset:12288
    ds_read_b128 v[132:135], v4 offset:1024
    ds_read_b128 v[48:51], v9 offset:0
    ds_read_b128 v[52:55], v9 offset:4096
    ds_read_b128 v[56:59], v9 offset:8192
    s_waitcnt lgkmcnt(7)
    v_mfma_f32_16x16x32_bf16 v[160:163], v[32:35], v[128:131], 0
    ds_read_b128 v[60:63], v9 offset:12288
    v_mul_f32 v192, v20, v192
    v_mul_f32 v193, v20, v193
    s_waitcnt lgkmcnt(6)
    v_mfma_f32_16x16x32_bf16 v[164:167], v[36:39], v[128:131], 0
    ds_read_b128 v[136:139], v4 offset:2048
    ds_read_b128 v[32:35], v10 offset:0
    v_mul_f32 v194, v20, v194
    v_mul_f32 v195, v20, v195
    v_mfma_f32_16x16x32_bf16 v[168:171], v[40:43], v[128:131], 0
    ds_read_b128 v[36:39], v10 offset:4096
    v_mul_f32 v196, v20, v196
    v_mul_f32 v197, v20, v197
    s_waitcnt lgkmcnt(6)
    v_mfma_f32_16x16x32_bf16 v[172:175], v[44:47], v[128:131], 0
    ds_read_b128 v[40:43], v10 offset:8192
    v_mul_f32 v198, v20, v198
    v_mul_f32 v199, v20, v199
    v_mfma_f32_16x16x32_bf16 v[160:163], v[48:51], v[132:135], v[160:163]
    ds_read_b128 v[44:47], v10 offset:12288
    v_mul_f32 v200, v20, v200
    v_mul_f32 v201, v20, v201
    s_waitcnt lgkmcnt(6)
    v_mfma_f32_16x16x32_bf16 v[164:167], v[52:55], v[132:135], v[164:167]
    ds_read_b128 v[140:143], v4 offset:3072
    ds_read_b128 v[48:51], v11 offset:0
    v_mul_f32 v202, v20, v202
    v_mul_f32 v203, v20, v203
    v_mfma_f32_16x16x32_bf16 v[168:171], v[56:59], v[132:135], v[168:171]
    ds_read_b128 v[52:55], v11 offset:4096
    v_mul_f32 v204, v20, v204
    v_mul_f32 v205, v20, v205
    s_waitcnt lgkmcnt(6)
    v_mfma_f32_16x16x32_bf16 v[172:175], v[60:63], v[132:135], v[172:175]
    ds_read_b128 v[56:59], v11 offset:8192
    v_mul_f32 v206, v20, v206
    v_mul_f32 v207, v20, v207
    v_mfma_f32_16x16x32_bf16 v[160:163], v[32:35], v[136:139], v[160:163]
    ds_read_b128 v[60:63], v11 offset:12288
    v_mul_f32 v208, v20, v208
    v_mul_f32 v209, v20, v209
    s_waitcnt lgkmcnt(6)
    v_mfma_f32_16x16x32_bf16 v[164:167], v[36:39], v[136:139], v[164:167]
    v_mul_f32 v210, v20, v210
    v_mul_f32 v211, v20, v211
    v_mfma_f32_16x16x32_bf16 v[168:171], v[40:43], v[136:139], v[168:171]
    v_mul_f32 v212, v20, v212
    v_mul_f32 v213, v20, v213
    s_waitcnt lgkmcnt(3)
    v_mfma_f32_16x16x32_bf16 v[172:175], v[44:47], v[136:139], v[172:175]
    v_mul_f32 v214, v20, v214
    v_mul_f32 v215, v20, v215
    v_mfma_f32_16x16x32_bf16 v[160:163], v[48:51], v[140:143], v[160:163]
    v_mul_f32 v216, v20, v216
    v_mul_f32 v217, v20, v217
    s_waitcnt lgkmcnt(1)
    v_mfma_f32_16x16x32_bf16 v[164:167], v[52:55], v[140:143], v[164:167]
    v_mul_f32 v218, v20, v218
    v_mul_f32 v219, v20, v219
    v_mfma_f32_16x16x32_bf16 v[168:171], v[56:59], v[140:143], v[168:171]
    v_mul_f32 v220, v20, v220
    v_mul_f32 v221, v20, v221
    s_waitcnt lgkmcnt(0)
    v_mfma_f32_16x16x32_bf16 v[172:175], v[60:63], v[140:143], v[172:175]
    v_mul_f32 v222, v20, v222
    v_mul_f32 v223, v20, v223
    s_mov_b32 s81, 4
    s_cmp_eq_u32 s82, 1
    s_cbranch_scc1 L_A1_save0
    s_cmp_eq_u32 s82, 2
    s_cbranch_scc1 L_A1_save1
    s_cmp_eq_u32 s82, 3
    s_cbranch_scc1 L_A1_save2
    s_nop 3
L_A1_go:
    v_max3_f32 v20, v160, v161, v162
    v_max3_f32 v20, v20, v163, v164
    v_max3_f32 v20, v20, v165, v166
    v_max3_f32 v20, v20, v167, v168
    v_max3_f32 v20, v20, v169, v170
    v_max3_f32 v20, v20, v171, v172
    v_max3_f32 v20, v20, v173, v174
    v_max_f32 v20, v20, v175
    v_mov_b32 v22, v20
    s_nop 1
    v_permlane32_swap_b32 v20, v22
    s_nop 1
    v_max_f32 v20, v20, v22
    v_mov_b32 v22, v20
    s_nop 1
    v_permlane16_swap_b32 v20, v22
    s_nop 1
    v_max_f32 v20, v20, v22
    v_sub_f32 v160, v160, v20
    v_sub_f32 v161, v161, v20
    v_sub_f32 v162, v162, v20
    v_sub_f32 v163, v163, v20
    v_sub_f32 v164, v164, v20
    v_sub_f32 v165, v165, v20
    v_sub_f32 v166, v166, v20
    v_sub_f32 v167, v167, v20
    v_sub_f32 v168, v168, v20
    v_sub_f32 v169, v169, v20
    v_sub_f32 v170, v170, v20
    v_sub_f32 v171, v171, v20
    v_sub_f32 v172, v172, v20
    v_sub_f32 v173, v173, v20
    v_sub_f32 v174, v174, v20
    v_sub_f32 v175, v175, v20
    v_sub_f32 v21, 0, v20
    v_sub_f32 v22, 0, v20
    v_sub_f32 v23, 0, v20
    v_sub_f32 v20, 0, v20
    s_waitcnt lgkmcnt(0)
    v_exp_f32 v160, v160
    v_exp_f32 v161, v161
    v_exp_f32 v162, v162
    v_cvt_pk_bf16_f32 v160, v160, v161
    v_exp_f32 v163, v163
    v_exp_f32 v164, v164
    v_cvt_pk_bf16_f32 v161, v162, v163
    v_exp_f32 v165, v165
    v_exp_f32 v166, v166
    v_cvt_pk_bf16_f32 v162, v164, v165
    v_exp_f32 v167, v167
    v_exp_f32 v168, v168
    v_cvt_pk_bf16_f32 v163, v166, v167
    v_exp_f32 v169, v169
    v_exp_f32 v170, v170
    v_cvt_pk_bf16_f32 v164, v168, v169
    v_exp_f32 v171, v171
    v_exp_f32 v172, v172
    v_cvt_pk_bf16_f32 v165, v170, v171
    v_exp_f32 v173, v173
    v_exp_f32 v174, v174
    v_cvt_pk_bf16_f32 v166, v172, v173
    v_exp_f32 v175, v175
    s_nop 0
    v_cvt_pk_bf16_f32 v167, v174, v175
    s_nop 0
    v_mfma_f32_16x16x32_bf16 v[32:35], v[28:31], v[160:163], 0
    v_mfma_f32_16x16x32_bf16 v[32:35], v[28:31], v[164:167], v[32:35]
    s_nop 7
    v_mov_b32 v2, v32
    s_waitcnt vmcnt(0)
    s_barrier
    ds_read_b64_tr_b16 v[32:33], v12 offset:16384
    ds_read_b64_tr_b16 v[34:35], v12 offset:20480
    ds_read_b64_tr_b16 v[36:37], v13 offset:16384
    ds_read_b64_tr_b16 v[38:39], v13 offset:20480
    ds_read_b64_tr_b16 v[40:41], v14 offset:16384
    ds_read_b64_tr_b16 v[42:43], v14 offset:20480
    ds_read_b64_tr_b16 v[44:45], v15 offset:16384
    ds_read_b64_tr_b16 v[46:47], v15 offset:20480
    ds_read_b64_tr_b16 v[48:49], v16 offset:16384
    ds_read_b64_tr_b16 v[50:51], v16 offset:20480
    ds_read_b64_tr_b16 v[52:53], v17 offset:16384
    ds_read_b64_tr_b16 v[54:55], v17 offset:20480
    ds_read_b64_tr_b16 v[56:57], v18 offset:16384
    ds_read_b64_tr_b16 v[58:59], v18 offset:20480
    s_waitcnt lgkmcnt(12)
    v_mfma_f32_16x16x32_bf16 v[192:195], v[32:35], v[160:163], 0
    ds_read_b64_tr_b16 v[60:61], v19 offset:16384
    ds_read_b64_tr_b16 v[62:63], v19 offset:20480
    s_waitcnt lgkmcnt(10)
    v_mfma_f32_16x16x32_bf16 v[196:199], v[36:39], v[160:163], 0
    ds_read_b64_tr_b16 v[32:33], v12 offset:24576
    ds_read_b64_tr_b16 v[34:35], v12 offset:28672
    v_mfma_f32_16x16x32_bf16 v[200:203], v[40:43], v[160:163], 0
    ds_read_b64_tr_b16 v[36:37], v13 offset:24576
    ds_read_b64_tr_b16 v[38:39], v13 offset:28672
    s_waitcnt lgkmcnt(10)
    v_mfma_f32_16x16x32_bf16 v[204:207], v[44:47], v[160:163], 0
    ds_read_b64_tr_b16 v[40:41], v14 offset:24576
    ds_read_b64_tr_b16 v[42:43], v14 offset:28672
    v_mfma_f32_16x16x32_bf16 v[208:211], v[48:51], v[160:163], 0
    ds_read_b64_tr_b16 v[44:45], v15 offset:24576
    ds_read_b64_tr_b16 v[46:47], v15 offset:28672
    s_waitcnt lgkmcnt(10)
    v_mfma_f32_16x16x32_bf16 v[212:215], v[52:55], v[160:163], 0
    ds_read_b64_tr_b16 v[48:49], v16 offset:24576
    ds_read_b64_tr_b16 v[50:51], v16 offset:28672
    v_mfma_f32_16x16x32_bf16 v[216:219], v[56:59], v[160:163], 0
    ds_read_b64_tr_b16 v[52:53], v17 offset:24576
    ds_read_b64_tr_b16 v[54:55], v17 offset:28672
    s_waitcnt lgkmcnt(10)
    v_mfma_f32_16x16x32_bf16 v[220:223], v[60:63], v[160:163], 0
    ds_read_b64_tr_b16 v[56:57], v18 offset:24576
    ds_read_b64_tr_b16 v[58:59], v18 offset:28672
    v_mfma_f32_16x16x32_bf16 v[192:195], v[32:35], v[164:167], v[192:195]
    ds_read_b64_tr_b16 v[60:61], v19 offset:24576
    ds_read_b64_tr_b16 v[62:63], v19 offset:28672
    s_waitcnt lgkmcnt(10)
    v_mfma_f32_16x16x32_bf16 v[196:199], v[36:39], v[164:167], v[196:199]
    v_mfma_f32_16x16x32_bf16 v[200:203], v[40:43], v[164:167], v[200:203]
    s_waitcnt lgkmcnt(6)
    v_mfma_f32_16x16x32_bf16 v[204:207], v[44:47], v[164:167], v[204:207]
    v_mfma_f32_16x16x32_bf16 v[208:211], v[48:51], v[164:167], v[208:211]
    s_waitcnt lgkmcnt(2)
    v_mfma_f32_16x16x32_bf16 v[212:215], v[52:55], v[164:167], v[212:215]
    v_mfma_f32_16x16x32_bf16 v[216:219], v[56:59], v[164:167], v[216:219]
    s_waitcnt lgkmcnt(0)
    v_mfma_f32_16x16x32_bf16 v[220:223], v[60:63], v[164:167], v[220:223]
    s_branch L_A1_mid
L_A1_save0:
    v_cvt_pk_bf16_f32 v64, v192, v193
    v_cvt_pk_bf16_f32 v65, v194, v195
    v_cvt_pk_bf16_f32 v66, v196, v197
    v_cvt_pk_bf16_f32 v67, v198, v199
    v_cvt_pk_bf16_f32 v68, v200, v201
    v_cvt_pk_bf16_f32 v69, v202, v203
    v_cvt_pk_bf16_f32 v70, v204, v205
    v_cvt_pk_bf16_f32 v71, v206, v207
    v_cvt_pk_bf16_f32 v72, v208, v209
    v_cvt_pk_bf16_f32 v73, v210, v211
    v_cvt_pk_bf16_f32 v74, v212, v213
    v_cvt_pk_bf16_f32 v75, v214, v215
    v_cvt_pk_bf16_f32 v76, v216, v217
    v_cvt_pk_bf16_f32 v77, v218, v219
    v_cvt_pk_bf16_f32 v78, v220, v221
    v_cvt_pk_bf16_f32 v79, v222, v223
    s_branch L_A1_go
L_A1_save1:
    v_cvt_pk_bf16_f32 v96, v192, v193
    v_cvt_pk_bf16_f32 v97, v194, v195
    v_cvt_pk_bf16_f32 v98, v196, v197
    v_cvt_pk_bf16_f32 v99, v198, v199
    v_cvt_pk_bf16_f32 v100, v200, v201
    v_cvt_pk_bf16_f32 v101, v202, v203
    v_cvt_pk_bf16_f32 v102, v204, v205
    v_cvt_pk_bf16_f32 v103, v206, v207
    v_cvt_pk_bf16_f32 v104, v208, v209
    v_cvt_pk_bf16_f32 v105, v210, v211
    v_cvt_pk_bf16_f32 v106, v212, v213
    v_cvt_pk_bf16_f32 v107, v214, v215
    v_cvt_pk_bf16_f32 v108, v216, v217
    v_cvt_pk_bf16_f32 v109, v218, v219
    v_cvt_pk_bf16_f32 v110, v220, v221
    v_cvt_pk_bf16_f32 v111, v222, v223
    s_branch L_A1_go
L_A1_save2:
    v_cvt_pk_bf16_f32 v32, v192, v193
    v_cvt_pk_bf16_f32 v33, v194, v195
    v_cvt_pk_bf16_f32 v34, v196, v197
    v_cvt_pk_bf16_f32 v35, v198, v199
    v_cvt_pk_bf16_f32 v36, v200, v201
    v_cvt_pk_bf16_f32 v37, v202, v203
    v_cvt_pk_bf16_f32 v38, v204, v205
    v_cvt_pk_bf16_f32 v39, v206, v207
    v_cvt_pk_bf16_f32 v40, v208, v209
    v_cvt_pk_bf16_f32 v41, v210, v211
    v_cvt_pk_bf16_f32 v42, v212, v213
    v_cvt_pk_bf16_f32 v43, v214, v215
    v_cvt_pk_bf16_f32 v44, v216, v217
    v_cvt_pk_bf16_f32 v45, v218, v219
    v_cvt_pk_bf16_f32 v46, v220, v221
    v_cvt_pk_bf16_f32 v47, v222, v223
    ds_write_b128 v4, v[32:35] offset:0
    ds_write_b128 v4, v[36:39] offset:1024
    ds_write_b128 v4, v[40:43] offset:2048
    ds_write_b128 v4, v[44:47] offset:3072
    s_branch L_A1_go
.p2align 3
L_A1_loop:
    s_barrier
    ds_read_b128 v[32:35], v8 offset:0
    ds_read_b128 v[36:39], v8 offset:4096
    ds_read_b128 v[40:43], v8 offset:8192
    ds_read_b128 v[44:47], v8 offset:12288
    ds_read_b128 v[48:51], v9 offset:0
    ds_read_b128 v[52:55], v9 offset:4096
    ds_read_b128 v[56:59], v9 offset:8192
    s_waitcnt lgkmcnt(6)
    v_mfma_f32_16x16x32_bf16 v[160:163], v[32:35], v[128:131], v[20:23]
    ds_read_b128 v[60:63], v9 offset:12288
    s_waitcnt lgkmcnt(5)
    v_mfma_f32_16x16x32_bf16 v[164:167], v[36:39], v[128:131], v[20:23]
    ds_read_b128 v[32:35], v10 offset:0
    v_mfma_f32_16x16x32_bf16 v[168:171], v[40:43], v[128:131], v[20:23]
    ds_read_b128 v[36:39], v10 offset:4096
    s_waitcnt lgkmcnt(5)
    v_mfma_f32_16x16x32_bf16 v[172:175], v[44:47], v[128:131], v[20:23]
    ds_read_b128 v[40:43], v10 offset:8192
    v_mfma_f32_16x16x32_bf16 v[160:163], v[48:51], v[132:135], v[160:163]
    ds_read_b128 v[44:47], v10 offset:12288
    s_waitcnt lgkmcnt(5)
    v_mfma_f32_16x16x32_bf16 v[164:167], v[52:55], v[132:135], v[164:167]
    ds_read_b128 v[48:51], v11 offset:0
    v_mfma_f32_16x16x32_bf16 v[168:171], v[56:59], v[132:135], v[168:171]
    ds_read_b128 v[52:55], v11 offset:4096
    s_waitcnt lgkmcnt(5)
    v_mfma_f32_16x16x32_bf16 v[172:175], v[60:63], v[132:135], v[172:175]
    ds_read_b128 v[56:59], v11 offset:8192
    v_mfma_f32_16x16x32_bf16 v[160:163], v[32:35], v[136:139], v[160:163]
    ds_read_b128 v[60:63], v11 offset:12288
    s_waitcnt lgkmcnt(5)
    v_mfma_f32_16x16x32_bf16 v[164:167], v[36:39], v[136:139], v[164:167]
    v_mfma_f32_16x16x32_bf16 v[168:171], v[40:43], v[136:139], v[168:171]
    s_waitcnt lgkmcnt(3)
    v_mfma_f32_16x16x32_bf16 v[172:175], v[44:47], v[136:139], v[172:175]
    v_mfma_f32_16x16x32_bf16 v[160:163], v[48:51], v[140:143], v[160:163]
    s_waitcnt lgkmcnt(1)
    v_mfma_f32_16x16x32_bf16 v[164:167], v[52:55], v[140:143], v[164:167]
    v_mfma_f32_16x16x32_bf16 v[168:171], v[56:59], v[140:143], v[168:171]
    s_waitcnt lgkmcnt(0)
    v_mfma_f32_16x16x32_bf16 v[172:175], v[60:63], v[140:143], v[172:175]
    s_nop 4
L_A1_exp0:
    v_exp_f32 v160, v160
    v_exp_f32 v161, v161
    v_exp_f32 v162, v162
    v_cvt_pk_bf16_f32 v160, v160, v161
    v_exp_f32 v163, v163
    v_exp_f32 v164, v164
    v_cvt_pk_bf16_f32 v161, v162, v163
    v_exp_f32 v165, v165
    v_exp_f32 v166, v166
    v_cvt_pk_bf16_f32 v162, v164, v165
    v_exp_f32 v167, v167
    v_exp_f32 v168, v168
    v_cvt_pk_bf16_f32 v163, v166, v167
    v_exp_f32 v169, v169
    v_exp_f32 v170, v170
    v_cvt_pk_bf16_f32 v164, v168, v169
    v_exp_f32 v171, v171
    v_exp_f32 v172, v172
    v_cvt_pk_bf16_f32 v165, v170, v171
    v_exp_f32 v173, v173
    v_exp_f32 v174, v174
    v_cvt_pk_bf16_f32 v166, v172, v173
    v_exp_f32 v175, v175
    s_nop 0
    v_cvt_pk_bf16_f32 v167, v174, v175
    s_nop 0
    v_mfma_f32_16x16x32_bf16 v[32:35], v[28:31], v[160:163], 0
    v_mfma_f32_16x16x32_bf16 v[32:35], v[28:31], v[164:167], v[32:35]
    s_nop 7
    v_cmp_lt_f32 vcc, s87, v32
    s_cbranch_vccnz L_A1_slow0
    v_add_f32 v2, v2, v32
    s_barrier
    ds_read_b64_tr_b16 v[32:33], v12 offset:16384
    ds_read_b64_tr_b16 v[34:35], v12 offset:20480
    ds_read_b64_tr_b16 v[36:37], v13 offset:16384
    ds_read_b64_tr_b16 v[38:39], v13 offset:20480
    ds_read_b64_tr_b16 v[40:41], v14 offset:16384
    ds_read_b64_tr_b16 v[42:43], v14 offset:20480
    ds_read_b64_tr_b16 v[44:45], v15 offset:16384
    ds_read_b64_tr_b16 v[46:47], v15 offset:20480
    ds_read_b64_tr_b16 v[48:49], v16 offset:16384
    ds_read_b64_tr_b16 v[50:51], v16 offset:20480
    ds_read_b64_tr_b16 v[52:53], v17 offset:16384
    ds_read_b64_tr_b16 v[54:55], v17 offset:20480
    ds_read_b64_tr_b16 v[56:57], v18 offset:16384
    ds_read_b64_tr_b16 v[58:59], v18 offset:20480
    s_waitcnt lgkmcnt(12)
    v_mfma_f32_16x16x32_bf16 v[192:195], v[32:35], v[160:163], v[192:195]
    ds_read_b64_tr_b16 v[60:61], v19 offset:16384
    ds_read_b64_tr_b16 v[62:63], v19 offset:20480
    s_waitcnt lgkmcnt(10)
    v_mfma_f32_16x16x32_bf16 v[196:199], v[36:39], v[160:163], v[196:199]
    ds_read_b64_tr_b16 v[32:33], v12 offset:24576
    ds_read_b64_tr_b16 v[34:35], v12 offset:28672
    v_mfma_f32_16x16x32_bf16 v[200:203], v[40:43], v[160:163], v[200:203]
    ds_read_b64_tr_b16 v[36:37], v13 offset:24576
    ds_read_b64_tr_b16 v[38:39], v13 offset:28672
    s_waitcnt lgkmcnt(10)
    v_mfma_f32_16x16x32_bf16 v[204:207], v[44:47], v[160:163], v[204:207]
    ds_read_b64_tr_b16 v[40:41], v14 offset:24576
    ds_read_b64_tr_b16 v[42:43], v14 offset:28672
    v_mfma_f32_16x16x32_bf16 v[208:211], v[48:51], v[160:163], v[208:211]
    ds_read_b64_tr_b16 v[44:45], v15 offset:24576
    ds_read_b64_tr_b16 v[46:47], v15 offset:28672
    s_waitcnt lgkmcnt(10)
    v_mfma_f32_16x16x32_bf16 v[212:215], v[52:55], v[160:163], v[212:215]
    ds_read_b64_tr_b16 v[48:49], v16 offset:24576
    ds_read_b64_tr_b16 v[50:51], v16 offset:28672
    v_mfma_f32_16x16x32_bf16 v[216:219], v[56:59], v[160:163], v[216:219]
    ds_read_b64_tr_b16 v[52:53], v17 offset:24576
    ds_read_b64_tr_b16 v[54:55], v17 offset:28672
    s_waitcnt lgkmcnt(10)
    v_mfma_f32_16x16x32_bf16 v[220:223], v[60:63], v[160:163], v[220:223]
    ds_read_b64_tr_b16 v[56:57], v18 offset:24576
    ds_read_b64_tr_b16 v[58:59], v18 offset:28672
    v_mfma_f32_16x16x32_bf16 v[192:195], v[32:35], v[164:167], v[192:195]
    ds_read_b64_tr_b16 v[60:61], v19 offset:24576
    ds_read_b64_tr_b16 v[62:63], v19 offset:28672
    s_waitcnt lgkmcnt(10)
    v_mfma_f32_16x16x32_bf16 v[196:199], v[36:39], v[164:167], v[196:199]
    v_mfma_f32_16x16x32_bf16 v[200:203], v[40:43], v[164:167], v[200:203]
    s_waitcnt lgkmcnt(6)
    v_mfma_f32_16x16x32_bf16 v[204:207], v[44:47], v[164:167], v[204:207]
    v_mfma_f32_16x16x32_bf16 v[208:211], v[48:51], v[164:167], v[208:211]
    s_waitcnt lgkmcnt(2)
    v_mfma_f32_16x16x32_bf16 v[212:215], v[52:55], v[164:167], v[212:215]
    v_mfma_f32_16x16x32_bf16 v[216:219], v[56:59], v[164:167], v[216:219]
    s_waitcnt lgkmcnt(0)
    v_mfma_f32_16x16x32_bf16 v[220:223], v[60:63], v[164:167], v[220:223]
L_A1_mid:
    s_barrier
    s_sub_u32 s94, s94, 1
    s_cbranch_scc0 L_A1_noadd
    buffer_atomic_add v91, v90, s[64:67], 0 offen sc1
L_A1_noadd:
    ds_read_b128 v[32:35], v8 offset:32768
    ds_read_b128 v[36:39], v8 offset:36864
    ds_read_b128 v[40:43], v8 offset:40960
    ds_read_b128 v[44:47], v8 offset:45056
    ds_read_b128 v[48:51], v9 offset:32768
    ds_read_b128 v[52:55], v9 offset:36864
    ds_read_b128 v[56:59], v9 offset:40960
    s_waitcnt lgkmcnt(6)
    v_mfma_f32_16x16x32_bf16 v[160:163], v[32:35], v[128:131], v[20:23]
    ds_read_b128 v[60:63], v9 offset:45056
    s_waitcnt lgkmcnt(5)
    v_mfma_f32_16x16x32_bf16 v[164:167], v[36:39], v[128:131], v[20:23]
    ds_read_b128 v[32:35], v10 offset:32768
    v_mfma_f32_16x16x32_bf16 v[168:171], v[40:43], v[128:131], v[20:23]
    ds_read_b128 v[36:39], v10 offset:36864
    s_waitcnt lgkmcnt(5)
    v_mfma_f32_16x16x32_bf16 v[172:175], v[44:47], v[128:131], v[20:23]
    ds_read_b128 v[40:43], v10 offset:40960
    v_mfma_f32_16x16x32_bf16 v[160:163], v[48:51], v[132:135], v[160:163]
    ds_read_b128 v[44:47], v10 offset:45056
    s_waitcnt lgkmcnt(5)
    v_mfma_f32_16x16x32_bf16 v[164:167], v[52:55], v[132:135], v[164:167]
    ds_read_b128 v[48:51], v11 offset:32768
    v_mfma_f32_16x16x32_bf16 v[168:171], v[56:59], v[132:135], v[168:171]
    ds_read_b128 v[52:55], v11 offset:36864
    s_waitcnt lgkmcnt(5)
    v_mfma_f32_16x16x32_bf16 v[172:175], v[60:63], v[132:135], v[172:175]
    ds_read_b128 v[56:59], v11 offset:40960
    v_mfma_f32_16x16x32_bf16 v[160:163], v[32:35], v[136:139], v[160:163]
    ds_read_b128 v[60:63], v11 offset:45056
    s_waitcnt lgkmcnt(5)
    v_mfma_f32_16x16x32_bf16 v[164:167], v[36:39], v[136:139], v[164:167]
    v_mfma_f32_16x16x32_bf16 v[168:171], v[40:43], v[136:139], v[168:171]
    s_waitcnt lgkmcnt(3)
    v_mfma_f32_16x16x32_bf16 v[172:175], v[44:47], v[136:139], v[172:175]
    v_mfma_f32_16x16x32_bf16 v[160:163], v[48:51], v[140:143], v[160:163]
    s_waitcnt lgkmcnt(1)
    v_mfma_f32_16x16x32_bf16 v[164:167], v[52:55], v[140:143], v[164:167]
    v_mfma_f32_16x16x32_bf16 v[168:171], v[56:59], v[140:143], v[168:171]
    s_waitcnt lgkmcnt(0)
    v_mfma_f32_16x16x32_bf16 v[172:175], v[60:63], v[140:143], v[172:175]
    s_nop 4
L_A1_exp1:
    v_exp_f32 v160, v160
    v_exp_f32 v161, v161
    v_exp_f32 v162, v162
    v_cvt_pk_bf16_f32 v160, v160, v161
    v_exp_f32 v163, v163
    v_exp_f32 v164, v164
    v_cvt_pk_bf16_f32 v161, v162, v163
    v_exp_f32 v165, v165
    v_exp_f32 v166, v166
    v_cvt_pk_bf16_f32 v162, v164, v165
    v_exp_f32 v167, v167
    v_exp_f32 v168, v168
    v_cvt_pk_bf16_f32 v163, v166, v167
    v_exp_f32 v169, v169
    v_exp_f32 v170, v170
    v_cvt_pk_bf16_f32 v164, v168, v169
    v_exp_f32 v171, v171
    v_exp_f32 v172, v172
    v_cvt_pk_bf16_f32 v165, v170, v171
    v_exp_f32 v173, v173
    v_exp_f32 v174, v174
    v_cvt_pk_bf16_f32 v166, v172, v173
    v_exp_f32 v175, v175
    s_nop 0
    v_cvt_pk_bf16_f32 v167, v174, v175
    s_nop 0
    v_mfma_f32_16x16x32_bf16 v[32:35], v[28:31], v[160:163], 0
    v_mfma_f32_16x16x32_bf16 v[32:35], v[28:31], v[164:167], v[32:35]
    s_nop 7
    v_cmp_lt_f32 vcc, s87, v32
    s_cbranch_vccnz L_A1_slow1
    v_add_f32 v2, v2, v32
    s_barrier
    ds_read_b64_tr_b16 v[32:33], v12 offset:49152
    ds_read_b64_tr_b16 v[34:35], v12 offset:53248
    ds_read_b64_tr_b16 v[36:37], v13 offset:49152
    ds_read_b64_tr_b16 v[38:39], v13 offset:53248
    ds_read_b64_tr_b16 v[40:41], v14 offset:49152
    ds_read_b64_tr_b16 v[42:43], v14 offset:53248
    ds_read_b64_tr_b16 v[44:45], v15 offset:49152
    ds_read_b64_tr_b16 v[46:47], v15 offset:53248
    ds_read_b64_tr_b16 v[48:49], v16 offset:49152
    ds_read_b64_tr_b16 v[50:51], v16 offset:53248
    ds_read_b64_tr_b16 v[52:53], v17 offset:49152
    ds_read_b64_tr_b16 v[54:55], v17 offset:53248
    ds_read_b64_tr_b16 v[56:57], v18 offset:49152
    ds_read_b64_tr_b16 v[58:59], v18 offset:53248
    s_waitcnt lgkmcnt(12)
    v_mfma_f32_16x16x32_bf16 v[192:195], v[32:35], v[160:163], v[192:195]
    ds_read_b64_tr_b16 v[60:61], v19 offset:49152
    ds_read_b64_tr_b16 v[62:63], v19 offset:53248
    s_waitcnt lgkmcnt(10)
    v_mfma_f32_16x16x32_bf16 v[196:199], v[36:39], v[160:163], v[196:199]
    ds_read_b64_tr_b16 v[32:33], v12 offset:57344
    ds_read_b64_tr_b16 v[34:35], v12 offset:61440
    v_mfma_f32_16x16x32_bf16 v[200:203], v[40:43], v[160:163], v[200:203]
    ds_read_b64_tr_b16 v[36:37], v13 offset:57344
    ds_read_b64_tr_b16 v[38:39], v13 offset:61440
    s_waitcnt lgkmcnt(10)
    v_mfma_f32_16x16x32_bf16 v[204:207], v[44:47], v[160:163], v[204:207]
    ds_read_b64_tr_b16 v[40:41], v14 offset:57344
    ds_read_b64_tr_b16 v[42:43], v14 offset:61440
    v_mfma_f32_16x16x32_bf16 v[208:211], v[48:51], v[160:163], v[208:211]
    ds_read_b64_tr_b16 v[44:45], v15 offset:57344
    ds_read_b64_tr_b16 v[46:47], v15 offset:61440
    s_waitcnt lgkmcnt(10)
    v_mfma_f32_16x16x32_bf16 v[212:215], v[52:55], v[160:163], v[212:215]
    ds_read_b64_tr_b16 v[48:49], v16 offset:57344
    ds_read_b64_tr_b16 v[50:51], v16 offset:61440
    v_mfma_f32_16x16x32_bf16 v[216:219], v[56:59], v[160:163], v[216:219]
    ds_read_b64_tr_b16 v[52:53], v17 offset:57344
    ds_read_b64_tr_b16 v[54:55], v17 offset:61440
    s_waitcnt lgkmcnt(10)
    v_mfma_f32_16x16x32_bf16 v[220:223], v[60:63], v[160:163], v[220:223]
    ds_read_b64_tr_b16 v[56:57], v18 offset:57344
    ds_read_b64_tr_b16 v[58:59], v18 offset:61440
    v_mfma_f32_16x16x32_bf16 v[192:195], v[32:35], v[164:167], v[192:195]
    ds_read_b64_tr_b16 v[60:61], v19 offset:57344
    ds_read_b64_tr_b16 v[62:63], v19 offset:61440
    s_waitcnt lgkmcnt(10)
    v_mfma_f32_16x16x32_bf16 v[196:199], v[36:39], v[164:167], v[196:199]
    v_mfma_f32_16x16x32_bf16 v[200:203], v[40:43], v[164:167], v[200:203]
    s_waitcnt lgkmcnt(6)
    v_mfma_f32_16x16x32_bf16 v[204:207], v[44:47], v[164:167], v[204:207]
    v_mfma_f32_16x16x32_bf16 v[208:211], v[48:51], v[164:167], v[208:211]
    s_waitcnt lgkmcnt(2)
    v_mfma_f32_16x16x32_bf16 v[212:215], v[52:55], v[164:167], v[212:215]
    v_mfma_f32_16x16x32_bf16 v[216:219], v[56:59], v[164:167], v[216:219]
    s_waitcnt lgkmcnt(0)
    v_mfma_f32_16x16x32_bf16 v[220:223], v[60:63], v[164:167], v[220:223]
    s_sub_u32 s81, s81, 1
    s_cmp_lg_u32 s81, 0
    s_cbranch_scc1 L_A1_loop
    s_add_u32 s82, s82, 1
    s_branch L_A1_item
L_A1_slow0:
    ds_read_b128 v[32:35], v8 offset:0
    ds_read_b128 v[36:39], v8 offset:4096
    ds_read_b128 v[40:43], v8 offset:8192
    ds_read_b128 v[44:47], v8 offset:12288
    ds_read_b128 v[48:51], v9 offset:0
    ds_read_b128 v[52:55], v9 offset:4096
    ds_read_b128 v[56:59], v9 offset:8192
    s_waitcnt lgkmcnt(6)
    v_mfma_f32_16x16x32_bf16 v[160:163], v[32:35], v[128:131], v[20:23]
    ds_read_b128 v[60:63], v9 offset:12288
    s_waitcnt lgkmcnt(5)
    v_mfma_f32_16x16x32_bf16 v[164:167], v[36:39], v[128:131], v[20:23]
    ds_read_b128 v[32:35], v10 offset:0
    v_mfma_f32_16x16x32_bf16 v[168:171], v[40:43], v[128:131], v[20:23]
    ds_read_b128 v[36:39], v10 offset:4096
    s_waitcnt lgkmcnt(5)
    v_mfma_f32_16x16x32_bf16 v[172:175], v[44:47], v[128:131], v[20:23]
    ds_read_b128 v[40:43], v10 offset:8192
    v_mfma_f32_16x16x32_bf16 v[160:163], v[48:51], v[132:135], v[160:163]
    ds_read_b128 v[44:47], v10 offset:12288
    s_waitcnt lgkmcnt(5)
    v_mfma_f32_16x16x32_bf16 v[164:167], v[52:55], v[132:135], v[164:167]
    ds_read_b128 v[48:51], v11 offset:0
    v_mfma_f32_16x16x32_bf16 v[168:171], v[56:59], v[132:135], v[168:171]
    ds_read_b128 v[52:55], v11 offset:4096
    s_waitcnt lgkmcnt(5)
    v_mfma_f32_16x16x32_bf16 v[172:175], v[60:63], v[132:135], v[172:175]
    ds_read_b128 v[56:59], v11 offset:8192
    v_mfma_f32_16x16x32_bf16 v[160:163], v[32:35], v[136:139], v[160:163]
    ds_read_b128 v[60:63], v11 offset:12288
    s_waitcnt lgkmcnt(5)
    v_mfma_f32_16x16x32_bf16 v[164:167], v[36:39], v[136:139], v[164:167]
    v_mfma_f32_16x16x32_bf16 v[168:171], v[40:43], v[136:139], v[168:171]
    s_waitcnt lgkmcnt(3)
    v_mfma_f32_16x16x32_bf16 v[172:175], v[44:47], v[136:139], v[172:175]
    v_mfma_f32_16x16x32_bf16 v[160:163], v[48:51], v[140:143], v[160:163]
    s_waitcnt lgkmcnt(1)
    v_mfma_f32_16x16x32_bf16 v[164:167], v[52:55], v[140:143], v[164:167]
    v_mfma_f32_16x16x32_bf16 v[168:171], v[56:59], v[140:143], v[168:171]
    s_waitcnt lgkmcnt(0)
    v_mfma_f32_16x16x32_bf16 v[172:175], v[60:63], v[140:143], v[172:175]
    s_nop 7
    v_max3_f32 v32, v160, v161, v162
    v_max3_f32 v32, v32, v163, v164
    v_max3_f32 v32, v32, v165, v166
    v_max3_f32 v32, v32, v167, v168
    v_max3_f32 v32, v32, v169, v170
    v_max3_f32 v32, v32, v171, v172
    v_max3_f32 v32, v32, v173, v174
    v_max3_f32 v32, v32, v175, 0
    v_mov_b32 v33, v32
    s_nop 1
    v_permlane32_swap_b32 v32, v33
    s_nop 1
    v_max_f32 v32, v32, v33
    v_mov_b32 v33, v32
    s_nop 1
    v_permlane16_swap_b32 v32, v33
    s_nop 1
    v_max_f32 v32, v32, v33
    v_exp_f32 v33, -v32
    v_sub_f32 v20, v20, v32
    v_sub_f32 v21, v21, v32
    v_sub_f32 v22, v22, v32
    v_sub_f32 v23, v23, v32
    v_sub_f32 v160, v160, v32
    v_sub_f32 v161, v161, v32
    v_sub_f32 v162, v162, v32
    v_sub_f32 v163, v163, v32
    v_sub_f32 v164, v164, v32
    v_sub_f32 v165, v165, v32
    v_sub_f32 v166, v166, v32
    v_sub_f32 v167, v167, v32
    v_sub_f32 v168, v168, v32
    v_sub_f32 v169, v169, v32
    v_sub_f32 v170, v170, v32
    v_sub_f32 v171, v171, v32
    v_sub_f32 v172, v172, v32
    v_sub_f32 v173, v173, v32
    v_sub_f32 v174, v174, v32
    v_sub_f32 v175, v175, v32
    v_mul_f32 v2, v33, v2
    v_mul_f32 v192, v33, v192
    v_mul_f32 v193, v33, v193
    v_mul_f32 v194, v33, v194
    v_mul_f32 v195, v33, v195
    v_mul_f32 v196, v33, v196
    v_mul_f32 v197, v33, v197
    v_mul_f32 v198, v33, v198
    v_mul_f32 v199, v33, v199
    v_mul_f32 v200, v33, v200
    v_mul_f32 v201, v33, v201
    v_mul_f32 v202, v33, v202
    v_mul_f32 v203, v33, v203
    v_mul_f32 v204, v33, v204
    v_mul_f32 v205, v33, v205
    v_mul_f32 v206, v33, v206
    v_mul_f32 v207, v33, v207
    v_mul_f32 v208, v33, v208
    v_mul_f32 v209, v33, v209
    v_mul_f32 v210, v33, v210
    v_mul_f32 v211, v33, v211
    v_mul_f32 v212, v33, v212
    v_mul_f32 v213, v33, v213
    v_mul_f32 v214, v33, v214
    v_mul_f32 v215, v33, v215
    v_mul_f32 v216, v33, v216
    v_mul_f32 v217, v33, v217
    v_mul_f32 v218, v33, v218
    v_mul_f32 v219, v33, v219
    v_mul_f32 v220, v33, v220
    v_mul_f32 v221, v33, v221
    v_mul_f32 v222, v33, v222
    v_mul_f32 v223, v33, v223
    s_branch L_A1_exp0
L_A1_slow1:
    ds_read_b128 v[32:35], v8 offset:32768
    ds_read_b128 v[36:39], v8 offset:36864
    ds_read_b128 v[40:43], v8 offset:40960
    ds_read_b128 v[44:47], v8 offset:45056
    ds_read_b128 v[48:51], v9 offset:32768
    ds_read_b128 v[52:55], v9 offset:36864
    ds_read_b128 v[56:59], v9 offset:40960
    s_waitcnt lgkmcnt(6)
    v_mfma_f32_16x16x32_bf16 v[160:163], v[32:35], v[128:131], v[20:23]
    ds_read_b128 v[60:63], v9 offset:45056
    s_waitcnt lgkmcnt(5)
    v_mfma_f32_16x16x32_bf16 v[164:167], v[36:39], v[128:131], v[20:23]
    ds_read_b128 v[32:35], v10 offset:32768
    v_mfma_f32_16x16x32_bf16 v[168:171], v[40:43], v[128:131], v[20:23]
    ds_read_b128 v[36:39], v10 offset:36864
    s_waitcnt lgkmcnt(5)
    v_mfma_f32_16x16x32_bf16 v[172:175], v[44:47], v[128:131], v[20:23]
    ds_read_b128 v[40:43], v10 offset:40960
    v_mfma_f32_16x16x32_bf16 v[160:163], v[48:51], v[132:135], v[160:163]
    ds_read_b128 v[44:47], v10 offset:45056
    s_waitcnt lgkmcnt(5)
    v_mfma_f32_16x16x32_bf16 v[164:167], v[52:55], v[132:135], v[164:167]
    ds_read_b128 v[48:51], v11 offset:32768
    v_mfma_f32_16x16x32_bf16 v[168:171], v[56:59], v[132:135], v[168:171]
    ds_read_b128 v[52:55], v11 offset:36864
    s_waitcnt lgkmcnt(5)
    v_mfma_f32_16x16x32_bf16 v[172:175], v[60:63], v[132:135], v[172:175]
    ds_read_b128 v[56:59], v11 offset:40960
    v_mfma_f32_16x16x32_bf16 v[160:163], v[32:35], v[136:139], v[160:163]
    ds_read_b128 v[60:63], v11 offset:45056
    s_waitcnt lgkmcnt(5)
    v_mfma_f32_16x16x32_bf16 v[164:167], v[36:39], v[136:139], v[164:167]
    v_mfma_f32_16x16x32_bf16 v[168:171], v[40:43], v[136:139], v[168:171]
    s_waitcnt lgkmcnt(3)
    v_mfma_f32_16x16x32_bf16 v[172:175], v[44:47], v[136:139], v[172:175]
    v_mfma_f32_16x16x32_bf16 v[160:163], v[48:51], v[140:143], v[160:163]
    s_waitcnt lgkmcnt(1)
    v_mfma_f32_16x16x32_bf16 v[164:167], v[52:55], v[140:143], v[164:167]
    v_mfma_f32_16x16x32_bf16 v[168:171], v[56:59], v[140:143], v[168:171]
    s_waitcnt lgkmcnt(0)
    v_mfma_f32_16x16x32_bf16 v[172:175], v[60:63], v[140:143], v[172:175]
    s_nop 7
    v_max3_f32 v32, v160, v161, v162
    v_max3_f32 v32, v32, v163, v164
    v_max3_f32 v32, v32, v165, v166
    v_max3_f32 v32, v32, v167, v168
    v_max3_f32 v32, v32, v169, v170
    v_max3_f32 v32, v32, v171, v172
    v_max3_f32 v32, v32, v173, v174
    v_max3_f32 v32, v32, v175, 0
    v_mov_b32 v33, v32
    s_nop 1
    v_permlane32_swap_b32 v32, v33
    s_nop 1
    v_max_f32 v32, v32, v33
    v_mov_b32 v33, v32
    s_nop 1
    v_permlane16_swap_b32 v32, v33
    s_nop 1
    v_max_f32 v32, v32, v33
    v_exp_f32 v33, -v32
    v_sub_f32 v20, v20, v32
    v_sub_f32 v21, v21, v32
    v_sub_f32 v22, v22, v32
    v_sub_f32 v23, v23, v32
    v_sub_f32 v160, v160, v32
    v_sub_f32 v161, v161, v32
    v_sub_f32 v162, v162, v32
    v_sub_f32 v163, v163, v32
    v_sub_f32 v164, v164, v32
    v_sub_f32 v165, v165, v32
    v_sub_f32 v166, v166, v32
    v_sub_f32 v167, v167, v32
    v_sub_f32 v168, v168, v32
    v_sub_f32 v169, v169, v32
    v_sub_f32 v170, v170, v32
    v_sub_f32 v171, v171, v32
    v_sub_f32 v172, v172, v32
    v_sub_f32 v173, v173, v32
    v_sub_f32 v174, v174, v32
    v_sub_f32 v175, v175, v32
    v_mul_f32 v2, v33, v2
    v_mul_f32 v192, v33, v192
    v_mul_f32 v193, v33, v193
    v_mul_f32 v194, v33, v194
    v_mul_f32 v195, v33, v195
    v_mul_f32 v196, v33, v196
    v_mul_f32 v197, v33, v197
    v_mul_f32 v198, v33, v198
    v_mul_f32 v199, v33, v199
    v_mul_f32 v200, v33, v200
    v_mul_f32 v201, v33, v201
    v_mul_f32 v202, v33, v202
    v_mul_f32 v203, v33, v203
    v_mul_f32 v204, v33, v204
    v_mul_f32 v205, v33, v205
    v_mul_f32 v206, v33, v206
    v_mul_f32 v207, v33, v207
    v_mul_f32 v208, v33, v208
    v_mul_f32 v209, v33, v209
    v_mul_f32 v210, v33, v210
    v_mul_f32 v211, v33, v211
    v_mul_f32 v212, v33, v212
    v_mul_f32 v213, v33, v213
    v_mul_f32 v214, v33, v214
    v_mul_f32 v215, v33, v215
    v_mul_f32 v216, v33, v216
    v_mul_f32 v217, v33, v217
    v_mul_f32 v218, v33, v218
    v_mul_f32 v219, v33, v219
    v_mul_f32 v220, v33, v220
    v_mul_f32 v221, v33, v221
    v_mul_f32 v222, v33, v222
    v_mul_f32 v223, v33, v223
    s_branch L_A1_exp1
L_A1_tail:
    ds_read_b128 v[128:131], v4 offset:0
    ds_read_b128 v[132:135], v4 offset:1024
    ds_read_b128 v[136:139], v4 offset:2048
    ds_read_b128 v[140:143], v4 offset:3072
    v_pk_mul_f32 v[192:193], v[20:21], v[192:193] op_sel_hi:[0,1]
    v_pk_mul_f32 v[194:195], v[20:21], v[194:195] op_sel_hi:[0,1]
    v_pk_mul_f32 v[196:197], v[20:21], v[196:197] op_sel_hi:[0,1]
    v_pk_mul_f32 v[198:199], v[20:21], v[198:199] op_sel_hi:[0,1]
    v_pk_mul_f32 v[200:201], v[20:21], v[200:201] op_sel_hi:[0,1]
    v_pk_mul_f32 v[202:203], v[20:21], v[202:203] op_sel_hi:[0,1]
    v_pk_mul_f32 v[204:205], v[20:21], v[204:205] op_sel_hi:[0,1]
    v_pk_mul_f32 v[206:207], v[20:21], v[206:207] op_sel_hi:[0,1]
    v_pk_mul_f32 v[208:209], v[20:21], v[208:209] op_sel_hi:[0,1]
    v_pk_mul_f32 v[210:211], v[20:21], v[210:211] op_sel_hi:[0,1]
    v_pk_mul_f32 v[212:213], v[20:21], v[212:213] op_sel_hi:[0,1]
    v_pk_mul_f32 v[214:215], v[20:21], v[214:215] op_sel_hi:[0,1]
    v_pk_mul_f32 v[216:217], v[20:21], v[216:217] op_sel_hi:[0,1]
    v_pk_mul_f32 v[218:219], v[20:21], v[218:219] op_sel_hi:[0,1]
    v_pk_mul_f32 v[220:221], v[20:21], v[220:221] op_sel_hi:[0,1]
    v_pk_mul_f32 v[222:223], v[20:21], v[222:223] op_sel_hi:[0,1]
    v_add_u32 v20, 0x10000, v12
    v_add_u32 v21, 0x10000, v13
    v_add_u32 v22, 0x10000, v14
    v_add_u32 v23, 0x10000, v15
    v_add_u32 v24, 0x10000, v16
    v_add_u32 v25, 0x10000, v17
    v_add_u32 v26, 0x10000, v18
    v_add_u32 v27, 0x10000, v19
    s_waitcnt lgkmcnt(0)
    s_setprio 2
    ds_read_b64_tr_b16 v[32:33], v20 offset:0
    ds_read_b64_tr_b16 v[34:35], v20 offset:4096
    ds_read_b64_tr_b16 v[36:37], v21 offset:0
    ds_read_b64_tr_b16 v[38:39], v21 offset:4096
    ds_read_b64_tr_b16 v[40:41], v22 offset:0
    ds_read_b64_tr_b16 v[42:43], v22 offset:4096
    ds_read_b64_tr_b16 v[44:45], v23 offset:0
    ds_read_b64_tr_b16 v[46:47], v23 offset:4096
    ds_read_b64_tr_b16 v[48:49], v20 offset:8192
    ds_read_b64_tr_b16 v[50:51], v20 offset:12288
    ds_read_b64_tr_b16 v[52:53], v21 offset:8192
    ds_read_b64_tr_b16 v[54:55], v21 offset:12288
    ds_read_b64_tr_b16 v[56:57], v22 offset:8192
    ds_read_b64_tr_b16 v[58:59], v22 offset:12288
    v_cvt_pk_bf16_f32 v160, v192, v193
    v_cvt_pk_bf16_f32 v161, v194, v195
    v_cvt_pk_bf16_f32 v162, v196, v197
    v_cvt_pk_bf16_f32 v163, v198, v199
    v_cvt_pk_bf16_f32 v164, v200, v201
    v_cvt_pk_bf16_f32 v165, v202, v203
    v_cvt_pk_bf16_f32 v166, v204, v205
    v_cvt_pk_bf16_f32 v167, v206, v207
    v_cvt_pk_bf16_f32 v168, v208, v209
    v_cvt_pk_bf16_f32 v169, v210, v211
    v_cvt_pk_bf16_f32 v170, v212, v213
    v_cvt_pk_bf16_f32 v171, v214, v215
    v_cvt_pk_bf16_f32 v172, v216, v217
    v_cvt_pk_bf16_f32 v173, v218, v219
    v_cvt_pk_bf16_f32 v174, v220, v221
    v_cvt_pk_bf16_f32 v175, v222, v223
    v_lshl_add_u32 v2, v0, 4, s79
    v_mov_b32 v3, 0x80000000
    s_mov_b32 s84, s80
    s_lshl_b32 s75, s80, 14
    s_mov_b32 s83, 0
    s_mov_b32 s88, 0
    s_mov_b32 s81, 4
.p2align 3
L_A1_op:
    s_waitcnt lgkmcnt(12)
    v_mfma_f32_16x16x32_bf16 v[192:195], v[32:35], v[64:67], 0
    ds_read_b64_tr_b16 v[60:61], v23 offset:8192
    ds_read_b64_tr_b16 v[62:63], v23 offset:12288
    s_waitcnt lgkmcnt(10)
    v_mfma_f32_16x16x32_bf16 v[196:199], v[36:39], v[64:67], 0
    ds_read_b64_tr_b16 v[32:33], v24 offset:0
    ds_read_b64_tr_b16 v[34:35], v24 offset:4096
    v_mfma_f32_16x16x32_bf16 v[200:203], v[40:43], v[64:67], 0
    ds_read_b64_tr_b16 v[36:37], v25 offset:0
    ds_read_b64_tr_b16 v[38:39], v25 offset:4096
    s_waitcnt lgkmcnt(10)
    v_mfma_f32_16x16x32_bf16 v[204:207], v[44:47], v[64:67], 0
    ds_read_b64_tr_b16 v[40:41], v26 offset:0
    ds_read_b64_tr_b16 v[42:43], v26 offset:4096
    v_cvt_pk_bf16_f32 v10, v224, v225
    v_cvt_pk_bf16_f32 v11, v226, v227
    v_mfma_f32_16x16x32_bf16 v[192:195], v[48:51], v[68:71], v[192:195]
    ds_read_b64_tr_b16 v[44:45], v27 offset:0
    ds_read_b64_tr_b16 v[46:47], v27 offset:4096
    v_cvt_pk_bf16_f32 v8, v228, v229
    v_cvt_pk_bf16_f32 v9, v230, v231
    s_waitcnt lgkmcnt(10)
    v_mfma_f32_16x16x32_bf16 v[196:199], v[52:55], v[68:71], v[196:199]
    ds_read_b64_tr_b16 v[48:49], v24 offset:8192
    ds_read_b64_tr_b16 v[50:51], v24 offset:12288
    buffer_store_dwordx4 v[8:11], v3, s[56:59], s83 offen offset:0 sc1
    v_mfma_f32_16x16x32_bf16 v[200:203], v[56:59], v[68:71], v[200:203]
    ds_read_b64_tr_b16 v[52:53], v25 offset:8192
    ds_read_b64_tr_b16 v[54:55], v25 offset:12288
    v_cvt_pk_bf16_f32 v30, v232, v233
    v_cvt_pk_bf16_f32 v31, v234, v235
    s_waitcnt lgkmcnt(10)
    v_mfma_f32_16x16x32_bf16 v[204:207], v[60:63], v[68:71], v[204:207]
    ds_read_b64_tr_b16 v[56:57], v26 offset:8192
    ds_read_b64_tr_b16 v[58:59], v26 offset:12288
    v_cvt_pk_bf16_f32 v28, v236, v237
    v_cvt_pk_bf16_f32 v29, v238, v239
    v_mfma_f32_16x16x32_bf16 v[192:195], v[32:35], v[72:75], v[192:195]
    ds_read_b64_tr_b16 v[60:61], v27 offset:8192
    ds_read_b64_tr_b16 v[62:63], v27 offset:12288
    buffer_store_dwordx4 v[28:31], v3, s[56:59], s83 offen offset:1024 sc1
    s_waitcnt lgkmcnt(10)
    v_mfma_f32_16x16x32_bf16 v[196:199], v[36:39], v[72:75], v[196:199]
    ds_read_b64_tr_b16 v[32:33], v20 offset:16384
    ds_read_b64_tr_b16 v[34:35], v20 offset:20480
    v_mfma_f32_16x16x32_bf16 v[200:203], v[40:43], v[72:75], v[200:203]
    ds_read_b64_tr_b16 v[36:37], v21 offset:16384
    ds_read_b64_tr_b16 v[38:39], v21 offset:20480
    s_waitcnt lgkmcnt(10)
    v_mfma_f32_16x16x32_bf16 v[204:207], v[44:47], v[72:75], v[204:207]
    ds_read_b64_tr_b16 v[40:41], v22 offset:16384
    ds_read_b64_tr_b16 v[42:43], v22 offset:20480
    v_mfma_f32_16x16x32_bf16 v[192:195], v[48:51], v[76:79], v[192:195]
    ds_read_b64_tr_b16 v[44:45], v23 offset:16384
    ds_read_b64_tr_b16 v[46:47], v23 offset:20480
    s_waitcnt lgkmcnt(10)
    v_mfma_f32_16x16x32_bf16 v[196:199], v[52:55], v[76:79], v[196:199]
    ds_read_b64_tr_b16 v[48:49], v20 offset:24576
    ds_read_b64_tr_b16 v[50:51], v20 offset:28672
    v_mfma_f32_16x16x32_bf16 v[200:203], v[56:59], v[76:79], v[200:203]
    ds_read_b64_tr_b16 v[52:53], v21 offset:24576
    ds_read_b64_tr_b16 v[54:55], v21 offset:28672
    s_waitcnt lgkmcnt(10)
    v_mfma_f32_16x16x32_bf16 v[204:207], v[60:63], v[76:79], v[204:207]
    ds_read_b64_tr_b16 v[56:57], v22 offset:24576
    ds_read_b64_tr_b16 v[58:59], v22 offset:28672
    s_barrier
    v_mfma_f32_16x16x32_bf16 v[192:195], v[32:35], v[96:99], v[192:195]
    ds_read_b64_tr_b16 v[60:61], v23 offset:24576
    ds_read_b64_tr_b16 v[62:63], v23 offset:28672
    s_waitcnt lgkmcnt(10)
    v_mfma_f32_16x16x32_bf16 v[196:199], v[36:39], v[96:99], v[196:199]
    ds_read_b64_tr_b16 v[32:33], v24 offset:16384
    ds_read_b64_tr_b16 v[34:35], v24 offset:20480
    v_mfma_f32_16x16x32_bf16 v[200:203], v[40:43], v[96:99], v[200:203]
    ds_read_b64_tr_b16 v[36:37], v25 offset:16384
    ds_read_b64_tr_b16 v[38:39], v25 offset:20480
    s_waitcnt lgkmcnt(10)
    v_mfma_f32_16x16x32_bf16 v[204:207], v[44:47], v[96:99], v[204:207]
    ds_read_b64_tr_b16 v[40:41], v26 offset:16384
    ds_read_b64_tr_b16 v[42:43], v26 offset:20480
    v_mfma_f32_16x16x32_bf16 v[192:195], v[48:51], v[100:103], v[192:195]
    ds_read_b64_tr_b16 v[44:45], v27 offset:16384
    ds_read_b64_tr_b16 v[46:47], v27 offset:20480
    s_add_u32 s84, s84, 1
    s_waitcnt lgkmcnt(10)
    v_mfma_f32_16x16x32_bf16 v[196:199], v[52:55], v[100:103], v[196:199]
    ds_read_b64_tr_b16 v[48:49], v24 offset:24576
    ds_read_b64_tr_b16 v[50:51], v24 offset:28672
    s_and_b32 s84, s84, 7
    v_mfma_f32_16x16x32_bf16 v[200:203], v[56:59], v[100:103], v[200:203]
    ds_read_b64_tr_b16 v[52:53], v25 offset:24576
    ds_read_b64_tr_b16 v[54:55], v25 offset:28672
    s_lshl_b32 s83, s84, 17
    s_waitcnt lgkmcnt(10)
    v_mfma_f32_16x16x32_bf16 v[204:207], v[60:63], v[100:103], v[204:207]
    ds_read_b64_tr_b16 v[56:57], v26 offset:24576
    ds_read_b64_tr_b16 v[58:59], v26 offset:28672
    s_add_u32 s83, s83, s75
    v_mfma_f32_16x16x32_bf16 v[192:195], v[32:35], v[104:107], v[192:195]
    ds_read_b64_tr_b16 v[60:61], v27 offset:24576
    ds_read_b64_tr_b16 v[62:63], v27 offset:28672
    s_waitcnt lgkmcnt(10)
    v_mfma_f32_16x16x32_bf16 v[196:199], v[36:39], v[104:107], v[196:199]
    ds_read_b64_tr_b16 v[32:33], v20 offset:32768
    ds_read_b64_tr_b16 v[34:35], v20 offset:36864
    v_mfma_f32_16x16x32_bf16 v[200:203], v[40:43], v[104:107], v[200:203]
    ds_read_b64_tr_b16 v[36:37], v21 offset:32768
    ds_read_b64_tr_b16 v[38:39], v21 offset:36864
    v_mov_b32 v3, v2
    s_waitcnt lgkmcnt(10)
    v_mfma_f32_16x16x32_bf16 v[204:207], v[44:47], v[104:107], v[204:207]
    ds_read_b64_tr_b16 v[40:41], v22 offset:32768
    ds_read_b64_tr_b16 v[42:43], v22 offset:36864
    v_mfma_f32_16x16x32_bf16 v[192:195], v[48:51], v[108:111], v[192:195]
    ds_read_b64_tr_b16 v[44:45], v23 offset:32768
    ds_read_b64_tr_b16 v[46:47], v23 offset:36864
    s_waitcnt lgkmcnt(10)
    v_mfma_f32_16x16x32_bf16 v[196:199], v[52:55], v[108:111], v[196:199]
    ds_read_b64_tr_b16 v[48:49], v20 offset:40960
    ds_read_b64_tr_b16 v[50:51], v20 offset:45056
    v_mfma_f32_16x16x32_bf16 v[200:203], v[56:59], v[108:111], v[200:203]
    ds_read_b64_tr_b16 v[52:53], v21 offset:40960
    ds_read_b64_tr_b16 v[54:55], v21 offset:45056
    s_waitcnt lgkmcnt(10)
    v_mfma_f32_16x16x32_bf16 v[204:207], v[60:63], v[108:111], v[204:207]
    ds_read_b64_tr_b16 v[56:57], v22 offset:40960
    ds_read_b64_tr_b16 v[58:59], v22 offset:45056
    s_barrier
    v_mfma_f32_16x16x32_bf16 v[192:195], v[32:35], v[128:131], v[192:195]
    ds_read_b64_tr_b16 v[60:61], v23 offset:40960
    ds_read_b64_tr_b16 v[62:63], v23 offset:45056
    s_waitcnt lgkmcnt(10)
    v_mfma_f32_16x16x32_bf16 v[196:199], v[36:39], v[128:131], v[196:199]
    ds_read_b64_tr_b16 v[32:33], v24 offset:32768
    ds_read_b64_tr_b16 v[34:35], v24 offset:36864
    v_mfma_f32_16x16x32_bf16 v[200:203], v[40:43], v[128:131], v[200:203]
    ds_read_b64_tr_b16 v[36:37], v25 offset:32768
    ds_read_b64_tr_b16 v[38:39], v25 offset:36864
    s_waitcnt lgkmcnt(10)
    v_mfma_f32_16x16x32_bf16 v[204:207], v[44:47], v[128:131], v[204:207]
    ds_read_b64_tr_b16 v[40:41], v26 offset:32768
    ds_read_b64_tr_b16 v[42:43], v26 offset:36864
    v_mfma_f32_16x16x32_bf16 v[192:195], v[48:51], v[132:135], v[192:195]
    ds_read_b64_tr_b16 v[44:45], v27 offset:32768
    ds_read_b64_tr_b16 v[46:47], v27 offset:36864
    s_waitcnt lgkmcnt(10)
    v_mfma_f32_16x16x32_bf16 v[196:199], v[52:55], v[132:135], v[196:199]
    ds_read_b64_tr_b16 v[48:49], v24 offset:40960
    ds_read_b64_tr_b16 v[50:51], v24 offset:45056
    v_mfma_f32_16x16x32_bf16 v[200:203], v[56:59], v[132:135], v[200:203]
    ds_read_b64_tr_b16 v[52:53], v25 offset:40960
    ds_read_b64_tr_b16 v[54:55], v25 offset:45056
    s_waitcnt lgkmcnt(10)
    v_mfma_f32_16x16x32_bf16 v[204:207], v[60:63], v[132:135], v[204:207]
    ds_read_b64_tr_b16 v[56:57], v26 offset:40960
    ds_read_b64_tr_b16 v[58:59], v26 offset:45056
    v_mfma_f32_16x16x32_bf16 v[192:195], v[32:35], v[136:139], v[192:195]
    ds_read_b64_tr_b16 v[60:61], v27 offset:40960
    ds_read_b64_tr_b16 v[62:63], v27 offset:45056
    s_waitcnt lgkmcnt(10)
    v_mfma_f32_16x16x32_bf16 v[196:199], v[36:39], v[136:139], v[196:199]
    ds_read_b64_tr_b16 v[32:33], v20 offset:49152
    ds_read_b64_tr_b16 v[34:35], v20 offset:53248
    v_mfma_f32_16x16x32_bf16 v[200:203], v[40:43], v[136:139], v[200:203]
    ds_read_b64_tr_b16 v[36:37], v21 offset:49152
    ds_read_b64_tr_b16 v[38:39], v21 offset:53248
    s_waitcnt lgkmcnt(10)
    v_mfma_f32_16x16x32_bf16 v[204:207], v[44:47], v[136:139], v[204:207]
    ds_read_b64_tr_b16 v[40:41], v22 offset:49152
    ds_read_b64_tr_b16 v[42:43], v22 offset:53248
    v_mfma_f32_16x16x32_bf16 v[192:195], v[48:51], v[140:143], v[192:195]
    ds_read_b64_tr_b16 v[44:45], v23 offset:49152
    ds_read_b64_tr_b16 v[46:47], v23 offset:53248
    s_waitcnt lgkmcnt(10)
    v_mfma_f32_16x16x32_bf16 v[196:199], v[52:55], v[140:143], v[196:199]
    ds_read_b64_tr_b16 v[48:49], v20 offset:57344
    ds_read_b64_tr_b16 v[50:51], v20 offset:61440
    v_mfma_f32_16x16x32_bf16 v[200:203], v[56:59], v[140:143], v[200:203]
    ds_read_b64_tr_b16 v[52:53], v21 offset:57344
    ds_read_b64_tr_b16 v[54:55], v21 offset:61440
    s_waitcnt lgkmcnt(10)
    v_mfma_f32_16x16x32_bf16 v[204:207], v[60:63], v[140:143], v[204:207]
    ds_read_b64_tr_b16 v[56:57], v22 offset:57344
    ds_read_b64_tr_b16 v[58:59], v22 offset:61440
    s_waitcnt vmcnt(0)
    s_barrier
    v_mfma_f32_16x16x32_bf16 v[192:195], v[32:35], v[160:163], v[192:195]
    ds_read_b64_tr_b16 v[60:61], v23 offset:57344
    ds_read_b64_tr_b16 v[62:63], v23 offset:61440
    v_mov_b32 v1, s88
    s_add_u32 s88, s88, 1
    buffer_store_dword v1, v5, s[60:63], 0 offen sc1
    s_waitcnt lgkmcnt(10)
    v_mfma_f32_16x16x32_bf16 v[196:199], v[36:39], v[160:163], v[196:199]
    ds_read_b64_tr_b16 v[32:33], v24 offset:49152
    ds_read_b64_tr_b16 v[34:35], v24 offset:53248
    v_mfma_f32_16x16x32_bf16 v[200:203], v[40:43], v[160:163], v[200:203]
    ds_read_b64_tr_b16 v[36:37], v25 offset:49152
    ds_read_b64_tr_b16 v[38:39], v25 offset:53248
    s_waitcnt lgkmcnt(10)
    v_mfma_f32_16x16x32_bf16 v[204:207], v[44:47], v[160:163], v[204:207]
    ds_read_b64_tr_b16 v[40:41], v26 offset:49152
    ds_read_b64_tr_b16 v[42:43], v26 offset:53248
    v_mfma_f32_16x16x32_bf16 v[192:195], v[48:51], v[164:167], v[192:195]
    ds_read_b64_tr_b16 v[44:45], v27 offset:49152
    ds_read_b64_tr_b16 v[46:47], v27 offset:53248
    s_waitcnt lgkmcnt(10)
    v_mfma_f32_16x16x32_bf16 v[196:199], v[52:55], v[164:167], v[196:199]
    ds_read_b64_tr_b16 v[48:49], v24 offset:57344
    ds_read_b64_tr_b16 v[50:51], v24 offset:61440
    v_mfma_f32_16x16x32_bf16 v[200:203], v[56:59], v[164:167], v[200:203]
    ds_read_b64_tr_b16 v[52:53], v25 offset:57344
    ds_read_b64_tr_b16 v[54:55], v25 offset:61440
    s_waitcnt lgkmcnt(10)
    v_mfma_f32_16x16x32_bf16 v[204:207], v[60:63], v[164:167], v[204:207]
    ds_read_b64_tr_b16 v[56:57], v26 offset:57344
    ds_read_b64_tr_b16 v[58:59], v26 offset:61440
    v_mfma_f32_16x16x32_bf16 v[192:195], v[32:35], v[168:171], v[192:195]
    ds_read_b64_tr_b16 v[60:61], v27 offset:57344
    ds_read_b64_tr_b16 v[62:63], v27 offset:61440
    s_waitcnt lgkmcnt(10)
    v_mfma_f32_16x16x32_bf16 v[196:199], v[36:39], v[168:171], v[196:199]
    ds_read_b64_tr_b16 v[32:33], v12 offset:0
    ds_read_b64_tr_b16 v[34:35], v12 offset:4096
    v_mfma_f32_16x16x32_bf16 v[200:203], v[40:43], v[168:171], v[200:203]
    ds_read_b64_tr_b16 v[36:37], v13 offset:0
    ds_read_b64_tr_b16 v[38:39], v13 offset:4096
    s_waitcnt lgkmcnt(10)
    v_mfma_f32_16x16x32_bf16 v[204:207], v[44:47], v[168:171], v[204:207]
    ds_read_b64_tr_b16 v[40:41], v14 offset:0
    ds_read_b64_tr_b16 v[42:43], v14 offset:4096
    v_mfma_f32_16x16x32_bf16 v[192:195], v[48:51], v[172:175], v[192:195]
    ds_read_b64_tr_b16 v[44:45], v15 offset:0
    ds_read_b64_tr_b16 v[46:47], v15 offset:4096
    s_waitcnt lgkmcnt(10)
    v_mfma_f32_16x16x32_bf16 v[196:199], v[52:55], v[172:175], v[196:199]
    ds_read_b64_tr_b16 v[48:49], v12 offset:8192
    ds_read_b64_tr_b16 v[50:51], v12 offset:12288
    v_mfma_f32_16x16x32_bf16 v[200:203], v[56:59], v[172:175], v[200:203]
    ds_read_b64_tr_b16 v[52:53], v13 offset:8192
    ds_read_b64_tr_b16 v[54:55], v13 offset:12288
    s_waitcnt lgkmcnt(10)
    v_mfma_f32_16x16x32_bf16 v[204:207], v[60:63], v[172:175], v[204:207]
    ds_read_b64_tr_b16 v[56:57], v14 offset:8192
    ds_read_b64_tr_b16 v[58:59], v14 offset:12288
    s_barrier
    v_mfma_f32_16x16x32_bf16 v[224:227], v[32:35], v[64:67], 0
    ds_read_b64_tr_b16 v[60:61], v15 offset:8192
    ds_read_b64_tr_b16 v[62:63], v15 offset:12288
    s_waitcnt lgkmcnt(10)
    v_mfma_f32_16x16x32_bf16 v[228:231], v[36:39], v[64:67], 0
    ds_read_b64_tr_b16 v[32:33], v16 offset:0
    ds_read_b64_tr_b16 v[34:35], v16 offset:4096
    v_mfma_f32_16x16x32_bf16 v[232:235], v[40:43], v[64:67], 0
    ds_read_b64_tr_b16 v[36:37], v17 offset:0
    ds_read_b64_tr_b16 v[38:39], v17 offset:4096
    s_waitcnt lgkmcnt(10)
    v_mfma_f32_16x16x32_bf16 v[236:239], v[44:47], v[64:67], 0
    ds_read_b64_tr_b16 v[40:41], v18 offset:0
    ds_read_b64_tr_b16 v[42:43], v18 offset:4096
    v_cvt_pk_bf16_f32 v8, v192, v193
    v_cvt_pk_bf16_f32 v9, v194, v195
    v_mfma_f32_16x16x32_bf16 v[224:227], v[48:51], v[68:71], v[224:227]
    ds_read_b64_tr_b16 v[44:45], v19 offset:0
    ds_read_b64_tr_b16 v[46:47], v19 offset:4096
    v_cvt_pk_bf16_f32 v10, v196, v197
    v_cvt_pk_bf16_f32 v11, v198, v199
    s_waitcnt lgkmcnt(10)
    v_mfma_f32_16x16x32_bf16 v[228:231], v[52:55], v[68:71], v[228:231]
    ds_read_b64_tr_b16 v[48:49], v16 offset:8192
    ds_read_b64_tr_b16 v[50:51], v16 offset:12288
    buffer_store_dwordx4 v[8:11], v2, s[56:59], s83 offen offset:0 sc1
    v_mfma_f32_16x16x32_bf16 v[232:235], v[56:59], v[68:71], v[232:235]
    ds_read_b64_tr_b16 v[52:53], v17 offset:8192
    ds_read_b64_tr_b16 v[54:55], v17 offset:12288
    v_cvt_pk_bf16_f32 v28, v200, v201
    v_cvt_pk_bf16_f32 v29, v202, v203
    s_waitcnt lgkmcnt(10)
    v_mfma_f32_16x16x32_bf16 v[236:239], v[60:63], v[68:71], v[236:239]
    ds_read_b64_tr_b16 v[56:57], v18 offset:8192
    ds_read_b64_tr_b16 v[58:59], v18 offset:12288
    v_cvt_pk_bf16_f32 v30, v204, v205
    v_cvt_pk_bf16_f32 v31, v206, v207
    v_mfma_f32_16x16x32_bf16 v[224:227], v[32:35], v[72:75], v[224:227]
    ds_read_b64_tr_b16 v[60:61], v19 offset:8192
    ds_read_b64_tr_b16 v[62:63], v19 offset:12288
    buffer_store_dwordx4 v[28:31], v2, s[56:59], s83 offen offset:1024 sc1
    s_waitcnt lgkmcnt(10)
    v_mfma_f32_16x16x32_bf16 v[228:231], v[36:39], v[72:75], v[228:231]
    ds_read_b64_tr_b16 v[32:33], v12 offset:16384
    ds_read_b64_tr_b16 v[34:35], v12 offset:20480
    v_mfma_f32_16x16x32_bf16 v[232:235], v[40:43], v[72:75], v[232:235]
    ds_read_b64_tr_b16 v[36:37], v13 offset:16384
    ds_read_b64_tr_b16 v[38:39], v13 offset:20480
    s_waitcnt lgkmcnt(10)
    v_mfma_f32_16x16x32_bf16 v[236:239], v[44:47], v[72:75], v[236:239]
    ds_read_b64_tr_b16 v[40:41], v14 offset:16384
    ds_read_b64_tr_b16 v[42:43], v14 offset:20480
    v_mfma_f32_16x16x32_bf16 v[224:227], v[48:51], v[76:79], v[224:227]
    ds_read_b64_tr_b16 v[44:45], v15 offset:16384
    ds_read_b64_tr_b16 v[46:47], v15 offset:20480
    s_waitcnt lgkmcnt(10)
    v_mfma_f32_16x16x32_bf16 v[228:231], v[52:55], v[76:79], v[228:231]
    ds_read_b64_tr_b16 v[48:49], v12 offset:24576
    ds_read_b64_tr_b16 v[50:51], v12 offset:28672
    v_mfma_f32_16x16x32_bf16 v[232:235], v[56:59], v[76:79], v[232:235]
    ds_read_b64_tr_b16 v[52:53], v13 offset:24576
    ds_read_b64_tr_b16 v[54:55], v13 offset:28672
    s_waitcnt lgkmcnt(10)
    v_mfma_f32_16x16x32_bf16 v[236:239], v[60:63], v[76:79], v[236:239]
    ds_read_b64_tr_b16 v[56:57], v14 offset:24576
    ds_read_b64_tr_b16 v[58:59], v14 offset:28672
    s_barrier
    v_mfma_f32_16x16x32_bf16 v[224:227], v[32:35], v[96:99], v[224:227]
    ds_read_b64_tr_b16 v[60:61], v15 offset:24576
    ds_read_b64_tr_b16 v[62:63], v15 offset:28672
    s_waitcnt lgkmcnt(10)
    v_mfma_f32_16x16x32_bf16 v[228:231], v[36:39], v[96:99], v[228:231]
    ds_read_b64_tr_b16 v[32:33], v16 offset:16384
    ds_read_b64_tr_b16 v[34:35], v16 offset:20480
    v_mfma_f32_16x16x32_bf16 v[232:235], v[40:43], v[96:99], v[232:235]
    ds_read_b64_tr_b16 v[36:37], v17 offset:16384
    ds_read_b64_tr_b16 v[38:39], v17 offset:20480
    s_waitcnt lgkmcnt(10)
    v_mfma_f32_16x16x32_bf16 v[236:239], v[44:47], v[96:99], v[236:239]
    ds_read_b64_tr_b16 v[40:41], v18 offset:16384
    ds_read_b64_tr_b16 v[42:43], v18 offset:20480
    v_mfma_f32_16x16x32_bf16 v[224:227], v[48:51], v[100:103], v[224:227]
    ds_read_b64_tr_b16 v[44:45], v19 offset:16384
    ds_read_b64_tr_b16 v[46:47], v19 offset:20480
    s_add_u32 s84, s84, 1
    s_waitcnt lgkmcnt(10)
    v_mfma_f32_16x16x32_bf16 v[228:231], v[52:55], v[100:103], v[228:231]
    ds_read_b64_tr_b16 v[48:49], v16 offset:24576
    ds_read_b64_tr_b16 v[50:51], v16 offset:28672
    s_and_b32 s84, s84, 7
    v_mfma_f32_16x16x32_bf16 v[232:235], v[56:59], v[100:103], v[232:235]
    ds_read_b64_tr_b16 v[52:53], v17 offset:24576
    ds_read_b64_tr_b16 v[54:55], v17 offset:28672
    s_lshl_b32 s83, s84, 17
    s_waitcnt lgkmcnt(10)
    v_mfma_f32_16x16x32_bf16 v[236:239], v[60:63], v[100:103], v[236:239]
    ds_read_b64_tr_b16 v[56:57], v18 offset:24576
    ds_read_b64_tr_b16 v[58:59], v18 offset:28672
    s_add_u32 s83, s83, s75
    v_mfma_f32_16x16x32_bf16 v[224:227], v[32:35], v[104:107], v[224:227]
    ds_read_b64_tr_b16 v[60:61], v19 offset:24576
    ds_read_b64_tr_b16 v[62:63], v19 offset:28672
    s_waitcnt lgkmcnt(10)
    v_mfma_f32_16x16x32_bf16 v[228:231], v[36:39], v[104:107], v[228:231]
    ds_read_b64_tr_b16 v[32:33], v12 offset:32768
    ds_read_b64_tr_b16 v[34:35], v12 offset:36864
    v_mfma_f32_16x16x32_bf16 v[232:235], v[40:43], v[104:107], v[232:235]
    ds_read_b64_tr_b16 v[36:37], v13 offset:32768
    ds_read_b64_tr_b16 v[38:39], v13 offset:36864
    s_waitcnt lgkmcnt(10)
    v_mfma_f32_16x16x32_bf16 v[236:239], v[44:47], v[104:107], v[236:239]
    ds_read_b64_tr_b16 v[40:41], v14 offset:32768
    ds_read_b64_tr_b16 v[42:43], v14 offset:36864
    v_mfma_f32_16x16x32_bf16 v[224:227], v[48:51], v[108:111], v[224:227]
    ds_read_b64_tr_b16 v[44:45], v15 offset:32768
    ds_read_b64_tr_b16 v[46:47], v15 offset:36864
    s_waitcnt lgkmcnt(10)
    v_mfma_f32_16x16x32_bf16 v[228:231], v[52:55], v[108:111], v[228:231]
    ds_read_b64_tr_b16 v[48:49], v12 offset:40960
    ds_read_b64_tr_b16 v[50:51], v12 offset:45056
    v_mfma_f32_16x16x32_bf16 v[232:235], v[56:59], v[108:111], v[232:235]
    ds_read_b64_tr_b16 v[52:53], v13 offset:40960
    ds_read_b64_tr_b16 v[54:55], v13 offset:45056
    s_waitcnt lgkmcnt(10)
    v_mfma_f32_16x16x32_bf16 v[236:239], v[60:63], v[108:111], v[236:239]
    ds_read_b64_tr_b16 v[56:57], v14 offset:40960
    ds_read_b64_tr_b16 v[58:59], v14 offset:45056
    s_barrier
    v_mfma_f32_16x16x32_bf16 v[224:227], v[32:35], v[128:131], v[224:227]
    ds_read_b64_tr_b16 v[60:61], v15 offset:40960
    ds_read_b64_tr_b16 v[62:63], v15 offset:45056
    s_waitcnt lgkmcnt(10)
    v_mfma_f32_16x16x32_bf16 v[228:231], v[36:39], v[128:131], v[228:231]
    ds_read_b64_tr_b16 v[32:33], v16 offset:32768
    ds_read_b64_tr_b16 v[34:35], v16 offset:36864
    v_mfma_f32_16x16x32_bf16 v[232:235], v[40:43], v[128:131], v[232:235]
    ds_read_b64_tr_b16 v[36:37], v17 offset:32768
    ds_read_b64_tr_b16 v[38:39], v17 offset:36864
    s_waitcnt lgkmcnt(10)
    v_mfma_f32_16x16x32_bf16 v[236:239], v[44:47], v[128:131], v[236:239]
    ds_read_b64_tr_b16 v[40:41], v18 offset:32768
    ds_read_b64_tr_b16 v[42:43], v18 offset:36864
    v_mfma_f32_16x16x32_bf16 v[224:227], v[48:51], v[132:135], v[224:227]
    ds_read_b64_tr_b16 v[44:45], v19 offset:32768
    ds_read_b64_tr_b16 v[46:47], v19 offset:36864
    s_waitcnt lgkmcnt(10)
    v_mfma_f32_16x16x32_bf16 v[228:231], v[52:55], v[132:135], v[228:231]
    ds_read_b64_tr_b16 v[48:49], v16 offset:40960
    ds_read_b64_tr_b16 v[50:51], v16 offset:45056
    v_mfma_f32_16x16x32_bf16 v[232:235], v[56:59], v[132:135], v[232:235]
    ds_read_b64_tr_b16 v[52:53], v17 offset:40960
    ds_read_b64_tr_b16 v[54:55], v17 offset:45056
    s_waitcnt lgkmcnt(10)
    v_mfma_f32_16x16x32_bf16 v[236:239], v[60:63], v[132:135], v[236:239]
    ds_read_b64_tr_b16 v[56:57], v18 offset:40960
    ds_read_b64_tr_b16 v[58:59], v18 offset:45056
    v_mfma_f32_16x16x32_bf16 v[224:227], v[32:35], v[136:139], v[224:227]
    ds_read_b64_tr_b16 v[60:61], v19 offset:40960
    ds_read_b64_tr_b16 v[62:63], v19 offset:45056
    s_waitcnt lgkmcnt(10)
    v_mfma_f32_16x16x32_bf16 v[228:231], v[36:39], v[136:139], v[228:231]
    ds_read_b64_tr_b16 v[32:33], v12 offset:49152
    ds_read_b64_tr_b16 v[34:35], v12 offset:53248
    v_mfma_f32_16x16x32_bf16 v[232:235], v[40:43], v[136:139], v[232:235]
    ds_read_b64_tr_b16 v[36:37], v13 offset:49152
    ds_read_b64_tr_b16 v[38:39], v13 offset:53248
    s_waitcnt lgkmcnt(10)
    v_mfma_f32_16x16x32_bf16 v[236:239], v[44:47], v[136:139], v[236:239]
    ds_read_b64_tr_b16 v[40:41], v14 offset:49152
    ds_read_b64_tr_b16 v[42:43], v14 offset:53248
    v_mfma_f32_16x16x32_bf16 v[224:227], v[48:51], v[140:143], v[224:227]
    ds_read_b64_tr_b16 v[44:45], v15 offset:49152
    ds_read_b64_tr_b16 v[46:47], v15 offset:53248
    s_waitcnt lgkmcnt(10)
    v_mfma_f32_16x16x32_bf16 v[228:231], v[52:55], v[140:143], v[228:231]
    ds_read_b64_tr_b16 v[48:49], v12 offset:57344
    ds_read_b64_tr_b16 v[50:51], v12 offset:61440
    v_mfma_f32_16x16x32_bf16 v[232:235], v[56:59], v[140:143], v[232:235]
    ds_read_b64_tr_b16 v[52:53], v13 offset:57344
    ds_read_b64_tr_b16 v[54:55], v13 offset:61440
    s_waitcnt lgkmcnt(10)
    v_mfma_f32_16x16x32_bf16 v[236:239], v[60:63], v[140:143], v[236:239]
    ds_read_b64_tr_b16 v[56:57], v14 offset:57344
    ds_read_b64_tr_b16 v[58:59], v14 offset:61440
    s_waitcnt vmcnt(0)
    s_barrier
    v_mfma_f32_16x16x32_bf16 v[224:227], v[32:35], v[160:163], v[224:227]
    ds_read_b64_tr_b16 v[60:61], v15 offset:57344
    ds_read_b64_tr_b16 v[62:63], v15 offset:61440
    v_mov_b32 v1, s88
    s_add_u32 s88, s88, 1
    buffer_store_dword v1, v5, s[60:63], 0 offen sc1
    s_waitcnt lgkmcnt(10)
    v_mfma_f32_16x16x32_bf16 v[228:231], v[36:39], v[160:163], v[228:231]
    ds_read_b64_tr_b16 v[32:33], v16 offset:49152
    ds_read_b64_tr_b16 v[34:35], v16 offset:53248
    v_mfma_f32_16x16x32_bf16 v[232:235], v[40:43], v[160:163], v[232:235]
    ds_read_b64_tr_b16 v[36:37], v17 offset:49152
    ds_read_b64_tr_b16 v[38:39], v17 offset:53248
    s_waitcnt lgkmcnt(10)
    v_mfma_f32_16x16x32_bf16 v[236:239], v[44:47], v[160:163], v[236:239]
    ds_read_b64_tr_b16 v[40:41], v18 offset:49152
    ds_read_b64_tr_b16 v[42:43], v18 offset:53248
    v_mfma_f32_16x16x32_bf16 v[224:227], v[48:51], v[164:167], v[224:227]
    ds_read_b64_tr_b16 v[44:45], v19 offset:49152
    ds_read_b64_tr_b16 v[46:47], v19 offset:53248
    s_waitcnt lgkmcnt(10)
    v_mfma_f32_16x16x32_bf16 v[228:231], v[52:55], v[164:167], v[228:231]
    ds_read_b64_tr_b16 v[48:49], v16 offset:57344
    ds_read_b64_tr_b16 v[50:51], v16 offset:61440
    v_mfma_f32_16x16x32_bf16 v[232:235], v[56:59], v[164:167], v[232:235]
    ds_read_b64_tr_b16 v[52:53], v17 offset:57344
    ds_read_b64_tr_b16 v[54:55], v17 offset:61440
    s_waitcnt lgkmcnt(10)
    v_mfma_f32_16x16x32_bf16 v[236:239], v[60:63], v[164:167], v[236:239]
    ds_read_b64_tr_b16 v[56:57], v18 offset:57344
    ds_read_b64_tr_b16 v[58:59], v18 offset:61440
    v_mfma_f32_16x16x32_bf16 v[224:227], v[32:35], v[168:171], v[224:227]
    ds_read_b64_tr_b16 v[60:61], v19 offset:57344
    ds_read_b64_tr_b16 v[62:63], v19 offset:61440
    s_waitcnt lgkmcnt(10)
    v_mfma_f32_16x16x32_bf16 v[228:231], v[36:39], v[168:171], v[228:231]
    ds_read_b64_tr_b16 v[32:33], v20 offset:0
    ds_read_b64_tr_b16 v[34:35], v20 offset:4096
    v_mfma_f32_16x16x32_bf16 v[232:235], v[40:43], v[168:171], v[232:235]
    ds_read_b64_tr_b16 v[36:37], v21 offset:0
    ds_read_b64_tr_b16 v[38:39], v21 offset:4096
    s_waitcnt lgkmcnt(10)
    v_mfma_f32_16x16x32_bf16 v[236:239], v[44:47], v[168:171], v[236:239]
    ds_read_b64_tr_b16 v[40:41], v22 offset:0
    ds_read_b64_tr_b16 v[42:43], v22 offset:4096
    v_mfma_f32_16x16x32_bf16 v[224:227], v[48:51], v[172:175], v[224:227]
    ds_read_b64_tr_b16 v[44:45], v23 offset:0
    ds_read_b64_tr_b16 v[46:47], v23 offset:4096
    s_sub_u32 s81, s81, 1
    s_waitcnt lgkmcnt(10)
    v_mfma_f32_16x16x32_bf16 v[228:231], v[52:55], v[172:175], v[228:231]
    ds_read_b64_tr_b16 v[48:49], v20 offset:8192
    ds_read_b64_tr_b16 v[50:51], v20 offset:12288
    s_cmp_lg_u32 s81, 0
    v_mfma_f32_16x16x32_bf16 v[232:235], v[56:59], v[172:175], v[232:235]
    ds_read_b64_tr_b16 v[52:53], v21 offset:8192
    ds_read_b64_tr_b16 v[54:55], v21 offset:12288
    s_waitcnt lgkmcnt(12)
    v_mfma_f32_16x16x32_bf16 v[236:239], v[60:63], v[172:175], v[236:239]
    ds_read_b64_tr_b16 v[56:57], v22 offset:8192
    ds_read_b64_tr_b16 v[58:59], v22 offset:12288
    s_barrier
    s_cbranch_scc1 L_A1_op
    s_nop 7
    ds_write_b128 v4, v[224:227] offset:0
    ds_write_b128 v4, v[228:231] offset:1024
    ds_write_b128 v4, v[232:235] offset:2048
    ds_write_b128 v4, v[236:239] offset:3072
    s_waitcnt lgkmcnt(0)
    s_barrier
    s_endpgm
L_B2:
    v_lshrrev_b32 v32, 4, v0
    v_and_b32 v33, 15, v0
    v_lshlrev_b32 v34, 1, v32
    v_xor_b32 v34, v34, v33
    v_xor_b32 v35, 8, v34
    s_lshl_b32 s73, s72, 17
    v_lshl_add_u32 v36, v32, 13, s73
    v_lshl_add_u32 v10, v34, 4, v36
    v_lshl_add_u32 v11, v35, 4, v36
    v_add_u32 v11, 31744, v11
    v_lshl_add_u32 v12, v34, 4, v36
    v_add_u32 v12, 63488, v12
    v_lshl_add_u32 v13, v35, 4, v36
    v_add_u32 v13, 95232, v13
    s_lshl_b32 s73, s72, 12
    v_lshl_add_u32 v36, v32, 8, s73
    v_add_u32 v37, 0, v32
    v_xor_b32 v37, v37, v33
    v_lshl_add_u32 v4, v37, 4, v36
    v_add_u32 v37, 4, v32
    v_xor_b32 v37, v37, v33
    v_lshl_add_u32 v5, v37, 4, v36
    v_add_u32 v37, 8, v32
    v_xor_b32 v37, v37, v33
    v_lshl_add_u32 v6, v37, 4, v36
    v_add_u32 v37, 12, v32
    v_xor_b32 v37, v37, v33
    v_lshl_add_u32 v7, v37, 4, v36
    v_lshl_add_u32 v8, v34, 4, v36
    v_lshl_add_u32 v9, v35, 4, v36
    s_lshl_b32 s73, s72, 14
    v_lshl_add_u32 v36, v32, 10, s73
    v_lshrrev_b32 v37, 3, v34
    v_lshl_add_u32 v14, v37, 16, v36
    v_and_b32 v37, 7, v34
    v_lshl_add_u32 v14, v37, 4, v14
    v_lshrrev_b32 v37, 3, v35
    v_lshl_add_u32 v15, v37, 16, v36
    v_and_b32 v37, 7, v35
    v_lshl_add_u32 v15, v37, 4, v15
    v_add_u32 v15, 3072, v15
    v_add_u32 v16, 6144, v14
    v_add_u32 v17, 6144, v15
    v_lshrrev_b32 v28, 2, v0
    v_and_b32 v29, 7, v28
    v_lshlrev_b32 v28, 8, v28
    v_lshl_add_u32 v28, v29, 5, v28
    v_and_b32 v29, 3, v0
    v_lshl_add_u32 v28, v29, 3, v28
    v_add_u32 v28, 0x10000, v28
    v_xor_b32 v18, 0x0, v28
    v_xor_b32 v19, 0x20, v28
    v_xor_b32 v20, 0x40, v28
    v_xor_b32 v21, 0x60, v28
    v_xor_b32 v22, 0x80, v28
    v_xor_b32 v23, 0xa0, v28
    v_xor_b32 v24, 0xc0, v28
    v_xor_b32 v25, 0xe0, v28
    v_and_b32 v1, 15, v0
    v_lshrrev_b32 v2, 5, v0
    v_bfe_u32 v3, v0, 4, 1
    v_xor_b32 v28, v2, v1
    v_lshlrev_b32 v28, 4, v28
    v_lshl_add_u32 v28, v1, 8, v28
    v_lshl_add_u32 v28, v3, 3, v28
    v_add_u32 v26, s85, v28
    v_add_u32 v31, 0x20000, v26
    s_add_u32 s73, s85, 131072
    v_lshl_add_u32 v27, v2, 8, s73
    v_lshl_add_u32 v27, v1, 4, v27
    v_lshl_add_u32 v27, v3, 3, v27
    s_mov_b32 s92, 0x3e0293ee
    s_mov_b32 s93, 0x3e0293ee
    s_xor_b32 s78, s95, 524544
    s_and_b32 s82, s3, 0x60000
    s_xor_b32 s77, s3, 16384
    s_waitcnt lgkmcnt(0)
    s_cmp_lg_u32 s90, 0
    s_cselect_b32 s40, s16, s6
    s_cselect_b32 s41, s17, s7
    s_cselect_b32 s44, s18, s8
    s_cselect_b32 s45, s19, s9
    s_cselect_b32 s48, s20, s10
    s_cselect_b32 s49, s21, s11
    s_cselect_b32 s52, s22, s12
    s_cselect_b32 s53, s23, s13
    s_lshl_b32 s73, s89, 3
    s_add_u32 s73, s73, s80
    s_lshl_b32 s73, s73, 19
    s_add_u32 s40, s40, s73
    s_addc_u32 s41, s41, 0
    s_mov_b32 s42, 524288
    s_mov_b32 s43, 0x20000
    s_lshl_b32 s73, s89, 3
    s_add_u32 s73, s73, s80
    s_lshl_b32 s73, s73, 19
    s_add_u32 s44, s44, s73
    s_addc_u32 s45, s45, 0
    s_mov_b32 s46, 524288
    s_mov_b32 s47, 0x20000
    s_lshl_b32 s73, s80, 10
    s_sub_u32 s50, 0x400000, s73
    s_add_u32 s48, s48, s73
    s_addc_u32 s49, s49, 0
    s_mov_b32 s51, 0x20000
    s_lshl_b32 s73, s80, 19
    s_add_u32 s52, s52, s73
    s_addc_u32 s53, s53, 0
    s_mov_b32 s54, 524288
    s_mov_b32 s55, 0x20000
    s_lshl_b32 s73, s91, 20
    s_add_u32 s56, s24, s73
    s_addc_u32 s57, s25, 0
    s_mov_b32 s58, 1048576
    s_mov_b32 s59, 0x20000
    s_lshl_b32 s73, s91, 10
    s_add_u32 s73, s73, 33554432
    s_add_u32 s60, s24, s73
    s_addc_u32 s61, s25, 0
    s_mov_b32 s62, 1024
    s_mov_b32 s63, 0x20000
    s_lshl_b32 s73, s91, 2
    s_add_u32 s64, s34, s73
    s_addc_u32 s65, s35, 0
    s_mov_b32 s66, 4
    s_mov_b32 s67, 0x20000
    s_mul_i32 s73, s89, 229376
    s_add_u32 s68, s32, s73
    s_addc_u32 s69, s33, 0
    s_mov_b32 s70, 229376
    s_mov_b32 s71, 0x20000
    s_waitcnt vmcnt(0)
    s_barrier
    v_xor_b32 v28, 0x0, v31
    ds_read_b64 v[128:129], v28 offset:0
    ds_read_b64 v[192:193], v28 offset:4096
    v_xor_b32 v29, 0x20, v31
    ds_read_b64 v[130:131], v29 offset:0
    ds_read_b64 v[194:195], v29 offset:4096
    ds_read_b64_tr_b16 v[32:33], v18 offset:0
    ds_read_b64_tr_b16 v[34:35], v18 offset:4096
    ds_read_b64_tr_b16 v[36:37], v19 offset:0
    ds_read_b64_tr_b16 v[38:39], v19 offset:4096
    v_xor_b32 v28, 0x40, v31
    ds_read_b64 v[132:133], v28 offset:0
    ds_read_b64 v[196:197], v28 offset:4096
    v_xor_b32 v29, 0x60, v31
    ds_read_b64 v[134:135], v29 offset:0
    ds_read_b64 v[198:199], v29 offset:4096
    ds_read_b64_tr_b16 v[40:41], v20 offset:0
    ds_read_b64_tr_b16 v[42:43], v20 offset:4096
    ds_read_b64_tr_b16 v[44:45], v21 offset:0
    ds_read_b64_tr_b16 v[46:47], v21 offset:4096
    v_xor_b32 v28, 0x80, v31
    ds_read_b64 v[136:137], v28 offset:0
    ds_read_b64 v[200:201], v28 offset:4096
    v_xor_b32 v29, 0xa0, v31
    ds_read_b64 v[138:139], v29 offset:0
    ds_read_b64 v[202:203], v29 offset:4096
    ds_read_b64_tr_b16 v[48:49], v22 offset:0
    ds_read_b64_tr_b16 v[50:51], v22 offset:4096
    ds_read_b64_tr_b16 v[52:53], v23 offset:0
    ds_read_b64_tr_b16 v[54:55], v23 offset:4096
    v_xor_b32 v28, 0xc0, v31
    ds_read_b64 v[140:141], v28 offset:0
    ds_read_b64 v[204:205], v28 offset:4096
    v_xor_b32 v29, 0xe0, v31
    ds_read_b64 v[142:143], v29 offset:0
    ds_read_b64 v[206:207], v29 offset:4096
    ds_read_b64_tr_b16 v[56:57], v24 offset:0
    ds_read_b64_tr_b16 v[58:59], v24 offset:4096
    s_waitcnt lgkmcnt(14)
    v_mfma_f32_16x16x32_bf16 v[64:67], v[32:35], v[128:131], 0
    ds_read_b64_tr_b16 v[60:61], v25 offset:0
    v_mfma_f32_16x16x32_bf16 v[96:99], v[32:35], v[192:195], 0
    ds_read_b64_tr_b16 v[62:63], v25 offset:4096
    s_waitcnt lgkmcnt(14)
    v_mfma_f32_16x16x32_bf16 v[100:103], v[36:39], v[192:195], 0
    ds_read_b64_tr_b16 v[32:33], v18 offset:8192
    v_mfma_f32_16x16x32_bf16 v[68:71], v[36:39], v[128:131], 0
    ds_read_b64_tr_b16 v[34:35], v18 offset:12288
    v_mfma_f32_16x16x32_bf16 v[72:75], v[40:43], v[128:131], 0
    ds_read_b64_tr_b16 v[36:37], v19 offset:8192
    v_mfma_f32_16x16x32_bf16 v[104:107], v[40:43], v[192:195], 0
    ds_read_b64_tr_b16 v[38:39], v19 offset:12288
    s_waitcnt lgkmcnt(14)
    v_mfma_f32_16x16x32_bf16 v[108:111], v[44:47], v[192:195], 0
    ds_read_b64_tr_b16 v[40:41], v20 offset:8192
    v_mfma_f32_16x16x32_bf16 v[76:79], v[44:47], v[128:131], 0
    ds_read_b64_tr_b16 v[42:43], v20 offset:12288
    v_mfma_f32_16x16x32_bf16 v[80:83], v[48:51], v[128:131], 0
    ds_read_b64_tr_b16 v[44:45], v21 offset:8192
    v_mfma_f32_16x16x32_bf16 v[112:115], v[48:51], v[192:195], 0
    ds_read_b64_tr_b16 v[46:47], v21 offset:12288
    s_waitcnt lgkmcnt(10)
    v_mfma_f32_16x16x32_bf16 v[116:119], v[52:55], v[192:195], 0
    ds_read_b64_tr_b16 v[48:49], v22 offset:8192
    v_mfma_f32_16x16x32_bf16 v[84:87], v[52:55], v[128:131], 0
    ds_read_b64_tr_b16 v[50:51], v22 offset:12288
    v_mfma_f32_16x16x32_bf16 v[88:91], v[56:59], v[128:131], 0
    ds_read_b64_tr_b16 v[52:53], v23 offset:8192
    v_mfma_f32_16x16x32_bf16 v[120:123], v[56:59], v[192:195], 0
    ds_read_b64_tr_b16 v[54:55], v23 offset:12288
    s_waitcnt lgkmcnt(10)
    v_mfma_f32_16x16x32_bf16 v[124:127], v[60:63], v[192:195], 0
    ds_read_b64_tr_b16 v[56:57], v24 offset:8192
    v_mfma_f32_16x16x32_bf16 v[92:95], v[60:63], v[128:131], 0
    ds_read_b64_tr_b16 v[58:59], v24 offset:12288
    v_mfma_f32_16x16x32_bf16 v[64:67], v[32:35], v[132:135], v[64:67]
    ds_read_b64_tr_b16 v[60:61], v25 offset:8192
    v_mfma_f32_16x16x32_bf16 v[96:99], v[32:35], v[196:199], v[96:99]
    ds_read_b64_tr_b16 v[62:63], v25 offset:12288
    s_waitcnt lgkmcnt(10)
    v_mfma_f32_16x16x32_bf16 v[100:103], v[36:39], v[196:199], v[100:103]
    s_barrier
    ds_read_b64_tr_b16 v[32:33], v18 offset:16384
    v_mfma_f32_16x16x32_bf16 v[68:71], v[36:39], v[132:135], v[68:71]
    ds_read_b64_tr_b16 v[34:35], v18 offset:20480
    v_mfma_f32_16x16x32_bf16 v[72:75], v[40:43], v[132:135], v[72:75]
    ds_read_b64_tr_b16 v[36:37], v19 offset:16384
    v_mfma_f32_16x16x32_bf16 v[104:107], v[40:43], v[196:199], v[104:107]
    ds_read_b64_tr_b16 v[38:39], v19 offset:20480
    s_waitcnt lgkmcnt(10)
    v_mfma_f32_16x16x32_bf16 v[108:111], v[44:47], v[196:199], v[108:111]
    ds_read_b64_tr_b16 v[40:41], v20 offset:16384
    v_mfma_f32_16x16x32_bf16 v[76:79], v[44:47], v[132:135], v[76:79]
    ds_read_b64_tr_b16 v[42:43], v20 offset:20480
    v_mfma_f32_16x16x32_bf16 v[80:83], v[48:51], v[132:135], v[80:83]
    ds_read_b64_tr_b16 v[44:45], v21 offset:16384
    v_mfma_f32_16x16x32_bf16 v[112:115], v[48:51], v[196:199], v[112:115]
    ds_read_b64_tr_b16 v[46:47], v21 offset:20480
    s_waitcnt lgkmcnt(10)
    v_mfma_f32_16x16x32_bf16 v[116:119], v[52:55], v[196:199], v[116:119]
    ds_read_b64_tr_b16 v[48:49], v22 offset:16384
    v_mfma_f32_16x16x32_bf16 v[84:87], v[52:55], v[132:135], v[84:87]
    ds_read_b64_tr_b16 v[50:51], v22 offset:20480
    v_mfma_f32_16x16x32_bf16 v[88:91], v[56:59], v[132:135], v[88:91]
    ds_read_b64_tr_b16 v[52:53], v23 offset:16384
    v_mfma_f32_16x16x32_bf16 v[120:123], v[56:59], v[196:199], v[120:123]
    ds_read_b64_tr_b16 v[54:55], v23 offset:20480
    s_waitcnt lgkmcnt(10)
    v_mfma_f32_16x16x32_bf16 v[124:127], v[60:63], v[196:199], v[124:127]
    ds_read_b64_tr_b16 v[56:57], v24 offset:16384
    v_mfma_f32_16x16x32_bf16 v[92:95], v[60:63], v[132:135], v[92:95]
    ds_read_b64_tr_b16 v[58:59], v24 offset:20480
    v_mfma_f32_16x16x32_bf16 v[64:67], v[32:35], v[136:139], v[64:67]
    ds_read_b64_tr_b16 v[60:61], v25 offset:16384
    v_mfma_f32_16x16x32_bf16 v[96:99], v[32:35], v[200:203], v[96:99]
    ds_read_b64_tr_b16 v[62:63], v25 offset:20480
    s_waitcnt lgkmcnt(10)
    v_mfma_f32_16x16x32_bf16 v[100:103], v[36:39], v[200:203], v[100:103]
    ds_read_b64_tr_b16 v[32:33], v18 offset:24576
    v_mfma_f32_16x16x32_bf16 v[68:71], v[36:39], v[136:139], v[68:71]
    ds_read_b64_tr_b16 v[34:35], v18 offset:28672
    v_mfma_f32_16x16x32_bf16 v[72:75], v[40:43], v[136:139], v[72:75]
    ds_read_b64_tr_b16 v[36:37], v19 offset:24576
    v_mfma_f32_16x16x32_bf16 v[104:107], v[40:43], v[200:203], v[104:107]
    ds_read_b64_tr_b16 v[38:39], v19 offset:28672
    s_waitcnt lgkmcnt(10)
    v_mfma_f32_16x16x32_bf16 v[108:111], v[44:47], v[200:203], v[108:111]
    ds_read_b64_tr_b16 v[40:41], v20 offset:24576
    v_mfma_f32_16x16x32_bf16 v[76:79], v[44:47], v[136:139], v[76:79]
    ds_read_b64_tr_b16 v[42:43], v20 offset:28672
    v_mfma_f32_16x16x32_bf16 v[80:83], v[48:51], v[136:139], v[80:83]
    ds_read_b64_tr_b16 v[44:45], v21 offset:24576
    v_mfma_f32_16x16x32_bf16 v[112:115], v[48:51], v[200:203], v[112:115]
    ds_read_b64_tr_b16 v[46:47], v21 offset:28672
    s_waitcnt lgkmcnt(10)
    v_mfma_f32_16x16x32_bf16 v[116:119], v[52:55], v[200:203], v[116:119]
    ds_read_b64_tr_b16 v[48:49], v22 offset:24576
    v_mfma_f32_16x16x32_bf16 v[84:87], v[52:55], v[136:139], v[84:87]
    ds_read_b64_tr_b16 v[50:51], v22 offset:28672
    v_mfma_f32_16x16x32_bf16 v[88:91], v[56:59], v[136:139], v[88:91]
    ds_read_b64_tr_b16 v[52:53], v23 offset:24576
    v_mfma_f32_16x16x32_bf16 v[120:123], v[56:59], v[200:203], v[120:123]
    ds_read_b64_tr_b16 v[54:55], v23 offset:28672
    s_waitcnt lgkmcnt(10)
    v_mfma_f32_16x16x32_bf16 v[124:127], v[60:63], v[200:203], v[124:127]
    ds_read_b64_tr_b16 v[56:57], v24 offset:24576
    v_mfma_f32_16x16x32_bf16 v[92:95], v[60:63], v[136:139], v[92:95]
    ds_read_b64_tr_b16 v[58:59], v24 offset:28672
    v_mfma_f32_16x16x32_bf16 v[64:67], v[32:35], v[140:143], v[64:67]
    ds_read_b64_tr_b16 v[60:61], v25 offset:24576
    v_mfma_f32_16x16x32_bf16 v[96:99], v[32:35], v[204:207], v[96:99]
    ds_read_b64_tr_b16 v[62:63], v25 offset:28672
    s_waitcnt lgkmcnt(10)
    v_mfma_f32_16x16x32_bf16 v[100:103], v[36:39], v[204:207], v[100:103]
    s_barrier
    v_xor_b32 v28, 0x0, v26
    ds_read_b64 v[144:145], v28 offset:0
    ds_read_b64 v[208:209], v28 offset:4096
    v_xor_b32 v29, 0x20, v26
    v_mfma_f32_16x16x32_bf16 v[68:71], v[36:39], v[140:143], v[68:71]
    ds_read_b64 v[146:147], v29 offset:0
    ds_read_b64 v[210:211], v29 offset:4096
    ds_read_b64_tr_b16 v[32:33], v18 offset:32768
    ds_read_b64_tr_b16 v[34:35], v18 offset:36864
    v_mfma_f32_16x16x32_bf16 v[72:75], v[40:43], v[140:143], v[72:75]
    ds_read_b64_tr_b16 v[36:37], v19 offset:32768
    v_mfma_f32_16x16x32_bf16 v[104:107], v[40:43], v[204:207], v[104:107]
    ds_read_b64_tr_b16 v[38:39], v19 offset:36864
    s_waitcnt lgkmcnt(14)
    v_mfma_f32_16x16x32_bf16 v[108:111], v[44:47], v[204:207], v[108:111]
    v_xor_b32 v28, 0x40, v26
    ds_read_b64 v[148:149], v28 offset:0
    ds_read_b64 v[212:213], v28 offset:4096
    v_xor_b32 v29, 0x60, v26
    v_mfma_f32_16x16x32_bf16 v[76:79], v[44:47], v[140:143], v[76:79]
    ds_read_b64 v[150:151], v29 offset:0
    ds_read_b64 v[214:215], v29 offset:4096
    ds_read_b64_tr_b16 v[40:41], v20 offset:32768
    ds_read_b64_tr_b16 v[42:43], v20 offset:36864
    v_mfma_f32_16x16x32_bf16 v[80:83], v[48:51], v[140:143], v[80:83]
    ds_read_b64_tr_b16 v[44:45], v21 offset:32768
    v_mfma_f32_16x16x32_bf16 v[112:115], v[48:51], v[204:207], v[112:115]
    ds_read_b64_tr_b16 v[46:47], v21 offset:36864
    s_waitcnt lgkmcnt(14)
    v_mfma_f32_16x16x32_bf16 v[116:119], v[52:55], v[204:207], v[116:119]
    v_xor_b32 v28, 0x80, v26
    ds_read_b64 v[152:153], v28 offset:0
    ds_read_b64 v[216:217], v28 offset:4096
    v_xor_b32 v29, 0xa0, v26
    v_mfma_f32_16x16x32_bf16 v[84:87], v[52:55], v[140:143], v[84:87]
    ds_read_b64 v[154:155], v29 offset:0
    ds_read_b64 v[218:219], v29 offset:4096
    ds_read_b64_tr_b16 v[48:49], v22 offset:32768
    ds_read_b64_tr_b16 v[50:51], v22 offset:36864
    v_mfma_f32_16x16x32_bf16 v[88:91], v[56:59], v[140:143], v[88:91]
    ds_read_b64_tr_b16 v[52:53], v23 offset:32768
    v_mfma_f32_16x16x32_bf16 v[120:123], v[56:59], v[204:207], v[120:123]
    ds_read_b64_tr_b16 v[54:55], v23 offset:36864
    s_waitcnt lgkmcnt(14)
    v_mfma_f32_16x16x32_bf16 v[124:127], v[60:63], v[204:207], v[124:127]
    v_xor_b32 v28, 0xc0, v26
    ds_read_b64 v[156:157], v28 offset:0
    ds_read_b64 v[220:221], v28 offset:4096
    v_xor_b32 v29, 0xe0, v26
    v_mfma_f32_16x16x32_bf16 v[92:95], v[60:63], v[140:143], v[92:95]
    ds_read_b64 v[158:159], v29 offset:0
    ds_read_b64 v[222:223], v29 offset:4096
    ds_read_b64_tr_b16 v[56:57], v24 offset:32768
    ds_read_b64_tr_b16 v[58:59], v24 offset:36864
    v_mfma_f32_16x16x32_bf16 v[64:67], v[32:35], v[144:147], v[64:67]
    ds_read_b64_tr_b16 v[60:61], v25 offset:32768
    v_mfma_f32_16x16x32_bf16 v[96:99], v[32:35], v[208:211], v[96:99]
    ds_read_b64_tr_b16 v[62:63], v25 offset:36864
    s_waitcnt lgkmcnt(14)
    v_mfma_f32_16x16x32_bf16 v[100:103], v[36:39], v[208:211], v[100:103]
    ds_read_b64_tr_b16 v[32:33], v18 offset:40960
    v_mfma_f32_16x16x32_bf16 v[68:71], v[36:39], v[144:147], v[68:71]
    ds_read_b64_tr_b16 v[34:35], v18 offset:45056
    v_mfma_f32_16x16x32_bf16 v[72:75], v[40:43], v[144:147], v[72:75]
    ds_read_b64_tr_b16 v[36:37], v19 offset:40960
    v_mfma_f32_16x16x32_bf16 v[104:107], v[40:43], v[208:211], v[104:107]
    ds_read_b64_tr_b16 v[38:39], v19 offset:45056
    s_waitcnt lgkmcnt(14)
    v_mfma_f32_16x16x32_bf16 v[108:111], v[44:47], v[208:211], v[108:111]
    ds_read_b64_tr_b16 v[40:41], v20 offset:40960
    v_mfma_f32_16x16x32_bf16 v[76:79], v[44:47], v[144:147], v[76:79]
    ds_read_b64_tr_b16 v[42:43], v20 offset:45056
    v_mfma_f32_16x16x32_bf16 v[80:83], v[48:51], v[144:147], v[80:83]
    ds_read_b64_tr_b16 v[44:45], v21 offset:40960
    v_mfma_f32_16x16x32_bf16 v[112:115], v[48:51], v[208:211], v[112:115]
    ds_read_b64_tr_b16 v[46:47], v21 offset:45056
    s_waitcnt lgkmcnt(10)
    v_mfma_f32_16x16x32_bf16 v[116:119], v[52:55], v[208:211], v[116:119]
    ds_read_b64_tr_b16 v[48:49], v22 offset:40960
    v_mfma_f32_16x16x32_bf16 v[84:87], v[52:55], v[144:147], v[84:87]
    ds_read_b64_tr_b16 v[50:51], v22 offset:45056
    v_mfma_f32_16x16x32_bf16 v[88:91], v[56:59], v[144:147], v[88:91]
    ds_read_b64_tr_b16 v[52:53], v23 offset:40960
    v_mfma_f32_16x16x32_bf16 v[120:123], v[56:59], v[208:211], v[120:123]
    ds_read_b64_tr_b16 v[54:55], v23 offset:45056
    s_waitcnt lgkmcnt(10)
    v_mfma_f32_16x16x32_bf16 v[124:127], v[60:63], v[208:211], v[124:127]
    ds_read_b64_tr_b16 v[56:57], v24 offset:40960
    v_mfma_f32_16x16x32_bf16 v[92:95], v[60:63], v[144:147], v[92:95]
    ds_read_b64_tr_b16 v[58:59], v24 offset:45056
    v_mfma_f32_16x16x32_bf16 v[64:67], v[32:35], v[148:151], v[64:67]
    ds_read_b64_tr_b16 v[60:61], v25 offset:40960
    v_mfma_f32_16x16x32_bf16 v[96:99], v[32:35], v[212:215], v[96:99]
    ds_read_b64_tr_b16 v[62:63], v25 offset:45056
    s_waitcnt lgkmcnt(10)
    v_mfma_f32_16x16x32_bf16 v[100:103], v[36:39], v[212:215], v[100:103]
    s_barrier
    ds_read_b64_tr_b16 v[32:33], v18 offset:49152
    v_mfma_f32_16x16x32_bf16 v[68:71], v[36:39], v[148:151], v[68:71]
    ds_read_b64_tr_b16 v[34:35], v18 offset:53248
    v_mfma_f32_16x16x32_bf16 v[72:75], v[40:43], v[148:151], v[72:75]
    ds_read_b64_tr_b16 v[36:37], v19 offset:49152
    v_mfma_f32_16x16x32_bf16 v[104:107], v[40:43], v[212:215], v[104:107]
    ds_read_b64_tr_b16 v[38:39], v19 offset:53248
    s_waitcnt lgkmcnt(10)
    v_mfma_f32_16x16x32_bf16 v[108:111], v[44:47], v[212:215], v[108:111]
    ds_read_b64_tr_b16 v[40:41], v20 offset:49152
    v_mfma_f32_16x16x32_bf16 v[76:79], v[44:47], v[148:151], v[76:79]
    ds_read_b64_tr_b16 v[42:43], v20 offset:53248
    v_mfma_f32_16x16x32_bf16 v[80:83], v[48:51], v[148:151], v[80:83]
    ds_read_b64_tr_b16 v[44:45], v21 offset:49152
    v_mfma_f32_16x16x32_bf16 v[112:115], v[48:51], v[212:215], v[112:115]
    ds_read_b64_tr_b16 v[46:47], v21 offset:53248
    s_waitcnt lgkmcnt(10)
    v_mfma_f32_16x16x32_bf16 v[116:119], v[52:55], v[212:215], v[116:119]
    ds_read_b64_tr_b16 v[48:49], v22 offset:49152
    v_mfma_f32_16x16x32_bf16 v[84:87], v[52:55], v[148:151], v[84:87]
    ds_read_b64_tr_b16 v[50:51], v22 offset:53248
    v_mfma_f32_16x16x32_bf16 v[88:91], v[56:59], v[148:151], v[88:91]
    ds_read_b64_tr_b16 v[52:53], v23 offset:49152
    v_mfma_f32_16x16x32_bf16 v[120:123], v[56:59], v[212:215], v[120:123]
    ds_read_b64_tr_b16 v[54:55], v23 offset:53248
    s_waitcnt lgkmcnt(10)
    v_mfma_f32_16x16x32_bf16 v[124:127], v[60:63], v[212:215], v[124:127]
    ds_read_b64_tr_b16 v[56:57], v24 offset:49152
    v_mfma_f32_16x16x32_bf16 v[92:95], v[60:63], v[148:151], v[92:95]
    ds_read_b64_tr_b16 v[58:59], v24 offset:53248
    v_mfma_f32_16x16x32_bf16 v[64:67], v[32:35], v[152:155], v[64:67]
    ds_read_b64_tr_b16 v[60:61], v25 offset:49152
    v_mfma_f32_16x16x32_bf16 v[96:99], v[32:35], v[216:219], v[96:99]
    ds_read_b64_tr_b16 v[62:63], v25 offset:53248
    s_waitcnt lgkmcnt(10)
    v_mfma_f32_16x16x32_bf16 v[100:103], v[36:39], v[216:219], v[100:103]
    ds_read_b64_tr_b16 v[32:33], v18 offset:57344
    v_mfma_f32_16x16x32_bf16 v[68:71], v[36:39], v[152:155], v[68:71]
    ds_read_b64_tr_b16 v[34:35], v18 offset:61440
    v_mfma_f32_16x16x32_bf16 v[72:75], v[40:43], v[152:155], v[72:75]
    ds_read_b64_tr_b16 v[36:37], v19 offset:57344
    v_mfma_f32_16x16x32_bf16 v[104:107], v[40:43], v[216:219], v[104:107]
    ds_read_b64_tr_b16 v[38:39], v19 offset:61440
    s_waitcnt lgkmcnt(10)
    v_mfma_f32_16x16x32_bf16 v[108:111], v[44:47], v[216:219], v[108:111]
    ds_read_b64_tr_b16 v[40:41], v20 offset:57344
    v_mfma_f32_16x16x32_bf16 v[76:79], v[44:47], v[152:155], v[76:79]
    ds_read_b64_tr_b16 v[42:43], v20 offset:61440
    v_mfma_f32_16x16x32_bf16 v[80:83], v[48:51], v[152:155], v[80:83]
    ds_read_b64_tr_b16 v[44:45], v21 offset:57344
    v_mfma_f32_16x16x32_bf16 v[112:115], v[48:51], v[216:219], v[112:115]
    ds_read_b64_tr_b16 v[46:47], v21 offset:61440
    s_waitcnt lgkmcnt(10)
    v_mfma_f32_16x16x32_bf16 v[116:119], v[52:55], v[216:219], v[116:119]
    ds_read_b64_tr_b16 v[48:49], v22 offset:57344
    v_mfma_f32_16x16x32_bf16 v[84:87], v[52:55], v[152:155], v[84:87]
    ds_read_b64_tr_b16 v[50:51], v22 offset:61440
    v_mfma_f32_16x16x32_bf16 v[88:91], v[56:59], v[152:155], v[88:91]
    ds_read_b64_tr_b16 v[52:53], v23 offset:57344
    v_mfma_f32_16x16x32_bf16 v[120:123], v[56:59], v[216:219], v[120:123]
    ds_read_b64_tr_b16 v[54:55], v23 offset:61440
    s_waitcnt lgkmcnt(10)
    v_mfma_f32_16x16x32_bf16 v[124:127], v[60:63], v[216:219], v[124:127]
    ds_read_b64_tr_b16 v[56:57], v24 offset:57344
    v_mfma_f32_16x16x32_bf16 v[92:95], v[60:63], v[152:155], v[92:95]
    ds_read_b64_tr_b16 v[58:59], v24 offset:61440
    v_mfma_f32_16x16x32_bf16 v[64:67], v[32:35], v[156:159], v[64:67]
    ds_read_b64_tr_b16 v[60:61], v25 offset:57344
    v_mfma_f32_16x16x32_bf16 v[96:99], v[32:35], v[220:223], v[96:99]
    ds_read_b64_tr_b16 v[62:63], v25 offset:61440
    s_waitcnt lgkmcnt(10)
    v_mfma_f32_16x16x32_bf16 v[100:103], v[36:39], v[220:223], v[100:103]
    s_barrier
    v_xor_b32 v28, 0x0, v26
    ds_read_b64 v[160:161], v28 offset:32768
    ds_read_b64 v[224:225], v28 offset:36864
    v_xor_b32 v29, 0x20, v26
    v_mfma_f32_16x16x32_bf16 v[68:71], v[36:39], v[156:159], v[68:71]
    ds_read_b64 v[162:163], v29 offset:32768
    ds_read_b64 v[226:227], v29 offset:36864
    ds_read_b64_tr_b16 v[32:33], v18 offset:0
    ds_read_b64_tr_b16 v[34:35], v18 offset:4096
    v_mfma_f32_16x16x32_bf16 v[72:75], v[40:43], v[156:159], v[72:75]
    ds_read_b64_tr_b16 v[36:37], v19 offset:0
    v_mfma_f32_16x16x32_bf16 v[104:107], v[40:43], v[220:223], v[104:107]
    ds_read_b64_tr_b16 v[38:39], v19 offset:4096
    s_waitcnt lgkmcnt(14)
    v_mfma_f32_16x16x32_bf16 v[108:111], v[44:47], v[220:223], v[108:111]
    v_xor_b32 v28, 0x40, v26
    ds_read_b64 v[164:165], v28 offset:32768
    ds_read_b64 v[228:229], v28 offset:36864
    v_xor_b32 v29, 0x60, v26
    v_mfma_f32_16x16x32_bf16 v[76:79], v[44:47], v[156:159], v[76:79]
    ds_read_b64 v[166:167], v29 offset:32768
    ds_read_b64 v[230:231], v29 offset:36864
    ds_read_b64_tr_b16 v[40:41], v20 offset:0
    ds_read_b64_tr_b16 v[42:43], v20 offset:4096
    v_mfma_f32_16x16x32_bf16 v[80:83], v[48:51], v[156:159], v[80:83]
    ds_read_b64_tr_b16 v[44:45], v21 offset:0
    v_mfma_f32_16x16x32_bf16 v[112:115], v[48:51], v[220:223], v[112:115]
    ds_read_b64_tr_b16 v[46:47], v21 offset:4096
    s_waitcnt lgkmcnt(14)
    v_mfma_f32_16x16x32_bf16 v[116:119], v[52:55], v[220:223], v[116:119]
    v_xor_b32 v28, 0x80, v26
    ds_read_b64 v[168:169], v28 offset:32768
    ds_read_b64 v[232:233], v28 offset:36864
    v_xor_b32 v29, 0xa0, v26
    v_mfma_f32_16x16x32_bf16 v[84:87], v[52:55], v[156:159], v[84:87]
    ds_read_b64 v[170:171], v29 offset:32768
    ds_read_b64 v[234:235], v29 offset:36864
    ds_read_b64_tr_b16 v[48:49], v22 offset:0
    ds_read_b64_tr_b16 v[50:51], v22 offset:4096
    v_mfma_f32_16x16x32_bf16 v[88:91], v[56:59], v[156:159], v[88:91]
    ds_read_b64_tr_b16 v[52:53], v23 offset:0
    v_mfma_f32_16x16x32_bf16 v[120:123], v[56:59], v[220:223], v[120:123]
    ds_read_b64_tr_b16 v[54:55], v23 offset:4096
    s_waitcnt lgkmcnt(14)
    v_mfma_f32_16x16x32_bf16 v[124:127], v[60:63], v[220:223], v[124:127]
    v_xor_b32 v28, 0xc0, v26
    ds_read_b64 v[172:173], v28 offset:32768
    ds_read_b64 v[236:237], v28 offset:36864
    v_xor_b32 v29, 0xe0, v26
    v_mfma_f32_16x16x32_bf16 v[92:95], v[60:63], v[156:159], v[92:95]
    ds_read_b64 v[174:175], v29 offset:32768
    ds_read_b64 v[238:239], v29 offset:36864
    ds_read_b64_tr_b16 v[56:57], v24 offset:0
    ds_read_b64_tr_b16 v[58:59], v24 offset:4096
    v_mfma_f32_16x16x32_bf16 v[64:67], v[32:35], v[160:163], v[64:67]
    ds_read_b64_tr_b16 v[60:61], v25 offset:0
    v_mfma_f32_16x16x32_bf16 v[96:99], v[32:35], v[224:227], v[96:99]
    ds_read_b64_tr_b16 v[62:63], v25 offset:4096
    s_waitcnt lgkmcnt(14)
    v_mfma_f32_16x16x32_bf16 v[100:103], v[36:39], v[224:227], v[100:103]
    ds_read_b64_tr_b16 v[32:33], v18 offset:8192
    v_mfma_f32_16x16x32_bf16 v[68:71], v[36:39], v[160:163], v[68:71]
    ds_read_b64_tr_b16 v[34:35], v18 offset:12288
    v_mfma_f32_16x16x32_bf16 v[72:75], v[40:43], v[160:163], v[72:75]
    ds_read_b64_tr_b16 v[36:37], v19 offset:8192
    v_mfma_f32_16x16x32_bf16 v[104:107], v[40:43], v[224:227], v[104:107]
    ds_read_b64_tr_b16 v[38:39], v19 offset:12288
    s_waitcnt lgkmcnt(14)
    v_mfma_f32_16x16x32_bf16 v[108:111], v[44:47], v[224:227], v[108:111]
    ds_read_b64_tr_b16 v[40:41], v20 offset:8192
    v_mfma_f32_16x16x32_bf16 v[76:79], v[44:47], v[160:163], v[76:79]
    ds_read_b64_tr_b16 v[42:43], v20 offset:12288
    v_mfma_f32_16x16x32_bf16 v[80:83], v[48:51], v[160:163], v[80:83]
    ds_read_b64_tr_b16 v[44:45], v21 offset:8192
    v_mfma_f32_16x16x32_bf16 v[112:115], v[48:51], v[224:227], v[112:115]
    ds_read_b64_tr_b16 v[46:47], v21 offset:12288
    s_waitcnt lgkmcnt(10)
    v_mfma_f32_16x16x32_bf16 v[116:119], v[52:55], v[224:227], v[116:119]
    ds_read_b64_tr_b16 v[48:49], v22 offset:8192
    v_mfma_f32_16x16x32_bf16 v[84:87], v[52:55], v[160:163], v[84:87]
    ds_read_b64_tr_b16 v[50:51], v22 offset:12288
    v_mfma_f32_16x16x32_bf16 v[88:91], v[56:59], v[160:163], v[88:91]
    ds_read_b64_tr_b16 v[52:53], v23 offset:8192
    v_mfma_f32_16x16x32_bf16 v[120:123], v[56:59], v[224:227], v[120:123]
    ds_read_b64_tr_b16 v[54:55], v23 offset:12288
    s_waitcnt lgkmcnt(10)
    v_mfma_f32_16x16x32_bf16 v[124:127], v[60:63], v[224:227], v[124:127]
    ds_read_b64_tr_b16 v[56:57], v24 offset:8192
    v_mfma_f32_16x16x32_bf16 v[92:95], v[60:63], v[160:163], v[92:95]
    ds_read_b64_tr_b16 v[58:59], v24 offset:12288
    v_mfma_f32_16x16x32_bf16 v[64:67], v[32:35], v[164:167], v[64:67]
    ds_read_b64_tr_b16 v[60:61], v25 offset:8192
    v_mfma_f32_16x16x32_bf16 v[96:99], v[32:35], v[228:231], v[96:99]
    ds_read_b64_tr_b16 v[62:63], v25 offset:12288
    s_waitcnt lgkmcnt(10)
    v_mfma_f32_16x16x32_bf16 v[100:103], v[36:39], v[228:231], v[100:103]
    s_barrier
    ds_read_b64_tr_b16 v[32:33], v18 offset:16384
    v_mfma_f32_16x16x32_bf16 v[68:71], v[36:39], v[164:167], v[68:71]
    ds_read_b64_tr_b16 v[34:35], v18 offset:20480
    v_mfma_f32_16x16x32_bf16 v[72:75], v[40:43], v[164:167], v[72:75]
    ds_read_b64_tr_b16 v[36:37], v19 offset:16384
    v_mfma_f32_16x16x32_bf16 v[104:107], v[40:43], v[228:231], v[104:107]
    ds_read_b64_tr_b16 v[38:39], v19 offset:20480
    s_waitcnt lgkmcnt(10)
    v_mfma_f32_16x16x32_bf16 v[108:111], v[44:47], v[228:231], v[108:111]
    ds_read_b64_tr_b16 v[40:41], v20 offset:16384
    v_mfma_f32_16x16x32_bf16 v[76:79], v[44:47], v[164:167], v[76:79]
    ds_read_b64_tr_b16 v[42:43], v20 offset:20480
    v_mfma_f32_16x16x32_bf16 v[80:83], v[48:51], v[164:167], v[80:83]
    ds_read_b64_tr_b16 v[44:45], v21 offset:16384
    v_mfma_f32_16x16x32_bf16 v[112:115], v[48:51], v[228:231], v[112:115]
    ds_read_b64_tr_b16 v[46:47], v21 offset:20480
    s_waitcnt lgkmcnt(10)
    v_mfma_f32_16x16x32_bf16 v[116:119], v[52:55], v[228:231], v[116:119]
    ds_read_b64_tr_b16 v[48:49], v22 offset:16384
    v_mfma_f32_16x16x32_bf16 v[84:87], v[52:55], v[164:167], v[84:87]
    ds_read_b64_tr_b16 v[50:51], v22 offset:20480
    v_mfma_f32_16x16x32_bf16 v[88:91], v[56:59], v[164:167], v[88:91]
    ds_read_b64_tr_b16 v[52:53], v23 offset:16384
    v_mfma_f32_16x16x32_bf16 v[120:123], v[56:59], v[228:231], v[120:123]
    ds_read_b64_tr_b16 v[54:55], v23 offset:20480
    s_waitcnt lgkmcnt(10)
    v_mfma_f32_16x16x32_bf16 v[124:127], v[60:63], v[228:231], v[124:127]
    ds_read_b64_tr_b16 v[56:57], v24 offset:16384
    v_mfma_f32_16x16x32_bf16 v[92:95], v[60:63], v[164:167], v[92:95]
    ds_read_b64_tr_b16 v[58:59], v24 offset:20480
    v_mfma_f32_16x16x32_bf16 v[64:67], v[32:35], v[168:171], v[64:67]
    ds_read_b64_tr_b16 v[60:61], v25 offset:16384
    v_mfma_f32_16x16x32_bf16 v[96:99], v[32:35], v[232:235], v[96:99]
    ds_read_b64_tr_b16 v[62:63], v25 offset:20480
    s_waitcnt lgkmcnt(10)
    v_mfma_f32_16x16x32_bf16 v[100:103], v[36:39], v[232:235], v[100:103]
    ds_read_b64_tr_b16 v[32:33], v18 offset:24576
    v_mfma_f32_16x16x32_bf16 v[68:71], v[36:39], v[168:171], v[68:71]
    ds_read_b64_tr_b16 v[34:35], v18 offset:28672
    v_mfma_f32_16x16x32_bf16 v[72:75], v[40:43], v[168:171], v[72:75]
    ds_read_b64_tr_b16 v[36:37], v19 offset:24576
    v_mfma_f32_16x16x32_bf16 v[104:107], v[40:43], v[232:235], v[104:107]
    ds_read_b64_tr_b16 v[38:39], v19 offset:28672
    s_waitcnt lgkmcnt(10)
    v_mfma_f32_16x16x32_bf16 v[108:111], v[44:47], v[232:235], v[108:111]
    ds_read_b64_tr_b16 v[40:41], v20 offset:24576
    v_mfma_f32_16x16x32_bf16 v[76:79], v[44:47], v[168:171], v[76:79]
    ds_read_b64_tr_b16 v[42:43], v20 offset:28672
    v_mfma_f32_16x16x32_bf16 v[80:83], v[48:51], v[168:171], v[80:83]
    ds_read_b64_tr_b16 v[44:45], v21 offset:24576
    v_mfma_f32_16x16x32_bf16 v[112:115], v[48:51], v[232:235], v[112:115]
    ds_read_b64_tr_b16 v[46:47], v21 offset:28672
    s_waitcnt lgkmcnt(10)
    v_mfma_f32_16x16x32_bf16 v[116:119], v[52:55], v[232:235], v[116:119]
    ds_read_b64_tr_b16 v[48:49], v22 offset:24576
    v_mfma_f32_16x16x32_bf16 v[84:87], v[52:55], v[168:171], v[84:87]
    ds_read_b64_tr_b16 v[50:51], v22 offset:28672
    v_mfma_f32_16x16x32_bf16 v[88:91], v[56:59], v[168:171], v[88:91]
    ds_read_b64_tr_b16 v[52:53], v23 offset:24576
    v_mfma_f32_16x16x32_bf16 v[120:123], v[56:59], v[232:235], v[120:123]
    ds_read_b64_tr_b16 v[54:55], v23 offset:28672
    s_waitcnt lgkmcnt(10)
    v_mfma_f32_16x16x32_bf16 v[124:127], v[60:63], v[232:235], v[124:127]
    ds_read_b64_tr_b16 v[56:57], v24 offset:24576
    v_mfma_f32_16x16x32_bf16 v[92:95], v[60:63], v[168:171], v[92:95]
    ds_read_b64_tr_b16 v[58:59], v24 offset:28672
    v_mfma_f32_16x16x32_bf16 v[64:67], v[32:35], v[172:175], v[64:67]
    ds_read_b64_tr_b16 v[60:61], v25 offset:24576
    v_mfma_f32_16x16x32_bf16 v[96:99], v[32:35], v[236:239], v[96:99]
    ds_read_b64_tr_b16 v[62:63], v25 offset:28672
    s_waitcnt lgkmcnt(10)
    v_mfma_f32_16x16x32_bf16 v[100:103], v[36:39], v[236:239], v[100:103]
    s_barrier
    v_xor_b32 v28, 0x0, v31
    ds_read_b64 v[176:177], v28 offset:0
    ds_read_b64 v[240:241], v28 offset:4096
    v_xor_b32 v29, 0x20, v31
    v_mfma_f32_16x16x32_bf16 v[68:71], v[36:39], v[172:175], v[68:71]
    ds_read_b64 v[178:179], v29 offset:0
    ds_read_b64 v[242:243], v29 offset:4096
    ds_read_b64_tr_b16 v[32:33], v18 offset:32768
    ds_read_b64_tr_b16 v[34:35], v18 offset:36864
    v_mfma_f32_16x16x32_bf16 v[72:75], v[40:43], v[172:175], v[72:75]
    ds_read_b64_tr_b16 v[36:37], v19 offset:32768
    v_mfma_f32_16x16x32_bf16 v[104:107], v[40:43], v[236:239], v[104:107]
    ds_read_b64_tr_b16 v[38:39], v19 offset:36864
    s_waitcnt lgkmcnt(14)
    v_mfma_f32_16x16x32_bf16 v[108:111], v[44:47], v[236:239], v[108:111]
    v_xor_b32 v28, 0x40, v31
    ds_read_b64 v[180:181], v28 offset:0
    ds_read_b64 v[244:245], v28 offset:4096
    v_xor_b32 v29, 0x60, v31
    v_mfma_f32_16x16x32_bf16 v[76:79], v[44:47], v[172:175], v[76:79]
    ds_read_b64 v[182:183], v29 offset:0
    ds_read_b64 v[246:247], v29 offset:4096
    ds_read_b64_tr_b16 v[40:41], v20 offset:32768
    ds_read_b64_tr_b16 v[42:43], v20 offset:36864
    v_mfma_f32_16x16x32_bf16 v[80:83], v[48:51], v[172:175], v[80:83]
    ds_read_b64_tr_b16 v[44:45], v21 offset:32768
    v_mfma_f32_16x16x32_bf16 v[112:115], v[48:51], v[236:239], v[112:115]
    ds_read_b64_tr_b16 v[46:47], v21 offset:36864
    s_waitcnt lgkmcnt(14)
    v_mfma_f32_16x16x32_bf16 v[116:119], v[52:55], v[236:239], v[116:119]
    v_xor_b32 v28, 0x80, v31
    ds_read_b64 v[184:185], v28 offset:0
    ds_read_b64 v[248:249], v28 offset:4096
    v_xor_b32 v29, 0xa0, v31
    v_mfma_f32_16x16x32_bf16 v[84:87], v[52:55], v[172:175], v[84:87]
    ds_read_b64 v[186:187], v29 offset:0
    ds_read_b64 v[250:251], v29 offset:4096
    ds_read_b64_tr_b16 v[48:49], v22 offset:32768
    ds_read_b64_tr_b16 v[50:51], v22 offset:36864
    v_mfma_f32_16x16x32_bf16 v[88:91], v[56:59], v[172:175], v[88:91]
    ds_read_b64_tr_b16 v[52:53], v23 offset:32768
    v_mfma_f32_16x16x32_bf16 v[120:123], v[56:59], v[236:239], v[120:123]
    ds_read_b64_tr_b16 v[54:55], v23 offset:36864
    s_waitcnt lgkmcnt(14)
    v_mfma_f32_16x16x32_bf16 v[124:127], v[60:63], v[236:239], v[124:127]
    v_xor_b32 v28, 0xc0, v31
    ds_read_b64 v[188:189], v28 offset:0
    ds_read_b64 v[252:253], v28 offset:4096
    v_xor_b32 v29, 0xe0, v31
    v_mfma_f32_16x16x32_bf16 v[92:95], v[60:63], v[172:175], v[92:95]
    ds_read_b64 v[190:191], v29 offset:0
    ds_read_b64 v[254:255], v29 offset:4096
    ds_read_b64_tr_b16 v[56:57], v24 offset:32768
    ds_read_b64_tr_b16 v[58:59], v24 offset:36864
    v_mfma_f32_16x16x32_bf16 v[64:67], v[32:35], v[176:179], v[64:67]
    ds_read_b64_tr_b16 v[60:61], v25 offset:32768
    v_mfma_f32_16x16x32_bf16 v[96:99], v[32:35], v[240:243], v[96:99]
    ds_read_b64_tr_b16 v[62:63], v25 offset:36864
    s_waitcnt lgkmcnt(14)
    v_mfma_f32_16x16x32_bf16 v[100:103], v[36:39], v[240:243], v[100:103]
    ds_read_b64_tr_b16 v[32:33], v18 offset:40960
    v_mfma_f32_16x16x32_bf16 v[68:71], v[36:39], v[176:179], v[68:71]
    ds_read_b64_tr_b16 v[34:35], v18 offset:45056
    v_mfma_f32_16x16x32_bf16 v[72:75], v[40:43], v[176:179], v[72:75]
    ds_read_b64_tr_b16 v[36:37], v19 offset:40960
    v_mfma_f32_16x16x32_bf16 v[104:107], v[40:43], v[240:243], v[104:107]
    ds_read_b64_tr_b16 v[38:39], v19 offset:45056
    s_waitcnt lgkmcnt(14)
    v_mfma_f32_16x16x32_bf16 v[108:111], v[44:47], v[240:243], v[108:111]
    ds_read_b64_tr_b16 v[40:41], v20 offset:40960
    v_mfma_f32_16x16x32_bf16 v[76:79], v[44:47], v[176:179], v[76:79]
    ds_read_b64_tr_b16 v[42:43], v20 offset:45056
    v_mfma_f32_16x16x32_bf16 v[80:83], v[48:51], v[176:179], v[80:83]
    ds_read_b64_tr_b16 v[44:45], v21 offset:40960
    v_mfma_f32_16x16x32_bf16 v[112:115], v[48:51], v[240:243], v[112:115]
    ds_read_b64_tr_b16 v[46:47], v21 offset:45056
    s_waitcnt lgkmcnt(10)
    v_mfma_f32_16x16x32_bf16 v[116:119], v[52:55], v[240:243], v[116:119]
    ds_read_b64_tr_b16 v[48:49], v22 offset:40960
    v_mfma_f32_16x16x32_bf16 v[84:87], v[52:55], v[176:179], v[84:87]
    ds_read_b64_tr_b16 v[50:51], v22 offset:45056
    v_mfma_f32_16x16x32_bf16 v[88:91], v[56:59], v[176:179], v[88:91]
    ds_read_b64_tr_b16 v[52:53], v23 offset:40960
    v_mfma_f32_16x16x32_bf16 v[120:123], v[56:59], v[240:243], v[120:123]
    ds_read_b64_tr_b16 v[54:55], v23 offset:45056
    s_waitcnt lgkmcnt(10)
    v_mfma_f32_16x16x32_bf16 v[124:127], v[60:63], v[240:243], v[124:127]
    ds_read_b64_tr_b16 v[56:57], v24 offset:40960
    v_mfma_f32_16x16x32_bf16 v[92:95], v[60:63], v[176:179], v[92:95]
    ds_read_b64_tr_b16 v[58:59], v24 offset:45056
    v_mfma_f32_16x16x32_bf16 v[64:67], v[32:35], v[180:183], v[64:67]
    ds_read_b64_tr_b16 v[60:61], v25 offset:40960
    v_mfma_f32_16x16x32_bf16 v[96:99], v[32:35], v[244:247], v[96:99]
    ds_read_b64_tr_b16 v[62:63], v25 offset:45056
    s_waitcnt lgkmcnt(10)
    v_mfma_f32_16x16x32_bf16 v[100:103], v[36:39], v[244:247], v[100:103]
    s_barrier
    ds_read_b64_tr_b16 v[32:33], v18 offset:49152
    v_mfma_f32_16x16x32_bf16 v[68:71], v[36:39], v[180:183], v[68:71]
    ds_read_b64_tr_b16 v[34:35], v18 offset:53248
    v_mfma_f32_16x16x32_bf16 v[72:75], v[40:43], v[180:183], v[72:75]
    ds_read_b64_tr_b16 v[36:37], v19 offset:49152
    v_mfma_f32_16x16x32_bf16 v[104:107], v[40:43], v[244:247], v[104:107]
    ds_read_b64_tr_b16 v[38:39], v19 offset:53248
    s_waitcnt lgkmcnt(10)
    v_mfma_f32_16x16x32_bf16 v[108:111], v[44:47], v[244:247], v[108:111]
    ds_read_b64_tr_b16 v[40:41], v20 offset:49152
    v_mfma_f32_16x16x32_bf16 v[76:79], v[44:47], v[180:183], v[76:79]
    ds_read_b64_tr_b16 v[42:43], v20 offset:53248
    v_mfma_f32_16x16x32_bf16 v[80:83], v[48:51], v[180:183], v[80:83]
    ds_read_b64_tr_b16 v[44:45], v21 offset:49152
    v_mfma_f32_16x16x32_bf16 v[112:115], v[48:51], v[244:247], v[112:115]
    ds_read_b64_tr_b16 v[46:47], v21 offset:53248
    s_waitcnt lgkmcnt(10)
    v_mfma_f32_16x16x32_bf16 v[116:119], v[52:55], v[244:247], v[116:119]
    ds_read_b64_tr_b16 v[48:49], v22 offset:49152
    v_mfma_f32_16x16x32_bf16 v[84:87], v[52:55], v[180:183], v[84:87]
    ds_read_b64_tr_b16 v[50:51], v22 offset:53248
    v_mfma_f32_16x16x32_bf16 v[88:91], v[56:59], v[180:183], v[88:91]
    ds_read_b64_tr_b16 v[52:53], v23 offset:49152
    v_mfma_f32_16x16x32_bf16 v[120:123], v[56:59], v[244:247], v[120:123]
    ds_read_b64_tr_b16 v[54:55], v23 offset:53248
    s_waitcnt lgkmcnt(10)
    v_mfma_f32_16x16x32_bf16 v[124:127], v[60:63], v[244:247], v[124:127]
    ds_read_b64_tr_b16 v[56:57], v24 offset:49152
    v_mfma_f32_16x16x32_bf16 v[92:95], v[60:63], v[180:183], v[92:95]
    ds_read_b64_tr_b16 v[58:59], v24 offset:53248
    v_mfma_f32_16x16x32_bf16 v[64:67], v[32:35], v[184:187], v[64:67]
    ds_read_b64_tr_b16 v[60:61], v25 offset:49152
    v_mfma_f32_16x16x32_bf16 v[96:99], v[32:35], v[248:251], v[96:99]
    ds_read_b64_tr_b16 v[62:63], v25 offset:53248
    s_waitcnt lgkmcnt(10)
    v_mfma_f32_16x16x32_bf16 v[100:103], v[36:39], v[248:251], v[100:103]
    ds_read_b64_tr_b16 v[32:33], v18 offset:57344
    v_mfma_f32_16x16x32_bf16 v[68:71], v[36:39], v[184:187], v[68:71]
    ds_read_b64_tr_b16 v[34:35], v18 offset:61440
    v_mfma_f32_16x16x32_bf16 v[72:75], v[40:43], v[184:187], v[72:75]
    ds_read_b64_tr_b16 v[36:37], v19 offset:57344
    v_mfma_f32_16x16x32_bf16 v[104:107], v[40:43], v[248:251], v[104:107]
    ds_read_b64_tr_b16 v[38:39], v19 offset:61440
    s_waitcnt lgkmcnt(10)
    v_mfma_f32_16x16x32_bf16 v[108:111], v[44:47], v[248:251], v[108:111]
    ds_read_b64_tr_b16 v[40:41], v20 offset:57344
    v_mfma_f32_16x16x32_bf16 v[76:79], v[44:47], v[184:187], v[76:79]
    ds_read_b64_tr_b16 v[42:43], v20 offset:61440
    v_mfma_f32_16x16x32_bf16 v[80:83], v[48:51], v[184:187], v[80:83]
    ds_read_b64_tr_b16 v[44:45], v21 offset:57344
    v_mfma_f32_16x16x32_bf16 v[112:115], v[48:51], v[248:251], v[112:115]
    ds_read_b64_tr_b16 v[46:47], v21 offset:61440
    s_waitcnt lgkmcnt(10)
    v_mfma_f32_16x16x32_bf16 v[116:119], v[52:55], v[248:251], v[116:119]
    ds_read_b64_tr_b16 v[48:49], v22 offset:57344
    v_mfma_f32_16x16x32_bf16 v[84:87], v[52:55], v[184:187], v[84:87]
    ds_read_b64_tr_b16 v[50:51], v22 offset:61440
    v_mfma_f32_16x16x32_bf16 v[88:91], v[56:59], v[184:187], v[88:91]
    ds_read_b64_tr_b16 v[52:53], v23 offset:57344
    v_mfma_f32_16x16x32_bf16 v[120:123], v[56:59], v[248:251], v[120:123]
    ds_read_b64_tr_b16 v[54:55], v23 offset:61440
    s_waitcnt lgkmcnt(10)
    v_mfma_f32_16x16x32_bf16 v[124:127], v[60:63], v[248:251], v[124:127]
    ds_read_b64_tr_b16 v[56:57], v24 offset:57344
    v_mfma_f32_16x16x32_bf16 v[92:95], v[60:63], v[184:187], v[92:95]
    ds_read_b64_tr_b16 v[58:59], v24 offset:61440
    v_mfma_f32_16x16x32_bf16 v[64:67], v[32:35], v[188:191], v[64:67]
    ds_read_b64_tr_b16 v[60:61], v25 offset:57344
    v_mfma_f32_16x16x32_bf16 v[96:99], v[32:35], v[252:255], v[96:99]
    ds_read_b64_tr_b16 v[62:63], v25 offset:61440
    s_waitcnt lgkmcnt(10)
    v_mfma_f32_16x16x32_bf16 v[100:103], v[36:39], v[252:255], v[100:103]
    v_mfma_f32_16x16x32_bf16 v[68:71], v[36:39], v[188:191], v[68:71]
    v_mfma_f32_16x16x32_bf16 v[72:75], v[40:43], v[188:191], v[72:75]
    v_mfma_f32_16x16x32_bf16 v[104:107], v[40:43], v[252:255], v[104:107]
    s_waitcnt lgkmcnt(6)
    v_mfma_f32_16x16x32_bf16 v[108:111], v[44:47], v[252:255], v[108:111]
    v_mfma_f32_16x16x32_bf16 v[76:79], v[44:47], v[188:191], v[76:79]
    v_mfma_f32_16x16x32_bf16 v[80:83], v[48:51], v[188:191], v[80:83]
    v_mfma_f32_16x16x32_bf16 v[112:115], v[48:51], v[252:255], v[112:115]
    s_waitcnt lgkmcnt(2)
    v_mfma_f32_16x16x32_bf16 v[116:119], v[52:55], v[252:255], v[116:119]
    v_mfma_f32_16x16x32_bf16 v[84:87], v[52:55], v[188:191], v[84:87]
    v_mfma_f32_16x16x32_bf16 v[88:91], v[56:59], v[188:191], v[88:91]
    v_mfma_f32_16x16x32_bf16 v[120:123], v[56:59], v[252:255], v[120:123]
    s_waitcnt lgkmcnt(0)
    v_mfma_f32_16x16x32_bf16 v[124:127], v[60:63], v[252:255], v[124:127]
    v_mfma_f32_16x16x32_bf16 v[92:95], v[60:63], v[188:191], v[92:95]
    s_nop 3
    s_add_u32 m0, s79, 81920
    s_nop 0
    buffer_load_dwordx4 v10, s[48:51], s78 offen offset:0  lds
    v_pk_mul_f32 v[64:65], s[92:93], v[64:65]
    v_pk_mul_f32 v[66:67], s[92:93], v[66:67]
    v_cvt_pk_bf16_f32 v32, v64, v65
    v_cvt_pk_bf16_f32 v33, v66, v67
    ds_write_b64 v27, v[32:33] offset:0
    v_pk_mul_f32 v[96:97], s[92:93], v[96:97]
    v_pk_mul_f32 v[98:99], s[92:93], v[98:99]
    v_cvt_pk_bf16_f32 v48, v96, v97
    v_cvt_pk_bf16_f32 v49, v98, v99
    ds_write_b64 v27, v[48:49] offset:4096
    v_pk_mul_f32 v[68:69], s[92:93], v[68:69]
    v_pk_mul_f32 v[70:71], s[92:93], v[70:71]
    v_cvt_pk_bf16_f32 v34, v68, v69
    v_cvt_pk_bf16_f32 v35, v70, v71
    ds_write_b64 v27, v[34:35] offset:512
    v_pk_mul_f32 v[100:101], s[92:93], v[100:101]
    v_pk_mul_f32 v[102:103], s[92:93], v[102:103]
    v_cvt_pk_bf16_f32 v50, v100, v101
    v_cvt_pk_bf16_f32 v51, v102, v103
    ds_write_b64 v27, v[50:51] offset:4608
    buffer_load_dwordx4 v11, s[48:51], s78 offen offset:1024  lds
    v_pk_mul_f32 v[72:73], s[92:93], v[72:73]
    v_pk_mul_f32 v[74:75], s[92:93], v[74:75]
    v_cvt_pk_bf16_f32 v36, v72, v73
    v_cvt_pk_bf16_f32 v37, v74, v75
    ds_write_b64 v27, v[36:37] offset:1024
    v_pk_mul_f32 v[104:105], s[92:93], v[104:105]
    v_pk_mul_f32 v[106:107], s[92:93], v[106:107]
    v_cvt_pk_bf16_f32 v52, v104, v105
    v_cvt_pk_bf16_f32 v53, v106, v107
    ds_write_b64 v27, v[52:53] offset:5120
    v_pk_mul_f32 v[76:77], s[92:93], v[76:77]
    v_pk_mul_f32 v[78:79], s[92:93], v[78:79]
    v_cvt_pk_bf16_f32 v38, v76, v77
    v_cvt_pk_bf16_f32 v39, v78, v79
    ds_write_b64 v27, v[38:39] offset:1536
    v_pk_mul_f32 v[108:109], s[92:93], v[108:109]
    v_pk_mul_f32 v[110:111], s[92:93], v[110:111]
    v_cvt_pk_bf16_f32 v54, v108, v109
    v_cvt_pk_bf16_f32 v55, v110, v111
    ds_write_b64 v27, v[54:55] offset:5632
    s_add_u32 m0, s79, 32768
    s_nop 0
    buffer_load_dwordx4 v4, s[40:43], s77 offen offset:0 nt lds
    v_pk_mul_f32 v[80:81], s[92:93], v[80:81]
    v_pk_mul_f32 v[82:83], s[92:93], v[82:83]
    v_cvt_pk_bf16_f32 v40, v80, v81
    v_cvt_pk_bf16_f32 v41, v82, v83
    ds_write_b64 v27, v[40:41] offset:2048
    v_pk_mul_f32 v[112:113], s[92:93], v[112:113]
    v_pk_mul_f32 v[114:115], s[92:93], v[114:115]
    v_cvt_pk_bf16_f32 v56, v112, v113
    v_cvt_pk_bf16_f32 v57, v114, v115
    ds_write_b64 v27, v[56:57] offset:6144
    v_pk_mul_f32 v[84:85], s[92:93], v[84:85]
    v_pk_mul_f32 v[86:87], s[92:93], v[86:87]
    v_cvt_pk_bf16_f32 v42, v84, v85
    v_cvt_pk_bf16_f32 v43, v86, v87
    ds_write_b64 v27, v[42:43] offset:2560
    v_pk_mul_f32 v[116:117], s[92:93], v[116:117]
    v_pk_mul_f32 v[118:119], s[92:93], v[118:119]
    v_cvt_pk_bf16_f32 v58, v116, v117
    v_cvt_pk_bf16_f32 v59, v118, v119
    ds_write_b64 v27, v[58:59] offset:6656
    buffer_load_dwordx4 v5, s[40:43], s77 offen offset:1024 nt lds
    v_pk_mul_f32 v[88:89], s[92:93], v[88:89]
    v_pk_mul_f32 v[90:91], s[92:93], v[90:91]
    v_cvt_pk_bf16_f32 v44, v88, v89
    v_cvt_pk_bf16_f32 v45, v90, v91
    ds_write_b64 v27, v[44:45] offset:3072
    v_pk_mul_f32 v[120:121], s[92:93], v[120:121]
    v_pk_mul_f32 v[122:123], s[92:93], v[122:123]
    v_cvt_pk_bf16_f32 v60, v120, v121
    v_cvt_pk_bf16_f32 v61, v122, v123
    ds_write_b64 v27, v[60:61] offset:7168
    v_pk_mul_f32 v[92:93], s[92:93], v[92:93]
    v_pk_mul_f32 v[94:95], s[92:93], v[94:95]
    v_cvt_pk_bf16_f32 v46, v92, v93
    v_cvt_pk_bf16_f32 v47, v94, v95
    ds_write_b64 v27, v[46:47] offset:3584
    v_pk_mul_f32 v[124:125], s[92:93], v[124:125]
    v_pk_mul_f32 v[126:127], s[92:93], v[126:127]
    v_cvt_pk_bf16_f32 v62, v124, v125
    v_cvt_pk_bf16_f32 v63, v126, v127
    ds_write_b64 v27, v[62:63] offset:7680
    s_waitcnt lgkmcnt(0)
    s_waitcnt vmcnt(4)
    s_barrier
    s_waitcnt vmcnt(7)
    buffer_load_dwordx4 v6, s[40:43], s77 offen offset:2048 nt lds
    s_waitcnt vmcnt(7)
    buffer_load_dwordx4 v7, s[40:43], s77 offen offset:3072 nt lds
    s_add_u32 m0, s79, 81920
    s_waitcnt vmcnt(7)
    buffer_load_dwordx4 v12, s[48:51], s78 offen offset:2048  lds
    ds_read_b64_tr_b16 v[32:33], v18 offset:0
    ds_read_b64_tr_b16 v[34:35], v18 offset:4096
    ds_read_b64_tr_b16 v[36:37], v19 offset:0
    ds_read_b64_tr_b16 v[38:39], v19 offset:4096
    ds_read_b64_tr_b16 v[40:41], v20 offset:0
    ds_read_b64_tr_b16 v[42:43], v20 offset:4096
    ds_read_b64_tr_b16 v[44:45], v21 offset:0
    ds_read_b64_tr_b16 v[46:47], v21 offset:4096
    ds_read_b64_tr_b16 v[48:49], v22 offset:0
    ds_read_b64_tr_b16 v[50:51], v22 offset:4096
    ds_read_b64_tr_b16 v[52:53], v23 offset:0
    ds_read_b64_tr_b16 v[54:55], v23 offset:4096
    ds_read_b64_tr_b16 v[56:57], v24 offset:0
    ds_read_b64_tr_b16 v[58:59], v24 offset:4096
    s_waitcnt lgkmcnt(12)
    v_mfma_f32_16x16x32_bf16 v[64:67], v[32:35], v[128:131], 0
    ds_read_b64_tr_b16 v[60:61], v25 offset:0
    v_mfma_f32_16x16x32_bf16 v[96:99], v[32:35], v[192:195], 0
    ds_read_b64_tr_b16 v[62:63], v25 offset:4096
    s_waitcnt lgkmcnt(10)
    v_mfma_f32_16x16x32_bf16 v[100:103], v[36:39], v[192:195], 0
    ds_read_b64_tr_b16 v[32:33], v18 offset:8192
    v_mfma_f32_16x16x32_bf16 v[68:71], v[36:39], v[128:131], 0
    ds_read_b64_tr_b16 v[34:35], v18 offset:12288
    s_waitcnt vmcnt(7)
    buffer_load_dwordx4 v13, s[48:51], s78 offen offset:3072  lds
    s_xor_b32 s78, s95, 1048832
    v_mfma_f32_16x16x32_bf16 v[72:75], v[40:43], v[128:131], 0
    ds_read_b64_tr_b16 v[36:37], v19 offset:8192
    v_mfma_f32_16x16x32_bf16 v[104:107], v[40:43], v[192:195], 0
    ds_read_b64_tr_b16 v[38:39], v19 offset:12288
    s_waitcnt lgkmcnt(10)
    v_mfma_f32_16x16x32_bf16 v[108:111], v[44:47], v[192:195], 0
    ds_read_b64_tr_b16 v[40:41], v20 offset:8192
    v_mfma_f32_16x16x32_bf16 v[76:79], v[44:47], v[128:131], 0
    ds_read_b64_tr_b16 v[42:43], v20 offset:12288
    v_mfma_f32_16x16x32_bf16 v[80:83], v[48:51], v[128:131], 0
    ds_read_b64_tr_b16 v[44:45], v21 offset:8192
    v_mfma_f32_16x16x32_bf16 v[112:115], v[48:51], v[192:195], 0
    ds_read_b64_tr_b16 v[46:47], v21 offset:12288
    s_add_u32 m0, s79, 49152
    s_waitcnt vmcnt(7)
    buffer_load_dwordx4 v8, s[44:47], s77 offen offset:0 nt lds
    s_waitcnt lgkmcnt(10)
    v_mfma_f32_16x16x32_bf16 v[116:119], v[52:55], v[192:195], 0
    ds_read_b64_tr_b16 v[48:49], v22 offset:8192
    v_mfma_f32_16x16x32_bf16 v[84:87], v[52:55], v[128:131], 0
    ds_read_b64_tr_b16 v[50:51], v22 offset:12288
    v_mfma_f32_16x16x32_bf16 v[88:91], v[56:59], v[128:131], 0
    ds_read_b64_tr_b16 v[52:53], v23 offset:8192
    v_mfma_f32_16x16x32_bf16 v[120:123], v[56:59], v[192:195], 0
    ds_read_b64_tr_b16 v[54:55], v23 offset:12288
    s_waitcnt lgkmcnt(10)
    v_mfma_f32_16x16x32_bf16 v[124:127], v[60:63], v[192:195], 0
    ds_read_b64_tr_b16 v[56:57], v24 offset:8192
    v_mfma_f32_16x16x32_bf16 v[92:95], v[60:63], v[128:131], 0
    ds_read_b64_tr_b16 v[58:59], v24 offset:12288
    s_waitcnt vmcnt(7)
    buffer_load_dwordx4 v9, s[44:47], s77 offen offset:1024 nt lds
    v_mfma_f32_16x16x32_bf16 v[64:67], v[32:35], v[132:135], v[64:67]
    ds_read_b64_tr_b16 v[60:61], v25 offset:8192
    v_mfma_f32_16x16x32_bf16 v[96:99], v[32:35], v[196:199], v[96:99]
    ds_read_b64_tr_b16 v[62:63], v25 offset:12288
    s_waitcnt lgkmcnt(10)
    v_mfma_f32_16x16x32_bf16 v[100:103], v[36:39], v[196:199], v[100:103]
    v_mfma_f32_16x16x32_bf16 v[68:71], v[36:39], v[132:135], v[68:71]
    s_waitcnt vmcnt(7)
    buffer_load_dwordx4 v8, s[44:47], s77 offen offset:2048 nt lds
    v_mfma_f32_16x16x32_bf16 v[72:75], v[40:43], v[132:135], v[72:75]
    v_mfma_f32_16x16x32_bf16 v[104:107], v[40:43], v[196:199], v[104:107]
    s_waitcnt lgkmcnt(6)
    v_mfma_f32_16x16x32_bf16 v[108:111], v[44:47], v[196:199], v[108:111]
    v_mfma_f32_16x16x32_bf16 v[76:79], v[44:47], v[132:135], v[76:79]
    v_mfma_f32_16x16x32_bf16 v[80:83], v[48:51], v[132:135], v[80:83]
    v_mfma_f32_16x16x32_bf16 v[112:115], v[48:51], v[196:199], v[112:115]
    s_waitcnt vmcnt(7)
    buffer_load_dwordx4 v9, s[44:47], s77 offen offset:3072 nt lds
    s_xor_b32 s77, s3, 32768
    s_waitcnt lgkmcnt(2)
    v_mfma_f32_16x16x32_bf16 v[116:119], v[52:55], v[196:199], v[116:119]
    v_mfma_f32_16x16x32_bf16 v[84:87], v[52:55], v[132:135], v[84:87]
    v_mfma_f32_16x16x32_bf16 v[88:91], v[56:59], v[132:135], v[88:91]
    v_mfma_f32_16x16x32_bf16 v[120:123], v[56:59], v[196:199], v[120:123]
    s_waitcnt lgkmcnt(0)
    v_mfma_f32_16x16x32_bf16 v[124:127], v[60:63], v[196:199], v[124:127]
    v_mfma_f32_16x16x32_bf16 v[92:95], v[60:63], v[132:135], v[92:95]
    s_add_u32 m0, s79, 98304
    s_waitcnt vmcnt(7)
    buffer_load_dwordx4 v10, s[48:51], s78 offen offset:0  lds
    s_waitcnt vmcnt(13)
    s_barrier
    s_waitcnt vmcnt(7)
    buffer_load_dwordx4 v11, s[48:51], s78 offen offset:1024  lds
    s_add_u32 m0, s79, 0
    s_waitcnt vmcnt(7)
    buffer_load_dwordx4 v4, s[40:43], s77 offen offset:0 nt lds
    s_waitcnt vmcnt(7)
    buffer_load_dwordx4 v5, s[40:43], s77 offen offset:1024 nt lds
    s_waitcnt vmcnt(7)
    buffer_load_dwordx4 v6, s[40:43], s77 offen offset:2048 nt lds
    s_waitcnt vmcnt(9)
    s_barrier
    s_waitcnt vmcnt(7)
    buffer_load_dwordx4 v7, s[40:43], s77 offen offset:3072 nt lds
    s_add_u32 m0, s79, 98304
    s_waitcnt vmcnt(7)
    buffer_load_dwordx4 v12, s[48:51], s78 offen offset:2048  lds
    s_waitcnt vmcnt(7)
    buffer_load_dwordx4 v13, s[48:51], s78 offen offset:3072  lds
    s_xor_b32 s78, s95, 1573120
    s_add_u32 m0, s79, 16384
    s_waitcnt vmcnt(7)
    buffer_load_dwordx4 v8, s[44:47], s77 offen offset:0 nt lds
    ds_read_b64_tr_b16 v[32:33], v18 offset:16384
    ds_read_b64_tr_b16 v[34:35], v18 offset:20480
    ds_read_b64_tr_b16 v[36:37], v19 offset:16384
    ds_read_b64_tr_b16 v[38:39], v19 offset:20480
    ds_read_b64_tr_b16 v[40:41], v20 offset:16384
    ds_read_b64_tr_b16 v[42:43], v20 offset:20480
    ds_read_b64_tr_b16 v[44:45], v21 offset:16384
    ds_read_b64_tr_b16 v[46:47], v21 offset:20480
    ds_read_b64_tr_b16 v[48:49], v22 offset:16384
    ds_read_b64_tr_b16 v[50:51], v22 offset:20480
    ds_read_b64_tr_b16 v[52:53], v23 offset:16384
    ds_read_b64_tr_b16 v[54:55], v23 offset:20480
    ds_read_b64_tr_b16 v[56:57], v24 offset:16384
    ds_read_b64_tr_b16 v[58:59], v24 offset:20480
    s_waitcnt lgkmcnt(12)
    v_mfma_f32_16x16x32_bf16 v[64:67], v[32:35], v[136:139], v[64:67]
    ds_read_b64_tr_b16 v[60:61], v25 offset:16384
    v_mfma_f32_16x16x32_bf16 v[96:99], v[32:35], v[200:203], v[96:99]
    ds_read_b64_tr_b16 v[62:63], v25 offset:20480
    s_waitcnt lgkmcnt(10)
    v_mfma_f32_16x16x32_bf16 v[100:103], v[36:39], v[200:203], v[100:103]
    ds_read_b64_tr_b16 v[32:33], v18 offset:24576
    v_mfma_f32_16x16x32_bf16 v[68:71], v[36:39], v[136:139], v[68:71]
    ds_read_b64_tr_b16 v[34:35], v18 offset:28672
    v_mfma_f32_16x16x32_bf16 v[72:75], v[40:43], v[136:139], v[72:75]
    ds_read_b64_tr_b16 v[36:37], v19 offset:24576
    v_mfma_f32_16x16x32_bf16 v[104:107], v[40:43], v[200:203], v[104:107]
    ds_read_b64_tr_b16 v[38:39], v19 offset:28672
    s_waitcnt lgkmcnt(10)
    v_mfma_f32_16x16x32_bf16 v[108:111], v[44:47], v[200:203], v[108:111]
    ds_read_b64_tr_b16 v[40:41], v20 offset:24576
    v_mfma_f32_16x16x32_bf16 v[76:79], v[44:47], v[136:139], v[76:79]
    ds_read_b64_tr_b16 v[42:43], v20 offset:28672
    s_waitcnt vmcnt(7)
    buffer_load_dwordx4 v9, s[44:47], s77 offen offset:1024 nt lds
    v_mfma_f32_16x16x32_bf16 v[80:83], v[48:51], v[136:139], v[80:83]
    ds_read_b64_tr_b16 v[44:45], v21 offset:24576
    v_mfma_f32_16x16x32_bf16 v[112:115], v[48:51], v[200:203], v[112:115]
    ds_read_b64_tr_b16 v[46:47], v21 offset:28672
    s_waitcnt lgkmcnt(10)
    v_mfma_f32_16x16x32_bf16 v[116:119], v[52:55], v[200:203], v[116:119]
    ds_read_b64_tr_b16 v[48:49], v22 offset:24576
    v_mfma_f32_16x16x32_bf16 v[84:87], v[52:55], v[136:139], v[84:87]
    ds_read_b64_tr_b16 v[50:51], v22 offset:28672
    v_mfma_f32_16x16x32_bf16 v[88:91], v[56:59], v[136:139], v[88:91]
    ds_read_b64_tr_b16 v[52:53], v23 offset:24576
    v_mfma_f32_16x16x32_bf16 v[120:123], v[56:59], v[200:203], v[120:123]
    ds_read_b64_tr_b16 v[54:55], v23 offset:28672
    s_waitcnt lgkmcnt(10)
    v_mfma_f32_16x16x32_bf16 v[124:127], v[60:63], v[200:203], v[124:127]
    ds_read_b64_tr_b16 v[56:57], v24 offset:24576
    v_mfma_f32_16x16x32_bf16 v[92:95], v[60:63], v[136:139], v[92:95]
    ds_read_b64_tr_b16 v[58:59], v24 offset:28672
    s_waitcnt vmcnt(7)
    buffer_load_dwordx4 v8, s[44:47], s77 offen offset:2048 nt lds
    v_mfma_f32_16x16x32_bf16 v[64:67], v[32:35], v[140:143], v[64:67]
    ds_read_b64_tr_b16 v[60:61], v25 offset:24576
    v_mfma_f32_16x16x32_bf16 v[96:99], v[32:35], v[204:207], v[96:99]
    ds_read_b64_tr_b16 v[62:63], v25 offset:28672
    s_waitcnt lgkmcnt(10)
    v_mfma_f32_16x16x32_bf16 v[100:103], v[36:39], v[204:207], v[100:103]
    v_mfma_f32_16x16x32_bf16 v[68:71], v[36:39], v[140:143], v[68:71]
    v_mfma_f32_16x16x32_bf16 v[72:75], v[40:43], v[140:143], v[72:75]
    v_mfma_f32_16x16x32_bf16 v[104:107], v[40:43], v[204:207], v[104:107]
    s_waitcnt lgkmcnt(6)
    v_mfma_f32_16x16x32_bf16 v[108:111], v[44:47], v[204:207], v[108:111]
    v_mfma_f32_16x16x32_bf16 v[76:79], v[44:47], v[140:143], v[76:79]
    s_waitcnt vmcnt(7)
    buffer_load_dwordx4 v9, s[44:47], s77 offen offset:3072 nt lds
    s_xor_b32 s77, s3, 49152
    v_mfma_f32_16x16x32_bf16 v[80:83], v[48:51], v[140:143], v[80:83]
    v_mfma_f32_16x16x32_bf16 v[112:115], v[48:51], v[204:207], v[112:115]
    s_waitcnt lgkmcnt(2)
    v_mfma_f32_16x16x32_bf16 v[116:119], v[52:55], v[204:207], v[116:119]
    v_mfma_f32_16x16x32_bf16 v[84:87], v[52:55], v[140:143], v[84:87]
    v_mfma_f32_16x16x32_bf16 v[88:91], v[56:59], v[140:143], v[88:91]
    v_mfma_f32_16x16x32_bf16 v[120:123], v[56:59], v[204:207], v[120:123]
    s_waitcnt lgkmcnt(0)
    v_mfma_f32_16x16x32_bf16 v[124:127], v[60:63], v[204:207], v[124:127]
    v_mfma_f32_16x16x32_bf16 v[92:95], v[60:63], v[140:143], v[92:95]
    s_add_u32 m0, s79, 114688
    s_waitcnt vmcnt(7)
    buffer_load_dwordx4 v10, s[48:51], s78 offen offset:0  lds
    s_waitcnt vmcnt(13)
    s_barrier
    s_waitcnt vmcnt(7)
    buffer_load_dwordx4 v11, s[48:51], s78 offen offset:1024  lds
    s_add_u32 m0, s79, 32768
    s_waitcnt vmcnt(7)
    buffer_load_dwordx4 v4, s[40:43], s77 offen offset:0 nt lds
    s_waitcnt vmcnt(7)
    buffer_load_dwordx4 v5, s[40:43], s77 offen offset:1024 nt lds
    s_waitcnt vmcnt(7)
    buffer_load_dwordx4 v6, s[40:43], s77 offen offset:2048 nt lds
    s_waitcnt vmcnt(9)
    s_barrier
    s_waitcnt vmcnt(7)
    buffer_load_dwordx4 v7, s[40:43], s77 offen offset:3072 nt lds
    s_add_u32 m0, s79, 114688
    s_waitcnt vmcnt(7)
    buffer_load_dwordx4 v12, s[48:51], s78 offen offset:2048  lds
    s_waitcnt vmcnt(7)
    buffer_load_dwordx4 v13, s[48:51], s78 offen offset:3072  lds
    s_xor_b32 s78, s95, 2097408
    s_add_u32 m0, s79, 49152
    s_waitcnt vmcnt(7)
    buffer_load_dwordx4 v8, s[44:47], s77 offen offset:0 nt lds
    ds_read_b64_tr_b16 v[32:33], v18 offset:32768
    ds_read_b64_tr_b16 v[34:35], v18 offset:36864
    ds_read_b64_tr_b16 v[36:37], v19 offset:32768
    ds_read_b64_tr_b16 v[38:39], v19 offset:36864
    ds_read_b64_tr_b16 v[40:41], v20 offset:32768
    ds_read_b64_tr_b16 v[42:43], v20 offset:36864
    ds_read_b64_tr_b16 v[44:45], v21 offset:32768
    ds_read_b64_tr_b16 v[46:47], v21 offset:36864
    ds_read_b64_tr_b16 v[48:49], v22 offset:32768
    ds_read_b64_tr_b16 v[50:51], v22 offset:36864
    ds_read_b64_tr_b16 v[52:53], v23 offset:32768
    ds_read_b64_tr_b16 v[54:55], v23 offset:36864
    ds_read_b64_tr_b16 v[56:57], v24 offset:32768
    ds_read_b64_tr_b16 v[58:59], v24 offset:36864
    s_waitcnt lgkmcnt(12)
    v_mfma_f32_16x16x32_bf16 v[64:67], v[32:35], v[144:147], v[64:67]
    ds_read_b64_tr_b16 v[60:61], v25 offset:32768
    v_mfma_f32_16x16x32_bf16 v[96:99], v[32:35], v[208:211], v[96:99]
    ds_read_b64_tr_b16 v[62:63], v25 offset:36864
    s_waitcnt lgkmcnt(10)
    v_mfma_f32_16x16x32_bf16 v[100:103], v[36:39], v[208:211], v[100:103]
    ds_read_b64_tr_b16 v[32:33], v18 offset:40960
    v_mfma_f32_16x16x32_bf16 v[68:71], v[36:39], v[144:147], v[68:71]
    ds_read_b64_tr_b16 v[34:35], v18 offset:45056
    v_mfma_f32_16x16x32_bf16 v[72:75], v[40:43], v[144:147], v[72:75]
    ds_read_b64_tr_b16 v[36:37], v19 offset:40960
    v_mfma_f32_16x16x32_bf16 v[104:107], v[40:43], v[208:211], v[104:107]
    ds_read_b64_tr_b16 v[38:39], v19 offset:45056
    s_waitcnt lgkmcnt(10)
    v_mfma_f32_16x16x32_bf16 v[108:111], v[44:47], v[208:211], v[108:111]
    ds_read_b64_tr_b16 v[40:41], v20 offset:40960
    v_mfma_f32_16x16x32_bf16 v[76:79], v[44:47], v[144:147], v[76:79]
    ds_read_b64_tr_b16 v[42:43], v20 offset:45056
    s_waitcnt vmcnt(7)
    buffer_load_dwordx4 v9, s[44:47], s77 offen offset:1024 nt lds
    v_mfma_f32_16x16x32_bf16 v[80:83], v[48:51], v[144:147], v[80:83]
    ds_read_b64_tr_b16 v[44:45], v21 offset:40960
    v_mfma_f32_16x16x32_bf16 v[112:115], v[48:51], v[208:211], v[112:115]
    ds_read_b64_tr_b16 v[46:47], v21 offset:45056
    s_waitcnt lgkmcnt(10)
    v_mfma_f32_16x16x32_bf16 v[116:119], v[52:55], v[208:211], v[116:119]
    ds_read_b64_tr_b16 v[48:49], v22 offset:40960
    v_mfma_f32_16x16x32_bf16 v[84:87], v[52:55], v[144:147], v[84:87]
    ds_read_b64_tr_b16 v[50:51], v22 offset:45056
    v_mfma_f32_16x16x32_bf16 v[88:91], v[56:59], v[144:147], v[88:91]
    ds_read_b64_tr_b16 v[52:53], v23 offset:40960
    v_mfma_f32_16x16x32_bf16 v[120:123], v[56:59], v[208:211], v[120:123]
    ds_read_b64_tr_b16 v[54:55], v23 offset:45056
    s_waitcnt lgkmcnt(10)
    v_mfma_f32_16x16x32_bf16 v[124:127], v[60:63], v[208:211], v[124:127]
    ds_read_b64_tr_b16 v[56:57], v24 offset:40960
    v_mfma_f32_16x16x32_bf16 v[92:95], v[60:63], v[144:147], v[92:95]
    ds_read_b64_tr_b16 v[58:59], v24 offset:45056
    s_waitcnt vmcnt(7)
    buffer_load_dwordx4 v8, s[44:47], s77 offen offset:2048 nt lds
    v_mfma_f32_16x16x32_bf16 v[64:67], v[32:35], v[148:151], v[64:67]
    ds_read_b64_tr_b16 v[60:61], v25 offset:40960
    v_mfma_f32_16x16x32_bf16 v[96:99], v[32:35], v[212:215], v[96:99]
    ds_read_b64_tr_b16 v[62:63], v25 offset:45056
    s_waitcnt lgkmcnt(10)
    v_mfma_f32_16x16x32_bf16 v[100:103], v[36:39], v[212:215], v[100:103]
    v_mfma_f32_16x16x32_bf16 v[68:71], v[36:39], v[148:151], v[68:71]
    v_mfma_f32_16x16x32_bf16 v[72:75], v[40:43], v[148:151], v[72:75]
    v_mfma_f32_16x16x32_bf16 v[104:107], v[40:43], v[212:215], v[104:107]
    s_waitcnt lgkmcnt(6)
    v_mfma_f32_16x16x32_bf16 v[108:111], v[44:47], v[212:215], v[108:111]
    v_mfma_f32_16x16x32_bf16 v[76:79], v[44:47], v[148:151], v[76:79]
    s_waitcnt vmcnt(7)
    buffer_load_dwordx4 v9, s[44:47], s77 offen offset:3072 nt lds
    s_xor_b32 s77, s3, 65536
    v_mfma_f32_16x16x32_bf16 v[80:83], v[48:51], v[148:151], v[80:83]
    v_mfma_f32_16x16x32_bf16 v[112:115], v[48:51], v[212:215], v[112:115]
    s_waitcnt lgkmcnt(2)
    v_mfma_f32_16x16x32_bf16 v[116:119], v[52:55], v[212:215], v[116:119]
    v_mfma_f32_16x16x32_bf16 v[84:87], v[52:55], v[148:151], v[84:87]
    v_mfma_f32_16x16x32_bf16 v[88:91], v[56:59], v[148:151], v[88:91]
    v_mfma_f32_16x16x32_bf16 v[120:123], v[56:59], v[212:215], v[120:123]
    s_waitcnt lgkmcnt(0)
    v_mfma_f32_16x16x32_bf16 v[124:127], v[60:63], v[212:215], v[124:127]
    v_mfma_f32_16x16x32_bf16 v[92:95], v[60:63], v[148:151], v[92:95]
    s_add_u32 m0, s79, 65536
    s_waitcnt vmcnt(7)
    buffer_load_dwordx4 v10, s[48:51], s78 offen offset:0  lds
    s_waitcnt vmcnt(13)
    s_barrier
    s_waitcnt vmcnt(7)
    buffer_load_dwordx4 v11, s[48:51], s78 offen offset:1024  lds
    s_add_u32 m0, s79, 0
    s_waitcnt vmcnt(7)
    buffer_load_dwordx4 v4, s[40:43], s77 offen offset:0 nt lds
    s_waitcnt vmcnt(7)
    buffer_load_dwordx4 v5, s[40:43], s77 offen offset:1024 nt lds
    s_waitcnt vmcnt(7)
    buffer_load_dwordx4 v6, s[40:43], s77 offen offset:2048 nt lds
    s_waitcnt vmcnt(9)
    s_barrier
    s_waitcnt vmcnt(7)
    buffer_load_dwordx4 v7, s[40:43], s77 offen offset:3072 nt lds
    s_add_u32 m0, s79, 65536
    s_waitcnt vmcnt(7)
    buffer_load_dwordx4 v12, s[48:51], s78 offen offset:2048  lds
    s_waitcnt vmcnt(7)
    buffer_load_dwordx4 v13, s[48:51], s78 offen offset:3072  lds
    s_xor_b32 s78, s95, 2621696
    s_add_u32 m0, s79, 16384
    s_waitcnt vmcnt(7)
    buffer_load_dwordx4 v8, s[44:47], s77 offen offset:0 nt lds
    ds_read_b64_tr_b16 v[32:33], v18 offset:49152
    ds_read_b64_tr_b16 v[34:35], v18 offset:53248
    ds_read_b64_tr_b16 v[36:37], v19 offset:49152
    ds_read_b64_tr_b16 v[38:39], v19 offset:53248
    ds_read_b64_tr_b16 v[40:41], v20 offset:49152
    ds_read_b64_tr_b16 v[42:43], v20 offset:53248
    ds_read_b64_tr_b16 v[44:45], v21 offset:49152
    ds_read_b64_tr_b16 v[46:47], v21 offset:53248
    ds_read_b64_tr_b16 v[48:49], v22 offset:49152
    ds_read_b64_tr_b16 v[50:51], v22 offset:53248
    ds_read_b64_tr_b16 v[52:53], v23 offset:49152
    ds_read_b64_tr_b16 v[54:55], v23 offset:53248
    ds_read_b64_tr_b16 v[56:57], v24 offset:49152
    ds_read_b64_tr_b16 v[58:59], v24 offset:53248
    s_waitcnt lgkmcnt(12)
    v_mfma_f32_16x16x32_bf16 v[64:67], v[32:35], v[152:155], v[64:67]
    ds_read_b64_tr_b16 v[60:61], v25 offset:49152
    v_mfma_f32_16x16x32_bf16 v[96:99], v[32:35], v[216:219], v[96:99]
    ds_read_b64_tr_b16 v[62:63], v25 offset:53248
    s_waitcnt lgkmcnt(10)
    v_mfma_f32_16x16x32_bf16 v[100:103], v[36:39], v[216:219], v[100:103]
    ds_read_b64_tr_b16 v[32:33], v18 offset:57344
    v_mfma_f32_16x16x32_bf16 v[68:71], v[36:39], v[152:155], v[68:71]
    ds_read_b64_tr_b16 v[34:35], v18 offset:61440
    v_mfma_f32_16x16x32_bf16 v[72:75], v[40:43], v[152:155], v[72:75]
    ds_read_b64_tr_b16 v[36:37], v19 offset:57344
    v_mfma_f32_16x16x32_bf16 v[104:107], v[40:43], v[216:219], v[104:107]
    ds_read_b64_tr_b16 v[38:39], v19 offset:61440
    s_waitcnt lgkmcnt(10)
    v_mfma_f32_16x16x32_bf16 v[108:111], v[44:47], v[216:219], v[108:111]
    ds_read_b64_tr_b16 v[40:41], v20 offset:57344
    v_mfma_f32_16x16x32_bf16 v[76:79], v[44:47], v[152:155], v[76:79]
    ds_read_b64_tr_b16 v[42:43], v20 offset:61440
    v_mfma_f32_16x16x32_bf16 v[80:83], v[48:51], v[152:155], v[80:83]
    ds_read_b64_tr_b16 v[44:45], v21 offset:57344
    v_mfma_f32_16x16x32_bf16 v[112:115], v[48:51], v[216:219], v[112:115]
    ds_read_b64_tr_b16 v[46:47], v21 offset:61440
    s_waitcnt vmcnt(7)
    buffer_load_dwordx4 v9, s[44:47], s77 offen offset:1024 nt lds
    s_waitcnt lgkmcnt(10)
    v_mfma_f32_16x16x32_bf16 v[116:119], v[52:55], v[216:219], v[116:119]
    ds_read_b64_tr_b16 v[48:49], v22 offset:57344
    v_mfma_f32_16x16x32_bf16 v[84:87], v[52:55], v[152:155], v[84:87]
    ds_read_b64_tr_b16 v[50:51], v22 offset:61440
    v_mfma_f32_16x16x32_bf16 v[88:91], v[56:59], v[152:155], v[88:91]
    ds_read_b64_tr_b16 v[52:53], v23 offset:57344
    v_mfma_f32_16x16x32_bf16 v[120:123], v[56:59], v[216:219], v[120:123]
    ds_read_b64_tr_b16 v[54:55], v23 offset:61440
    s_waitcnt lgkmcnt(10)
    v_mfma_f32_16x16x32_bf16 v[124:127], v[60:63], v[216:219], v[124:127]
    ds_read_b64_tr_b16 v[56:57], v24 offset:57344
    v_mfma_f32_16x16x32_bf16 v[92:95], v[60:63], v[152:155], v[92:95]
    ds_read_b64_tr_b16 v[58:59], v24 offset:61440
    v_mfma_f32_16x16x32_bf16 v[64:67], v[32:35], v[156:159], v[64:67]
    ds_read_b64_tr_b16 v[60:61], v25 offset:57344
    v_mfma_f32_16x16x32_bf16 v[96:99], v[32:35], v[220:223], v[96:99]
    ds_read_b64_tr_b16 v[62:63], v25 offset:61440
    s_waitcnt lgkmcnt(10)
    v_mfma_f32_16x16x32_bf16 v[100:103], v[36:39], v[220:223], v[100:103]
    v_mfma_f32_16x16x32_bf16 v[68:71], v[36:39], v[156:159], v[68:71]
    s_waitcnt vmcnt(7)
    buffer_load_dwordx4 v8, s[44:47], s77 offen offset:2048 nt lds
    v_mfma_f32_16x16x32_bf16 v[72:75], v[40:43], v[156:159], v[72:75]
    v_mfma_f32_16x16x32_bf16 v[104:107], v[40:43], v[220:223], v[104:107]
    s_waitcnt lgkmcnt(6)
    v_mfma_f32_16x16x32_bf16 v[108:111], v[44:47], v[220:223], v[108:111]
    v_mfma_f32_16x16x32_bf16 v[76:79], v[44:47], v[156:159], v[76:79]
    v_mfma_f32_16x16x32_bf16 v[80:83], v[48:51], v[156:159], v[80:83]
    v_mfma_f32_16x16x32_bf16 v[112:115], v[48:51], v[220:223], v[112:115]
    s_waitcnt lgkmcnt(2)
    v_mfma_f32_16x16x32_bf16 v[116:119], v[52:55], v[220:223], v[116:119]
    v_mfma_f32_16x16x32_bf16 v[84:87], v[52:55], v[156:159], v[84:87]
    v_mfma_f32_16x16x32_bf16 v[88:91], v[56:59], v[156:159], v[88:91]
    v_mfma_f32_16x16x32_bf16 v[120:123], v[56:59], v[220:223], v[120:123]
    s_waitcnt lgkmcnt(0)
    v_mfma_f32_16x16x32_bf16 v[124:127], v[60:63], v[220:223], v[124:127]
    v_mfma_f32_16x16x32_bf16 v[92:95], v[60:63], v[156:159], v[92:95]
    s_waitcnt vmcnt(7)
    buffer_load_dwordx4 v9, s[44:47], s77 offen offset:3072 nt lds
    s_xor_b32 s77, s3, 81920
    s_waitcnt vmcnt(12)
    s_barrier
    s_add_u32 m0, s79, 81920
    s_waitcnt vmcnt(7)
    buffer_load_dwordx4 v10, s[48:51], s78 offen offset:0  lds
    s_waitcnt vmcnt(7)
    buffer_load_dwordx4 v11, s[48:51], s78 offen offset:1024  lds
    s_add_u32 m0, s79, 32768
    s_waitcnt vmcnt(7)
    buffer_load_dwordx4 v4, s[40:43], s77 offen offset:0 nt lds
    s_waitcnt vmcnt(7)
    buffer_load_dwordx4 v5, s[40:43], s77 offen offset:1024 nt lds
    s_waitcnt vmcnt(8)
    s_barrier
    s_waitcnt vmcnt(7)
    buffer_load_dwordx4 v6, s[40:43], s77 offen offset:2048 nt lds
    s_waitcnt vmcnt(7)
    buffer_load_dwordx4 v7, s[40:43], s77 offen offset:3072 nt lds
    s_add_u32 m0, s79, 81920
    s_waitcnt vmcnt(7)
    buffer_load_dwordx4 v12, s[48:51], s78 offen offset:2048  lds
    s_waitcnt vmcnt(7)
    buffer_load_dwordx4 v13, s[48:51], s78 offen offset:3072  lds
    s_xor_b32 s78, s95, 3145984
    ds_read_b64_tr_b16 v[32:33], v18 offset:0
    ds_read_b64_tr_b16 v[34:35], v18 offset:4096
    ds_read_b64_tr_b16 v[36:37], v19 offset:0
    ds_read_b64_tr_b16 v[38:39], v19 offset:4096
    ds_read_b64_tr_b16 v[40:41], v20 offset:0
    ds_read_b64_tr_b16 v[42:43], v20 offset:4096
    ds_read_b64_tr_b16 v[44:45], v21 offset:0
    ds_read_b64_tr_b16 v[46:47], v21 offset:4096
    ds_read_b64_tr_b16 v[48:49], v22 offset:0
    ds_read_b64_tr_b16 v[50:51], v22 offset:4096
    ds_read_b64_tr_b16 v[52:53], v23 offset:0
    ds_read_b64_tr_b16 v[54:55], v23 offset:4096
    ds_read_b64_tr_b16 v[56:57], v24 offset:0
    ds_read_b64_tr_b16 v[58:59], v24 offset:4096
    s_waitcnt lgkmcnt(12)
    v_mfma_f32_16x16x32_bf16 v[64:67], v[32:35], v[160:163], v[64:67]
    ds_read_b64_tr_b16 v[60:61], v25 offset:0
    v_mfma_f32_16x16x32_bf16 v[96:99], v[32:35], v[224:227], v[96:99]
    ds_read_b64_tr_b16 v[62:63], v25 offset:4096
    s_waitcnt lgkmcnt(10)
    v_mfma_f32_16x16x32_bf16 v[100:103], v[36:39], v[224:227], v[100:103]
    ds_read_b64_tr_b16 v[32:33], v18 offset:8192
    v_mfma_f32_16x16x32_bf16 v[68:71], v[36:39], v[160:163], v[68:71]
    ds_read_b64_tr_b16 v[34:35], v18 offset:12288
    v_mfma_f32_16x16x32_bf16 v[72:75], v[40:43], v[160:163], v[72:75]
    ds_read_b64_tr_b16 v[36:37], v19 offset:8192
    v_mfma_f32_16x16x32_bf16 v[104:107], v[40:43], v[224:227], v[104:107]
    ds_read_b64_tr_b16 v[38:39], v19 offset:12288
    s_waitcnt lgkmcnt(10)
    v_mfma_f32_16x16x32_bf16 v[108:111], v[44:47], v[224:227], v[108:111]
    ds_read_b64_tr_b16 v[40:41], v20 offset:8192
    v_mfma_f32_16x16x32_bf16 v[76:79], v[44:47], v[160:163], v[76:79]
    ds_read_b64_tr_b16 v[42:43], v20 offset:12288
    s_add_u32 m0, s79, 49152
    s_waitcnt vmcnt(7)
    buffer_load_dwordx4 v8, s[44:47], s77 offen offset:0 nt lds
    v_mfma_f32_16x16x32_bf16 v[80:83], v[48:51], v[160:163], v[80:83]
    ds_read_b64_tr_b16 v[44:45], v21 offset:8192
    v_mfma_f32_16x16x32_bf16 v[112:115], v[48:51], v[224:227], v[112:115]
    ds_read_b64_tr_b16 v[46:47], v21 offset:12288
    s_waitcnt lgkmcnt(10)
    v_mfma_f32_16x16x32_bf16 v[116:119], v[52:55], v[224:227], v[116:119]
    ds_read_b64_tr_b16 v[48:49], v22 offset:8192
    v_mfma_f32_16x16x32_bf16 v[84:87], v[52:55], v[160:163], v[84:87]
    ds_read_b64_tr_b16 v[50:51], v22 offset:12288
    v_mfma_f32_16x16x32_bf16 v[88:91], v[56:59], v[160:163], v[88:91]
    ds_read_b64_tr_b16 v[52:53], v23 offset:8192
    v_mfma_f32_16x16x32_bf16 v[120:123], v[56:59], v[224:227], v[120:123]
    ds_read_b64_tr_b16 v[54:55], v23 offset:12288
    s_waitcnt lgkmcnt(10)
    v_mfma_f32_16x16x32_bf16 v[124:127], v[60:63], v[224:227], v[124:127]
    ds_read_b64_tr_b16 v[56:57], v24 offset:8192
    v_mfma_f32_16x16x32_bf16 v[92:95], v[60:63], v[160:163], v[92:95]
    ds_read_b64_tr_b16 v[58:59], v24 offset:12288
    s_waitcnt vmcnt(7)
    buffer_load_dwordx4 v9, s[44:47], s77 offen offset:1024 nt lds
    v_mfma_f32_16x16x32_bf16 v[64:67], v[32:35], v[164:167], v[64:67]
    ds_read_b64_tr_b16 v[60:61], v25 offset:8192
    v_mfma_f32_16x16x32_bf16 v[96:99], v[32:35], v[228:231], v[96:99]
    ds_read_b64_tr_b16 v[62:63], v25 offset:12288
    s_waitcnt lgkmcnt(10)
    v_mfma_f32_16x16x32_bf16 v[100:103], v[36:39], v[228:231], v[100:103]
    v_mfma_f32_16x16x32_bf16 v[68:71], v[36:39], v[164:167], v[68:71]
    v_mfma_f32_16x16x32_bf16 v[72:75], v[40:43], v[164:167], v[72:75]
    v_mfma_f32_16x16x32_bf16 v[104:107], v[40:43], v[228:231], v[104:107]
    s_waitcnt lgkmcnt(6)
    v_mfma_f32_16x16x32_bf16 v[108:111], v[44:47], v[228:231], v[108:111]
    v_mfma_f32_16x16x32_bf16 v[76:79], v[44:47], v[164:167], v[76:79]
    s_waitcnt vmcnt(7)
    buffer_load_dwordx4 v8, s[44:47], s77 offen offset:2048 nt lds
    v_mfma_f32_16x16x32_bf16 v[80:83], v[48:51], v[164:167], v[80:83]
    v_mfma_f32_16x16x32_bf16 v[112:115], v[48:51], v[228:231], v[112:115]
    s_waitcnt lgkmcnt(2)
    v_mfma_f32_16x16x32_bf16 v[116:119], v[52:55], v[228:231], v[116:119]
    v_mfma_f32_16x16x32_bf16 v[84:87], v[52:55], v[164:167], v[84:87]
    v_mfma_f32_16x16x32_bf16 v[88:91], v[56:59], v[164:167], v[88:91]
    v_mfma_f32_16x16x32_bf16 v[120:123], v[56:59], v[228:231], v[120:123]
    s_waitcnt lgkmcnt(0)
    v_mfma_f32_16x16x32_bf16 v[124:127], v[60:63], v[228:231], v[124:127]
    v_mfma_f32_16x16x32_bf16 v[92:95], v[60:63], v[164:167], v[92:95]
    s_waitcnt vmcnt(7)
    buffer_load_dwordx4 v9, s[44:47], s77 offen offset:3072 nt lds
    s_xor_b32 s77, s3, 98304
    s_waitcnt vmcnt(12)
    s_barrier
    s_add_u32 m0, s79, 98304
    s_waitcnt vmcnt(7)
    buffer_load_dwordx4 v10, s[48:51], s78 offen offset:0  lds
    s_waitcnt vmcnt(7)
    buffer_load_dwordx4 v11, s[48:51], s78 offen offset:1024  lds
    s_add_u32 m0, s79, 0
    s_waitcnt vmcnt(7)
    buffer_load_dwordx4 v4, s[40:43], s77 offen offset:0 nt lds
    s_waitcnt vmcnt(7)
    buffer_load_dwordx4 v5, s[40:43], s77 offen offset:1024 nt lds
    s_waitcnt vmcnt(8)
    s_barrier
    s_waitcnt vmcnt(7)
    buffer_load_dwordx4 v6, s[40:43], s77 offen offset:2048 nt lds
    s_waitcnt vmcnt(7)
    buffer_load_dwordx4 v7, s[40:43], s77 offen offset:3072 nt lds
    s_add_u32 m0, s79, 98304
    s_waitcnt vmcnt(7)
    buffer_load_dwordx4 v12, s[48:51], s78 offen offset:2048  lds
    s_waitcnt vmcnt(7)
    buffer_load_dwordx4 v13, s[48:51], s78 offen offset:3072  lds
    s_xor_b32 s78, s95, 3670272
    ds_read_b64_tr_b16 v[32:33], v18 offset:16384
    ds_read_b64_tr_b16 v[34:35], v18 offset:20480
    ds_read_b64_tr_b16 v[36:37], v19 offset:16384
    ds_read_b64_tr_b16 v[38:39], v19 offset:20480
    ds_read_b64_tr_b16 v[40:41], v20 offset:16384
    ds_read_b64_tr_b16 v[42:43], v20 offset:20480
    ds_read_b64_tr_b16 v[44:45], v21 offset:16384
    ds_read_b64_tr_b16 v[46:47], v21 offset:20480
    ds_read_b64_tr_b16 v[48:49], v22 offset:16384
    ds_read_b64_tr_b16 v[50:51], v22 offset:20480
    ds_read_b64_tr_b16 v[52:53], v23 offset:16384
    ds_read_b64_tr_b16 v[54:55], v23 offset:20480
    ds_read_b64_tr_b16 v[56:57], v24 offset:16384
    ds_read_b64_tr_b16 v[58:59], v24 offset:20480
    s_waitcnt lgkmcnt(12)
    v_mfma_f32_16x16x32_bf16 v[64:67], v[32:35], v[168:171], v[64:67]
    ds_read_b64_tr_b16 v[60:61], v25 offset:16384
    v_mfma_f32_16x16x32_bf16 v[96:99], v[32:35], v[232:235], v[96:99]
    ds_read_b64_tr_b16 v[62:63], v25 offset:20480
    s_waitcnt lgkmcnt(10)
    v_mfma_f32_16x16x32_bf16 v[100:103], v[36:39], v[232:235], v[100:103]
    ds_read_b64_tr_b16 v[32:33], v18 offset:24576
    v_mfma_f32_16x16x32_bf16 v[68:71], v[36:39], v[168:171], v[68:71]
    ds_read_b64_tr_b16 v[34:35], v18 offset:28672
    v_mfma_f32_16x16x32_bf16 v[72:75], v[40:43], v[168:171], v[72:75]
    ds_read_b64_tr_b16 v[36:37], v19 offset:24576
    v_mfma_f32_16x16x32_bf16 v[104:107], v[40:43], v[232:235], v[104:107]
    ds_read_b64_tr_b16 v[38:39], v19 offset:28672
    s_waitcnt lgkmcnt(10)
    v_mfma_f32_16x16x32_bf16 v[108:111], v[44:47], v[232:235], v[108:111]
    ds_read_b64_tr_b16 v[40:41], v20 offset:24576
    v_mfma_f32_16x16x32_bf16 v[76:79], v[44:47], v[168:171], v[76:79]
    ds_read_b64_tr_b16 v[42:43], v20 offset:28672
    s_add_u32 m0, s79, 16384
    s_waitcnt vmcnt(7)
    buffer_load_dwordx4 v8, s[44:47], s77 offen offset:0 nt lds
    v_mfma_f32_16x16x32_bf16 v[80:83], v[48:51], v[168:171], v[80:83]
    ds_read_b64_tr_b16 v[44:45], v21 offset:24576
    v_mfma_f32_16x16x32_bf16 v[112:115], v[48:51], v[232:235], v[112:115]
    ds_read_b64_tr_b16 v[46:47], v21 offset:28672
    s_waitcnt lgkmcnt(10)
    v_mfma_f32_16x16x32_bf16 v[116:119], v[52:55], v[232:235], v[116:119]
    ds_read_b64_tr_b16 v[48:49], v22 offset:24576
    v_mfma_f32_16x16x32_bf16 v[84:87], v[52:55], v[168:171], v[84:87]
    ds_read_b64_tr_b16 v[50:51], v22 offset:28672
    v_mfma_f32_16x16x32_bf16 v[88:91], v[56:59], v[168:171], v[88:91]
    ds_read_b64_tr_b16 v[52:53], v23 offset:24576
    v_mfma_f32_16x16x32_bf16 v[120:123], v[56:59], v[232:235], v[120:123]
    ds_read_b64_tr_b16 v[54:55], v23 offset:28672
    s_waitcnt lgkmcnt(10)
    v_mfma_f32_16x16x32_bf16 v[124:127], v[60:63], v[232:235], v[124:127]
    ds_read_b64_tr_b16 v[56:57], v24 offset:24576
    v_mfma_f32_16x16x32_bf16 v[92:95], v[60:63], v[168:171], v[92:95]
    ds_read_b64_tr_b16 v[58:59], v24 offset:28672
    s_waitcnt vmcnt(7)
    buffer_load_dwordx4 v9, s[44:47], s77 offen offset:1024 nt lds
    v_mfma_f32_16x16x32_bf16 v[64:67], v[32:35], v[172:175], v[64:67]
    ds_read_b64_tr_b16 v[60:61], v25 offset:24576
    v_mfma_f32_16x16x32_bf16 v[96:99], v[32:35], v[236:239], v[96:99]
    ds_read_b64_tr_b16 v[62:63], v25 offset:28672
    s_waitcnt lgkmcnt(10)
    v_mfma_f32_16x16x32_bf16 v[100:103], v[36:39], v[236:239], v[100:103]
    v_mfma_f32_16x16x32_bf16 v[68:71], v[36:39], v[172:175], v[68:71]
    v_mfma_f32_16x16x32_bf16 v[72:75], v[40:43], v[172:175], v[72:75]
    v_mfma_f32_16x16x32_bf16 v[104:107], v[40:43], v[236:239], v[104:107]
    s_waitcnt lgkmcnt(6)
    v_mfma_f32_16x16x32_bf16 v[108:111], v[44:47], v[236:239], v[108:111]
    v_mfma_f32_16x16x32_bf16 v[76:79], v[44:47], v[172:175], v[76:79]
    s_waitcnt vmcnt(7)
    buffer_load_dwordx4 v8, s[44:47], s77 offen offset:2048 nt lds
    v_mfma_f32_16x16x32_bf16 v[80:83], v[48:51], v[172:175], v[80:83]
    v_mfma_f32_16x16x32_bf16 v[112:115], v[48:51], v[236:239], v[112:115]
    s_waitcnt lgkmcnt(2)
    v_mfma_f32_16x16x32_bf16 v[116:119], v[52:55], v[236:239], v[116:119]
    v_mfma_f32_16x16x32_bf16 v[84:87], v[52:55], v[172:175], v[84:87]
    v_mfma_f32_16x16x32_bf16 v[88:91], v[56:59], v[172:175], v[88:91]
    v_mfma_f32_16x16x32_bf16 v[120:123], v[56:59], v[236:239], v[120:123]
    s_waitcnt lgkmcnt(0)
    v_mfma_f32_16x16x32_bf16 v[124:127], v[60:63], v[236:239], v[124:127]
    v_mfma_f32_16x16x32_bf16 v[92:95], v[60:63], v[172:175], v[92:95]
    s_waitcnt vmcnt(7)
    buffer_load_dwordx4 v9, s[44:47], s77 offen offset:3072 nt lds
    s_xor_b32 s77, s3, 114688
    s_waitcnt vmcnt(12)
    s_barrier
    s_add_u32 m0, s79, 114688
    s_waitcnt vmcnt(7)
    buffer_load_dwordx4 v10, s[48:51], s78 offen offset:0  lds
    s_waitcnt vmcnt(7)
    buffer_load_dwordx4 v11, s[48:51], s78 offen offset:1024  lds
    s_add_u32 m0, s79, 32768
    s_waitcnt vmcnt(7)
    buffer_load_dwordx4 v4, s[40:43], s77 offen offset:0 nt lds
    s_waitcnt vmcnt(7)
    buffer_load_dwordx4 v5, s[40:43], s77 offen offset:1024 nt lds
    s_waitcnt vmcnt(8)
    s_barrier
    s_waitcnt vmcnt(7)
    buffer_load_dwordx4 v6, s[40:43], s77 offen offset:2048 nt lds
    s_waitcnt vmcnt(7)
    buffer_load_dwordx4 v7, s[40:43], s77 offen offset:3072 nt lds
    s_add_u32 m0, s79, 114688
    s_waitcnt vmcnt(7)
    buffer_load_dwordx4 v12, s[48:51], s78 offen offset:2048  lds
    s_waitcnt vmcnt(7)
    buffer_load_dwordx4 v13, s[48:51], s78 offen offset:3072  lds
    s_xor_b32 s78, s95, 512
    ds_read_b64_tr_b16 v[32:33], v18 offset:32768
    ds_read_b64_tr_b16 v[34:35], v18 offset:36864
    ds_read_b64_tr_b16 v[36:37], v19 offset:32768
    ds_read_b64_tr_b16 v[38:39], v19 offset:36864
    ds_read_b64_tr_b16 v[40:41], v20 offset:32768
    ds_read_b64_tr_b16 v[42:43], v20 offset:36864
    ds_read_b64_tr_b16 v[44:45], v21 offset:32768
    ds_read_b64_tr_b16 v[46:47], v21 offset:36864
    ds_read_b64_tr_b16 v[48:49], v22 offset:32768
    ds_read_b64_tr_b16 v[50:51], v22 offset:36864
    ds_read_b64_tr_b16 v[52:53], v23 offset:32768
    ds_read_b64_tr_b16 v[54:55], v23 offset:36864
    ds_read_b64_tr_b16 v[56:57], v24 offset:32768
    ds_read_b64_tr_b16 v[58:59], v24 offset:36864
    s_waitcnt lgkmcnt(12)
    v_mfma_f32_16x16x32_bf16 v[64:67], v[32:35], v[176:179], v[64:67]
    ds_read_b64_tr_b16 v[60:61], v25 offset:32768
    v_mfma_f32_16x16x32_bf16 v[96:99], v[32:35], v[240:243], v[96:99]
    ds_read_b64_tr_b16 v[62:63], v25 offset:36864
    s_waitcnt lgkmcnt(10)
    v_mfma_f32_16x16x32_bf16 v[100:103], v[36:39], v[240:243], v[100:103]
    ds_read_b64_tr_b16 v[32:33], v18 offset:40960
    v_mfma_f32_16x16x32_bf16 v[68:71], v[36:39], v[176:179], v[68:71]
    ds_read_b64_tr_b16 v[34:35], v18 offset:45056
    v_mfma_f32_16x16x32_bf16 v[72:75], v[40:43], v[176:179], v[72:75]
    ds_read_b64_tr_b16 v[36:37], v19 offset:40960
    v_mfma_f32_16x16x32_bf16 v[104:107], v[40:43], v[240:243], v[104:107]
    ds_read_b64_tr_b16 v[38:39], v19 offset:45056
    s_waitcnt lgkmcnt(10)
    v_mfma_f32_16x16x32_bf16 v[108:111], v[44:47], v[240:243], v[108:111]
    ds_read_b64_tr_b16 v[40:41], v20 offset:40960
    v_mfma_f32_16x16x32_bf16 v[76:79], v[44:47], v[176:179], v[76:79]
    ds_read_b64_tr_b16 v[42:43], v20 offset:45056
    s_add_u32 m0, s79, 49152
    s_waitcnt vmcnt(7)
    buffer_load_dwordx4 v8, s[44:47], s77 offen offset:0 nt lds
    v_mfma_f32_16x16x32_bf16 v[80:83], v[48:51], v[176:179], v[80:83]
    ds_read_b64_tr_b16 v[44:45], v21 offset:40960
    v_mfma_f32_16x16x32_bf16 v[112:115], v[48:51], v[240:243], v[112:115]
    ds_read_b64_tr_b16 v[46:47], v21 offset:45056
    s_waitcnt lgkmcnt(10)
    v_mfma_f32_16x16x32_bf16 v[116:119], v[52:55], v[240:243], v[116:119]
    ds_read_b64_tr_b16 v[48:49], v22 offset:40960
    v_mfma_f32_16x16x32_bf16 v[84:87], v[52:55], v[176:179], v[84:87]
    ds_read_b64_tr_b16 v[50:51], v22 offset:45056
    v_mfma_f32_16x16x32_bf16 v[88:91], v[56:59], v[176:179], v[88:91]
    ds_read_b64_tr_b16 v[52:53], v23 offset:40960
    v_mfma_f32_16x16x32_bf16 v[120:123], v[56:59], v[240:243], v[120:123]
    ds_read_b64_tr_b16 v[54:55], v23 offset:45056
    s_waitcnt lgkmcnt(10)
    v_mfma_f32_16x16x32_bf16 v[124:127], v[60:63], v[240:243], v[124:127]
    ds_read_b64_tr_b16 v[56:57], v24 offset:40960
    v_mfma_f32_16x16x32_bf16 v[92:95], v[60:63], v[176:179], v[92:95]
    ds_read_b64_tr_b16 v[58:59], v24 offset:45056
    s_waitcnt vmcnt(7)
    buffer_load_dwordx4 v9, s[44:47], s77 offen offset:1024 nt lds
    v_mfma_f32_16x16x32_bf16 v[64:67], v[32:35], v[180:183], v[64:67]
    ds_read_b64_tr_b16 v[60:61], v25 offset:40960
    v_mfma_f32_16x16x32_bf16 v[96:99], v[32:35], v[244:247], v[96:99]
    ds_read_b64_tr_b16 v[62:63], v25 offset:45056
    s_waitcnt lgkmcnt(10)
    v_mfma_f32_16x16x32_bf16 v[100:103], v[36:39], v[244:247], v[100:103]
    v_mfma_f32_16x16x32_bf16 v[68:71], v[36:39], v[180:183], v[68:71]
    v_mfma_f32_16x16x32_bf16 v[72:75], v[40:43], v[180:183], v[72:75]
    v_mfma_f32_16x16x32_bf16 v[104:107], v[40:43], v[244:247], v[104:107]
    s_waitcnt lgkmcnt(6)
    v_mfma_f32_16x16x32_bf16 v[108:111], v[44:47], v[244:247], v[108:111]
    v_mfma_f32_16x16x32_bf16 v[76:79], v[44:47], v[180:183], v[76:79]
    s_waitcnt vmcnt(7)
    buffer_load_dwordx4 v8, s[44:47], s77 offen offset:2048 nt lds
    v_mfma_f32_16x16x32_bf16 v[80:83], v[48:51], v[180:183], v[80:83]
    v_mfma_f32_16x16x32_bf16 v[112:115], v[48:51], v[244:247], v[112:115]
    s_waitcnt lgkmcnt(2)
    v_mfma_f32_16x16x32_bf16 v[116:119], v[52:55], v[244:247], v[116:119]
    v_mfma_f32_16x16x32_bf16 v[84:87], v[52:55], v[180:183], v[84:87]
    v_mfma_f32_16x16x32_bf16 v[88:91], v[56:59], v[180:183], v[88:91]
    v_mfma_f32_16x16x32_bf16 v[120:123], v[56:59], v[244:247], v[120:123]
    s_waitcnt lgkmcnt(0)
    v_mfma_f32_16x16x32_bf16 v[124:127], v[60:63], v[244:247], v[124:127]
    v_mfma_f32_16x16x32_bf16 v[92:95], v[60:63], v[180:183], v[92:95]
    s_waitcnt vmcnt(7)
    buffer_load_dwordx4 v9, s[44:47], s77 offen offset:3072 nt lds
    s_xor_b32 s77, s3, 131072
    s_waitcnt vmcnt(12)
    s_barrier
    s_add_u32 m0, s79, 65536
    s_waitcnt vmcnt(7)
    buffer_load_dwordx4 v10, s[48:51], s78 offen offset:0  lds
    s_waitcnt vmcnt(7)
    buffer_load_dwordx4 v11, s[48:51], s78 offen offset:1024  lds
    s_add_u32 m0, s79, 0
    s_waitcnt vmcnt(7)
    buffer_load_dwordx4 v4, s[40:43], s77 offen offset:0 nt lds
    s_waitcnt vmcnt(7)
    buffer_load_dwordx4 v5, s[40:43], s77 offen offset:1024 nt lds
    s_waitcnt vmcnt(8)
    s_barrier
    s_waitcnt vmcnt(7)
    buffer_load_dwordx4 v6, s[40:43], s77 offen offset:2048 nt lds
    s_waitcnt vmcnt(7)
    buffer_load_dwordx4 v7, s[40:43], s77 offen offset:3072 nt lds
    s_add_u32 m0, s79, 65536
    s_waitcnt vmcnt(7)
    buffer_load_dwordx4 v12, s[48:51], s78 offen offset:2048  lds
    s_waitcnt vmcnt(7)
    buffer_load_dwordx4 v13, s[48:51], s78 offen offset:3072  lds
    s_xor_b32 s78, s95, 524800
    ds_read_b64_tr_b16 v[32:33], v18 offset:49152
    ds_read_b64_tr_b16 v[34:35], v18 offset:53248
    ds_read_b64_tr_b16 v[36:37], v19 offset:49152
    ds_read_b64_tr_b16 v[38:39], v19 offset:53248
    ds_read_b64_tr_b16 v[40:41], v20 offset:49152
    ds_read_b64_tr_b16 v[42:43], v20 offset:53248
    ds_read_b64_tr_b16 v[44:45], v21 offset:49152
    ds_read_b64_tr_b16 v[46:47], v21 offset:53248
    ds_read_b64_tr_b16 v[48:49], v22 offset:49152
    ds_read_b64_tr_b16 v[50:51], v22 offset:53248
    ds_read_b64_tr_b16 v[52:53], v23 offset:49152
    ds_read_b64_tr_b16 v[54:55], v23 offset:53248
    ds_read_b64_tr_b16 v[56:57], v24 offset:49152
    ds_read_b64_tr_b16 v[58:59], v24 offset:53248
    s_waitcnt lgkmcnt(12)
    v_mfma_f32_16x16x32_bf16 v[64:67], v[32:35], v[184:187], v[64:67]
    ds_read_b64_tr_b16 v[60:61], v25 offset:49152
    v_mfma_f32_16x16x32_bf16 v[96:99], v[32:35], v[248:251], v[96:99]
    ds_read_b64_tr_b16 v[62:63], v25 offset:53248
    s_waitcnt lgkmcnt(10)
    v_mfma_f32_16x16x32_bf16 v[100:103], v[36:39], v[248:251], v[100:103]
    ds_read_b64_tr_b16 v[32:33], v18 offset:57344
    v_mfma_f32_16x16x32_bf16 v[68:71], v[36:39], v[184:187], v[68:71]
    ds_read_b64_tr_b16 v[34:35], v18 offset:61440
    v_mfma_f32_16x16x32_bf16 v[72:75], v[40:43], v[184:187], v[72:75]
    ds_read_b64_tr_b16 v[36:37], v19 offset:57344
    v_mfma_f32_16x16x32_bf16 v[104:107], v[40:43], v[248:251], v[104:107]
    ds_read_b64_tr_b16 v[38:39], v19 offset:61440
    s_waitcnt lgkmcnt(10)
    v_mfma_f32_16x16x32_bf16 v[108:111], v[44:47], v[248:251], v[108:111]
    ds_read_b64_tr_b16 v[40:41], v20 offset:57344
    v_mfma_f32_16x16x32_bf16 v[76:79], v[44:47], v[184:187], v[76:79]
    ds_read_b64_tr_b16 v[42:43], v20 offset:61440
    v_mfma_f32_16x16x32_bf16 v[80:83], v[48:51], v[184:187], v[80:83]
    ds_read_b64_tr_b16 v[44:45], v21 offset:57344
    v_mfma_f32_16x16x32_bf16 v[112:115], v[48:51], v[248:251], v[112:115]
    ds_read_b64_tr_b16 v[46:47], v21 offset:61440
    s_waitcnt lgkmcnt(10)
    v_mfma_f32_16x16x32_bf16 v[116:119], v[52:55], v[248:251], v[116:119]
    ds_read_b64_tr_b16 v[48:49], v22 offset:57344
    v_mfma_f32_16x16x32_bf16 v[84:87], v[52:55], v[184:187], v[84:87]
    ds_read_b64_tr_b16 v[50:51], v22 offset:61440
    v_mfma_f32_16x16x32_bf16 v[88:91], v[56:59], v[184:187], v[88:91]
    ds_read_b64_tr_b16 v[52:53], v23 offset:57344
    v_mfma_f32_16x16x32_bf16 v[120:123], v[56:59], v[248:251], v[120:123]
    ds_read_b64_tr_b16 v[54:55], v23 offset:61440
    s_waitcnt lgkmcnt(10)
    v_mfma_f32_16x16x32_bf16 v[124:127], v[60:63], v[248:251], v[124:127]
    ds_read_b64_tr_b16 v[56:57], v24 offset:57344
    v_mfma_f32_16x16x32_bf16 v[92:95], v[60:63], v[184:187], v[92:95]
    ds_read_b64_tr_b16 v[58:59], v24 offset:61440
    s_add_u32 m0, s79, 16384
    s_waitcnt vmcnt(7)
    buffer_load_dwordx4 v8, s[44:47], s77 offen offset:0 nt lds
    v_mfma_f32_16x16x32_bf16 v[64:67], v[32:35], v[188:191], v[64:67]
    ds_read_b64_tr_b16 v[60:61], v25 offset:57344
    v_mfma_f32_16x16x32_bf16 v[96:99], v[32:35], v[252:255], v[96:99]
    ds_read_b64_tr_b16 v[62:63], v25 offset:61440
    s_waitcnt lgkmcnt(10)
    v_mfma_f32_16x16x32_bf16 v[100:103], v[36:39], v[252:255], v[100:103]
    v_mfma_f32_16x16x32_bf16 v[68:71], v[36:39], v[188:191], v[68:71]
    v_mfma_f32_16x16x32_bf16 v[72:75], v[40:43], v[188:191], v[72:75]
    v_mfma_f32_16x16x32_bf16 v[104:107], v[40:43], v[252:255], v[104:107]
    s_waitcnt lgkmcnt(6)
    v_mfma_f32_16x16x32_bf16 v[108:111], v[44:47], v[252:255], v[108:111]
    v_mfma_f32_16x16x32_bf16 v[76:79], v[44:47], v[188:191], v[76:79]
    v_mfma_f32_16x16x32_bf16 v[80:83], v[48:51], v[188:191], v[80:83]
    v_mfma_f32_16x16x32_bf16 v[112:115], v[48:51], v[252:255], v[112:115]
    s_waitcnt lgkmcnt(2)
    v_mfma_f32_16x16x32_bf16 v[116:119], v[52:55], v[252:255], v[116:119]
    v_mfma_f32_16x16x32_bf16 v[84:87], v[52:55], v[188:191], v[84:87]
    v_mfma_f32_16x16x32_bf16 v[88:91], v[56:59], v[188:191], v[88:91]
    v_mfma_f32_16x16x32_bf16 v[120:123], v[56:59], v[252:255], v[120:123]
    s_waitcnt lgkmcnt(0)
    v_mfma_f32_16x16x32_bf16 v[124:127], v[60:63], v[252:255], v[124:127]
    v_mfma_f32_16x16x32_bf16 v[92:95], v[60:63], v[188:191], v[92:95]
    s_waitcnt vmcnt(7)
    buffer_load_dwordx4 v9, s[44:47], s77 offen offset:1024 nt lds
    s_waitcnt vmcnt(10)
    s_barrier
    s_setprio 1
    s_waitcnt vmcnt(7)
    buffer_load_dwordx4 v8, s[44:47], s77 offen offset:2048 nt lds
    v_mul_f32 v64, s92, v64
    v_mul_f32 v65, s92, v65
    v_mul_f32 v66, s92, v66
    v_mul_f32 v67, s92, v67
    v_cvt_pk_bf16_f32 v32, v64, v65
    v_cvt_pk_bf16_f32 v33, v66, v67
    ds_write_b64 v27, v[32:33] offset:0
    v_mul_f32 v96, s92, v96
    v_mul_f32 v97, s92, v97
    v_mul_f32 v98, s92, v98
    v_mul_f32 v99, s92, v99
    v_cvt_pk_bf16_f32 v48, v96, v97
    v_cvt_pk_bf16_f32 v49, v98, v99
    ds_write_b64 v27, v[48:49] offset:4096
    v_mul_f32 v68, s92, v68
    v_mul_f32 v69, s92, v69
    v_mul_f32 v70, s92, v70
    v_mul_f32 v71, s92, v71
    v_cvt_pk_bf16_f32 v34, v68, v69
    v_cvt_pk_bf16_f32 v35, v70, v71
    ds_write_b64 v27, v[34:35] offset:512
    v_mul_f32 v100, s92, v100
    v_mul_f32 v101, s92, v101
    v_mul_f32 v102, s92, v102
    v_mul_f32 v103, s92, v103
    v_cvt_pk_bf16_f32 v50, v100, v101
    v_cvt_pk_bf16_f32 v51, v102, v103
    ds_write_b64 v27, v[50:51] offset:4608
    s_waitcnt vmcnt(7)
    buffer_load_dwordx4 v9, s[44:47], s77 offen offset:3072 nt lds
    s_xor_b32 s77, s3, 147456
    v_mul_f32 v72, s92, v72
    v_mul_f32 v73, s92, v73
    v_mul_f32 v74, s92, v74
    v_mul_f32 v75, s92, v75
    v_cvt_pk_bf16_f32 v36, v72, v73
    v_cvt_pk_bf16_f32 v37, v74, v75
    ds_write_b64 v27, v[36:37] offset:1024
    v_mul_f32 v104, s92, v104
    v_mul_f32 v105, s92, v105
    v_mul_f32 v106, s92, v106
    v_mul_f32 v107, s92, v107
    v_cvt_pk_bf16_f32 v52, v104, v105
    v_cvt_pk_bf16_f32 v53, v106, v107
    ds_write_b64 v27, v[52:53] offset:5120
    v_mul_f32 v76, s92, v76
    v_mul_f32 v77, s92, v77
    v_mul_f32 v78, s92, v78
    v_mul_f32 v79, s92, v79
    v_cvt_pk_bf16_f32 v38, v76, v77
    v_cvt_pk_bf16_f32 v39, v78, v79
    ds_write_b64 v27, v[38:39] offset:1536
    v_mul_f32 v108, s92, v108
    v_mul_f32 v109, s92, v109
    v_mul_f32 v110, s92, v110
    v_mul_f32 v111, s92, v111
    v_cvt_pk_bf16_f32 v54, v108, v109
    v_cvt_pk_bf16_f32 v55, v110, v111
    ds_write_b64 v27, v[54:55] offset:5632
    s_add_u32 m0, s79, 81920
    s_waitcnt vmcnt(7)
    buffer_load_dwordx4 v10, s[48:51], s78 offen offset:0  lds
    v_mul_f32 v80, s92, v80
    v_mul_f32 v81, s92, v81
    v_mul_f32 v82, s92, v82
    v_mul_f32 v83, s92, v83
    v_cvt_pk_bf16_f32 v40, v80, v81
    v_cvt_pk_bf16_f32 v41, v82, v83
    ds_write_b64 v27, v[40:41] offset:2048
    v_mul_f32 v112, s92, v112
    v_mul_f32 v113, s92, v113
    v_mul_f32 v114, s92, v114
    v_mul_f32 v115, s92, v115
    v_cvt_pk_bf16_f32 v56, v112, v113
    v_cvt_pk_bf16_f32 v57, v114, v115
    ds_write_b64 v27, v[56:57] offset:6144
    v_mul_f32 v84, s92, v84
    v_mul_f32 v85, s92, v85
    v_mul_f32 v86, s92, v86
    v_mul_f32 v87, s92, v87
    v_cvt_pk_bf16_f32 v42, v84, v85
    v_cvt_pk_bf16_f32 v43, v86, v87
    ds_write_b64 v27, v[42:43] offset:2560
    v_mul_f32 v116, s92, v116
    v_mul_f32 v117, s92, v117
    v_mul_f32 v118, s92, v118
    v_mul_f32 v119, s92, v119
    v_cvt_pk_bf16_f32 v58, v116, v117
    v_cvt_pk_bf16_f32 v59, v118, v119
    ds_write_b64 v27, v[58:59] offset:6656
    s_waitcnt vmcnt(7)
    buffer_load_dwordx4 v11, s[48:51], s78 offen offset:1024  lds
    v_mul_f32 v88, s92, v88
    v_mul_f32 v89, s92, v89
    v_mul_f32 v90, s92, v90
    v_mul_f32 v91, s92, v91
    v_cvt_pk_bf16_f32 v44, v88, v89
    v_cvt_pk_bf16_f32 v45, v90, v91
    ds_write_b64 v27, v[44:45] offset:3072
    v_mul_f32 v120, s92, v120
    v_mul_f32 v121, s92, v121
    v_mul_f32 v122, s92, v122
    v_mul_f32 v123, s92, v123
    v_cvt_pk_bf16_f32 v60, v120, v121
    v_cvt_pk_bf16_f32 v61, v122, v123
    ds_write_b64 v27, v[60:61] offset:7168
    v_mul_f32 v92, s92, v92
    v_mul_f32 v93, s92, v93
    v_mul_f32 v94, s92, v94
    v_mul_f32 v95, s92, v95
    v_cvt_pk_bf16_f32 v46, v92, v93
    v_cvt_pk_bf16_f32 v47, v94, v95
    ds_write_b64 v27, v[46:47] offset:3584
    v_mul_f32 v124, s92, v124
    v_mul_f32 v125, s92, v125
    v_mul_f32 v126, s92, v126
    v_mul_f32 v127, s92, v127
    v_cvt_pk_bf16_f32 v62, v124, v125
    v_cvt_pk_bf16_f32 v63, v126, v127
    ds_write_b64 v27, v[62:63] offset:7680
    s_add_u32 m0, s79, 32768
    s_waitcnt vmcnt(7)
    buffer_load_dwordx4 v4, s[40:43], s77 offen offset:0 nt lds
    s_waitcnt vmcnt(7)
    buffer_load_dwordx4 v5, s[40:43], s77 offen offset:1024 nt lds
    s_setprio 0
    s_waitcnt lgkmcnt(0)
    s_waitcnt vmcnt(8)
    s_barrier
    s_waitcnt vmcnt(6)
    buffer_load_dwordx4 v6, s[40:43], s77 offen offset:2048 nt lds
    s_waitcnt vmcnt(6)
    buffer_load_dwordx4 v7, s[40:43], s77 offen offset:3072 nt lds
    s_add_u32 m0, s79, 81920
    s_waitcnt vmcnt(6)
    buffer_load_dwordx4 v12, s[48:51], s78 offen offset:2048  lds
    ds_read_b64_tr_b16 v[32:33], v18 offset:0
    ds_read_b64_tr_b16 v[34:35], v18 offset:4096
    ds_read_b64_tr_b16 v[36:37], v19 offset:0
    ds_read_b64_tr_b16 v[38:39], v19 offset:4096
    ds_read_b64_tr_b16 v[40:41], v20 offset:0
    ds_read_b64_tr_b16 v[42:43], v20 offset:4096
    ds_read_b64_tr_b16 v[44:45], v21 offset:0
    ds_read_b64_tr_b16 v[46:47], v21 offset:4096
    ds_read_b64_tr_b16 v[48:49], v22 offset:0
    ds_read_b64_tr_b16 v[50:51], v22 offset:4096
    ds_read_b64_tr_b16 v[52:53], v23 offset:0
    ds_read_b64_tr_b16 v[54:55], v23 offset:4096
    ds_read_b64_tr_b16 v[56:57], v24 offset:0
    ds_read_b64_tr_b16 v[58:59], v24 offset:4096
    s_waitcnt lgkmcnt(12)
    v_mfma_f32_16x16x32_bf16 v[64:67], v[32:35], v[128:131], 0
    ds_read_b64_tr_b16 v[60:61], v25 offset:0
    v_mfma_f32_16x16x32_bf16 v[96:99], v[32:35], v[192:195], 0
    ds_read_b64_tr_b16 v[62:63], v25 offset:4096
    s_waitcnt lgkmcnt(10)
    v_mfma_f32_16x16x32_bf16 v[100:103], v[36:39], v[192:195], 0
    ds_read_b64_tr_b16 v[32:33], v18 offset:8192
    v_mfma_f32_16x16x32_bf16 v[68:71], v[36:39], v[128:131], 0
    ds_read_b64_tr_b16 v[34:35], v18 offset:12288
    s_waitcnt vmcnt(6)
    buffer_load_dwordx4 v13, s[48:51], s78 offen offset:3072  lds
    s_xor_b32 s78, s95, 1049088
    v_mfma_f32_16x16x32_bf16 v[72:75], v[40:43], v[128:131], 0
    ds_read_b64_tr_b16 v[36:37], v19 offset:8192
    v_mfma_f32_16x16x32_bf16 v[104:107], v[40:43], v[192:195], 0
    ds_read_b64_tr_b16 v[38:39], v19 offset:12288
    s_waitcnt lgkmcnt(10)
    v_mfma_f32_16x16x32_bf16 v[108:111], v[44:47], v[192:195], 0
    ds_read_b64_tr_b16 v[40:41], v20 offset:8192
    v_mfma_f32_16x16x32_bf16 v[76:79], v[44:47], v[128:131], 0
    ds_read_b64_tr_b16 v[42:43], v20 offset:12288
    v_mfma_f32_16x16x32_bf16 v[80:83], v[48:51], v[128:131], 0
    ds_read_b64_tr_b16 v[44:45], v21 offset:8192
    v_mfma_f32_16x16x32_bf16 v[112:115], v[48:51], v[192:195], 0
    ds_read_b64_tr_b16 v[46:47], v21 offset:12288
    s_add_u32 m0, s79, 49152
    s_waitcnt vmcnt(6)
    buffer_load_dwordx4 v8, s[44:47], s77 offen offset:0 nt lds
    s_waitcnt lgkmcnt(10)
    v_mfma_f32_16x16x32_bf16 v[116:119], v[52:55], v[192:195], 0
    ds_read_b64_tr_b16 v[48:49], v22 offset:8192
    v_mfma_f32_16x16x32_bf16 v[84:87], v[52:55], v[128:131], 0
    ds_read_b64_tr_b16 v[50:51], v22 offset:12288
    v_mfma_f32_16x16x32_bf16 v[88:91], v[56:59], v[128:131], 0
    ds_read_b64_tr_b16 v[52:53], v23 offset:8192
    v_mfma_f32_16x16x32_bf16 v[120:123], v[56:59], v[192:195], 0
    ds_read_b64_tr_b16 v[54:55], v23 offset:12288
    s_waitcnt lgkmcnt(10)
    v_mfma_f32_16x16x32_bf16 v[124:127], v[60:63], v[192:195], 0
    ds_read_b64_tr_b16 v[56:57], v24 offset:8192
    v_mfma_f32_16x16x32_bf16 v[92:95], v[60:63], v[128:131], 0
    ds_read_b64_tr_b16 v[58:59], v24 offset:12288
    s_waitcnt vmcnt(6)
    buffer_load_dwordx4 v9, s[44:47], s77 offen offset:1024 nt lds
    v_mfma_f32_16x16x32_bf16 v[64:67], v[32:35], v[132:135], v[64:67]
    ds_read_b64_tr_b16 v[60:61], v25 offset:8192
    v_mfma_f32_16x16x32_bf16 v[96:99], v[32:35], v[196:199], v[96:99]
    ds_read_b64_tr_b16 v[62:63], v25 offset:12288
    s_waitcnt lgkmcnt(10)
    v_mfma_f32_16x16x32_bf16 v[100:103], v[36:39], v[196:199], v[100:103]
    v_mfma_f32_16x16x32_bf16 v[68:71], v[36:39], v[132:135], v[68:71]
    s_waitcnt vmcnt(6)
    buffer_load_dwordx4 v8, s[44:47], s77 offen offset:2048 nt lds
    v_mfma_f32_16x16x32_bf16 v[72:75], v[40:43], v[132:135], v[72:75]
    v_mfma_f32_16x16x32_bf16 v[104:107], v[40:43], v[196:199], v[104:107]
    s_waitcnt lgkmcnt(6)
    v_mfma_f32_16x16x32_bf16 v[108:111], v[44:47], v[196:199], v[108:111]
    v_mfma_f32_16x16x32_bf16 v[76:79], v[44:47], v[132:135], v[76:79]
    v_mfma_f32_16x16x32_bf16 v[80:83], v[48:51], v[132:135], v[80:83]
    v_mfma_f32_16x16x32_bf16 v[112:115], v[48:51], v[196:199], v[112:115]
    s_waitcnt vmcnt(6)
    buffer_load_dwordx4 v9, s[44:47], s77 offen offset:3072 nt lds
    s_xor_b32 s77, s3, 163840
    s_waitcnt lgkmcnt(2)
    v_mfma_f32_16x16x32_bf16 v[116:119], v[52:55], v[196:199], v[116:119]
    v_mfma_f32_16x16x32_bf16 v[84:87], v[52:55], v[132:135], v[84:87]
    v_mfma_f32_16x16x32_bf16 v[88:91], v[56:59], v[132:135], v[88:91]
    v_mfma_f32_16x16x32_bf16 v[120:123], v[56:59], v[196:199], v[120:123]
    s_waitcnt lgkmcnt(0)
    v_mfma_f32_16x16x32_bf16 v[124:127], v[60:63], v[196:199], v[124:127]
    v_mfma_f32_16x16x32_bf16 v[92:95], v[60:63], v[132:135], v[92:95]
    s_add_u32 m0, s79, 98304
    s_waitcnt vmcnt(6)
    buffer_load_dwordx4 v10, s[48:51], s78 offen offset:0  lds
    s_waitcnt vmcnt(13)
    s_barrier
    s_waitcnt vmcnt(6)
    buffer_load_dwordx4 v11, s[48:51], s78 offen offset:1024  lds
    s_add_u32 m0, s79, 0
    s_waitcnt vmcnt(6)
    buffer_load_dwordx4 v4, s[40:43], s77 offen offset:0 nt lds
    s_waitcnt vmcnt(6)
    buffer_load_dwordx4 v5, s[40:43], s77 offen offset:1024 nt lds
    s_waitcnt vmcnt(6)
    buffer_load_dwordx4 v6, s[40:43], s77 offen offset:2048 nt lds
    s_waitcnt vmcnt(9)
    s_barrier
    s_waitcnt vmcnt(6)
    buffer_load_dwordx4 v7, s[40:43], s77 offen offset:3072 nt lds
    s_add_u32 m0, s79, 98304
    s_waitcnt vmcnt(6)
    buffer_load_dwordx4 v12, s[48:51], s78 offen offset:2048  lds
    s_waitcnt vmcnt(6)
    buffer_load_dwordx4 v13, s[48:51], s78 offen offset:3072  lds
    s_xor_b32 s78, s95, 1573376
    s_add_u32 m0, s79, 16384
    s_waitcnt vmcnt(6)
    buffer_load_dwordx4 v8, s[44:47], s77 offen offset:0 nt lds
    ds_read_b64_tr_b16 v[32:33], v18 offset:16384
    ds_read_b64_tr_b16 v[34:35], v18 offset:20480
    ds_read_b64_tr_b16 v[36:37], v19 offset:16384
    ds_read_b64_tr_b16 v[38:39], v19 offset:20480
    ds_read_b64_tr_b16 v[40:41], v20 offset:16384
    ds_read_b64_tr_b16 v[42:43], v20 offset:20480
    ds_read_b64_tr_b16 v[44:45], v21 offset:16384
    ds_read_b64_tr_b16 v[46:47], v21 offset:20480
    ds_read_b64_tr_b16 v[48:49], v22 offset:16384
    ds_read_b64_tr_b16 v[50:51], v22 offset:20480
    ds_read_b64_tr_b16 v[52:53], v23 offset:16384
    ds_read_b64_tr_b16 v[54:55], v23 offset:20480
    ds_read_b64_tr_b16 v[56:57], v24 offset:16384
    ds_read_b64_tr_b16 v[58:59], v24 offset:20480
    s_waitcnt lgkmcnt(12)
    v_mfma_f32_16x16x32_bf16 v[64:67], v[32:35], v[136:139], v[64:67]
    ds_read_b64_tr_b16 v[60:61], v25 offset:16384
    v_mfma_f32_16x16x32_bf16 v[96:99], v[32:35], v[200:203], v[96:99]
    ds_read_b64_tr_b16 v[62:63], v25 offset:20480
    s_waitcnt lgkmcnt(10)
    v_mfma_f32_16x16x32_bf16 v[100:103], v[36:39], v[200:203], v[100:103]
    ds_read_b64_tr_b16 v[32:33], v18 offset:24576
    v_mfma_f32_16x16x32_bf16 v[68:71], v[36:39], v[136:139], v[68:71]
    ds_read_b64_tr_b16 v[34:35], v18 offset:28672
    v_mfma_f32_16x16x32_bf16 v[72:75], v[40:43], v[136:139], v[72:75]
    ds_read_b64_tr_b16 v[36:37], v19 offset:24576
    v_mfma_f32_16x16x32_bf16 v[104:107], v[40:43], v[200:203], v[104:107]
    ds_read_b64_tr_b16 v[38:39], v19 offset:28672
    s_waitcnt lgkmcnt(10)
    v_mfma_f32_16x16x32_bf16 v[108:111], v[44:47], v[200:203], v[108:111]
    ds_read_b64_tr_b16 v[40:41], v20 offset:24576
    v_mfma_f32_16x16x32_bf16 v[76:79], v[44:47], v[136:139], v[76:79]
    ds_read_b64_tr_b16 v[42:43], v20 offset:28672
    s_waitcnt vmcnt(6)
    buffer_load_dwordx4 v9, s[44:47], s77 offen offset:1024 nt lds
    v_mfma_f32_16x16x32_bf16 v[80:83], v[48:51], v[136:139], v[80:83]
    ds_read_b64_tr_b16 v[44:45], v21 offset:24576
    v_mfma_f32_16x16x32_bf16 v[112:115], v[48:51], v[200:203], v[112:115]
    ds_read_b64_tr_b16 v[46:47], v21 offset:28672
    s_waitcnt lgkmcnt(10)
    v_mfma_f32_16x16x32_bf16 v[116:119], v[52:55], v[200:203], v[116:119]
    ds_read_b64_tr_b16 v[48:49], v22 offset:24576
    v_mfma_f32_16x16x32_bf16 v[84:87], v[52:55], v[136:139], v[84:87]
    ds_read_b64_tr_b16 v[50:51], v22 offset:28672
    v_mfma_f32_16x16x32_bf16 v[88:91], v[56:59], v[136:139], v[88:91]
    ds_read_b64_tr_b16 v[52:53], v23 offset:24576
    v_mfma_f32_16x16x32_bf16 v[120:123], v[56:59], v[200:203], v[120:123]
    ds_read_b64_tr_b16 v[54:55], v23 offset:28672
    s_waitcnt lgkmcnt(10)
    v_mfma_f32_16x16x32_bf16 v[124:127], v[60:63], v[200:203], v[124:127]
    ds_read_b64_tr_b16 v[56:57], v24 offset:24576
    v_mfma_f32_16x16x32_bf16 v[92:95], v[60:63], v[136:139], v[92:95]
    ds_read_b64_tr_b16 v[58:59], v24 offset:28672
    s_waitcnt vmcnt(6)
    buffer_load_dwordx4 v8, s[44:47], s77 offen offset:2048 nt lds
    v_mfma_f32_16x16x32_bf16 v[64:67], v[32:35], v[140:143], v[64:67]
    ds_read_b64_tr_b16 v[60:61], v25 offset:24576
    v_mfma_f32_16x16x32_bf16 v[96:99], v[32:35], v[204:207], v[96:99]
    ds_read_b64_tr_b16 v[62:63], v25 offset:28672
    s_waitcnt lgkmcnt(10)
    v_mfma_f32_16x16x32_bf16 v[100:103], v[36:39], v[204:207], v[100:103]
    v_mfma_f32_16x16x32_bf16 v[68:71], v[36:39], v[140:143], v[68:71]
    v_mfma_f32_16x16x32_bf16 v[72:75], v[40:43], v[140:143], v[72:75]
    v_mfma_f32_16x16x32_bf16 v[104:107], v[40:43], v[204:207], v[104:107]
    s_waitcnt lgkmcnt(6)
    v_mfma_f32_16x16x32_bf16 v[108:111], v[44:47], v[204:207], v[108:111]
    v_mfma_f32_16x16x32_bf16 v[76:79], v[44:47], v[140:143], v[76:79]
    s_waitcnt vmcnt(6)
    buffer_load_dwordx4 v9, s[44:47], s77 offen offset:3072 nt lds
    s_xor_b32 s77, s3, 180224
    v_mfma_f32_16x16x32_bf16 v[80:83], v[48:51], v[140:143], v[80:83]
    v_mfma_f32_16x16x32_bf16 v[112:115], v[48:51], v[204:207], v[112:115]
    s_waitcnt lgkmcnt(2)
    v_mfma_f32_16x16x32_bf16 v[116:119], v[52:55], v[204:207], v[116:119]
    v_mfma_f32_16x16x32_bf16 v[84:87], v[52:55], v[140:143], v[84:87]
    v_mfma_f32_16x16x32_bf16 v[88:91], v[56:59], v[140:143], v[88:91]
    v_mfma_f32_16x16x32_bf16 v[120:123], v[56:59], v[204:207], v[120:123]
    s_waitcnt lgkmcnt(0)
    v_mfma_f32_16x16x32_bf16 v[124:127], v[60:63], v[204:207], v[124:127]
    v_mfma_f32_16x16x32_bf16 v[92:95], v[60:63], v[140:143], v[92:95]
    s_add_u32 m0, s79, 114688
    s_waitcnt vmcnt(6)
    buffer_load_dwordx4 v10, s[48:51], s78 offen offset:0  lds
    s_waitcnt vmcnt(13)
    s_barrier
    s_waitcnt vmcnt(6)
    buffer_load_dwordx4 v11, s[48:51], s78 offen offset:1024  lds
    s_add_u32 m0, s79, 32768
    s_waitcnt vmcnt(6)
    buffer_load_dwordx4 v4, s[40:43], s77 offen offset:0 nt lds
    s_waitcnt vmcnt(6)
    buffer_load_dwordx4 v5, s[40:43], s77 offen offset:1024 nt lds
    s_waitcnt vmcnt(6)
    buffer_load_dwordx4 v6, s[40:43], s77 offen offset:2048 nt lds
    s_waitcnt vmcnt(9)
    s_barrier
    s_waitcnt vmcnt(6)
    buffer_load_dwordx4 v7, s[40:43], s77 offen offset:3072 nt lds
    s_add_u32 m0, s79, 114688
    s_waitcnt vmcnt(6)
    buffer_load_dwordx4 v12, s[48:51], s78 offen offset:2048  lds
    s_waitcnt vmcnt(6)
    buffer_load_dwordx4 v13, s[48:51], s78 offen offset:3072  lds
    s_xor_b32 s78, s95, 2097664
    s_add_u32 m0, s79, 49152
    s_waitcnt vmcnt(6)
    buffer_load_dwordx4 v8, s[44:47], s77 offen offset:0 nt lds
    ds_read_b64_tr_b16 v[32:33], v18 offset:32768
    ds_read_b64_tr_b16 v[34:35], v18 offset:36864
    ds_read_b64_tr_b16 v[36:37], v19 offset:32768
    ds_read_b64_tr_b16 v[38:39], v19 offset:36864
    ds_read_b64_tr_b16 v[40:41], v20 offset:32768
    ds_read_b64_tr_b16 v[42:43], v20 offset:36864
    ds_read_b64_tr_b16 v[44:45], v21 offset:32768
    ds_read_b64_tr_b16 v[46:47], v21 offset:36864
    ds_read_b64_tr_b16 v[48:49], v22 offset:32768
    ds_read_b64_tr_b16 v[50:51], v22 offset:36864
    ds_read_b64_tr_b16 v[52:53], v23 offset:32768
    ds_read_b64_tr_b16 v[54:55], v23 offset:36864
    ds_read_b64_tr_b16 v[56:57], v24 offset:32768
    ds_read_b64_tr_b16 v[58:59], v24 offset:36864
    s_waitcnt lgkmcnt(12)
    v_mfma_f32_16x16x32_bf16 v[64:67], v[32:35], v[144:147], v[64:67]
    ds_read_b64_tr_b16 v[60:61], v25 offset:32768
    v_mfma_f32_16x16x32_bf16 v[96:99], v[32:35], v[208:211], v[96:99]
    ds_read_b64_tr_b16 v[62:63], v25 offset:36864
    s_waitcnt lgkmcnt(10)
    v_mfma_f32_16x16x32_bf16 v[100:103], v[36:39], v[208:211], v[100:103]
    ds_read_b64_tr_b16 v[32:33], v18 offset:40960
    v_mfma_f32_16x16x32_bf16 v[68:71], v[36:39], v[144:147], v[68:71]
    ds_read_b64_tr_b16 v[34:35], v18 offset:45056
    v_mfma_f32_16x16x32_bf16 v[72:75], v[40:43], v[144:147], v[72:75]
    ds_read_b64_tr_b16 v[36:37], v19 offset:40960
    v_mfma_f32_16x16x32_bf16 v[104:107], v[40:43], v[208:211], v[104:107]
    ds_read_b64_tr_b16 v[38:39], v19 offset:45056
    s_waitcnt lgkmcnt(10)
    v_mfma_f32_16x16x32_bf16 v[108:111], v[44:47], v[208:211], v[108:111]
    ds_read_b64_tr_b16 v[40:41], v20 offset:40960
    v_mfma_f32_16x16x32_bf16 v[76:79], v[44:47], v[144:147], v[76:79]
    ds_read_b64_tr_b16 v[42:43], v20 offset:45056
    s_waitcnt vmcnt(6)
    buffer_load_dwordx4 v9, s[44:47], s77 offen offset:1024 nt lds
    v_mfma_f32_16x16x32_bf16 v[80:83], v[48:51], v[144:147], v[80:83]
    ds_read_b64_tr_b16 v[44:45], v21 offset:40960
    v_mfma_f32_16x16x32_bf16 v[112:115], v[48:51], v[208:211], v[112:115]
    ds_read_b64_tr_b16 v[46:47], v21 offset:45056
    s_waitcnt lgkmcnt(10)
    v_mfma_f32_16x16x32_bf16 v[116:119], v[52:55], v[208:211], v[116:119]
    ds_read_b64_tr_b16 v[48:49], v22 offset:40960
    v_mfma_f32_16x16x32_bf16 v[84:87], v[52:55], v[144:147], v[84:87]
    ds_read_b64_tr_b16 v[50:51], v22 offset:45056
    v_mfma_f32_16x16x32_bf16 v[88:91], v[56:59], v[144:147], v[88:91]
    ds_read_b64_tr_b16 v[52:53], v23 offset:40960
    v_mfma_f32_16x16x32_bf16 v[120:123], v[56:59], v[208:211], v[120:123]
    ds_read_b64_tr_b16 v[54:55], v23 offset:45056
    s_waitcnt lgkmcnt(10)
    v_mfma_f32_16x16x32_bf16 v[124:127], v[60:63], v[208:211], v[124:127]
    ds_read_b64_tr_b16 v[56:57], v24 offset:40960
    v_mfma_f32_16x16x32_bf16 v[92:95], v[60:63], v[144:147], v[92:95]
    ds_read_b64_tr_b16 v[58:59], v24 offset:45056
    s_waitcnt vmcnt(6)
    buffer_load_dwordx4 v8, s[44:47], s77 offen offset:2048 nt lds
    v_mfma_f32_16x16x32_bf16 v[64:67], v[32:35], v[148:151], v[64:67]
    ds_read_b64_tr_b16 v[60:61], v25 offset:40960
    v_mfma_f32_16x16x32_bf16 v[96:99], v[32:35], v[212:215], v[96:99]
    ds_read_b64_tr_b16 v[62:63], v25 offset:45056
    s_waitcnt lgkmcnt(10)
    v_mfma_f32_16x16x32_bf16 v[100:103], v[36:39], v[212:215], v[100:103]
    v_mfma_f32_16x16x32_bf16 v[68:71], v[36:39], v[148:151], v[68:71]
    v_mfma_f32_16x16x32_bf16 v[72:75], v[40:43], v[148:151], v[72:75]
    v_mfma_f32_16x16x32_bf16 v[104:107], v[40:43], v[212:215], v[104:107]
    s_waitcnt lgkmcnt(6)
    v_mfma_f32_16x16x32_bf16 v[108:111], v[44:47], v[212:215], v[108:111]
    v_mfma_f32_16x16x32_bf16 v[76:79], v[44:47], v[148:151], v[76:79]
    s_waitcnt vmcnt(6)
    buffer_load_dwordx4 v9, s[44:47], s77 offen offset:3072 nt lds
    s_xor_b32 s77, s3, 196608
    v_mfma_f32_16x16x32_bf16 v[80:83], v[48:51], v[148:151], v[80:83]
    v_mfma_f32_16x16x32_bf16 v[112:115], v[48:51], v[212:215], v[112:115]
    s_waitcnt lgkmcnt(2)
    v_mfma_f32_16x16x32_bf16 v[116:119], v[52:55], v[212:215], v[116:119]
    v_mfma_f32_16x16x32_bf16 v[84:87], v[52:55], v[148:151], v[84:87]
    v_mfma_f32_16x16x32_bf16 v[88:91], v[56:59], v[148:151], v[88:91]
    v_mfma_f32_16x16x32_bf16 v[120:123], v[56:59], v[212:215], v[120:123]
    s_waitcnt lgkmcnt(0)
    v_mfma_f32_16x16x32_bf16 v[124:127], v[60:63], v[212:215], v[124:127]
    v_mfma_f32_16x16x32_bf16 v[92:95], v[60:63], v[148:151], v[92:95]
    s_add_u32 m0, s79, 65536
    s_waitcnt vmcnt(6)
    buffer_load_dwordx4 v10, s[48:51], s78 offen offset:0  lds
    s_waitcnt vmcnt(13)
    s_barrier
    s_waitcnt vmcnt(6)
    buffer_load_dwordx4 v11, s[48:51], s78 offen offset:1024  lds
    s_add_u32 m0, s79, 0
    s_waitcnt vmcnt(6)
    buffer_load_dwordx4 v4, s[40:43], s77 offen offset:0 nt lds
    s_waitcnt vmcnt(6)
    buffer_load_dwordx4 v5, s[40:43], s77 offen offset:1024 nt lds
    s_waitcnt vmcnt(6)
    buffer_load_dwordx4 v6, s[40:43], s77 offen offset:2048 nt lds
    s_waitcnt vmcnt(9)
    s_barrier
    s_waitcnt vmcnt(6)
    buffer_load_dwordx4 v7, s[40:43], s77 offen offset:3072 nt lds
    s_add_u32 m0, s79, 65536
    s_waitcnt vmcnt(6)
    buffer_load_dwordx4 v12, s[48:51], s78 offen offset:2048  lds
    s_waitcnt vmcnt(6)
    buffer_load_dwordx4 v13, s[48:51], s78 offen offset:3072  lds
    s_xor_b32 s78, s95, 2621952
    s_add_u32 m0, s79, 16384
    s_waitcnt vmcnt(6)
    buffer_load_dwordx4 v8, s[44:47], s77 offen offset:0 nt lds
    ds_read_b64_tr_b16 v[32:33], v18 offset:49152
    ds_read_b64_tr_b16 v[34:35], v18 offset:53248
    ds_read_b64_tr_b16 v[36:37], v19 offset:49152
    ds_read_b64_tr_b16 v[38:39], v19 offset:53248
    ds_read_b64_tr_b16 v[40:41], v20 offset:49152
    ds_read_b64_tr_b16 v[42:43], v20 offset:53248
    ds_read_b64_tr_b16 v[44:45], v21 offset:49152
    ds_read_b64_tr_b16 v[46:47], v21 offset:53248
    ds_read_b64_tr_b16 v[48:49], v22 offset:49152
    ds_read_b64_tr_b16 v[50:51], v22 offset:53248
    ds_read_b64_tr_b16 v[52:53], v23 offset:49152
    ds_read_b64_tr_b16 v[54:55], v23 offset:53248
    ds_read_b64_tr_b16 v[56:57], v24 offset:49152
    ds_read_b64_tr_b16 v[58:59], v24 offset:53248
    s_waitcnt lgkmcnt(12)
    v_mfma_f32_16x16x32_bf16 v[64:67], v[32:35], v[152:155], v[64:67]
    ds_read_b64_tr_b16 v[60:61], v25 offset:49152
    v_mfma_f32_16x16x32_bf16 v[96:99], v[32:35], v[216:219], v[96:99]
    ds_read_b64_tr_b16 v[62:63], v25 offset:53248
    s_waitcnt lgkmcnt(10)
    v_mfma_f32_16x16x32_bf16 v[100:103], v[36:39], v[216:219], v[100:103]
    ds_read_b64_tr_b16 v[32:33], v18 offset:57344
    v_mfma_f32_16x16x32_bf16 v[68:71], v[36:39], v[152:155], v[68:71]
    ds_read_b64_tr_b16 v[34:35], v18 offset:61440
    v_mfma_f32_16x16x32_bf16 v[72:75], v[40:43], v[152:155], v[72:75]
    ds_read_b64_tr_b16 v[36:37], v19 offset:57344
    v_mfma_f32_16x16x32_bf16 v[104:107], v[40:43], v[216:219], v[104:107]
    ds_read_b64_tr_b16 v[38:39], v19 offset:61440
    s_waitcnt lgkmcnt(10)
    v_mfma_f32_16x16x32_bf16 v[108:111], v[44:47], v[216:219], v[108:111]
    ds_read_b64_tr_b16 v[40:41], v20 offset:57344
    v_mfma_f32_16x16x32_bf16 v[76:79], v[44:47], v[152:155], v[76:79]
    ds_read_b64_tr_b16 v[42:43], v20 offset:61440
    v_mfma_f32_16x16x32_bf16 v[80:83], v[48:51], v[152:155], v[80:83]
    ds_read_b64_tr_b16 v[44:45], v21 offset:57344
    v_mfma_f32_16x16x32_bf16 v[112:115], v[48:51], v[216:219], v[112:115]
    ds_read_b64_tr_b16 v[46:47], v21 offset:61440
    s_waitcnt vmcnt(6)
    buffer_load_dwordx4 v9, s[44:47], s77 offen offset:1024 nt lds
    s_waitcnt lgkmcnt(10)
    v_mfma_f32_16x16x32_bf16 v[116:119], v[52:55], v[216:219], v[116:119]
    ds_read_b64_tr_b16 v[48:49], v22 offset:57344
    v_mfma_f32_16x16x32_bf16 v[84:87], v[52:55], v[152:155], v[84:87]
    ds_read_b64_tr_b16 v[50:51], v22 offset:61440
    v_mfma_f32_16x16x32_bf16 v[88:91], v[56:59], v[152:155], v[88:91]
    ds_read_b64_tr_b16 v[52:53], v23 offset:57344
    v_mfma_f32_16x16x32_bf16 v[120:123], v[56:59], v[216:219], v[120:123]
    ds_read_b64_tr_b16 v[54:55], v23 offset:61440
    s_waitcnt lgkmcnt(10)
    v_mfma_f32_16x16x32_bf16 v[124:127], v[60:63], v[216:219], v[124:127]
    ds_read_b64_tr_b16 v[56:57], v24 offset:57344
    v_mfma_f32_16x16x32_bf16 v[92:95], v[60:63], v[152:155], v[92:95]
    ds_read_b64_tr_b16 v[58:59], v24 offset:61440
    v_mfma_f32_16x16x32_bf16 v[64:67], v[32:35], v[156:159], v[64:67]
    ds_read_b64_tr_b16 v[60:61], v25 offset:57344
    v_mfma_f32_16x16x32_bf16 v[96:99], v[32:35], v[220:223], v[96:99]
    ds_read_b64_tr_b16 v[62:63], v25 offset:61440
    s_waitcnt lgkmcnt(10)
    v_mfma_f32_16x16x32_bf16 v[100:103], v[36:39], v[220:223], v[100:103]
    v_mfma_f32_16x16x32_bf16 v[68:71], v[36:39], v[156:159], v[68:71]
    s_waitcnt vmcnt(6)
    buffer_load_dwordx4 v8, s[44:47], s77 offen offset:2048 nt lds
    v_mfma_f32_16x16x32_bf16 v[72:75], v[40:43], v[156:159], v[72:75]
    v_mfma_f32_16x16x32_bf16 v[104:107], v[40:43], v[220:223], v[104:107]
    s_waitcnt lgkmcnt(6)
    v_mfma_f32_16x16x32_bf16 v[108:111], v[44:47], v[220:223], v[108:111]
    v_mfma_f32_16x16x32_bf16 v[76:79], v[44:47], v[156:159], v[76:79]
    v_mfma_f32_16x16x32_bf16 v[80:83], v[48:51], v[156:159], v[80:83]
    v_mfma_f32_16x16x32_bf16 v[112:115], v[48:51], v[220:223], v[112:115]
    s_waitcnt lgkmcnt(2)
    v_mfma_f32_16x16x32_bf16 v[116:119], v[52:55], v[220:223], v[116:119]
    v_mfma_f32_16x16x32_bf16 v[84:87], v[52:55], v[156:159], v[84:87]
    v_mfma_f32_16x16x32_bf16 v[88:91], v[56:59], v[156:159], v[88:91]
    v_mfma_f32_16x16x32_bf16 v[120:123], v[56:59], v[220:223], v[120:123]
    s_waitcnt lgkmcnt(0)
    v_mfma_f32_16x16x32_bf16 v[124:127], v[60:63], v[220:223], v[124:127]
    v_mfma_f32_16x16x32_bf16 v[92:95], v[60:63], v[156:159], v[92:95]
    s_waitcnt vmcnt(6)
    buffer_load_dwordx4 v9, s[44:47], s77 offen offset:3072 nt lds
    s_xor_b32 s77, s3, 212992
    s_waitcnt vmcnt(12)
    s_barrier
    s_add_u32 m0, s79, 81920
    s_waitcnt vmcnt(6)
    buffer_load_dwordx4 v10, s[48:51], s78 offen offset:0  lds
    s_waitcnt vmcnt(6)
    buffer_load_dwordx4 v11, s[48:51], s78 offen offset:1024  lds
    s_add_u32 m0, s79, 32768
    s_waitcnt vmcnt(6)
    buffer_load_dwordx4 v4, s[40:43], s77 offen offset:0 nt lds
    s_waitcnt vmcnt(6)
    buffer_load_dwordx4 v5, s[40:43], s77 offen offset:1024 nt lds
    s_waitcnt vmcnt(8)
    s_barrier
    s_waitcnt vmcnt(6)
    buffer_load_dwordx4 v6, s[40:43], s77 offen offset:2048 nt lds
    s_waitcnt vmcnt(6)
    buffer_load_dwordx4 v7, s[40:43], s77 offen offset:3072 nt lds
    s_add_u32 m0, s79, 81920
    s_waitcnt vmcnt(6)
    buffer_load_dwordx4 v12, s[48:51], s78 offen offset:2048  lds
    s_waitcnt vmcnt(6)
    buffer_load_dwordx4 v13, s[48:51], s78 offen offset:3072  lds
    s_xor_b32 s78, s95, 3146240
    ds_read_b64_tr_b16 v[32:33], v18 offset:0
    ds_read_b64_tr_b16 v[34:35], v18 offset:4096
    ds_read_b64_tr_b16 v[36:37], v19 offset:0
    ds_read_b64_tr_b16 v[38:39], v19 offset:4096
    ds_read_b64_tr_b16 v[40:41], v20 offset:0
    ds_read_b64_tr_b16 v[42:43], v20 offset:4096
    ds_read_b64_tr_b16 v[44:45], v21 offset:0
    ds_read_b64_tr_b16 v[46:47], v21 offset:4096
    ds_read_b64_tr_b16 v[48:49], v22 offset:0
    ds_read_b64_tr_b16 v[50:51], v22 offset:4096
    ds_read_b64_tr_b16 v[52:53], v23 offset:0
    ds_read_b64_tr_b16 v[54:55], v23 offset:4096
    ds_read_b64_tr_b16 v[56:57], v24 offset:0
    ds_read_b64_tr_b16 v[58:59], v24 offset:4096
    s_waitcnt lgkmcnt(12)
    v_mfma_f32_16x16x32_bf16 v[64:67], v[32:35], v[160:163], v[64:67]
    ds_read_b64_tr_b16 v[60:61], v25 offset:0
    v_mfma_f32_16x16x32_bf16 v[96:99], v[32:35], v[224:227], v[96:99]
    ds_read_b64_tr_b16 v[62:63], v25 offset:4096
    s_waitcnt lgkmcnt(10)
    v_mfma_f32_16x16x32_bf16 v[100:103], v[36:39], v[224:227], v[100:103]
    ds_read_b64_tr_b16 v[32:33], v18 offset:8192
    v_mfma_f32_16x16x32_bf16 v[68:71], v[36:39], v[160:163], v[68:71]
    ds_read_b64_tr_b16 v[34:35], v18 offset:12288
    v_mfma_f32_16x16x32_bf16 v[72:75], v[40:43], v[160:163], v[72:75]
    ds_read_b64_tr_b16 v[36:37], v19 offset:8192
    v_mfma_f32_16x16x32_bf16 v[104:107], v[40:43], v[224:227], v[104:107]
    ds_read_b64_tr_b16 v[38:39], v19 offset:12288
    s_waitcnt lgkmcnt(10)
    v_mfma_f32_16x16x32_bf16 v[108:111], v[44:47], v[224:227], v[108:111]
    ds_read_b64_tr_b16 v[40:41], v20 offset:8192
    v_mfma_f32_16x16x32_bf16 v[76:79], v[44:47], v[160:163], v[76:79]
    ds_read_b64_tr_b16 v[42:43], v20 offset:12288
    s_add_u32 m0, s79, 49152
    s_waitcnt vmcnt(6)
    buffer_load_dwordx4 v8, s[44:47], s77 offen offset:0 nt lds
    v_mfma_f32_16x16x32_bf16 v[80:83], v[48:51], v[160:163], v[80:83]
    ds_read_b64_tr_b16 v[44:45], v21 offset:8192
    v_mfma_f32_16x16x32_bf16 v[112:115], v[48:51], v[224:227], v[112:115]
    ds_read_b64_tr_b16 v[46:47], v21 offset:12288
    s_waitcnt lgkmcnt(10)
    v_mfma_f32_16x16x32_bf16 v[116:119], v[52:55], v[224:227], v[116:119]
    ds_read_b64_tr_b16 v[48:49], v22 offset:8192
    v_mfma_f32_16x16x32_bf16 v[84:87], v[52:55], v[160:163], v[84:87]
    ds_read_b64_tr_b16 v[50:51], v22 offset:12288
    v_mfma_f32_16x16x32_bf16 v[88:91], v[56:59], v[160:163], v[88:91]
    ds_read_b64_tr_b16 v[52:53], v23 offset:8192
    v_mfma_f32_16x16x32_bf16 v[120:123], v[56:59], v[224:227], v[120:123]
    ds_read_b64_tr_b16 v[54:55], v23 offset:12288
    s_waitcnt lgkmcnt(10)
    v_mfma_f32_16x16x32_bf16 v[124:127], v[60:63], v[224:227], v[124:127]
    ds_read_b64_tr_b16 v[56:57], v24 offset:8192
    v_mfma_f32_16x16x32_bf16 v[92:95], v[60:63], v[160:163], v[92:95]
    ds_read_b64_tr_b16 v[58:59], v24 offset:12288
    s_waitcnt vmcnt(6)
    buffer_load_dwordx4 v9, s[44:47], s77 offen offset:1024 nt lds
    v_mfma_f32_16x16x32_bf16 v[64:67], v[32:35], v[164:167], v[64:67]
    ds_read_b64_tr_b16 v[60:61], v25 offset:8192
    v_mfma_f32_16x16x32_bf16 v[96:99], v[32:35], v[228:231], v[96:99]
    ds_read_b64_tr_b16 v[62:63], v25 offset:12288
    s_waitcnt lgkmcnt(10)
    v_mfma_f32_16x16x32_bf16 v[100:103], v[36:39], v[228:231], v[100:103]
    v_mfma_f32_16x16x32_bf16 v[68:71], v[36:39], v[164:167], v[68:71]
    v_mfma_f32_16x16x32_bf16 v[72:75], v[40:43], v[164:167], v[72:75]
    v_mfma_f32_16x16x32_bf16 v[104:107], v[40:43], v[228:231], v[104:107]
    s_waitcnt lgkmcnt(6)
    v_mfma_f32_16x16x32_bf16 v[108:111], v[44:47], v[228:231], v[108:111]
    v_mfma_f32_16x16x32_bf16 v[76:79], v[44:47], v[164:167], v[76:79]
    s_waitcnt vmcnt(6)
    buffer_load_dwordx4 v8, s[44:47], s77 offen offset:2048 nt lds
    v_mfma_f32_16x16x32_bf16 v[80:83], v[48:51], v[164:167], v[80:83]
    v_mfma_f32_16x16x32_bf16 v[112:115], v[48:51], v[228:231], v[112:115]
    s_waitcnt lgkmcnt(2)
    v_mfma_f32_16x16x32_bf16 v[116:119], v[52:55], v[228:231], v[116:119]
    v_mfma_f32_16x16x32_bf16 v[84:87], v[52:55], v[164:167], v[84:87]
    v_mfma_f32_16x16x32_bf16 v[88:91], v[56:59], v[164:167], v[88:91]
    v_mfma_f32_16x16x32_bf16 v[120:123], v[56:59], v[228:231], v[120:123]
    s_waitcnt lgkmcnt(0)
    v_mfma_f32_16x16x32_bf16 v[124:127], v[60:63], v[228:231], v[124:127]
    v_mfma_f32_16x16x32_bf16 v[92:95], v[60:63], v[164:167], v[92:95]
    s_waitcnt vmcnt(6)
    buffer_load_dwordx4 v9, s[44:47], s77 offen offset:3072 nt lds
    s_xor_b32 s77, s3, 229376
    s_waitcnt vmcnt(12)
    s_barrier
    s_add_u32 m0, s79, 98304
    s_waitcnt vmcnt(6)
    buffer_load_dwordx4 v10, s[48:51], s78 offen offset:0  lds
    s_waitcnt vmcnt(6)
    buffer_load_dwordx4 v11, s[48:51], s78 offen offset:1024  lds
    s_add_u32 m0, s79, 0
    s_waitcnt vmcnt(6)
    buffer_load_dwordx4 v4, s[40:43], s77 offen offset:0 nt lds
    s_waitcnt vmcnt(6)
    buffer_load_dwordx4 v5, s[40:43], s77 offen offset:1024 nt lds
    s_waitcnt vmcnt(8)
    s_barrier
    s_waitcnt vmcnt(6)
    buffer_load_dwordx4 v6, s[40:43], s77 offen offset:2048 nt lds
    s_waitcnt vmcnt(6)
    buffer_load_dwordx4 v7, s[40:43], s77 offen offset:3072 nt lds
    s_add_u32 m0, s79, 98304
    s_waitcnt vmcnt(6)
    buffer_load_dwordx4 v12, s[48:51], s78 offen offset:2048  lds
    s_waitcnt vmcnt(6)
    buffer_load_dwordx4 v13, s[48:51], s78 offen offset:3072  lds
    s_xor_b32 s78, s95, 3670528
    ds_read_b64_tr_b16 v[32:33], v18 offset:16384
    ds_read_b64_tr_b16 v[34:35], v18 offset:20480
    ds_read_b64_tr_b16 v[36:37], v19 offset:16384
    ds_read_b64_tr_b16 v[38:39], v19 offset:20480
    ds_read_b64_tr_b16 v[40:41], v20 offset:16384
    ds_read_b64_tr_b16 v[42:43], v20 offset:20480
    ds_read_b64_tr_b16 v[44:45], v21 offset:16384
    ds_read_b64_tr_b16 v[46:47], v21 offset:20480
    ds_read_b64_tr_b16 v[48:49], v22 offset:16384
    ds_read_b64_tr_b16 v[50:51], v22 offset:20480
    ds_read_b64_tr_b16 v[52:53], v23 offset:16384
    ds_read_b64_tr_b16 v[54:55], v23 offset:20480
    ds_read_b64_tr_b16 v[56:57], v24 offset:16384
    ds_read_b64_tr_b16 v[58:59], v24 offset:20480
    s_waitcnt lgkmcnt(12)
    v_mfma_f32_16x16x32_bf16 v[64:67], v[32:35], v[168:171], v[64:67]
    ds_read_b64_tr_b16 v[60:61], v25 offset:16384
    v_mfma_f32_16x16x32_bf16 v[96:99], v[32:35], v[232:235], v[96:99]
    ds_read_b64_tr_b16 v[62:63], v25 offset:20480
    s_waitcnt lgkmcnt(10)
    v_mfma_f32_16x16x32_bf16 v[100:103], v[36:39], v[232:235], v[100:103]
    ds_read_b64_tr_b16 v[32:33], v18 offset:24576
    v_mfma_f32_16x16x32_bf16 v[68:71], v[36:39], v[168:171], v[68:71]
    ds_read_b64_tr_b16 v[34:35], v18 offset:28672
    v_mfma_f32_16x16x32_bf16 v[72:75], v[40:43], v[168:171], v[72:75]
    ds_read_b64_tr_b16 v[36:37], v19 offset:24576
    v_mfma_f32_16x16x32_bf16 v[104:107], v[40:43], v[232:235], v[104:107]
    ds_read_b64_tr_b16 v[38:39], v19 offset:28672
    s_waitcnt lgkmcnt(10)
    v_mfma_f32_16x16x32_bf16 v[108:111], v[44:47], v[232:235], v[108:111]
    ds_read_b64_tr_b16 v[40:41], v20 offset:24576
    v_mfma_f32_16x16x32_bf16 v[76:79], v[44:47], v[168:171], v[76:79]
    ds_read_b64_tr_b16 v[42:43], v20 offset:28672
    s_add_u32 m0, s79, 16384
    s_waitcnt vmcnt(6)
    buffer_load_dwordx4 v8, s[44:47], s77 offen offset:0 nt lds
    v_mfma_f32_16x16x32_bf16 v[80:83], v[48:51], v[168:171], v[80:83]
    ds_read_b64_tr_b16 v[44:45], v21 offset:24576
    v_mfma_f32_16x16x32_bf16 v[112:115], v[48:51], v[232:235], v[112:115]
    ds_read_b64_tr_b16 v[46:47], v21 offset:28672
    s_waitcnt lgkmcnt(10)
    v_mfma_f32_16x16x32_bf16 v[116:119], v[52:55], v[232:235], v[116:119]
    ds_read_b64_tr_b16 v[48:49], v22 offset:24576
    v_mfma_f32_16x16x32_bf16 v[84:87], v[52:55], v[168:171], v[84:87]
    ds_read_b64_tr_b16 v[50:51], v22 offset:28672
    v_mfma_f32_16x16x32_bf16 v[88:91], v[56:59], v[168:171], v[88:91]
    ds_read_b64_tr_b16 v[52:53], v23 offset:24576
    v_mfma_f32_16x16x32_bf16 v[120:123], v[56:59], v[232:235], v[120:123]
    ds_read_b64_tr_b16 v[54:55], v23 offset:28672
    s_waitcnt lgkmcnt(10)
    v_mfma_f32_16x16x32_bf16 v[124:127], v[60:63], v[232:235], v[124:127]
    ds_read_b64_tr_b16 v[56:57], v24 offset:24576
    v_mfma_f32_16x16x32_bf16 v[92:95], v[60:63], v[168:171], v[92:95]
    ds_read_b64_tr_b16 v[58:59], v24 offset:28672
    s_waitcnt vmcnt(6)
    buffer_load_dwordx4 v9, s[44:47], s77 offen offset:1024 nt lds
    v_mfma_f32_16x16x32_bf16 v[64:67], v[32:35], v[172:175], v[64:67]
    ds_read_b64_tr_b16 v[60:61], v25 offset:24576
    v_mfma_f32_16x16x32_bf16 v[96:99], v[32:35], v[236:239], v[96:99]
    ds_read_b64_tr_b16 v[62:63], v25 offset:28672
    s_waitcnt lgkmcnt(10)
    v_mfma_f32_16x16x32_bf16 v[100:103], v[36:39], v[236:239], v[100:103]
    v_mfma_f32_16x16x32_bf16 v[68:71], v[36:39], v[172:175], v[68:71]
    v_mfma_f32_16x16x32_bf16 v[72:75], v[40:43], v[172:175], v[72:75]
    v_mfma_f32_16x16x32_bf16 v[104:107], v[40:43], v[236:239], v[104:107]
    s_waitcnt lgkmcnt(6)
    v_mfma_f32_16x16x32_bf16 v[108:111], v[44:47], v[236:239], v[108:111]
    v_mfma_f32_16x16x32_bf16 v[76:79], v[44:47], v[172:175], v[76:79]
    s_waitcnt vmcnt(6)
    buffer_load_dwordx4 v8, s[44:47], s77 offen offset:2048 nt lds
    v_mfma_f32_16x16x32_bf16 v[80:83], v[48:51], v[172:175], v[80:83]
    v_mfma_f32_16x16x32_bf16 v[112:115], v[48:51], v[236:239], v[112:115]
    s_waitcnt lgkmcnt(2)
    v_mfma_f32_16x16x32_bf16 v[116:119], v[52:55], v[236:239], v[116:119]
    v_mfma_f32_16x16x32_bf16 v[84:87], v[52:55], v[172:175], v[84:87]
    v_mfma_f32_16x16x32_bf16 v[88:91], v[56:59], v[172:175], v[88:91]
    v_mfma_f32_16x16x32_bf16 v[120:123], v[56:59], v[236:239], v[120:123]
    s_waitcnt lgkmcnt(0)
    v_mfma_f32_16x16x32_bf16 v[124:127], v[60:63], v[236:239], v[124:127]
    v_mfma_f32_16x16x32_bf16 v[92:95], v[60:63], v[172:175], v[92:95]
    s_waitcnt vmcnt(6)
    buffer_load_dwordx4 v9, s[44:47], s77 offen offset:3072 nt lds
    s_xor_b32 s77, s3, 245760
    s_waitcnt vmcnt(12)
    s_barrier
    s_add_u32 m0, s79, 114688
    s_waitcnt vmcnt(6)
    buffer_load_dwordx4 v10, s[48:51], s78 offen offset:0  lds
    s_waitcnt vmcnt(6)
    buffer_load_dwordx4 v11, s[48:51], s78 offen offset:1024  lds
    s_add_u32 m0, s79, 32768
    s_waitcnt vmcnt(6)
    buffer_load_dwordx4 v4, s[40:43], s77 offen offset:0 nt lds
    s_waitcnt vmcnt(6)
    buffer_load_dwordx4 v5, s[40:43], s77 offen offset:1024 nt lds
    s_waitcnt vmcnt(8)
    s_barrier
    s_waitcnt vmcnt(6)
    buffer_load_dwordx4 v6, s[40:43], s77 offen offset:2048 nt lds
    s_waitcnt vmcnt(6)
    buffer_load_dwordx4 v7, s[40:43], s77 offen offset:3072 nt lds
    s_add_u32 m0, s79, 114688
    s_waitcnt vmcnt(6)
    buffer_load_dwordx4 v12, s[48:51], s78 offen offset:2048  lds
    s_waitcnt vmcnt(6)
    buffer_load_dwordx4 v13, s[48:51], s78 offen offset:3072  lds
    s_xor_b32 s78, s95, 768
    ds_read_b64_tr_b16 v[32:33], v18 offset:32768
    ds_read_b64_tr_b16 v[34:35], v18 offset:36864
    ds_read_b64_tr_b16 v[36:37], v19 offset:32768
    ds_read_b64_tr_b16 v[38:39], v19 offset:36864
    ds_read_b64_tr_b16 v[40:41], v20 offset:32768
    ds_read_b64_tr_b16 v[42:43], v20 offset:36864
    ds_read_b64_tr_b16 v[44:45], v21 offset:32768
    ds_read_b64_tr_b16 v[46:47], v21 offset:36864
    ds_read_b64_tr_b16 v[48:49], v22 offset:32768
    ds_read_b64_tr_b16 v[50:51], v22 offset:36864
    ds_read_b64_tr_b16 v[52:53], v23 offset:32768
    ds_read_b64_tr_b16 v[54:55], v23 offset:36864
    ds_read_b64_tr_b16 v[56:57], v24 offset:32768
    ds_read_b64_tr_b16 v[58:59], v24 offset:36864
    s_waitcnt lgkmcnt(12)
    v_mfma_f32_16x16x32_bf16 v[64:67], v[32:35], v[176:179], v[64:67]
    ds_read_b64_tr_b16 v[60:61], v25 offset:32768
    v_mfma_f32_16x16x32_bf16 v[96:99], v[32:35], v[240:243], v[96:99]
    ds_read_b64_tr_b16 v[62:63], v25 offset:36864
    s_waitcnt lgkmcnt(10)
    v_mfma_f32_16x16x32_bf16 v[100:103], v[36:39], v[240:243], v[100:103]
    ds_read_b64_tr_b16 v[32:33], v18 offset:40960
    v_mfma_f32_16x16x32_bf16 v[68:71], v[36:39], v[176:179], v[68:71]
    ds_read_b64_tr_b16 v[34:35], v18 offset:45056
    v_mfma_f32_16x16x32_bf16 v[72:75], v[40:43], v[176:179], v[72:75]
    ds_read_b64_tr_b16 v[36:37], v19 offset:40960
    v_mfma_f32_16x16x32_bf16 v[104:107], v[40:43], v[240:243], v[104:107]
    ds_read_b64_tr_b16 v[38:39], v19 offset:45056
    s_waitcnt lgkmcnt(10)
    v_mfma_f32_16x16x32_bf16 v[108:111], v[44:47], v[240:243], v[108:111]
    ds_read_b64_tr_b16 v[40:41], v20 offset:40960
    v_mfma_f32_16x16x32_bf16 v[76:79], v[44:47], v[176:179], v[76:79]
    ds_read_b64_tr_b16 v[42:43], v20 offset:45056
    s_add_u32 m0, s79, 49152
    s_waitcnt vmcnt(6)
    buffer_load_dwordx4 v8, s[44:47], s77 offen offset:0 nt lds
    v_mfma_f32_16x16x32_bf16 v[80:83], v[48:51], v[176:179], v[80:83]
    ds_read_b64_tr_b16 v[44:45], v21 offset:40960
    v_mfma_f32_16x16x32_bf16 v[112:115], v[48:51], v[240:243], v[112:115]
    ds_read_b64_tr_b16 v[46:47], v21 offset:45056
    s_waitcnt lgkmcnt(10)
    v_mfma_f32_16x16x32_bf16 v[116:119], v[52:55], v[240:243], v[116:119]
    ds_read_b64_tr_b16 v[48:49], v22 offset:40960
    v_mfma_f32_16x16x32_bf16 v[84:87], v[52:55], v[176:179], v[84:87]
    ds_read_b64_tr_b16 v[50:51], v22 offset:45056
    v_mfma_f32_16x16x32_bf16 v[88:91], v[56:59], v[176:179], v[88:91]
    ds_read_b64_tr_b16 v[52:53], v23 offset:40960
    v_mfma_f32_16x16x32_bf16 v[120:123], v[56:59], v[240:243], v[120:123]
    ds_read_b64_tr_b16 v[54:55], v23 offset:45056
    s_waitcnt lgkmcnt(10)
    v_mfma_f32_16x16x32_bf16 v[124:127], v[60:63], v[240:243], v[124:127]
    ds_read_b64_tr_b16 v[56:57], v24 offset:40960
    v_mfma_f32_16x16x32_bf16 v[92:95], v[60:63], v[176:179], v[92:95]
    ds_read_b64_tr_b16 v[58:59], v24 offset:45056
    s_waitcnt vmcnt(6)
    buffer_load_dwordx4 v9, s[44:47], s77 offen offset:1024 nt lds
    v_mfma_f32_16x16x32_bf16 v[64:67], v[32:35], v[180:183], v[64:67]
    ds_read_b64_tr_b16 v[60:61], v25 offset:40960
    v_mfma_f32_16x16x32_bf16 v[96:99], v[32:35], v[244:247], v[96:99]
    ds_read_b64_tr_b16 v[62:63], v25 offset:45056
    s_waitcnt lgkmcnt(10)
    v_mfma_f32_16x16x32_bf16 v[100:103], v[36:39], v[244:247], v[100:103]
    v_mfma_f32_16x16x32_bf16 v[68:71], v[36:39], v[180:183], v[68:71]
    v_mfma_f32_16x16x32_bf16 v[72:75], v[40:43], v[180:183], v[72:75]
    v_mfma_f32_16x16x32_bf16 v[104:107], v[40:43], v[244:247], v[104:107]
    s_waitcnt lgkmcnt(6)
    v_mfma_f32_16x16x32_bf16 v[108:111], v[44:47], v[244:247], v[108:111]
    v_mfma_f32_16x16x32_bf16 v[76:79], v[44:47], v[180:183], v[76:79]
    s_waitcnt vmcnt(6)
    buffer_load_dwordx4 v8, s[44:47], s77 offen offset:2048 nt lds
    v_mfma_f32_16x16x32_bf16 v[80:83], v[48:51], v[180:183], v[80:83]
    v_mfma_f32_16x16x32_bf16 v[112:115], v[48:51], v[244:247], v[112:115]
    s_waitcnt lgkmcnt(2)
    v_mfma_f32_16x16x32_bf16 v[116:119], v[52:55], v[244:247], v[116:119]
    v_mfma_f32_16x16x32_bf16 v[84:87], v[52:55], v[180:183], v[84:87]
    v_mfma_f32_16x16x32_bf16 v[88:91], v[56:59], v[180:183], v[88:91]
    v_mfma_f32_16x16x32_bf16 v[120:123], v[56:59], v[244:247], v[120:123]
    s_waitcnt lgkmcnt(0)
    v_mfma_f32_16x16x32_bf16 v[124:127], v[60:63], v[244:247], v[124:127]
    v_mfma_f32_16x16x32_bf16 v[92:95], v[60:63], v[180:183], v[92:95]
    s_waitcnt vmcnt(6)
    buffer_load_dwordx4 v9, s[44:47], s77 offen offset:3072 nt lds
    s_xor_b32 s77, s3, 262144
    s_waitcnt vmcnt(12)
    s_barrier
    s_add_u32 m0, s79, 65536
    s_waitcnt vmcnt(6)
    buffer_load_dwordx4 v10, s[48:51], s78 offen offset:0  lds
    s_waitcnt vmcnt(6)
    buffer_load_dwordx4 v11, s[48:51], s78 offen offset:1024  lds
    s_add_u32 m0, s79, 0
    s_waitcnt vmcnt(6)
    buffer_load_dwordx4 v4, s[40:43], s77 offen offset:0 nt lds
    s_waitcnt vmcnt(6)
    buffer_load_dwordx4 v5, s[40:43], s77 offen offset:1024 nt lds
    s_waitcnt vmcnt(8)
    s_barrier
    s_waitcnt vmcnt(6)
    buffer_load_dwordx4 v6, s[40:43], s77 offen offset:2048 nt lds
    s_waitcnt vmcnt(6)
    buffer_load_dwordx4 v7, s[40:43], s77 offen offset:3072 nt lds
    s_add_u32 m0, s79, 65536
    s_waitcnt vmcnt(6)
    buffer_load_dwordx4 v12, s[48:51], s78 offen offset:2048  lds
    s_waitcnt vmcnt(6)
    buffer_load_dwordx4 v13, s[48:51], s78 offen offset:3072  lds
    s_xor_b32 s78, s95, 525056
    ds_read_b64_tr_b16 v[32:33], v18 offset:49152
    ds_read_b64_tr_b16 v[34:35], v18 offset:53248
    ds_read_b64_tr_b16 v[36:37], v19 offset:49152
    ds_read_b64_tr_b16 v[38:39], v19 offset:53248
    ds_read_b64_tr_b16 v[40:41], v20 offset:49152
    ds_read_b64_tr_b16 v[42:43], v20 offset:53248
    ds_read_b64_tr_b16 v[44:45], v21 offset:49152
    ds_read_b64_tr_b16 v[46:47], v21 offset:53248
    ds_read_b64_tr_b16 v[48:49], v22 offset:49152
    ds_read_b64_tr_b16 v[50:51], v22 offset:53248
    ds_read_b64_tr_b16 v[52:53], v23 offset:49152
    ds_read_b64_tr_b16 v[54:55], v23 offset:53248
    ds_read_b64_tr_b16 v[56:57], v24 offset:49152
    ds_read_b64_tr_b16 v[58:59], v24 offset:53248
    s_waitcnt lgkmcnt(12)
    v_mfma_f32_16x16x32_bf16 v[64:67], v[32:35], v[184:187], v[64:67]
    ds_read_b64_tr_b16 v[60:61], v25 offset:49152
    v_mfma_f32_16x16x32_bf16 v[96:99], v[32:35], v[248:251], v[96:99]
    ds_read_b64_tr_b16 v[62:63], v25 offset:53248
    s_waitcnt lgkmcnt(10)
    v_mfma_f32_16x16x32_bf16 v[100:103], v[36:39], v[248:251], v[100:103]
    ds_read_b64_tr_b16 v[32:33], v18 offset:57344
    v_mfma_f32_16x16x32_bf16 v[68:71], v[36:39], v[184:187], v[68:71]
    ds_read_b64_tr_b16 v[34:35], v18 offset:61440
    v_mfma_f32_16x16x32_bf16 v[72:75], v[40:43], v[184:187], v[72:75]
    ds_read_b64_tr_b16 v[36:37], v19 offset:57344
    v_mfma_f32_16x16x32_bf16 v[104:107], v[40:43], v[248:251], v[104:107]
    ds_read_b64_tr_b16 v[38:39], v19 offset:61440
    s_waitcnt lgkmcnt(10)
    v_mfma_f32_16x16x32_bf16 v[108:111], v[44:47], v[248:251], v[108:111]
    ds_read_b64_tr_b16 v[40:41], v20 offset:57344
    v_mfma_f32_16x16x32_bf16 v[76:79], v[44:47], v[184:187], v[76:79]
    ds_read_b64_tr_b16 v[42:43], v20 offset:61440
    v_mfma_f32_16x16x32_bf16 v[80:83], v[48:51], v[184:187], v[80:83]
    ds_read_b64_tr_b16 v[44:45], v21 offset:57344
    v_mfma_f32_16x16x32_bf16 v[112:115], v[48:51], v[248:251], v[112:115]
    ds_read_b64_tr_b16 v[46:47], v21 offset:61440
    s_waitcnt lgkmcnt(10)
    v_mfma_f32_16x16x32_bf16 v[116:119], v[52:55], v[248:251], v[116:119]
    ds_read_b64_tr_b16 v[48:49], v22 offset:57344
    v_mfma_f32_16x16x32_bf16 v[84:87], v[52:55], v[184:187], v[84:87]
    ds_read_b64_tr_b16 v[50:51], v22 offset:61440
    v_mfma_f32_16x16x32_bf16 v[88:91], v[56:59], v[184:187], v[88:91]
    ds_read_b64_tr_b16 v[52:53], v23 offset:57344
    v_mfma_f32_16x16x32_bf16 v[120:123], v[56:59], v[248:251], v[120:123]
    ds_read_b64_tr_b16 v[54:55], v23 offset:61440
    s_waitcnt lgkmcnt(10)
    v_mfma_f32_16x16x32_bf16 v[124:127], v[60:63], v[248:251], v[124:127]
    ds_read_b64_tr_b16 v[56:57], v24 offset:57344
    v_mfma_f32_16x16x32_bf16 v[92:95], v[60:63], v[184:187], v[92:95]
    ds_read_b64_tr_b16 v[58:59], v24 offset:61440
    s_add_u32 m0, s79, 16384
    s_waitcnt vmcnt(6)
    buffer_load_dwordx4 v8, s[44:47], s77 offen offset:0 nt lds
    v_mfma_f32_16x16x32_bf16 v[64:67], v[32:35], v[188:191], v[64:67]
    ds_read_b64_tr_b16 v[60:61], v25 offset:57344
    v_mfma_f32_16x16x32_bf16 v[96:99], v[32:35], v[252:255], v[96:99]
    ds_read_b64_tr_b16 v[62:63], v25 offset:61440
    s_waitcnt lgkmcnt(10)
    v_mfma_f32_16x16x32_bf16 v[100:103], v[36:39], v[252:255], v[100:103]
    v_mfma_f32_16x16x32_bf16 v[68:71], v[36:39], v[188:191], v[68:71]
    v_mfma_f32_16x16x32_bf16 v[72:75], v[40:43], v[188:191], v[72:75]
    v_mfma_f32_16x16x32_bf16 v[104:107], v[40:43], v[252:255], v[104:107]
    s_waitcnt lgkmcnt(6)
    v_mfma_f32_16x16x32_bf16 v[108:111], v[44:47], v[252:255], v[108:111]
    v_mfma_f32_16x16x32_bf16 v[76:79], v[44:47], v[188:191], v[76:79]
    v_mfma_f32_16x16x32_bf16 v[80:83], v[48:51], v[188:191], v[80:83]
    v_mfma_f32_16x16x32_bf16 v[112:115], v[48:51], v[252:255], v[112:115]
    s_waitcnt lgkmcnt(2)
    v_mfma_f32_16x16x32_bf16 v[116:119], v[52:55], v[252:255], v[116:119]
    v_mfma_f32_16x16x32_bf16 v[84:87], v[52:55], v[188:191], v[84:87]
    v_mfma_f32_16x16x32_bf16 v[88:91], v[56:59], v[188:191], v[88:91]
    v_mfma_f32_16x16x32_bf16 v[120:123], v[56:59], v[252:255], v[120:123]
    s_waitcnt lgkmcnt(0)
    v_mfma_f32_16x16x32_bf16 v[124:127], v[60:63], v[252:255], v[124:127]
    v_mfma_f32_16x16x32_bf16 v[92:95], v[60:63], v[188:191], v[92:95]
    s_waitcnt vmcnt(6)
    buffer_load_dwordx4 v9, s[44:47], s77 offen offset:1024 nt lds
    s_waitcnt vmcnt(10)
    s_barrier
    s_setprio 1
    s_waitcnt vmcnt(6)
    buffer_load_dwordx4 v8, s[44:47], s77 offen offset:2048 nt lds
    v_mul_f32 v64, s92, v64
    v_mul_f32 v65, s92, v65
    v_mul_f32 v66, s92, v66
    v_mul_f32 v67, s92, v67
    v_cvt_pk_bf16_f32 v32, v64, v65
    v_cvt_pk_bf16_f32 v33, v66, v67
    ds_write_b64 v27, v[32:33] offset:0
    v_mul_f32 v96, s92, v96
    v_mul_f32 v97, s92, v97
    v_mul_f32 v98, s92, v98
    v_mul_f32 v99, s92, v99
    v_cvt_pk_bf16_f32 v48, v96, v97
    v_cvt_pk_bf16_f32 v49, v98, v99
    ds_write_b64 v27, v[48:49] offset:4096
    v_mul_f32 v68, s92, v68
    v_mul_f32 v69, s92, v69
    v_mul_f32 v70, s92, v70
    v_mul_f32 v71, s92, v71
    v_cvt_pk_bf16_f32 v34, v68, v69
    v_cvt_pk_bf16_f32 v35, v70, v71
    ds_write_b64 v27, v[34:35] offset:512
    v_mul_f32 v100, s92, v100
    v_mul_f32 v101, s92, v101
    v_mul_f32 v102, s92, v102
    v_mul_f32 v103, s92, v103
    v_cvt_pk_bf16_f32 v50, v100, v101
    v_cvt_pk_bf16_f32 v51, v102, v103
    ds_write_b64 v27, v[50:51] offset:4608
    s_waitcnt vmcnt(6)
    buffer_load_dwordx4 v9, s[44:47], s77 offen offset:3072 nt lds
    s_xor_b32 s77, s3, 278528
    v_mul_f32 v72, s92, v72
    v_mul_f32 v73, s92, v73
    v_mul_f32 v74, s92, v74
    v_mul_f32 v75, s92, v75
    v_cvt_pk_bf16_f32 v36, v72, v73
    v_cvt_pk_bf16_f32 v37, v74, v75
    ds_write_b64 v27, v[36:37] offset:1024
    v_mul_f32 v104, s92, v104
    v_mul_f32 v105, s92, v105
    v_mul_f32 v106, s92, v106
    v_mul_f32 v107, s92, v107
    v_cvt_pk_bf16_f32 v52, v104, v105
    v_cvt_pk_bf16_f32 v53, v106, v107
    ds_write_b64 v27, v[52:53] offset:5120
    v_mul_f32 v76, s92, v76
    v_mul_f32 v77, s92, v77
    v_mul_f32 v78, s92, v78
    v_mul_f32 v79, s92, v79
    v_cvt_pk_bf16_f32 v38, v76, v77
    v_cvt_pk_bf16_f32 v39, v78, v79
    ds_write_b64 v27, v[38:39] offset:1536
    v_mul_f32 v108, s92, v108
    v_mul_f32 v109, s92, v109
    v_mul_f32 v110, s92, v110
    v_mul_f32 v111, s92, v111
    v_cvt_pk_bf16_f32 v54, v108, v109
    v_cvt_pk_bf16_f32 v55, v110, v111
    ds_write_b64 v27, v[54:55] offset:5632
    s_add_u32 m0, s79, 81920
    s_waitcnt vmcnt(6)
    buffer_load_dwordx4 v10, s[48:51], s78 offen offset:0  lds
    v_mul_f32 v80, s92, v80
    v_mul_f32 v81, s92, v81
    v_mul_f32 v82, s92, v82
    v_mul_f32 v83, s92, v83
    v_cvt_pk_bf16_f32 v40, v80, v81
    v_cvt_pk_bf16_f32 v41, v82, v83
    ds_write_b64 v27, v[40:41] offset:2048
    v_mul_f32 v112, s92, v112
    v_mul_f32 v113, s92, v113
    v_mul_f32 v114, s92, v114
    v_mul_f32 v115, s92, v115
    v_cvt_pk_bf16_f32 v56, v112, v113
    v_cvt_pk_bf16_f32 v57, v114, v115
    ds_write_b64 v27, v[56:57] offset:6144
    v_mul_f32 v84, s92, v84
    v_mul_f32 v85, s92, v85
    v_mul_f32 v86, s92, v86
    v_mul_f32 v87, s92, v87
    v_cvt_pk_bf16_f32 v42, v84, v85
    v_cvt_pk_bf16_f32 v43, v86, v87
    ds_write_b64 v27, v[42:43] offset:2560
    v_mul_f32 v116, s92, v116
    v_mul_f32 v117, s92, v117
    v_mul_f32 v118, s92, v118
    v_mul_f32 v119, s92, v119
    v_cvt_pk_bf16_f32 v58, v116, v117
    v_cvt_pk_bf16_f32 v59, v118, v119
    ds_write_b64 v27, v[58:59] offset:6656
    s_waitcnt vmcnt(6)
    buffer_load_dwordx4 v11, s[48:51], s78 offen offset:1024  lds
    v_mul_f32 v88, s92, v88
    v_mul_f32 v89, s92, v89
    v_mul_f32 v90, s92, v90
    v_mul_f32 v91, s92, v91
    v_cvt_pk_bf16_f32 v44, v88, v89
    v_cvt_pk_bf16_f32 v45, v90, v91
    ds_write_b64 v27, v[44:45] offset:3072
    v_mul_f32 v120, s92, v120
    v_mul_f32 v121, s92, v121
    v_mul_f32 v122, s92, v122
    v_mul_f32 v123, s92, v123
    v_cvt_pk_bf16_f32 v60, v120, v121
    v_cvt_pk_bf16_f32 v61, v122, v123
    ds_write_b64 v27, v[60:61] offset:7168
    v_mul_f32 v92, s92, v92
    v_mul_f32 v93, s92, v93
    v_mul_f32 v94, s92, v94
    v_mul_f32 v95, s92, v95
    v_cvt_pk_bf16_f32 v46, v92, v93
    v_cvt_pk_bf16_f32 v47, v94, v95
    ds_write_b64 v27, v[46:47] offset:3584
    v_mul_f32 v124, s92, v124
    v_mul_f32 v125, s92, v125
    v_mul_f32 v126, s92, v126
    v_mul_f32 v127, s92, v127
    v_cvt_pk_bf16_f32 v62, v124, v125
    v_cvt_pk_bf16_f32 v63, v126, v127
    ds_write_b64 v27, v[62:63] offset:7680
    s_add_u32 m0, s79, 32768
    s_waitcnt vmcnt(6)
    buffer_load_dwordx4 v4, s[40:43], s77 offen offset:0 nt lds
    s_waitcnt vmcnt(6)
    buffer_load_dwordx4 v5, s[40:43], s77 offen offset:1024 nt lds
    s_setprio 0
    s_waitcnt lgkmcnt(0)
    s_waitcnt vmcnt(8)
    s_barrier
    s_waitcnt vmcnt(6)
    buffer_load_dwordx4 v6, s[40:43], s77 offen offset:2048 nt lds
    s_waitcnt vmcnt(6)
    buffer_load_dwordx4 v7, s[40:43], s77 offen offset:3072 nt lds
    s_add_u32 m0, s79, 81920
    s_waitcnt vmcnt(6)
    buffer_load_dwordx4 v12, s[48:51], s78 offen offset:2048  lds
    ds_read_b64_tr_b16 v[32:33], v18 offset:0
    ds_read_b64_tr_b16 v[34:35], v18 offset:4096
    ds_read_b64_tr_b16 v[36:37], v19 offset:0
    ds_read_b64_tr_b16 v[38:39], v19 offset:4096
    ds_read_b64_tr_b16 v[40:41], v20 offset:0
    ds_read_b64_tr_b16 v[42:43], v20 offset:4096
    ds_read_b64_tr_b16 v[44:45], v21 offset:0
    ds_read_b64_tr_b16 v[46:47], v21 offset:4096
    ds_read_b64_tr_b16 v[48:49], v22 offset:0
    ds_read_b64_tr_b16 v[50:51], v22 offset:4096
    ds_read_b64_tr_b16 v[52:53], v23 offset:0
    ds_read_b64_tr_b16 v[54:55], v23 offset:4096
    ds_read_b64_tr_b16 v[56:57], v24 offset:0
    ds_read_b64_tr_b16 v[58:59], v24 offset:4096
    s_waitcnt lgkmcnt(12)
    v_mfma_f32_16x16x32_bf16 v[64:67], v[32:35], v[128:131], 0
    ds_read_b64_tr_b16 v[60:61], v25 offset:0
    v_mfma_f32_16x16x32_bf16 v[96:99], v[32:35], v[192:195], 0
    ds_read_b64_tr_b16 v[62:63], v25 offset:4096
    s_waitcnt lgkmcnt(10)
    v_mfma_f32_16x16x32_bf16 v[100:103], v[36:39], v[192:195], 0
    ds_read_b64_tr_b16 v[32:33], v18 offset:8192
    v_mfma_f32_16x16x32_bf16 v[68:71], v[36:39], v[128:131], 0
    ds_read_b64_tr_b16 v[34:35], v18 offset:12288
    s_waitcnt vmcnt(6)
    buffer_load_dwordx4 v13, s[48:51], s78 offen offset:3072  lds
    s_xor_b32 s78, s95, 1049344
    v_mfma_f32_16x16x32_bf16 v[72:75], v[40:43], v[128:131], 0
    ds_read_b64_tr_b16 v[36:37], v19 offset:8192
    v_mfma_f32_16x16x32_bf16 v[104:107], v[40:43], v[192:195], 0
    ds_read_b64_tr_b16 v[38:39], v19 offset:12288
    s_waitcnt lgkmcnt(10)
    v_mfma_f32_16x16x32_bf16 v[108:111], v[44:47], v[192:195], 0
    ds_read_b64_tr_b16 v[40:41], v20 offset:8192
    v_mfma_f32_16x16x32_bf16 v[76:79], v[44:47], v[128:131], 0
    ds_read_b64_tr_b16 v[42:43], v20 offset:12288
    v_mfma_f32_16x16x32_bf16 v[80:83], v[48:51], v[128:131], 0
    ds_read_b64_tr_b16 v[44:45], v21 offset:8192
    v_mfma_f32_16x16x32_bf16 v[112:115], v[48:51], v[192:195], 0
    ds_read_b64_tr_b16 v[46:47], v21 offset:12288
    s_add_u32 m0, s79, 49152
    s_waitcnt vmcnt(6)
    buffer_load_dwordx4 v8, s[44:47], s77 offen offset:0 nt lds
    s_waitcnt lgkmcnt(10)
    v_mfma_f32_16x16x32_bf16 v[116:119], v[52:55], v[192:195], 0
    ds_read_b64_tr_b16 v[48:49], v22 offset:8192
    v_mfma_f32_16x16x32_bf16 v[84:87], v[52:55], v[128:131], 0
    ds_read_b64_tr_b16 v[50:51], v22 offset:12288
    v_mfma_f32_16x16x32_bf16 v[88:91], v[56:59], v[128:131], 0
    ds_read_b64_tr_b16 v[52:53], v23 offset:8192
    v_mfma_f32_16x16x32_bf16 v[120:123], v[56:59], v[192:195], 0
    ds_read_b64_tr_b16 v[54:55], v23 offset:12288
    s_waitcnt lgkmcnt(10)
    v_mfma_f32_16x16x32_bf16 v[124:127], v[60:63], v[192:195], 0
    ds_read_b64_tr_b16 v[56:57], v24 offset:8192
    v_mfma_f32_16x16x32_bf16 v[92:95], v[60:63], v[128:131], 0
    ds_read_b64_tr_b16 v[58:59], v24 offset:12288
    s_waitcnt vmcnt(6)
    buffer_load_dwordx4 v9, s[44:47], s77 offen offset:1024 nt lds
    v_mfma_f32_16x16x32_bf16 v[64:67], v[32:35], v[132:135], v[64:67]
    ds_read_b64_tr_b16 v[60:61], v25 offset:8192
    v_mfma_f32_16x16x32_bf16 v[96:99], v[32:35], v[196:199], v[96:99]
    ds_read_b64_tr_b16 v[62:63], v25 offset:12288
    s_waitcnt lgkmcnt(10)
    v_mfma_f32_16x16x32_bf16 v[100:103], v[36:39], v[196:199], v[100:103]
    v_mfma_f32_16x16x32_bf16 v[68:71], v[36:39], v[132:135], v[68:71]
    s_waitcnt vmcnt(6)
    buffer_load_dwordx4 v8, s[44:47], s77 offen offset:2048 nt lds
    v_mfma_f32_16x16x32_bf16 v[72:75], v[40:43], v[132:135], v[72:75]
    v_mfma_f32_16x16x32_bf16 v[104:107], v[40:43], v[196:199], v[104:107]
    s_waitcnt lgkmcnt(6)
    v_mfma_f32_16x16x32_bf16 v[108:111], v[44:47], v[196:199], v[108:111]
    v_mfma_f32_16x16x32_bf16 v[76:79], v[44:47], v[132:135], v[76:79]
    v_mfma_f32_16x16x32_bf16 v[80:83], v[48:51], v[132:135], v[80:83]
    v_mfma_f32_16x16x32_bf16 v[112:115], v[48:51], v[196:199], v[112:115]
    s_waitcnt vmcnt(6)
    buffer_load_dwordx4 v9, s[44:47], s77 offen offset:3072 nt lds
    s_xor_b32 s77, s3, 294912
    s_waitcnt lgkmcnt(2)
    v_mfma_f32_16x16x32_bf16 v[116:119], v[52:55], v[196:199], v[116:119]
    v_mfma_f32_16x16x32_bf16 v[84:87], v[52:55], v[132:135], v[84:87]
    v_mfma_f32_16x16x32_bf16 v[88:91], v[56:59], v[132:135], v[88:91]
    v_mfma_f32_16x16x32_bf16 v[120:123], v[56:59], v[196:199], v[120:123]
    s_waitcnt lgkmcnt(0)
    v_mfma_f32_16x16x32_bf16 v[124:127], v[60:63], v[196:199], v[124:127]
    v_mfma_f32_16x16x32_bf16 v[92:95], v[60:63], v[132:135], v[92:95]
    s_add_u32 m0, s79, 98304
    s_waitcnt vmcnt(6)
    buffer_load_dwordx4 v10, s[48:51], s78 offen offset:0  lds
    s_waitcnt vmcnt(13)
    s_barrier
    s_waitcnt vmcnt(6)
    buffer_load_dwordx4 v11, s[48:51], s78 offen offset:1024  lds
    s_add_u32 m0, s79, 0
    s_waitcnt vmcnt(6)
    buffer_load_dwordx4 v4, s[40:43], s77 offen offset:0 nt lds
    s_waitcnt vmcnt(6)
    buffer_load_dwordx4 v5, s[40:43], s77 offen offset:1024 nt lds
    s_waitcnt vmcnt(6)
    buffer_load_dwordx4 v6, s[40:43], s77 offen offset:2048 nt lds
    s_waitcnt vmcnt(9)
    s_barrier
    s_waitcnt vmcnt(6)
    buffer_load_dwordx4 v7, s[40:43], s77 offen offset:3072 nt lds
    s_add_u32 m0, s79, 98304
    s_waitcnt vmcnt(6)
    buffer_load_dwordx4 v12, s[48:51], s78 offen offset:2048  lds
    s_waitcnt vmcnt(6)
    buffer_load_dwordx4 v13, s[48:51], s78 offen offset:3072  lds
    s_xor_b32 s78, s95, 1573632
    s_add_u32 m0, s79, 16384
    s_waitcnt vmcnt(6)
    buffer_load_dwordx4 v8, s[44:47], s77 offen offset:0 nt lds
    ds_read_b64_tr_b16 v[32:33], v18 offset:16384
    ds_read_b64_tr_b16 v[34:35], v18 offset:20480
    ds_read_b64_tr_b16 v[36:37], v19 offset:16384
    ds_read_b64_tr_b16 v[38:39], v19 offset:20480
    ds_read_b64_tr_b16 v[40:41], v20 offset:16384
    ds_read_b64_tr_b16 v[42:43], v20 offset:20480
    ds_read_b64_tr_b16 v[44:45], v21 offset:16384
    ds_read_b64_tr_b16 v[46:47], v21 offset:20480
    ds_read_b64_tr_b16 v[48:49], v22 offset:16384
    ds_read_b64_tr_b16 v[50:51], v22 offset:20480
    ds_read_b64_tr_b16 v[52:53], v23 offset:16384
    ds_read_b64_tr_b16 v[54:55], v23 offset:20480
    ds_read_b64_tr_b16 v[56:57], v24 offset:16384
    ds_read_b64_tr_b16 v[58:59], v24 offset:20480
    s_waitcnt lgkmcnt(12)
    v_mfma_f32_16x16x32_bf16 v[64:67], v[32:35], v[136:139], v[64:67]
    ds_read_b64_tr_b16 v[60:61], v25 offset:16384
    v_mfma_f32_16x16x32_bf16 v[96:99], v[32:35], v[200:203], v[96:99]
    ds_read_b64_tr_b16 v[62:63], v25 offset:20480
    s_waitcnt lgkmcnt(10)
    v_mfma_f32_16x16x32_bf16 v[100:103], v[36:39], v[200:203], v[100:103]
    ds_read_b64_tr_b16 v[32:33], v18 offset:24576
    v_mfma_f32_16x16x32_bf16 v[68:71], v[36:39], v[136:139], v[68:71]
    ds_read_b64_tr_b16 v[34:35], v18 offset:28672
    v_mfma_f32_16x16x32_bf16 v[72:75], v[40:43], v[136:139], v[72:75]
    ds_read_b64_tr_b16 v[36:37], v19 offset:24576
    v_mfma_f32_16x16x32_bf16 v[104:107], v[40:43], v[200:203], v[104:107]
    ds_read_b64_tr_b16 v[38:39], v19 offset:28672
    s_waitcnt lgkmcnt(10)
    v_mfma_f32_16x16x32_bf16 v[108:111], v[44:47], v[200:203], v[108:111]
    ds_read_b64_tr_b16 v[40:41], v20 offset:24576
    v_mfma_f32_16x16x32_bf16 v[76:79], v[44:47], v[136:139], v[76:79]
    ds_read_b64_tr_b16 v[42:43], v20 offset:28672
    s_waitcnt vmcnt(6)
    buffer_load_dwordx4 v9, s[44:47], s77 offen offset:1024 nt lds
    v_mfma_f32_16x16x32_bf16 v[80:83], v[48:51], v[136:139], v[80:83]
    ds_read_b64_tr_b16 v[44:45], v21 offset:24576
    v_mfma_f32_16x16x32_bf16 v[112:115], v[48:51], v[200:203], v[112:115]
    ds_read_b64_tr_b16 v[46:47], v21 offset:28672
    s_waitcnt lgkmcnt(10)
    v_mfma_f32_16x16x32_bf16 v[116:119], v[52:55], v[200:203], v[116:119]
    ds_read_b64_tr_b16 v[48:49], v22 offset:24576
    v_mfma_f32_16x16x32_bf16 v[84:87], v[52:55], v[136:139], v[84:87]
    ds_read_b64_tr_b16 v[50:51], v22 offset:28672
    v_mfma_f32_16x16x32_bf16 v[88:91], v[56:59], v[136:139], v[88:91]
    ds_read_b64_tr_b16 v[52:53], v23 offset:24576
    v_mfma_f32_16x16x32_bf16 v[120:123], v[56:59], v[200:203], v[120:123]
    ds_read_b64_tr_b16 v[54:55], v23 offset:28672
    s_waitcnt lgkmcnt(10)
    v_mfma_f32_16x16x32_bf16 v[124:127], v[60:63], v[200:203], v[124:127]
    ds_read_b64_tr_b16 v[56:57], v24 offset:24576
    v_mfma_f32_16x16x32_bf16 v[92:95], v[60:63], v[136:139], v[92:95]
    ds_read_b64_tr_b16 v[58:59], v24 offset:28672
    s_waitcnt vmcnt(6)
    buffer_load_dwordx4 v8, s[44:47], s77 offen offset:2048 nt lds
    v_mfma_f32_16x16x32_bf16 v[64:67], v[32:35], v[140:143], v[64:67]
    ds_read_b64_tr_b16 v[60:61], v25 offset:24576
    v_mfma_f32_16x16x32_bf16 v[96:99], v[32:35], v[204:207], v[96:99]
    ds_read_b64_tr_b16 v[62:63], v25 offset:28672
    s_waitcnt lgkmcnt(10)
    v_mfma_f32_16x16x32_bf16 v[100:103], v[36:39], v[204:207], v[100:103]
    v_mfma_f32_16x16x32_bf16 v[68:71], v[36:39], v[140:143], v[68:71]
    v_mfma_f32_16x16x32_bf16 v[72:75], v[40:43], v[140:143], v[72:75]
    v_mfma_f32_16x16x32_bf16 v[104:107], v[40:43], v[204:207], v[104:107]
    s_waitcnt lgkmcnt(6)
    v_mfma_f32_16x16x32_bf16 v[108:111], v[44:47], v[204:207], v[108:111]
    v_mfma_f32_16x16x32_bf16 v[76:79], v[44:47], v[140:143], v[76:79]
    s_waitcnt vmcnt(6)
    buffer_load_dwordx4 v9, s[44:47], s77 offen offset:3072 nt lds
    s_xor_b32 s77, s3, 311296
    v_mfma_f32_16x16x32_bf16 v[80:83], v[48:51], v[140:143], v[80:83]
    v_mfma_f32_16x16x32_bf16 v[112:115], v[48:51], v[204:207], v[112:115]
    s_waitcnt lgkmcnt(2)
    v_mfma_f32_16x16x32_bf16 v[116:119], v[52:55], v[204:207], v[116:119]
    v_mfma_f32_16x16x32_bf16 v[84:87], v[52:55], v[140:143], v[84:87]
    v_mfma_f32_16x16x32_bf16 v[88:91], v[56:59], v[140:143], v[88:91]
    v_mfma_f32_16x16x32_bf16 v[120:123], v[56:59], v[204:207], v[120:123]
    s_waitcnt lgkmcnt(0)
    v_mfma_f32_16x16x32_bf16 v[124:127], v[60:63], v[204:207], v[124:127]
    v_mfma_f32_16x16x32_bf16 v[92:95], v[60:63], v[140:143], v[92:95]
    s_add_u32 m0, s79, 114688
    s_waitcnt vmcnt(6)
    buffer_load_dwordx4 v10, s[48:51], s78 offen offset:0  lds
    s_waitcnt vmcnt(13)
    s_barrier
    s_waitcnt vmcnt(6)
    buffer_load_dwordx4 v11, s[48:51], s78 offen offset:1024  lds
    s_add_u32 m0, s79, 32768
    s_waitcnt vmcnt(6)
    buffer_load_dwordx4 v4, s[40:43], s77 offen offset:0 nt lds
    s_waitcnt vmcnt(6)
    buffer_load_dwordx4 v5, s[40:43], s77 offen offset:1024 nt lds
    s_waitcnt vmcnt(6)
    buffer_load_dwordx4 v6, s[40:43], s77 offen offset:2048 nt lds
    s_waitcnt vmcnt(9)
    s_barrier
    s_waitcnt vmcnt(6)
    buffer_load_dwordx4 v7, s[40:43], s77 offen offset:3072 nt lds
    s_add_u32 m0, s79, 114688
    s_waitcnt vmcnt(6)
    buffer_load_dwordx4 v12, s[48:51], s78 offen offset:2048  lds
    s_waitcnt vmcnt(6)
    buffer_load_dwordx4 v13, s[48:51], s78 offen offset:3072  lds
    s_xor_b32 s78, s95, 2097920
    s_add_u32 m0, s79, 49152
    s_waitcnt vmcnt(6)
    buffer_load_dwordx4 v8, s[44:47], s77 offen offset:0 nt lds
    ds_read_b64_tr_b16 v[32:33], v18 offset:32768
    ds_read_b64_tr_b16 v[34:35], v18 offset:36864
    ds_read_b64_tr_b16 v[36:37], v19 offset:32768
    ds_read_b64_tr_b16 v[38:39], v19 offset:36864
    ds_read_b64_tr_b16 v[40:41], v20 offset:32768
    ds_read_b64_tr_b16 v[42:43], v20 offset:36864
    ds_read_b64_tr_b16 v[44:45], v21 offset:32768
    ds_read_b64_tr_b16 v[46:47], v21 offset:36864
    ds_read_b64_tr_b16 v[48:49], v22 offset:32768
    ds_read_b64_tr_b16 v[50:51], v22 offset:36864
    ds_read_b64_tr_b16 v[52:53], v23 offset:32768
    ds_read_b64_tr_b16 v[54:55], v23 offset:36864
    ds_read_b64_tr_b16 v[56:57], v24 offset:32768
    ds_read_b64_tr_b16 v[58:59], v24 offset:36864
    s_waitcnt lgkmcnt(12)
    v_mfma_f32_16x16x32_bf16 v[64:67], v[32:35], v[144:147], v[64:67]
    ds_read_b64_tr_b16 v[60:61], v25 offset:32768
    v_mfma_f32_16x16x32_bf16 v[96:99], v[32:35], v[208:211], v[96:99]
    ds_read_b64_tr_b16 v[62:63], v25 offset:36864
    s_waitcnt lgkmcnt(10)
    v_mfma_f32_16x16x32_bf16 v[100:103], v[36:39], v[208:211], v[100:103]
    ds_read_b64_tr_b16 v[32:33], v18 offset:40960
    v_mfma_f32_16x16x32_bf16 v[68:71], v[36:39], v[144:147], v[68:71]
    ds_read_b64_tr_b16 v[34:35], v18 offset:45056
    v_mfma_f32_16x16x32_bf16 v[72:75], v[40:43], v[144:147], v[72:75]
    ds_read_b64_tr_b16 v[36:37], v19 offset:40960
    v_mfma_f32_16x16x32_bf16 v[104:107], v[40:43], v[208:211], v[104:107]
    ds_read_b64_tr_b16 v[38:39], v19 offset:45056
    s_waitcnt lgkmcnt(10)
    v_mfma_f32_16x16x32_bf16 v[108:111], v[44:47], v[208:211], v[108:111]
    ds_read_b64_tr_b16 v[40:41], v20 offset:40960
    v_mfma_f32_16x16x32_bf16 v[76:79], v[44:47], v[144:147], v[76:79]
    ds_read_b64_tr_b16 v[42:43], v20 offset:45056
    s_waitcnt vmcnt(6)
    buffer_load_dwordx4 v9, s[44:47], s77 offen offset:1024 nt lds
    v_mfma_f32_16x16x32_bf16 v[80:83], v[48:51], v[144:147], v[80:83]
    ds_read_b64_tr_b16 v[44:45], v21 offset:40960
    v_mfma_f32_16x16x32_bf16 v[112:115], v[48:51], v[208:211], v[112:115]
    ds_read_b64_tr_b16 v[46:47], v21 offset:45056
    s_waitcnt lgkmcnt(10)
    v_mfma_f32_16x16x32_bf16 v[116:119], v[52:55], v[208:211], v[116:119]
    ds_read_b64_tr_b16 v[48:49], v22 offset:40960
    v_mfma_f32_16x16x32_bf16 v[84:87], v[52:55], v[144:147], v[84:87]
    ds_read_b64_tr_b16 v[50:51], v22 offset:45056
    v_mfma_f32_16x16x32_bf16 v[88:91], v[56:59], v[144:147], v[88:91]
    ds_read_b64_tr_b16 v[52:53], v23 offset:40960
    v_mfma_f32_16x16x32_bf16 v[120:123], v[56:59], v[208:211], v[120:123]
    ds_read_b64_tr_b16 v[54:55], v23 offset:45056
    s_waitcnt lgkmcnt(10)
    v_mfma_f32_16x16x32_bf16 v[124:127], v[60:63], v[208:211], v[124:127]
    ds_read_b64_tr_b16 v[56:57], v24 offset:40960
    v_mfma_f32_16x16x32_bf16 v[92:95], v[60:63], v[144:147], v[92:95]
    ds_read_b64_tr_b16 v[58:59], v24 offset:45056
    s_waitcnt vmcnt(6)
    buffer_load_dwordx4 v8, s[44:47], s77 offen offset:2048 nt lds
    v_mfma_f32_16x16x32_bf16 v[64:67], v[32:35], v[148:151], v[64:67]
    ds_read_b64_tr_b16 v[60:61], v25 offset:40960
    v_mfma_f32_16x16x32_bf16 v[96:99], v[32:35], v[212:215], v[96:99]
    ds_read_b64_tr_b16 v[62:63], v25 offset:45056
    s_waitcnt lgkmcnt(10)
    v_mfma_f32_16x16x32_bf16 v[100:103], v[36:39], v[212:215], v[100:103]
    v_mfma_f32_16x16x32_bf16 v[68:71], v[36:39], v[148:151], v[68:71]
    v_mfma_f32_16x16x32_bf16 v[72:75], v[40:43], v[148:151], v[72:75]
    v_mfma_f32_16x16x32_bf16 v[104:107], v[40:43], v[212:215], v[104:107]
    s_waitcnt lgkmcnt(6)
    v_mfma_f32_16x16x32_bf16 v[108:111], v[44:47], v[212:215], v[108:111]
    v_mfma_f32_16x16x32_bf16 v[76:79], v[44:47], v[148:151], v[76:79]
    s_waitcnt vmcnt(6)
    buffer_load_dwordx4 v9, s[44:47], s77 offen offset:3072 nt lds
    s_xor_b32 s77, s3, 327680
    v_mfma_f32_16x16x32_bf16 v[80:83], v[48:51], v[148:151], v[80:83]
    v_mfma_f32_16x16x32_bf16 v[112:115], v[48:51], v[212:215], v[112:115]
    s_waitcnt lgkmcnt(2)
    v_mfma_f32_16x16x32_bf16 v[116:119], v[52:55], v[212:215], v[116:119]
    v_mfma_f32_16x16x32_bf16 v[84:87], v[52:55], v[148:151], v[84:87]
    v_mfma_f32_16x16x32_bf16 v[88:91], v[56:59], v[148:151], v[88:91]
    v_mfma_f32_16x16x32_bf16 v[120:123], v[56:59], v[212:215], v[120:123]
    s_waitcnt lgkmcnt(0)
    v_mfma_f32_16x16x32_bf16 v[124:127], v[60:63], v[212:215], v[124:127]
    v_mfma_f32_16x16x32_bf16 v[92:95], v[60:63], v[148:151], v[92:95]
    s_add_u32 m0, s79, 65536
    s_waitcnt vmcnt(6)
    buffer_load_dwordx4 v10, s[48:51], s78 offen offset:0  lds
    s_waitcnt vmcnt(13)
    s_barrier
    s_waitcnt vmcnt(6)
    buffer_load_dwordx4 v11, s[48:51], s78 offen offset:1024  lds
    s_add_u32 m0, s79, 0
    s_waitcnt vmcnt(6)
    buffer_load_dwordx4 v4, s[40:43], s77 offen offset:0 nt lds
    s_waitcnt vmcnt(6)
    buffer_load_dwordx4 v5, s[40:43], s77 offen offset:1024 nt lds
    s_waitcnt vmcnt(6)
    buffer_load_dwordx4 v6, s[40:43], s77 offen offset:2048 nt lds
    s_waitcnt vmcnt(9)
    s_barrier
    s_waitcnt vmcnt(6)
    buffer_load_dwordx4 v7, s[40:43], s77 offen offset:3072 nt lds
    s_add_u32 m0, s79, 65536
    s_waitcnt vmcnt(6)
    buffer_load_dwordx4 v12, s[48:51], s78 offen offset:2048  lds
    s_waitcnt vmcnt(6)
    buffer_load_dwordx4 v13, s[48:51], s78 offen offset:3072  lds
    s_xor_b32 s78, s95, 2622208
    s_add_u32 m0, s79, 16384
    s_waitcnt vmcnt(6)
    buffer_load_dwordx4 v8, s[44:47], s77 offen offset:0 nt lds
    ds_read_b64_tr_b16 v[32:33], v18 offset:49152
    ds_read_b64_tr_b16 v[34:35], v18 offset:53248
    ds_read_b64_tr_b16 v[36:37], v19 offset:49152
    ds_read_b64_tr_b16 v[38:39], v19 offset:53248
    ds_read_b64_tr_b16 v[40:41], v20 offset:49152
    ds_read_b64_tr_b16 v[42:43], v20 offset:53248
    ds_read_b64_tr_b16 v[44:45], v21 offset:49152
    ds_read_b64_tr_b16 v[46:47], v21 offset:53248
    ds_read_b64_tr_b16 v[48:49], v22 offset:49152
    ds_read_b64_tr_b16 v[50:51], v22 offset:53248
    ds_read_b64_tr_b16 v[52:53], v23 offset:49152
    ds_read_b64_tr_b16 v[54:55], v23 offset:53248
    ds_read_b64_tr_b16 v[56:57], v24 offset:49152
    ds_read_b64_tr_b16 v[58:59], v24 offset:53248
    s_waitcnt lgkmcnt(12)
    v_mfma_f32_16x16x32_bf16 v[64:67], v[32:35], v[152:155], v[64:67]
    ds_read_b64_tr_b16 v[60:61], v25 offset:49152
    v_mfma_f32_16x16x32_bf16 v[96:99], v[32:35], v[216:219], v[96:99]
    ds_read_b64_tr_b16 v[62:63], v25 offset:53248
    s_waitcnt lgkmcnt(10)
    v_mfma_f32_16x16x32_bf16 v[100:103], v[36:39], v[216:219], v[100:103]
    ds_read_b64_tr_b16 v[32:33], v18 offset:57344
    v_mfma_f32_16x16x32_bf16 v[68:71], v[36:39], v[152:155], v[68:71]
    ds_read_b64_tr_b16 v[34:35], v18 offset:61440
    v_mfma_f32_16x16x32_bf16 v[72:75], v[40:43], v[152:155], v[72:75]
    ds_read_b64_tr_b16 v[36:37], v19 offset:57344
    v_mfma_f32_16x16x32_bf16 v[104:107], v[40:43], v[216:219], v[104:107]
    ds_read_b64_tr_b16 v[38:39], v19 offset:61440
    s_waitcnt lgkmcnt(10)
    v_mfma_f32_16x16x32_bf16 v[108:111], v[44:47], v[216:219], v[108:111]
    ds_read_b64_tr_b16 v[40:41], v20 offset:57344
    v_mfma_f32_16x16x32_bf16 v[76:79], v[44:47], v[152:155], v[76:79]
    ds_read_b64_tr_b16 v[42:43], v20 offset:61440
    v_mfma_f32_16x16x32_bf16 v[80:83], v[48:51], v[152:155], v[80:83]
    ds_read_b64_tr_b16 v[44:45], v21 offset:57344
    v_mfma_f32_16x16x32_bf16 v[112:115], v[48:51], v[216:219], v[112:115]
    ds_read_b64_tr_b16 v[46:47], v21 offset:61440
    s_waitcnt vmcnt(6)
    buffer_load_dwordx4 v9, s[44:47], s77 offen offset:1024 nt lds
    s_waitcnt lgkmcnt(10)
    v_mfma_f32_16x16x32_bf16 v[116:119], v[52:55], v[216:219], v[116:119]
    ds_read_b64_tr_b16 v[48:49], v22 offset:57344
    v_mfma_f32_16x16x32_bf16 v[84:87], v[52:55], v[152:155], v[84:87]
    ds_read_b64_tr_b16 v[50:51], v22 offset:61440
    v_mfma_f32_16x16x32_bf16 v[88:91], v[56:59], v[152:155], v[88:91]
    ds_read_b64_tr_b16 v[52:53], v23 offset:57344
    v_mfma_f32_16x16x32_bf16 v[120:123], v[56:59], v[216:219], v[120:123]
    ds_read_b64_tr_b16 v[54:55], v23 offset:61440
    s_waitcnt lgkmcnt(10)
    v_mfma_f32_16x16x32_bf16 v[124:127], v[60:63], v[216:219], v[124:127]
    ds_read_b64_tr_b16 v[56:57], v24 offset:57344
    v_mfma_f32_16x16x32_bf16 v[92:95], v[60:63], v[152:155], v[92:95]
    ds_read_b64_tr_b16 v[58:59], v24 offset:61440
    v_mfma_f32_16x16x32_bf16 v[64:67], v[32:35], v[156:159], v[64:67]
    ds_read_b64_tr_b16 v[60:61], v25 offset:57344
    v_mfma_f32_16x16x32_bf16 v[96:99], v[32:35], v[220:223], v[96:99]
    ds_read_b64_tr_b16 v[62:63], v25 offset:61440
    s_waitcnt lgkmcnt(10)
    v_mfma_f32_16x16x32_bf16 v[100:103], v[36:39], v[220:223], v[100:103]
    v_mfma_f32_16x16x32_bf16 v[68:71], v[36:39], v[156:159], v[68:71]
    s_waitcnt vmcnt(6)
    buffer_load_dwordx4 v8, s[44:47], s77 offen offset:2048 nt lds
    v_mfma_f32_16x16x32_bf16 v[72:75], v[40:43], v[156:159], v[72:75]
    v_mfma_f32_16x16x32_bf16 v[104:107], v[40:43], v[220:223], v[104:107]
    s_waitcnt lgkmcnt(6)
    v_mfma_f32_16x16x32_bf16 v[108:111], v[44:47], v[220:223], v[108:111]
    v_mfma_f32_16x16x32_bf16 v[76:79], v[44:47], v[156:159], v[76:79]
    v_mfma_f32_16x16x32_bf16 v[80:83], v[48:51], v[156:159], v[80:83]
    v_mfma_f32_16x16x32_bf16 v[112:115], v[48:51], v[220:223], v[112:115]
    s_waitcnt lgkmcnt(2)
    v_mfma_f32_16x16x32_bf16 v[116:119], v[52:55], v[220:223], v[116:119]
    v_mfma_f32_16x16x32_bf16 v[84:87], v[52:55], v[156:159], v[84:87]
    v_mfma_f32_16x16x32_bf16 v[88:91], v[56:59], v[156:159], v[88:91]
    v_mfma_f32_16x16x32_bf16 v[120:123], v[56:59], v[220:223], v[120:123]
    s_waitcnt lgkmcnt(0)
    v_mfma_f32_16x16x32_bf16 v[124:127], v[60:63], v[220:223], v[124:127]
    v_mfma_f32_16x16x32_bf16 v[92:95], v[60:63], v[156:159], v[92:95]
    s_waitcnt vmcnt(6)
    buffer_load_dwordx4 v9, s[44:47], s77 offen offset:3072 nt lds
    s_xor_b32 s77, s3, 344064
    s_waitcnt vmcnt(12)
    s_barrier
    s_add_u32 m0, s79, 81920
    s_waitcnt vmcnt(6)
    buffer_load_dwordx4 v10, s[48:51], s78 offen offset:0  lds
    s_waitcnt vmcnt(6)
    buffer_load_dwordx4 v11, s[48:51], s78 offen offset:1024  lds
    s_add_u32 m0, s79, 32768
    s_waitcnt vmcnt(6)
    buffer_load_dwordx4 v4, s[40:43], s77 offen offset:0 nt lds
    s_waitcnt vmcnt(6)
    buffer_load_dwordx4 v5, s[40:43], s77 offen offset:1024 nt lds
    s_waitcnt vmcnt(8)
    s_barrier
    s_waitcnt vmcnt(6)
    buffer_load_dwordx4 v6, s[40:43], s77 offen offset:2048 nt lds
    s_waitcnt vmcnt(6)
    buffer_load_dwordx4 v7, s[40:43], s77 offen offset:3072 nt lds
    s_add_u32 m0, s79, 81920
    s_waitcnt vmcnt(6)
    buffer_load_dwordx4 v12, s[48:51], s78 offen offset:2048  lds
    s_waitcnt vmcnt(6)
    buffer_load_dwordx4 v13, s[48:51], s78 offen offset:3072  lds
    s_xor_b32 s78, s95, 3146496
    ds_read_b64_tr_b16 v[32:33], v18 offset:0
    ds_read_b64_tr_b16 v[34:35], v18 offset:4096
    ds_read_b64_tr_b16 v[36:37], v19 offset:0
    ds_read_b64_tr_b16 v[38:39], v19 offset:4096
    ds_read_b64_tr_b16 v[40:41], v20 offset:0
    ds_read_b64_tr_b16 v[42:43], v20 offset:4096
    ds_read_b64_tr_b16 v[44:45], v21 offset:0
    ds_read_b64_tr_b16 v[46:47], v21 offset:4096
    ds_read_b64_tr_b16 v[48:49], v22 offset:0
    ds_read_b64_tr_b16 v[50:51], v22 offset:4096
    ds_read_b64_tr_b16 v[52:53], v23 offset:0
    ds_read_b64_tr_b16 v[54:55], v23 offset:4096
    ds_read_b64_tr_b16 v[56:57], v24 offset:0
    ds_read_b64_tr_b16 v[58:59], v24 offset:4096
    s_waitcnt lgkmcnt(12)
    v_mfma_f32_16x16x32_bf16 v[64:67], v[32:35], v[160:163], v[64:67]
    ds_read_b64_tr_b16 v[60:61], v25 offset:0
    v_mfma_f32_16x16x32_bf16 v[96:99], v[32:35], v[224:227], v[96:99]
    ds_read_b64_tr_b16 v[62:63], v25 offset:4096
    s_waitcnt lgkmcnt(10)
    v_mfma_f32_16x16x32_bf16 v[100:103], v[36:39], v[224:227], v[100:103]
    ds_read_b64_tr_b16 v[32:33], v18 offset:8192
    v_mfma_f32_16x16x32_bf16 v[68:71], v[36:39], v[160:163], v[68:71]
    ds_read_b64_tr_b16 v[34:35], v18 offset:12288
    v_mfma_f32_16x16x32_bf16 v[72:75], v[40:43], v[160:163], v[72:75]
    ds_read_b64_tr_b16 v[36:37], v19 offset:8192
    v_mfma_f32_16x16x32_bf16 v[104:107], v[40:43], v[224:227], v[104:107]
    ds_read_b64_tr_b16 v[38:39], v19 offset:12288
    s_waitcnt lgkmcnt(10)
    v_mfma_f32_16x16x32_bf16 v[108:111], v[44:47], v[224:227], v[108:111]
    ds_read_b64_tr_b16 v[40:41], v20 offset:8192
    v_mfma_f32_16x16x32_bf16 v[76:79], v[44:47], v[160:163], v[76:79]
    ds_read_b64_tr_b16 v[42:43], v20 offset:12288
    s_add_u32 m0, s79, 49152
    s_waitcnt vmcnt(6)
    buffer_load_dwordx4 v8, s[44:47], s77 offen offset:0 nt lds
    v_mfma_f32_16x16x32_bf16 v[80:83], v[48:51], v[160:163], v[80:83]
    ds_read_b64_tr_b16 v[44:45], v21 offset:8192
    v_mfma_f32_16x16x32_bf16 v[112:115], v[48:51], v[224:227], v[112:115]
    ds_read_b64_tr_b16 v[46:47], v21 offset:12288
    s_waitcnt lgkmcnt(10)
    v_mfma_f32_16x16x32_bf16 v[116:119], v[52:55], v[224:227], v[116:119]
    ds_read_b64_tr_b16 v[48:49], v22 offset:8192
    v_mfma_f32_16x16x32_bf16 v[84:87], v[52:55], v[160:163], v[84:87]
    ds_read_b64_tr_b16 v[50:51], v22 offset:12288
    v_mfma_f32_16x16x32_bf16 v[88:91], v[56:59], v[160:163], v[88:91]
    ds_read_b64_tr_b16 v[52:53], v23 offset:8192
    v_mfma_f32_16x16x32_bf16 v[120:123], v[56:59], v[224:227], v[120:123]
    ds_read_b64_tr_b16 v[54:55], v23 offset:12288
    s_waitcnt lgkmcnt(10)
    v_mfma_f32_16x16x32_bf16 v[124:127], v[60:63], v[224:227], v[124:127]
    ds_read_b64_tr_b16 v[56:57], v24 offset:8192
    v_mfma_f32_16x16x32_bf16 v[92:95], v[60:63], v[160:163], v[92:95]
    ds_read_b64_tr_b16 v[58:59], v24 offset:12288
    s_waitcnt vmcnt(6)
    buffer_load_dwordx4 v9, s[44:47], s77 offen offset:1024 nt lds
    v_mfma_f32_16x16x32_bf16 v[64:67], v[32:35], v[164:167], v[64:67]
    ds_read_b64_tr_b16 v[60:61], v25 offset:8192
    v_mfma_f32_16x16x32_bf16 v[96:99], v[32:35], v[228:231], v[96:99]
    ds_read_b64_tr_b16 v[62:63], v25 offset:12288
    s_waitcnt lgkmcnt(10)
    v_mfma_f32_16x16x32_bf16 v[100:103], v[36:39], v[228:231], v[100:103]
    v_mfma_f32_16x16x32_bf16 v[68:71], v[36:39], v[164:167], v[68:71]
    v_mfma_f32_16x16x32_bf16 v[72:75], v[40:43], v[164:167], v[72:75]
    v_mfma_f32_16x16x32_bf16 v[104:107], v[40:43], v[228:231], v[104:107]
    s_waitcnt lgkmcnt(6)
    v_mfma_f32_16x16x32_bf16 v[108:111], v[44:47], v[228:231], v[108:111]
    v_mfma_f32_16x16x32_bf16 v[76:79], v[44:47], v[164:167], v[76:79]
    s_waitcnt vmcnt(6)
    buffer_load_dwordx4 v8, s[44:47], s77 offen offset:2048 nt lds
    v_mfma_f32_16x16x32_bf16 v[80:83], v[48:51], v[164:167], v[80:83]
    v_mfma_f32_16x16x32_bf16 v[112:115], v[48:51], v[228:231], v[112:115]
    s_waitcnt lgkmcnt(2)
    v_mfma_f32_16x16x32_bf16 v[116:119], v[52:55], v[228:231], v[116:119]
    v_mfma_f32_16x16x32_bf16 v[84:87], v[52:55], v[164:167], v[84:87]
    v_mfma_f32_16x16x32_bf16 v[88:91], v[56:59], v[164:167], v[88:91]
    v_mfma_f32_16x16x32_bf16 v[120:123], v[56:59], v[228:231], v[120:123]
    s_waitcnt lgkmcnt(0)
    v_mfma_f32_16x16x32_bf16 v[124:127], v[60:63], v[228:231], v[124:127]
    v_mfma_f32_16x16x32_bf16 v[92:95], v[60:63], v[164:167], v[92:95]
    s_waitcnt vmcnt(6)
    buffer_load_dwordx4 v9, s[44:47], s77 offen offset:3072 nt lds
    s_xor_b32 s77, s3, 360448
    s_waitcnt vmcnt(12)
    s_barrier
    s_add_u32 m0, s79, 98304
    s_waitcnt vmcnt(6)
    buffer_load_dwordx4 v10, s[48:51], s78 offen offset:0  lds
    s_waitcnt vmcnt(6)
    buffer_load_dwordx4 v11, s[48:51], s78 offen offset:1024  lds
    s_add_u32 m0, s79, 0
    s_waitcnt vmcnt(6)
    buffer_load_dwordx4 v4, s[40:43], s77 offen offset:0 nt lds
    s_waitcnt vmcnt(6)
    buffer_load_dwordx4 v5, s[40:43], s77 offen offset:1024 nt lds
    s_waitcnt vmcnt(8)
    s_barrier
    s_waitcnt vmcnt(6)
    buffer_load_dwordx4 v6, s[40:43], s77 offen offset:2048 nt lds
    s_waitcnt vmcnt(6)
    buffer_load_dwordx4 v7, s[40:43], s77 offen offset:3072 nt lds
    s_add_u32 m0, s79, 98304
    s_waitcnt vmcnt(6)
    buffer_load_dwordx4 v12, s[48:51], s78 offen offset:2048  lds
    s_waitcnt vmcnt(6)
    buffer_load_dwordx4 v13, s[48:51], s78 offen offset:3072  lds
    s_xor_b32 s78, s95, 3670784
    ds_read_b64_tr_b16 v[32:33], v18 offset:16384
    ds_read_b64_tr_b16 v[34:35], v18 offset:20480
    ds_read_b64_tr_b16 v[36:37], v19 offset:16384
    ds_read_b64_tr_b16 v[38:39], v19 offset:20480
    ds_read_b64_tr_b16 v[40:41], v20 offset:16384
    ds_read_b64_tr_b16 v[42:43], v20 offset:20480
    ds_read_b64_tr_b16 v[44:45], v21 offset:16384
    ds_read_b64_tr_b16 v[46:47], v21 offset:20480
    ds_read_b64_tr_b16 v[48:49], v22 offset:16384
    ds_read_b64_tr_b16 v[50:51], v22 offset:20480
    ds_read_b64_tr_b16 v[52:53], v23 offset:16384
    ds_read_b64_tr_b16 v[54:55], v23 offset:20480
    ds_read_b64_tr_b16 v[56:57], v24 offset:16384
    ds_read_b64_tr_b16 v[58:59], v24 offset:20480
    s_waitcnt lgkmcnt(12)
    v_mfma_f32_16x16x32_bf16 v[64:67], v[32:35], v[168:171], v[64:67]
    ds_read_b64_tr_b16 v[60:61], v25 offset:16384
    v_mfma_f32_16x16x32_bf16 v[96:99], v[32:35], v[232:235], v[96:99]
    ds_read_b64_tr_b16 v[62:63], v25 offset:20480
    s_waitcnt lgkmcnt(10)
    v_mfma_f32_16x16x32_bf16 v[100:103], v[36:39], v[232:235], v[100:103]
    ds_read_b64_tr_b16 v[32:33], v18 offset:24576
    v_mfma_f32_16x16x32_bf16 v[68:71], v[36:39], v[168:171], v[68:71]
    ds_read_b64_tr_b16 v[34:35], v18 offset:28672
    v_mfma_f32_16x16x32_bf16 v[72:75], v[40:43], v[168:171], v[72:75]
    ds_read_b64_tr_b16 v[36:37], v19 offset:24576
    v_mfma_f32_16x16x32_bf16 v[104:107], v[40:43], v[232:235], v[104:107]
    ds_read_b64_tr_b16 v[38:39], v19 offset:28672
    s_waitcnt lgkmcnt(10)
    v_mfma_f32_16x16x32_bf16 v[108:111], v[44:47], v[232:235], v[108:111]
    ds_read_b64_tr_b16 v[40:41], v20 offset:24576
    v_mfma_f32_16x16x32_bf16 v[76:79], v[44:47], v[168:171], v[76:79]
    ds_read_b64_tr_b16 v[42:43], v20 offset:28672
    s_add_u32 m0, s79, 16384
    s_waitcnt vmcnt(6)
    buffer_load_dwordx4 v8, s[44:47], s77 offen offset:0 nt lds
    v_mfma_f32_16x16x32_bf16 v[80:83], v[48:51], v[168:171], v[80:83]
    ds_read_b64_tr_b16 v[44:45], v21 offset:24576
    v_mfma_f32_16x16x32_bf16 v[112:115], v[48:51], v[232:235], v[112:115]
    ds_read_b64_tr_b16 v[46:47], v21 offset:28672
    s_waitcnt lgkmcnt(10)
    v_mfma_f32_16x16x32_bf16 v[116:119], v[52:55], v[232:235], v[116:119]
    ds_read_b64_tr_b16 v[48:49], v22 offset:24576
    v_mfma_f32_16x16x32_bf16 v[84:87], v[52:55], v[168:171], v[84:87]
    ds_read_b64_tr_b16 v[50:51], v22 offset:28672
    v_mfma_f32_16x16x32_bf16 v[88:91], v[56:59], v[168:171], v[88:91]
    ds_read_b64_tr_b16 v[52:53], v23 offset:24576
    v_mfma_f32_16x16x32_bf16 v[120:123], v[56:59], v[232:235], v[120:123]
    ds_read_b64_tr_b16 v[54:55], v23 offset:28672
    s_waitcnt lgkmcnt(10)
    v_mfma_f32_16x16x32_bf16 v[124:127], v[60:63], v[232:235], v[124:127]
    ds_read_b64_tr_b16 v[56:57], v24 offset:24576
    v_mfma_f32_16x16x32_bf16 v[92:95], v[60:63], v[168:171], v[92:95]
    ds_read_b64_tr_b16 v[58:59], v24 offset:28672
    s_waitcnt vmcnt(6)
    buffer_load_dwordx4 v9, s[44:47], s77 offen offset:1024 nt lds
    v_mfma_f32_16x16x32_bf16 v[64:67], v[32:35], v[172:175], v[64:67]
    ds_read_b64_tr_b16 v[60:61], v25 offset:24576
    v_mfma_f32_16x16x32_bf16 v[96:99], v[32:35], v[236:239], v[96:99]
    ds_read_b64_tr_b16 v[62:63], v25 offset:28672
    s_waitcnt lgkmcnt(10)
    v_mfma_f32_16x16x32_bf16 v[100:103], v[36:39], v[236:239], v[100:103]
    v_mfma_f32_16x16x32_bf16 v[68:71], v[36:39], v[172:175], v[68:71]
    v_mfma_f32_16x16x32_bf16 v[72:75], v[40:43], v[172:175], v[72:75]
    v_mfma_f32_16x16x32_bf16 v[104:107], v[40:43], v[236:239], v[104:107]
    s_waitcnt lgkmcnt(6)
    v_mfma_f32_16x16x32_bf16 v[108:111], v[44:47], v[236:239], v[108:111]
    v_mfma_f32_16x16x32_bf16 v[76:79], v[44:47], v[172:175], v[76:79]
    s_waitcnt vmcnt(6)
    buffer_load_dwordx4 v8, s[44:47], s77 offen offset:2048 nt lds
    v_mfma_f32_16x16x32_bf16 v[80:83], v[48:51], v[172:175], v[80:83]
    v_mfma_f32_16x16x32_bf16 v[112:115], v[48:51], v[236:239], v[112:115]
    s_waitcnt lgkmcnt(2)
    v_mfma_f32_16x16x32_bf16 v[116:119], v[52:55], v[236:239], v[116:119]
    v_mfma_f32_16x16x32_bf16 v[84:87], v[52:55], v[172:175], v[84:87]
    v_mfma_f32_16x16x32_bf16 v[88:91], v[56:59], v[172:175], v[88:91]
    v_mfma_f32_16x16x32_bf16 v[120:123], v[56:59], v[236:239], v[120:123]
    s_waitcnt lgkmcnt(0)
    v_mfma_f32_16x16x32_bf16 v[124:127], v[60:63], v[236:239], v[124:127]
    v_mfma_f32_16x16x32_bf16 v[92:95], v[60:63], v[172:175], v[92:95]
    s_waitcnt vmcnt(6)
    buffer_load_dwordx4 v9, s[44:47], s77 offen offset:3072 nt lds
    s_xor_b32 s77, s3, 376832
    s_waitcnt vmcnt(12)
    s_barrier
    s_add_u32 m0, s79, 114688
    s_waitcnt vmcnt(6)
    buffer_load_dwordx4 v10, s[48:51], s78 offen offset:0  lds
    s_waitcnt vmcnt(6)
    buffer_load_dwordx4 v11, s[48:51], s78 offen offset:1024  lds
    s_add_u32 m0, s79, 32768
    s_waitcnt vmcnt(6)
    buffer_load_dwordx4 v4, s[40:43], s77 offen offset:0 nt lds
    s_waitcnt vmcnt(6)
    buffer_load_dwordx4 v5, s[40:43], s77 offen offset:1024 nt lds
    s_waitcnt vmcnt(8)
    s_barrier
    s_waitcnt vmcnt(5)
    buffer_load_dwordx4 v6, s[40:43], s77 offen offset:2048 nt lds
    s_waitcnt vmcnt(5)
    buffer_load_dwordx4 v7, s[40:43], s77 offen offset:3072 nt lds
    s_add_u32 m0, s79, 114688
    s_waitcnt vmcnt(5)
    buffer_load_dwordx4 v12, s[48:51], s78 offen offset:2048  lds
    s_waitcnt vmcnt(5)
    buffer_load_dwordx4 v13, s[48:51], s78 offen offset:3072  lds
    s_xor_b32 s78, s95, 0
    ds_read_b64_tr_b16 v[32:33], v18 offset:32768
    ds_read_b64_tr_b16 v[34:35], v18 offset:36864
    ds_read_b64_tr_b16 v[36:37], v19 offset:32768
    ds_read_b64_tr_b16 v[38:39], v19 offset:36864
    ds_read_b64_tr_b16 v[40:41], v20 offset:32768
    ds_read_b64_tr_b16 v[42:43], v20 offset:36864
    ds_read_b64_tr_b16 v[44:45], v21 offset:32768
    ds_read_b64_tr_b16 v[46:47], v21 offset:36864
    ds_read_b64_tr_b16 v[48:49], v22 offset:32768
    ds_read_b64_tr_b16 v[50:51], v22 offset:36864
    ds_read_b64_tr_b16 v[52:53], v23 offset:32768
    ds_read_b64_tr_b16 v[54:55], v23 offset:36864
    ds_read_b64_tr_b16 v[56:57], v24 offset:32768
    ds_read_b64_tr_b16 v[58:59], v24 offset:36864
    s_waitcnt lgkmcnt(12)
    v_mfma_f32_16x16x32_bf16 v[64:67], v[32:35], v[176:179], v[64:67]
    ds_read_b64_tr_b16 v[60:61], v25 offset:32768
    v_mfma_f32_16x16x32_bf16 v[96:99], v[32:35], v[240:243], v[96:99]
    ds_read_b64_tr_b16 v[62:63], v25 offset:36864
    s_waitcnt lgkmcnt(10)
    v_mfma_f32_16x16x32_bf16 v[100:103], v[36:39], v[240:243], v[100:103]
    ds_read_b64_tr_b16 v[32:33], v18 offset:40960
    v_mfma_f32_16x16x32_bf16 v[68:71], v[36:39], v[176:179], v[68:71]
    ds_read_b64_tr_b16 v[34:35], v18 offset:45056
    v_mfma_f32_16x16x32_bf16 v[72:75], v[40:43], v[176:179], v[72:75]
    ds_read_b64_tr_b16 v[36:37], v19 offset:40960
    v_mfma_f32_16x16x32_bf16 v[104:107], v[40:43], v[240:243], v[104:107]
    ds_read_b64_tr_b16 v[38:39], v19 offset:45056
    s_waitcnt lgkmcnt(10)
    v_mfma_f32_16x16x32_bf16 v[108:111], v[44:47], v[240:243], v[108:111]
    ds_read_b64_tr_b16 v[40:41], v20 offset:40960
    v_mfma_f32_16x16x32_bf16 v[76:79], v[44:47], v[176:179], v[76:79]
    ds_read_b64_tr_b16 v[42:43], v20 offset:45056
    v_mfma_f32_16x16x32_bf16 v[80:83], v[48:51], v[176:179], v[80:83]
    ds_read_b64_tr_b16 v[44:45], v21 offset:40960
    v_mfma_f32_16x16x32_bf16 v[112:115], v[48:51], v[240:243], v[112:115]
    ds_read_b64_tr_b16 v[46:47], v21 offset:45056
    s_waitcnt lgkmcnt(10)
    v_mfma_f32_16x16x32_bf16 v[116:119], v[52:55], v[240:243], v[116:119]
    ds_read_b64_tr_b16 v[48:49], v22 offset:40960
    v_mfma_f32_16x16x32_bf16 v[84:87], v[52:55], v[176:179], v[84:87]
    ds_read_b64_tr_b16 v[50:51], v22 offset:45056
    v_mfma_f32_16x16x32_bf16 v[88:91], v[56:59], v[176:179], v[88:91]
    ds_read_b64_tr_b16 v[52:53], v23 offset:40960
    v_mfma_f32_16x16x32_bf16 v[120:123], v[56:59], v[240:243], v[120:123]
    ds_read_b64_tr_b16 v[54:55], v23 offset:45056
    s_waitcnt lgkmcnt(10)
    v_mfma_f32_16x16x32_bf16 v[124:127], v[60:63], v[240:243], v[124:127]
    ds_read_b64_tr_b16 v[56:57], v24 offset:40960
    v_mfma_f32_16x16x32_bf16 v[92:95], v[60:63], v[176:179], v[92:95]
    ds_read_b64_tr_b16 v[58:59], v24 offset:45056
    s_add_u32 m0, s79, 49152
    s_waitcnt vmcnt(5)
    buffer_load_dwordx4 v8, s[44:47], s77 offen offset:0 nt lds
    v_mfma_f32_16x16x32_bf16 v[64:67], v[32:35], v[180:183], v[64:67]
    ds_read_b64_tr_b16 v[60:61], v25 offset:40960
    v_mfma_f32_16x16x32_bf16 v[96:99], v[32:35], v[244:247], v[96:99]
    ds_read_b64_tr_b16 v[62:63], v25 offset:45056
    s_waitcnt lgkmcnt(10)
    v_mfma_f32_16x16x32_bf16 v[100:103], v[36:39], v[244:247], v[100:103]
    v_mfma_f32_16x16x32_bf16 v[68:71], v[36:39], v[180:183], v[68:71]
    v_mfma_f32_16x16x32_bf16 v[72:75], v[40:43], v[180:183], v[72:75]
    v_mfma_f32_16x16x32_bf16 v[104:107], v[40:43], v[244:247], v[104:107]
    s_waitcnt lgkmcnt(6)
    v_mfma_f32_16x16x32_bf16 v[108:111], v[44:47], v[244:247], v[108:111]
    v_mfma_f32_16x16x32_bf16 v[76:79], v[44:47], v[180:183], v[76:79]
    v_mfma_f32_16x16x32_bf16 v[80:83], v[48:51], v[180:183], v[80:83]
    v_mfma_f32_16x16x32_bf16 v[112:115], v[48:51], v[244:247], v[112:115]
    s_waitcnt lgkmcnt(2)
    v_mfma_f32_16x16x32_bf16 v[116:119], v[52:55], v[244:247], v[116:119]
    v_mfma_f32_16x16x32_bf16 v[84:87], v[52:55], v[180:183], v[84:87]
    v_mfma_f32_16x16x32_bf16 v[88:91], v[56:59], v[180:183], v[88:91]
    v_mfma_f32_16x16x32_bf16 v[120:123], v[56:59], v[244:247], v[120:123]
    s_waitcnt lgkmcnt(0)
    v_mfma_f32_16x16x32_bf16 v[124:127], v[60:63], v[244:247], v[124:127]
    v_mfma_f32_16x16x32_bf16 v[92:95], v[60:63], v[180:183], v[92:95]
    s_waitcnt vmcnt(5)
    buffer_load_dwordx4 v9, s[44:47], s77 offen offset:1024 nt lds
    s_waitcnt vmcnt(10)
    s_barrier
    s_waitcnt vmcnt(5)
    buffer_load_dwordx4 v8, s[44:47], s77 offen offset:2048 nt lds
    s_waitcnt vmcnt(5)
    buffer_load_dwordx4 v9, s[44:47], s77 offen offset:3072 nt lds
    s_xor_b32 s77, s3, 393216
    s_add_u32 m0, s79, 0
    s_waitcnt vmcnt(5)
    buffer_load_dwordx4 v4, s[40:43], s77 offen offset:0 nt lds
    s_waitcnt vmcnt(5)
    buffer_load_dwordx4 v5, s[40:43], s77 offen offset:1024 nt lds
    s_waitcnt vmcnt(6)
    s_barrier
    s_waitcnt vmcnt(5)
    buffer_load_dwordx4 v6, s[40:43], s77 offen offset:2048 nt lds
    s_waitcnt vmcnt(5)
    buffer_load_dwordx4 v7, s[40:43], s77 offen offset:3072 nt lds
    s_add_u32 s74, s80, 1
    s_and_b32 s74, s74, 7
    s_lshl_b32 s74, s74, 7
    s_or_b32 s74, s74, s82
    s_xor_b32 s74, s74, 0
    s_add_u32 m0, s79, 65536
    s_waitcnt vmcnt(5)
    buffer_load_dwordx4 v14, s[52:55], s74 offen offset:0  lds
    s_add_u32 m0, s79, 16384
    s_waitcnt vmcnt(5)
    buffer_load_dwordx4 v8, s[44:47], s77 offen offset:0 nt lds
    ds_read_b64_tr_b16 v[32:33], v18 offset:49152
    ds_read_b64_tr_b16 v[34:35], v18 offset:53248
    ds_read_b64_tr_b16 v[36:37], v19 offset:49152
    ds_read_b64_tr_b16 v[38:39], v19 offset:53248
    ds_read_b64_tr_b16 v[40:41], v20 offset:49152
    ds_read_b64_tr_b16 v[42:43], v20 offset:53248
    ds_read_b64_tr_b16 v[44:45], v21 offset:49152
    ds_read_b64_tr_b16 v[46:47], v21 offset:53248
    ds_read_b64_tr_b16 v[48:49], v22 offset:49152
    ds_read_b64_tr_b16 v[50:51], v22 offset:53248
    ds_read_b64_tr_b16 v[52:53], v23 offset:49152
    ds_read_b64_tr_b16 v[54:55], v23 offset:53248
    ds_read_b64_tr_b16 v[56:57], v24 offset:49152
    ds_read_b64_tr_b16 v[58:59], v24 offset:53248
    s_waitcnt lgkmcnt(12)
    v_mfma_f32_16x16x32_bf16 v[64:67], v[32:35], v[184:187], v[64:67]
    ds_read_b64_tr_b16 v[60:61], v25 offset:49152
    v_mfma_f32_16x16x32_bf16 v[96:99], v[32:35], v[248:251], v[96:99]
    ds_read_b64_tr_b16 v[62:63], v25 offset:53248
    s_waitcnt lgkmcnt(10)
    v_mfma_f32_16x16x32_bf16 v[100:103], v[36:39], v[248:251], v[100:103]
    ds_read_b64_tr_b16 v[32:33], v18 offset:57344
    v_mfma_f32_16x16x32_bf16 v[68:71], v[36:39], v[184:187], v[68:71]
    ds_read_b64_tr_b16 v[34:35], v18 offset:61440
    v_mfma_f32_16x16x32_bf16 v[72:75], v[40:43], v[184:187], v[72:75]
    ds_read_b64_tr_b16 v[36:37], v19 offset:57344
    v_mfma_f32_16x16x32_bf16 v[104:107], v[40:43], v[248:251], v[104:107]
    ds_read_b64_tr_b16 v[38:39], v19 offset:61440
    s_waitcnt lgkmcnt(10)
    v_mfma_f32_16x16x32_bf16 v[108:111], v[44:47], v[248:251], v[108:111]
    ds_read_b64_tr_b16 v[40:41], v20 offset:57344
    v_mfma_f32_16x16x32_bf16 v[76:79], v[44:47], v[184:187], v[76:79]
    ds_read_b64_tr_b16 v[42:43], v20 offset:61440
    v_mfma_f32_16x16x32_bf16 v[80:83], v[48:51], v[184:187], v[80:83]
    ds_read_b64_tr_b16 v[44:45], v21 offset:57344
    v_mfma_f32_16x16x32_bf16 v[112:115], v[48:51], v[248:251], v[112:115]
    ds_read_b64_tr_b16 v[46:47], v21 offset:61440
    s_waitcnt lgkmcnt(10)
    v_mfma_f32_16x16x32_bf16 v[116:119], v[52:55], v[248:251], v[116:119]
    ds_read_b64_tr_b16 v[48:49], v22 offset:57344
    v_mfma_f32_16x16x32_bf16 v[84:87], v[52:55], v[184:187], v[84:87]
    ds_read_b64_tr_b16 v[50:51], v22 offset:61440
    v_mfma_f32_16x16x32_bf16 v[88:91], v[56:59], v[184:187], v[88:91]
    ds_read_b64_tr_b16 v[52:53], v23 offset:57344
    v_mfma_f32_16x16x32_bf16 v[120:123], v[56:59], v[248:251], v[120:123]
    ds_read_b64_tr_b16 v[54:55], v23 offset:61440
    s_waitcnt lgkmcnt(10)
    v_mfma_f32_16x16x32_bf16 v[124:127], v[60:63], v[248:251], v[124:127]
    ds_read_b64_tr_b16 v[56:57], v24 offset:57344
    v_mfma_f32_16x16x32_bf16 v[92:95], v[60:63], v[184:187], v[92:95]
    ds_read_b64_tr_b16 v[58:59], v24 offset:61440
    s_waitcnt vmcnt(5)
    buffer_load_dwordx4 v9, s[44:47], s77 offen offset:1024 nt lds
    v_mfma_f32_16x16x32_bf16 v[64:67], v[32:35], v[188:191], v[64:67]
    ds_read_b64_tr_b16 v[60:61], v25 offset:57344
    v_mfma_f32_16x16x32_bf16 v[96:99], v[32:35], v[252:255], v[96:99]
    ds_read_b64_tr_b16 v[62:63], v25 offset:61440
    s_waitcnt lgkmcnt(10)
    v_mfma_f32_16x16x32_bf16 v[100:103], v[36:39], v[252:255], v[100:103]
    v_mfma_f32_16x16x32_bf16 v[68:71], v[36:39], v[188:191], v[68:71]
    v_mfma_f32_16x16x32_bf16 v[72:75], v[40:43], v[188:191], v[72:75]
    v_mfma_f32_16x16x32_bf16 v[104:107], v[40:43], v[252:255], v[104:107]
    s_waitcnt lgkmcnt(6)
    v_mfma_f32_16x16x32_bf16 v[108:111], v[44:47], v[252:255], v[108:111]
    v_mfma_f32_16x16x32_bf16 v[76:79], v[44:47], v[188:191], v[76:79]
    v_mfma_f32_16x16x32_bf16 v[80:83], v[48:51], v[188:191], v[80:83]
    v_mfma_f32_16x16x32_bf16 v[112:115], v[48:51], v[252:255], v[112:115]
    s_waitcnt lgkmcnt(2)
    v_mfma_f32_16x16x32_bf16 v[116:119], v[52:55], v[252:255], v[116:119]
    v_mfma_f32_16x16x32_bf16 v[84:87], v[52:55], v[188:191], v[84:87]
    v_mfma_f32_16x16x32_bf16 v[88:91], v[56:59], v[188:191], v[88:91]
    v_mfma_f32_16x16x32_bf16 v[120:123], v[56:59], v[252:255], v[120:123]
    s_waitcnt lgkmcnt(0)
    v_mfma_f32_16x16x32_bf16 v[124:127], v[60:63], v[252:255], v[124:127]
    v_mfma_f32_16x16x32_bf16 v[92:95], v[60:63], v[188:191], v[92:95]
    s_waitcnt vmcnt(5)
    buffer_load_dwordx4 v8, s[44:47], s77 offen offset:2048 nt lds
    s_waitcnt vmcnt(8)
    s_barrier
    s_setprio 1
    s_waitcnt vmcnt(5)
    buffer_load_dwordx4 v9, s[44:47], s77 offen offset:3072 nt lds
    s_xor_b32 s77, s3, 409600
    v_mul_f32 v64, s92, v64
    v_mul_f32 v65, s92, v65
    v_mul_f32 v66, s92, v66
    v_mul_f32 v67, s92, v67
    v_cvt_pk_bf16_f32 v32, v64, v65
    v_cvt_pk_bf16_f32 v33, v66, v67
    ds_write_b64 v27, v[32:33] offset:0
    v_mul_f32 v96, s92, v96
    v_mul_f32 v97, s92, v97
    v_mul_f32 v98, s92, v98
    v_mul_f32 v99, s92, v99
    v_cvt_pk_bf16_f32 v48, v96, v97
    v_cvt_pk_bf16_f32 v49, v98, v99
    ds_write_b64 v27, v[48:49] offset:4096
    v_mul_f32 v68, s92, v68
    v_mul_f32 v69, s92, v69
    v_mul_f32 v70, s92, v70
    v_mul_f32 v71, s92, v71
    v_cvt_pk_bf16_f32 v34, v68, v69
    v_cvt_pk_bf16_f32 v35, v70, v71
    ds_write_b64 v27, v[34:35] offset:512
    v_mul_f32 v100, s92, v100
    v_mul_f32 v101, s92, v101
    v_mul_f32 v102, s92, v102
    v_mul_f32 v103, s92, v103
    v_cvt_pk_bf16_f32 v50, v100, v101
    v_cvt_pk_bf16_f32 v51, v102, v103
    ds_write_b64 v27, v[50:51] offset:4608
    v_mul_f32 v72, s92, v72
    v_mul_f32 v73, s92, v73
    v_mul_f32 v74, s92, v74
    v_mul_f32 v75, s92, v75
    v_cvt_pk_bf16_f32 v36, v72, v73
    v_cvt_pk_bf16_f32 v37, v74, v75
    ds_write_b64 v27, v[36:37] offset:1024
    v_mul_f32 v104, s92, v104
    v_mul_f32 v105, s92, v105
    v_mul_f32 v106, s92, v106
    v_mul_f32 v107, s92, v107
    v_cvt_pk_bf16_f32 v52, v104, v105
    v_cvt_pk_bf16_f32 v53, v106, v107
    ds_write_b64 v27, v[52:53] offset:5120
    v_mul_f32 v76, s92, v76
    v_mul_f32 v77, s92, v77
    v_mul_f32 v78, s92, v78
    v_mul_f32 v79, s92, v79
    v_cvt_pk_bf16_f32 v38, v76, v77
    v_cvt_pk_bf16_f32 v39, v78, v79
    ds_write_b64 v27, v[38:39] offset:1536
    v_mul_f32 v108, s92, v108
    v_mul_f32 v109, s92, v109
    v_mul_f32 v110, s92, v110
    v_mul_f32 v111, s92, v111
    v_cvt_pk_bf16_f32 v54, v108, v109
    v_cvt_pk_bf16_f32 v55, v110, v111
    ds_write_b64 v27, v[54:55] offset:5632
    s_add_u32 m0, s79, 65536
    s_waitcnt vmcnt(5)
    buffer_load_dwordx4 v15, s[52:55], s74 offen offset:1024  lds
    v_mul_f32 v80, s92, v80
    v_mul_f32 v81, s92, v81
    v_mul_f32 v82, s92, v82
    v_mul_f32 v83, s92, v83
    v_cvt_pk_bf16_f32 v40, v80, v81
    v_cvt_pk_bf16_f32 v41, v82, v83
    ds_write_b64 v27, v[40:41] offset:2048
    v_mul_f32 v112, s92, v112
    v_mul_f32 v113, s92, v113
    v_mul_f32 v114, s92, v114
    v_mul_f32 v115, s92, v115
    v_cvt_pk_bf16_f32 v56, v112, v113
    v_cvt_pk_bf16_f32 v57, v114, v115
    ds_write_b64 v27, v[56:57] offset:6144
    v_mul_f32 v84, s92, v84
    v_mul_f32 v85, s92, v85
    v_mul_f32 v86, s92, v86
    v_mul_f32 v87, s92, v87
    v_cvt_pk_bf16_f32 v42, v84, v85
    v_cvt_pk_bf16_f32 v43, v86, v87
    ds_write_b64 v27, v[42:43] offset:2560
    v_mul_f32 v116, s92, v116
    v_mul_f32 v117, s92, v117
    v_mul_f32 v118, s92, v118
    v_mul_f32 v119, s92, v119
    v_cvt_pk_bf16_f32 v58, v116, v117
    v_cvt_pk_bf16_f32 v59, v118, v119
    ds_write_b64 v27, v[58:59] offset:6656
    v_mul_f32 v88, s92, v88
    v_mul_f32 v89, s92, v89
    v_mul_f32 v90, s92, v90
    v_mul_f32 v91, s92, v91
    v_cvt_pk_bf16_f32 v44, v88, v89
    v_cvt_pk_bf16_f32 v45, v90, v91
    ds_write_b64 v27, v[44:45] offset:3072
    v_mul_f32 v120, s92, v120
    v_mul_f32 v121, s92, v121
    v_mul_f32 v122, s92, v122
    v_mul_f32 v123, s92, v123
    v_cvt_pk_bf16_f32 v60, v120, v121
    v_cvt_pk_bf16_f32 v61, v122, v123
    ds_write_b64 v27, v[60:61] offset:7168
    v_mul_f32 v92, s92, v92
    v_mul_f32 v93, s92, v93
    v_mul_f32 v94, s92, v94
    v_mul_f32 v95, s92, v95
    v_cvt_pk_bf16_f32 v46, v92, v93
    v_cvt_pk_bf16_f32 v47, v94, v95
    ds_write_b64 v27, v[46:47] offset:3584
    v_mul_f32 v124, s92, v124
    v_mul_f32 v125, s92, v125
    v_mul_f32 v126, s92, v126
    v_mul_f32 v127, s92, v127
    v_cvt_pk_bf16_f32 v62, v124, v125
    v_cvt_pk_bf16_f32 v63, v126, v127
    ds_write_b64 v27, v[62:63] offset:7680
    s_add_u32 m0, s79, 32768
    s_waitcnt vmcnt(5)
    buffer_load_dwordx4 v4, s[40:43], s77 offen offset:0 nt lds
    s_waitcnt vmcnt(5)
    buffer_load_dwordx4 v5, s[40:43], s77 offen offset:1024 nt lds
    s_setprio 0
    s_waitcnt lgkmcnt(0)
    s_waitcnt vmcnt(8)
    s_barrier
    v_lshlrev_b32 v128, 24, v0
    s_mov_b32 s81, 0x40000
    v_lshl_add_u32 v129, v0, 4, s79
    s_add_u32 s73, s85, 131072
    v_lshl_add_u32 v130, v0, 4, s73
    s_lshl_b32 s83, s80, 17
    s_lshl_b32 s73, s72, 16
    s_lshl_b32 s75, s90, 10
    s_add_u32 s73, s73, s75
    s_lshl_b32 s75, s80, 7
    s_add_u32 s73, s73, s75
    v_lshrrev_b32 v1, 3, v0
    v_and_b32 v2, 7, v0
    v_lshl_add_u32 v132, v1, 11, s73
    v_lshl_add_u32 v132, v2, 4, v132
    s_add_u32 s73, s85, 131072
    v_xor_b32 v3, v1, v2
    v_lshl_add_u32 v133, v1, 7, s73
    v_lshl_add_u32 v133, v3, 4, v133
    v_and_b32 v1, 15, v0
    v_lshl_add_u32 v10, v1, 7, s73
    v_lshrrev_b32 v3, 5, v0
    v_xor_b32 v3, v3, v2
    v_lshl_add_u32 v10, v3, 4, v10
    v_bfe_u32 v1, v0, 4, 1
    v_lshl_add_u32 v10, v1, 3, v10
    v_xor_b32 v11, 32, v10
    v_xor_b32 v12, 64, v10
    v_xor_b32 v13, 96, v10
    s_mov_b32 s37, 16384
    s_mov_b32 s38, 32768
    s_mov_b32 s39, 49152
    v_bfe_u32 v1, v0, 2, 2
    v_lshrrev_b32 v2, 4, v0
    v_and_b32 v3, 1, v0
    v_lshlrev_b32 v3, 4, v3
    v_mov_b32 v28, 0x3f80
    v_lshlrev_b32 v3, v3, v28
    v_cmp_eq_u32 vcc, v1, v2
    v_bfe_u32 v1, v0, 1, 1
    v_mov_b32 v136, 0
    v_cndmask_b32 v3, 0, v3, vcc
    v_cmp_eq_u32 vcc, 0, v1
    v_mov_b32 v137, 0
    v_mov_b32 v142, 0
    v_cndmask_b32 v138, 0, v3, vcc
    v_mov_b32 v143, 0
    v_sub_u32 v139, v3, v138
    v_mov_b32 v140, v138
    v_mov_b32 v141, v139
    v_mov_b32 v28, -1
    v_mov_b32 v29, -1
    v_mov_b32 v30, -1
    v_mov_b32 v31, -1
    s_waitcnt vmcnt(6)
    buffer_load_dwordx4 v6, s[40:43], s77 offen offset:2048 nt lds
    s_waitcnt vmcnt(6)
    buffer_load_dwordx4 v7, s[40:43], s77 offen offset:3072 nt lds
    s_add_u32 m0, s79, 65536
    s_waitcnt vmcnt(6)
    buffer_load_dwordx4 v16, s[52:55], s74 offen offset:2048  lds
    s_add_u32 m0, s79, 49152
    s_waitcnt vmcnt(6)
    buffer_load_dwordx4 v8, s[44:47], s77 offen offset:0 nt lds
    s_waitcnt vmcnt(6)
    buffer_load_dwordx4 v9, s[44:47], s77 offen offset:1024 nt lds
    s_waitcnt vmcnt(6)
    buffer_load_dwordx4 v8, s[44:47], s77 offen offset:2048 nt lds
    s_waitcnt vmcnt(6)
    buffer_load_dwordx4 v9, s[44:47], s77 offen offset:3072 nt lds
    s_xor_b32 s77, s3, 425984
    s_add_u32 m0, s79, 65536
    s_waitcnt vmcnt(6)
    buffer_load_dwordx4 v17, s[52:55], s74 offen offset:3072  lds
    s_waitcnt vmcnt(11)
    s_barrier
    s_add_u32 m0, s79, 0
    s_waitcnt vmcnt(6)
    buffer_load_dwordx4 v4, s[40:43], s77 offen offset:0 nt lds
    s_waitcnt vmcnt(6)
    buffer_load_dwordx4 v5, s[40:43], s77 offen offset:1024 nt lds
    s_waitcnt vmcnt(6)
    buffer_load_dwordx4 v6, s[40:43], s77 offen offset:2048 nt lds
    s_waitcnt vmcnt(9)
    s_barrier
    s_waitcnt vmcnt(6)
    buffer_load_dwordx4 v7, s[40:43], s77 offen offset:3072 nt lds
    s_add_u32 s74, s80, 1
    s_and_b32 s74, s74, 7
    s_lshl_b32 s74, s74, 7
    s_or_b32 s74, s74, s82
    s_xor_b32 s74, s74, 131072
    s_add_u32 m0, s79, 81920
    s_waitcnt vmcnt(6)
    buffer_load_dwordx4 v14, s[52:55], s74 offen offset:0  lds
    s_add_u32 m0, s79, 16384
    s_waitcnt vmcnt(6)
    buffer_load_dwordx4 v8, s[44:47], s77 offen offset:0 nt lds
    s_waitcnt vmcnt(6)
    buffer_load_dwordx4 v9, s[44:47], s77 offen offset:1024 nt lds
    s_waitcnt vmcnt(6)
    buffer_load_dwordx4 v8, s[44:47], s77 offen offset:2048 nt lds
    s_waitcnt vmcnt(9)
    s_barrier
    s_waitcnt vmcnt(6)
    buffer_load_dwordx4 v9, s[44:47], s77 offen offset:3072 nt lds
    s_xor_b32 s77, s3, 442368
    s_add_u32 m0, s79, 81920
    s_waitcnt vmcnt(6)
    buffer_load_dwordx4 v15, s[52:55], s74 offen offset:1024  lds
    s_add_u32 m0, s79, 32768
    s_waitcnt vmcnt(6)
    buffer_load_dwordx4 v4, s[40:43], s77 offen offset:0 nt lds
    s_waitcnt vmcnt(6)
    buffer_load_dwordx4 v5, s[40:43], s77 offen offset:1024 nt lds
    s_waitcnt vmcnt(8)
    s_barrier
    s_waitcnt vmcnt(6)
    buffer_load_dwordx4 v6, s[40:43], s77 offen offset:2048 nt lds
    s_waitcnt vmcnt(6)
    buffer_load_dwordx4 v7, s[40:43], s77 offen offset:3072 nt lds
    s_add_u32 m0, s79, 81920
    s_waitcnt vmcnt(6)
    buffer_load_dwordx4 v16, s[52:55], s74 offen offset:2048  lds
    s_add_u32 m0, s79, 49152
    s_waitcnt vmcnt(6)
    buffer_load_dwordx4 v8, s[44:47], s77 offen offset:0 nt lds
    s_waitcnt vmcnt(6)
    buffer_load_dwordx4 v9, s[44:47], s77 offen offset:1024 nt lds
    s_waitcnt vmcnt(8)
    s_barrier
    s_waitcnt vmcnt(6)
    buffer_load_dwordx4 v8, s[44:47], s77 offen offset:2048 nt lds
    s_waitcnt vmcnt(6)
    buffer_load_dwordx4 v9, s[44:47], s77 offen offset:3072 nt lds
    s_xor_b32 s77, s3, 458752
    s_add_u32 m0, s79, 81920
    s_waitcnt vmcnt(6)
    buffer_load_dwordx4 v17, s[52:55], s74 offen offset:3072  lds
    s_add_u32 m0, s79, 0
    s_waitcnt vmcnt(6)
    buffer_load_dwordx4 v4, s[40:43], s77 offen offset:0 nt lds
    s_waitcnt vmcnt(7)
    s_barrier
    s_waitcnt vmcnt(6)
    buffer_load_dwordx4 v5, s[40:43], s77 offen offset:1024 nt lds
    s_waitcnt vmcnt(6)
    buffer_load_dwordx4 v6, s[40:43], s77 offen offset:2048 nt lds
    s_waitcnt vmcnt(6)
    buffer_load_dwordx4 v7, s[40:43], s77 offen offset:3072 nt lds
    s_add_u32 s74, s80, 1
    s_and_b32 s74, s74, 7
    s_lshl_b32 s74, s74, 7
    s_or_b32 s74, s74, s82
    s_xor_b32 s74, s74, 262144
    s_add_u32 m0, s79, 98304
    s_waitcnt vmcnt(6)
    buffer_load_dwordx4 v14, s[52:55], s74 offen offset:0  lds
    s_add_u32 m0, s79, 16384
    s_waitcnt vmcnt(6)
    buffer_load_dwordx4 v8, s[44:47], s77 offen offset:0 nt lds
    s_waitcnt vmcnt(7)
    s_barrier
    s_waitcnt vmcnt(6)
    buffer_load_dwordx4 v9, s[44:47], s77 offen offset:1024 nt lds
    s_waitcnt vmcnt(6)
    buffer_load_dwordx4 v8, s[44:47], s77 offen offset:2048 nt lds
    s_waitcnt vmcnt(6)
    buffer_load_dwordx4 v9, s[44:47], s77 offen offset:3072 nt lds
    s_xor_b32 s77, s3, 475136
    s_add_u32 m0, s79, 98304
    s_waitcnt vmcnt(6)
    buffer_load_dwordx4 v15, s[52:55], s74 offen offset:1024  lds
    s_waitcnt vmcnt(6)
    s_barrier
    s_add_u32 m0, s79, 32768
    s_waitcnt vmcnt(6)
    buffer_load_dwordx4 v4, s[40:43], s77 offen offset:0 nt lds
    s_waitcnt vmcnt(6)
    buffer_load_dwordx4 v5, s[40:43], s77 offen offset:1024 nt lds
    s_waitcnt vmcnt(6)
    buffer_load_dwordx4 v6, s[40:43], s77 offen offset:2048 nt lds
    s_waitcnt vmcnt(6)
    buffer_load_dwordx4 v7, s[40:43], s77 offen offset:3072 nt lds
    s_add_u32 m0, s79, 98304
    s_waitcnt vmcnt(6)
    buffer_load_dwordx4 v16, s[52:55], s74 offen offset:2048  lds
    s_waitcnt vmcnt(6)
    s_barrier
    s_add_u32 m0, s79, 49152
    s_waitcnt vmcnt(6)
    buffer_load_dwordx4 v8, s[44:47], s77 offen offset:0 nt lds
    s_waitcnt vmcnt(6)
    buffer_load_dwordx4 v9, s[44:47], s77 offen offset:1024 nt lds
    s_waitcnt vmcnt(6)
    buffer_load_dwordx4 v8, s[44:47], s77 offen offset:2048 nt lds
    s_waitcnt vmcnt(6)
    buffer_load_dwordx4 v9, s[44:47], s77 offen offset:3072 nt lds
    s_xor_b32 s77, s3, 491520
    s_waitcnt vmcnt(5)
    s_barrier
    s_add_u32 m0, s79, 98304
    s_waitcnt vmcnt(6)
    buffer_load_dwordx4 v17, s[52:55], s74 offen offset:3072  lds
    s_add_u32 m0, s79, 0
    s_waitcnt vmcnt(6)
    buffer_load_dwordx4 v4, s[40:43], s77 offen offset:0 nt lds
    s_waitcnt vmcnt(6)
    buffer_load_dwordx4 v5, s[40:43], s77 offen offset:1024 nt lds
    s_waitcnt vmcnt(6)
    buffer_load_dwordx4 v6, s[40:43], s77 offen offset:2048 nt lds
    s_waitcnt vmcnt(6)
    buffer_load_dwordx4 v7, s[40:43], s77 offen offset:3072 nt lds
    s_add_u32 s74, s80, 1
    s_and_b32 s74, s74, 7
    s_lshl_b32 s74, s74, 7
    s_or_b32 s74, s74, s82
    s_xor_b32 s74, s74, 393216
    s_add_u32 m0, s79, 114688
    s_waitcnt vmcnt(6)
    buffer_load_dwordx4 v14, s[52:55], s74 offen offset:0  lds
    s_waitcnt vmcnt(6)
    s_barrier
    s_add_u32 m0, s79, 16384
    s_waitcnt vmcnt(6)
    buffer_load_dwordx4 v8, s[44:47], s77 offen offset:0 nt lds
    s_waitcnt vmcnt(6)
    buffer_load_dwordx4 v9, s[44:47], s77 offen offset:1024 nt lds
    s_waitcnt vmcnt(6)
    buffer_load_dwordx4 v8, s[44:47], s77 offen offset:2048 nt lds
    s_waitcnt vmcnt(6)
    buffer_load_dwordx4 v9, s[44:47], s77 offen offset:3072 nt lds
    s_xor_b32 s77, s3, 507904
    s_waitcnt vmcnt(5)
    s_barrier
    s_add_u32 m0, s79, 114688
    s_waitcnt vmcnt(6)
    buffer_load_dwordx4 v15, s[52:55], s74 offen offset:1024  lds
    s_add_u32 m0, s79, 32768
    s_waitcnt vmcnt(6)
    buffer_load_dwordx4 v4, s[40:43], s77 offen offset:0 nt lds
    s_waitcnt vmcnt(6)
    buffer_load_dwordx4 v5, s[40:43], s77 offen offset:1024 nt lds
    s_waitcnt vmcnt(6)
    buffer_load_dwordx4 v6, s[40:43], s77 offen offset:2048 nt lds
    s_waitcnt vmcnt(6)
    buffer_load_dwordx4 v7, s[40:43], s77 offen offset:3072 nt lds
    s_add_u32 m0, s79, 114688
    s_waitcnt vmcnt(6)
    buffer_load_dwordx4 v16, s[52:55], s74 offen offset:2048  lds
    s_waitcnt vmcnt(6)
    s_barrier
    s_add_u32 m0, s79, 49152
    s_waitcnt vmcnt(6)
    buffer_load_dwordx4 v8, s[44:47], s77 offen offset:0 nt lds
    s_waitcnt vmcnt(6)
    buffer_load_dwordx4 v9, s[44:47], s77 offen offset:1024 nt lds
    s_waitcnt vmcnt(6)
    buffer_load_dwordx4 v8, s[44:47], s77 offen offset:2048 nt lds
    s_waitcnt vmcnt(6)
    buffer_load_dwordx4 v9, s[44:47], s77 offen offset:3072 nt lds
    s_xor_b32 s77, s3, 524288
    s_add_u32 m0, s79, 114688
    s_waitcnt vmcnt(6)
    buffer_load_dwordx4 v17, s[52:55], s74 offen offset:3072  lds
    s_waitcnt vmcnt(6)
    s_barrier
    s_add_u32 s74, s80, 2
    s_and_b32 s74, s74, 7
    s_lshl_b32 s74, s74, 7
    s_or_b32 s74, s74, s82
    s_xor_b32 s74, s74, 0
    s_add_u32 m0, s79, 0
    s_nop 0
    buffer_load_dwordx4 v14, s[52:55], s74 offen offset:0  lds
    buffer_load_dwordx4 v15, s[52:55], s74 offen offset:1024  lds
    buffer_load_dwordx4 v16, s[52:55], s74 offen offset:2048  lds
    buffer_load_dwordx4 v17, s[52:55], s74 offen offset:3072  lds
    s_add_u32 s74, s80, 2
    s_and_b32 s74, s74, 7
    s_lshl_b32 s74, s74, 7
    s_or_b32 s74, s74, s82
    s_xor_b32 s74, s74, 131072
    s_add_u32 m0, s79, 16384
    s_nop 0
    buffer_load_dwordx4 v14, s[52:55], s74 offen offset:0  lds
    buffer_load_dwordx4 v15, s[52:55], s74 offen offset:1024  lds
    buffer_load_dwordx4 v16, s[52:55], s74 offen offset:2048  lds
    buffer_load_dwordx4 v17, s[52:55], s74 offen offset:3072  lds
    s_xor_b32 s75, s89, 0
    s_lshl_b32 s75, s75, 15
    s_add_u32 s75, s75, s85
    v_lshlrev_b32 v1, 7, v0
    buffer_load_dword v2, v1, s[52:55], s75 offen
    s_waitcnt vmcnt(10)
    s_barrier
    s_add_u32 s74, s80, 2
    s_and_b32 s74, s74, 7
    s_lshl_b32 s74, s74, 7
    s_or_b32 s74, s74, s82
    s_xor_b32 s74, s74, 262144
    s_add_u32 m0, s79, 32768
    s_nop 0
    buffer_load_dwordx4 v14, s[52:55], s74 offen offset:0  lds
    buffer_load_dwordx4 v15, s[52:55], s74 offen offset:1024  lds
    buffer_load_dwordx4 v16, s[52:55], s74 offen offset:2048  lds
    buffer_load_dwordx4 v17, s[52:55], s74 offen offset:3072  lds
    s_waitcnt vmcnt(14)
    s_barrier
    s_add_u32 s74, s80, 2
    s_and_b32 s74, s74, 7
    s_lshl_b32 s74, s74, 7
    s_or_b32 s74, s74, s82
    s_xor_b32 s74, s74, 393216
    s_add_u32 m0, s79, 49152
    s_nop 0
    buffer_load_dwordx4 v14, s[52:55], s74 offen offset:0  lds
    buffer_load_dwordx4 v15, s[52:55], s74 offen offset:1024  lds
    buffer_load_dwordx4 v16, s[52:55], s74 offen offset:2048  lds
    buffer_load_dwordx4 v17, s[52:55], s74 offen offset:3072  lds
    s_waitcnt vmcnt(18)
    s_barrier
    s_add_u32 s74, s80, 3
    s_and_b32 s74, s74, 7
    s_lshl_b32 s74, s74, 7
    s_or_b32 s74, s74, s82
    s_xor_b32 s74, s74, 0
    s_add_u32 m0, s79, 65536
    s_nop 0
    buffer_load_dwordx4 v14, s[52:55], s74 offen offset:0  lds
    buffer_load_dwordx4 v15, s[52:55], s74 offen offset:1024  lds
    buffer_load_dwordx4 v16, s[52:55], s74 offen offset:2048  lds
    buffer_load_dwordx4 v17, s[52:55], s74 offen offset:3072  lds
    s_waitcnt vmcnt(21)
    s_barrier
    s_add_u32 s74, s80, 3
    s_and_b32 s74, s74, 7
    s_lshl_b32 s74, s74, 7
    s_or_b32 s74, s74, s82
    s_xor_b32 s74, s74, 131072
    s_add_u32 m0, s79, 81920
    s_nop 0
    buffer_load_dwordx4 v14, s[52:55], s74 offen offset:0  lds
    buffer_load_dwordx4 v15, s[52:55], s74 offen offset:1024  lds
    buffer_load_dwordx4 v16, s[52:55], s74 offen offset:2048  lds
    buffer_load_dwordx4 v17, s[52:55], s74 offen offset:3072  lds
    s_waitcnt vmcnt(21)
    s_barrier
    s_add_u32 s74, s80, 3
    s_and_b32 s74, s74, 7
    s_lshl_b32 s74, s74, 7
    s_or_b32 s74, s74, s82
    s_xor_b32 s74, s74, 262144
    s_add_u32 m0, s79, 98304
    s_nop 0
    buffer_load_dwordx4 v14, s[52:55], s74 offen offset:0  lds
    buffer_load_dwordx4 v15, s[52:55], s74 offen offset:1024  lds
    buffer_load_dwordx4 v16, s[52:55], s74 offen offset:2048  lds
    buffer_load_dwordx4 v17, s[52:55], s74 offen offset:3072  lds
    s_waitcnt vmcnt(21)
    s_barrier
    s_add_u32 s74, s80, 3
    s_and_b32 s74, s74, 7
    s_lshl_b32 s74, s74, 7
    s_or_b32 s74, s74, s82
    s_xor_b32 s74, s74, 393216
    s_add_u32 m0, s79, 114688
    s_nop 0
    buffer_load_dwordx4 v14, s[52:55], s74 offen offset:0  lds
    buffer_load_dwordx4 v15, s[52:55], s74 offen offset:1024  lds
    buffer_load_dwordx4 v16, s[52:55], s74 offen offset:2048  lds
    buffer_load_dwordx4 v17, s[52:55], s74 offen offset:3072  lds
    s_waitcnt vmcnt(20)
    s_barrier
    s_add_u32 s74, s80, 4
    s_and_b32 s74, s74, 7
    s_lshl_b32 s74, s74, 7
    s_or_b32 s74, s74, s82
    s_xor_b32 s74, s74, 0
    s_add_u32 m0, s79, 0
    s_nop 0
    buffer_load_dwordx4 v14, s[52:55], s74 offen offset:0  lds
    buffer_load_dwordx4 v15, s[52:55], s74 offen offset:1024  lds
    buffer_load_dwordx4 v16, s[52:55], s74 offen offset:2048  lds
    buffer_load_dwordx4 v17, s[52:55], s74 offen offset:3072  lds
    s_waitcnt vmcnt(20)
    s_barrier
    s_add_u32 s74, s80, 4
    s_and_b32 s74, s74, 7
    s_lshl_b32 s74, s74, 7
    s_or_b32 s74, s74, s82
    s_xor_b32 s74, s74, 131072
    s_add_u32 m0, s79, 16384
    s_nop 0
    buffer_load_dwordx4 v14, s[52:55], s74 offen offset:0  lds
    buffer_load_dwordx4 v15, s[52:55], s74 offen offset:1024  lds
    buffer_load_dwordx4 v16, s[52:55], s74 offen offset:2048  lds
    buffer_load_dwordx4 v17, s[52:55], s74 offen offset:3072  lds
    s_waitcnt vmcnt(20)
    s_barrier
    s_add_u32 s74, s80, 4
    s_and_b32 s74, s74, 7
    s_lshl_b32 s74, s74, 7
    s_or_b32 s74, s74, s82
    s_xor_b32 s74, s74, 262144
    s_add_u32 m0, s79, 32768
    s_nop 0
    buffer_load_dwordx4 v14, s[52:55], s74 offen offset:0  lds
    buffer_load_dwordx4 v15, s[52:55], s74 offen offset:1024  lds
    buffer_load_dwordx4 v16, s[52:55], s74 offen offset:2048  lds
    buffer_load_dwordx4 v17, s[52:55], s74 offen offset:3072  lds
    s_waitcnt vmcnt(20)
    s_barrier
    s_add_u32 s74, s80, 4
    s_and_b32 s74, s74, 7
    s_lshl_b32 s74, s74, 7
    s_or_b32 s74, s74, s82
    s_xor_b32 s74, s74, 393216
    s_add_u32 m0, s79, 49152
    s_nop 0
    buffer_load_dwordx4 v14, s[52:55], s74 offen offset:0  lds
    buffer_load_dwordx4 v15, s[52:55], s74 offen offset:1024  lds
    buffer_load_dwordx4 v16, s[52:55], s74 offen offset:2048  lds
    buffer_load_dwordx4 v17, s[52:55], s74 offen offset:3072  lds
    s_waitcnt vmcnt(20)
    s_barrier
    s_add_u32 s74, s80, 5
    s_and_b32 s74, s74, 7
    s_lshl_b32 s74, s74, 7
    s_or_b32 s74, s74, s82
    s_xor_b32 s74, s74, 0
    s_add_u32 m0, s79, 65536
    s_nop 0
    buffer_load_dwordx4 v14, s[52:55], s74 offen offset:0  lds
    buffer_load_dwordx4 v15, s[52:55], s74 offen offset:1024  lds
    buffer_load_dwordx4 v16, s[52:55], s74 offen offset:2048  lds
    buffer_load_dwordx4 v17, s[52:55], s74 offen offset:3072  lds
    s_waitcnt vmcnt(20)
    s_barrier
    s_add_u32 s74, s80, 5
    s_and_b32 s74, s74, 7
    s_lshl_b32 s74, s74, 7
    s_or_b32 s74, s74, s82
    s_xor_b32 s74, s74, 131072
    s_add_u32 m0, s79, 81920
    s_nop 0
    buffer_load_dwordx4 v14, s[52:55], s74 offen offset:0  lds
    buffer_load_dwordx4 v15, s[52:55], s74 offen offset:1024  lds
    buffer_load_dwordx4 v16, s[52:55], s74 offen offset:2048  lds
    buffer_load_dwordx4 v17, s[52:55], s74 offen offset:3072  lds
    s_waitcnt vmcnt(20)
    s_barrier
    s_add_u32 s74, s80, 5
    s_and_b32 s74, s74, 7
    s_lshl_b32 s74, s74, 7
    s_or_b32 s74, s74, s82
    s_xor_b32 s74, s74, 262144
    s_add_u32 m0, s79, 98304
    s_nop 0
    buffer_load_dwordx4 v14, s[52:55], s74 offen offset:0  lds
    buffer_load_dwordx4 v15, s[52:55], s74 offen offset:1024  lds
    buffer_load_dwordx4 v16, s[52:55], s74 offen offset:2048  lds
    buffer_load_dwordx4 v17, s[52:55], s74 offen offset:3072  lds
    s_waitcnt vmcnt(20)
    s_barrier
    s_add_u32 s74, s80, 5
    s_and_b32 s74, s74, 7
    s_lshl_b32 s74, s74, 7
    s_or_b32 s74, s74, s82
    s_xor_b32 s74, s74, 393216
    s_add_u32 m0, s79, 114688
    s_nop 0
    buffer_load_dwordx4 v14, s[52:55], s74 offen offset:0  lds
    buffer_load_dwordx4 v15, s[52:55], s74 offen offset:1024  lds
    buffer_load_dwordx4 v16, s[52:55], s74 offen offset:2048  lds
    buffer_load_dwordx4 v17, s[52:55], s74 offen offset:3072  lds
    s_waitcnt vmcnt(20)
    s_barrier
    s_add_u32 s74, s80, 6
    s_and_b32 s74, s74, 7
    s_lshl_b32 s74, s74, 7
    s_or_b32 s74, s74, s82
    s_xor_b32 s74, s74, 0
    s_add_u32 m0, s79, 0
    s_nop 0
    buffer_load_dwordx4 v14, s[52:55], s74 offen offset:0  lds
    buffer_load_dwordx4 v15, s[52:55], s74 offen offset:1024  lds
    buffer_load_dwordx4 v16, s[52:55], s74 offen offset:2048  lds
    buffer_load_dwordx4 v17, s[52:55], s74 offen offset:3072  lds
    s_sub_u32 s75, s80, 1
    s_and_b32 s75, s75, 7
    s_lshl_b32 s75, s75, 14
    s_add_u32 s75, s75, s83
    buffer_load_dwordx4 v[144:147], v129, s[56:59], s75 offen offset:0 sc1
    buffer_load_dwordx4 v[172:175], v129, s[56:59], s75 offen offset:1024 sc1
    buffer_load_dwordx4 v[200:203], v129, s[56:59], s75 offen offset:2048 sc1
    buffer_load_dwordx4 v[228:231], v129, s[56:59], s75 offen offset:3072 sc1
    s_waitcnt vmcnt(24)
    s_barrier
    s_add_u32 s74, s80, 6
    s_and_b32 s74, s74, 7
    s_lshl_b32 s74, s74, 7
    s_or_b32 s74, s74, s82
    s_xor_b32 s74, s74, 131072
    s_add_u32 m0, s79, 16384
    s_nop 0
    buffer_load_dwordx4 v14, s[52:55], s74 offen offset:0  lds
    buffer_load_dwordx4 v15, s[52:55], s74 offen offset:1024  lds
    buffer_load_dwordx4 v16, s[52:55], s74 offen offset:2048  lds
    buffer_load_dwordx4 v17, s[52:55], s74 offen offset:3072  lds
    s_waitcnt vmcnt(24)
    s_barrier
    s_add_u32 s74, s80, 6
    s_and_b32 s74, s74, 7
    s_lshl_b32 s74, s74, 7
    s_or_b32 s74, s74, s82
    s_xor_b32 s74, s74, 262144
    s_add_u32 m0, s79, 32768
    s_nop 0
    buffer_load_dwordx4 v14, s[52:55], s74 offen offset:0  lds
    buffer_load_dwordx4 v15, s[52:55], s74 offen offset:1024  lds
    buffer_load_dwordx4 v16, s[52:55], s74 offen offset:2048  lds
    buffer_load_dwordx4 v17, s[52:55], s74 offen offset:3072  lds
    s_waitcnt vmcnt(24)
    s_barrier
    s_add_u32 s74, s80, 6
    s_and_b32 s74, s74, 7
    s_lshl_b32 s74, s74, 7
    s_or_b32 s74, s74, s82
    s_xor_b32 s74, s74, 393216
    s_add_u32 m0, s79, 49152
    s_nop 0
    buffer_load_dwordx4 v14, s[52:55], s74 offen offset:0  lds
    buffer_load_dwordx4 v15, s[52:55], s74 offen offset:1024  lds
    buffer_load_dwordx4 v16, s[52:55], s74 offen offset:2048  lds
    buffer_load_dwordx4 v17, s[52:55], s74 offen offset:3072  lds
    s_waitcnt vmcnt(24)
    s_barrier
    s_add_u32 s74, s80, 7
    s_and_b32 s74, s74, 7
    s_lshl_b32 s74, s74, 7
    s_or_b32 s74, s74, s82
    s_xor_b32 s74, s74, 0
    s_add_u32 m0, s79, 65536
    s_nop 0
    buffer_load_dwordx4 v14, s[52:55], s74 offen offset:0  lds
    buffer_load_dwordx4 v15, s[52:55], s74 offen offset:1024  lds
    buffer_load_dwordx4 v16, s[52:55], s74 offen offset:2048  lds
    buffer_load_dwordx4 v17, s[52:55], s74 offen offset:3072  lds
    s_sub_u32 s75, s80, 2
    s_and_b32 s75, s75, 7
    s_lshl_b32 s75, s75, 14
    s_add_u32 s75, s75, s83
    buffer_load_dwordx4 v[148:151], v129, s[56:59], s75 offen offset:0 sc1
    buffer_load_dwordx4 v[176:179], v129, s[56:59], s75 offen offset:1024 sc1
    buffer_load_dwordx4 v[204:207], v129, s[56:59], s75 offen offset:2048 sc1
    buffer_load_dwordx4 v[232:235], v129, s[56:59], s75 offen offset:3072 sc1
    s_waitcnt vmcnt(28)
    s_barrier
    s_add_u32 s74, s80, 7
    s_and_b32 s74, s74, 7
    s_lshl_b32 s74, s74, 7
    s_or_b32 s74, s74, s82
    s_xor_b32 s74, s74, 131072
    s_add_u32 m0, s79, 81920
    s_nop 0
    buffer_load_dwordx4 v14, s[52:55], s74 offen offset:0  lds
    buffer_load_dwordx4 v15, s[52:55], s74 offen offset:1024  lds
    buffer_load_dwordx4 v16, s[52:55], s74 offen offset:2048  lds
    buffer_load_dwordx4 v17, s[52:55], s74 offen offset:3072  lds
    s_waitcnt vmcnt(28)
    s_barrier
    s_add_u32 s74, s80, 7
    s_and_b32 s74, s74, 7
    s_lshl_b32 s74, s74, 7
    s_or_b32 s74, s74, s82
    s_xor_b32 s74, s74, 262144
    s_add_u32 m0, s79, 98304
    s_nop 0
    buffer_load_dwordx4 v14, s[52:55], s74 offen offset:0  lds
    buffer_load_dwordx4 v15, s[52:55], s74 offen offset:1024  lds
    buffer_load_dwordx4 v16, s[52:55], s74 offen offset:2048  lds
    buffer_load_dwordx4 v17, s[52:55], s74 offen offset:3072  lds
    s_waitcnt vmcnt(24)
    s_barrier
    s_add_u32 s74, s80, 7
    s_and_b32 s74, s74, 7
    s_lshl_b32 s74, s74, 7
    s_or_b32 s74, s74, s82
    s_xor_b32 s74, s74, 393216
    s_add_u32 m0, s79, 114688
    s_nop 0
    buffer_load_dwordx4 v14, s[52:55], s74 offen offset:0  lds
    buffer_load_dwordx4 v15, s[52:55], s74 offen offset:1024  lds
    buffer_load_dwordx4 v16, s[52:55], s74 offen offset:2048  lds
    buffer_load_dwordx4 v17, s[52:55], s74 offen offset:3072  lds
    s_waitcnt vmcnt(24)
    s_barrier
    s_add_u32 s74, s80, 8
    s_and_b32 s74, s74, 7
    s_lshl_b32 s74, s74, 7
    s_or_b32 s74, s74, s82
    s_xor_b32 s74, s74, 0
    s_add_u32 m0, s79, 0
    s_nop 0
    buffer_load_dwordx4 v14, s[52:55], s74 offen offset:0  lds
    buffer_load_dwordx4 v15, s[52:55], s74 offen offset:1024  lds
    buffer_load_dwordx4 v16, s[52:55], s74 offen offset:2048  lds
    buffer_load_dwordx4 v17, s[52:55], s74 offen offset:3072  lds
    s_sub_u32 s75, s80, 3
    s_and_b32 s75, s75, 7
    s_lshl_b32 s75, s75, 14
    s_add_u32 s75, s75, s83
    buffer_load_dwordx4 v[152:155], v129, s[56:59], s75 offen offset:0 sc1
    buffer_load_dwordx4 v[180:183], v129, s[56:59], s75 offen offset:1024 sc1
    buffer_load_dwordx4 v[208:211], v129, s[56:59], s75 offen offset:2048 sc1
    buffer_load_dwordx4 v[236:239], v129, s[56:59], s75 offen offset:3072 sc1
    s_waitcnt vmcnt(28)
    s_barrier
    s_add_u32 s74, s80, 8
    s_and_b32 s74, s74, 7
    s_lshl_b32 s74, s74, 7
    s_or_b32 s74, s74, s82
    s_xor_b32 s74, s74, 131072
    s_add_u32 m0, s79, 16384
    s_nop 0
    buffer_load_dwordx4 v14, s[52:55], s74 offen offset:0  lds
    buffer_load_dwordx4 v15, s[52:55], s74 offen offset:1024  lds
    buffer_load_dwordx4 v16, s[52:55], s74 offen offset:2048  lds
    buffer_load_dwordx4 v17, s[52:55], s74 offen offset:3072  lds
    s_waitcnt vmcnt(28)
    s_barrier
    s_add_u32 s74, s80, 8
    s_and_b32 s74, s74, 7
    s_lshl_b32 s74, s74, 7
    s_or_b32 s74, s74, s82
    s_xor_b32 s74, s74, 262144
    s_add_u32 m0, s79, 32768
    s_nop 0
    buffer_load_dwordx4 v14, s[52:55], s74 offen offset:0  lds
    buffer_load_dwordx4 v15, s[52:55], s74 offen offset:1024  lds
    buffer_load_dwordx4 v16, s[52:55], s74 offen offset:2048  lds
    buffer_load_dwordx4 v17, s[52:55], s74 offen offset:3072  lds
    s_waitcnt vmcnt(24)
    s_barrier
    s_add_u32 s74, s80, 8
    s_and_b32 s74, s74, 7
    s_lshl_b32 s74, s74, 7
    s_or_b32 s74, s74, s82
    s_xor_b32 s74, s74, 393216
    s_add_u32 m0, s79, 49152
    s_nop 0
    buffer_load_dwordx4 v14, s[52:55], s74 offen offset:0  lds
    buffer_load_dwordx4 v15, s[52:55], s74 offen offset:1024  lds
    buffer_load_dwordx4 v16, s[52:55], s74 offen offset:2048  lds
    buffer_load_dwordx4 v17, s[52:55], s74 offen offset:3072  lds
    s_waitcnt vmcnt(24)
    s_barrier
    s_sub_u32 s75, s80, 4
    s_and_b32 s75, s75, 7
    s_lshl_b32 s75, s75, 14
    s_add_u32 s75, s75, s83
    buffer_load_dwordx4 v[156:159], v129, s[56:59], s75 offen offset:0 sc1
    buffer_load_dwordx4 v[184:187], v129, s[56:59], s75 offen offset:1024 sc1
    buffer_load_dwordx4 v[212:215], v129, s[56:59], s75 offen offset:2048 sc1
    buffer_load_dwordx4 v[240:243], v129, s[56:59], s75 offen offset:3072 sc1
    s_waitcnt vmcnt(24)
    s_barrier
    s_waitcnt vmcnt(20)
    s_barrier
    s_waitcnt vmcnt(12)
    s_barrier
    s_waitcnt vmcnt(8)
    s_barrier
    s_sub_u32 s75, s80, 5
    s_and_b32 s75, s75, 7
    s_lshl_b32 s75, s75, 14
    s_add_u32 s75, s75, s83
    buffer_load_dwordx4 v[160:163], v129, s[56:59], s75 offen offset:0 sc1
    buffer_load_dwordx4 v[188:191], v129, s[56:59], s75 offen offset:1024 sc1
    buffer_load_dwordx4 v[216:219], v129, s[56:59], s75 offen offset:2048 sc1
    buffer_load_dwordx4 v[244:247], v129, s[56:59], s75 offen offset:3072 sc1
    s_waitcnt vmcnt(8)
    s_barrier
    s_waitcnt vmcnt(8)
    s_barrier
    s_waitcnt vmcnt(8)
    s_barrier
    s_sub_u32 s75, s80, 6
    s_and_b32 s75, s75, 7
    s_lshl_b32 s75, s75, 14
    s_add_u32 s75, s75, s83
    buffer_load_dwordx4 v[164:167], v129, s[56:59], s75 offen offset:0 sc1
    buffer_load_dwordx4 v[192:195], v129, s[56:59], s75 offen offset:1024 sc1
    buffer_load_dwordx4 v[220:223], v129, s[56:59], s75 offen offset:2048 sc1
    buffer_load_dwordx4 v[248:251], v129, s[56:59], s75 offen offset:3072 sc1
    s_waitcnt vmcnt(4)
    v_mfma_f32_16x16x32_bf16 v[64:67], v[140:143], v[144:147], 0
    v_mfma_f32_16x16x32_bf16 v[72:75], v[140:143], v[172:175], 0
    v_mfma_f32_16x16x32_bf16 v[80:83], v[140:143], v[200:203], 0
    v_mfma_f32_16x16x32_bf16 v[88:91], v[140:143], v[228:231], 0
    v_mfma_f32_16x16x32_bf16 v[68:71], v[138:141], v[146:149], 0
    v_mfma_f32_16x16x32_bf16 v[76:79], v[138:141], v[174:177], 0
    v_mfma_f32_16x16x32_bf16 v[84:87], v[138:141], v[202:205], 0
    v_mfma_f32_16x16x32_bf16 v[92:95], v[138:141], v[230:233], 0
    v_mfma_f32_16x16x32_bf16 v[64:67], v[138:141], v[150:153], v[64:67]
    v_mfma_f32_16x16x32_bf16 v[72:75], v[138:141], v[178:181], v[72:75]
    v_mfma_f32_16x16x32_bf16 v[80:83], v[138:141], v[206:209], v[80:83]
    v_mfma_f32_16x16x32_bf16 v[88:91], v[138:141], v[234:237], v[88:91]
    v_mfma_f32_16x16x32_bf16 v[68:71], v[138:141], v[154:157], v[68:71]
    v_mfma_f32_16x16x32_bf16 v[76:79], v[138:141], v[182:185], v[76:79]
    v_mfma_f32_16x16x32_bf16 v[84:87], v[138:141], v[210:213], v[84:87]
    v_mfma_f32_16x16x32_bf16 v[92:95], v[138:141], v[238:241], v[92:95]
    v_mfma_f32_16x16x32_bf16 v[64:67], v[138:141], v[158:161], v[64:67]
    v_mfma_f32_16x16x32_bf16 v[72:75], v[138:141], v[186:189], v[72:75]
    v_mfma_f32_16x16x32_bf16 v[80:83], v[138:141], v[214:217], v[80:83]
    v_mfma_f32_16x16x32_bf16 v[88:91], v[138:141], v[242:245], v[88:91]
    s_barrier
    s_sub_u32 s75, s80, 7
    s_and_b32 s75, s75, 7
    s_lshl_b32 s75, s75, 14
    s_add_u32 s75, s75, s83
    buffer_load_dwordx4 v[168:171], v129, s[56:59], s75 offen offset:0 sc1
    buffer_load_dwordx4 v[196:199], v129, s[56:59], s75 offen offset:1024 sc1
    buffer_load_dwordx4 v[224:227], v129, s[56:59], s75 offen offset:2048 sc1
    buffer_load_dwordx4 v[252:255], v129, s[56:59], s75 offen offset:3072 sc1
    ds_read_b128 v[32:35], v130 offset:0
    ds_read_b128 v[36:39], v130 offset:1024
    ds_read_b128 v[40:43], v130 offset:2048
    ds_read_b128 v[44:47], v130 offset:3072
    ds_read_b128 v[48:51], v130 offset:4096
    ds_read_b128 v[52:55], v130 offset:5120
    ds_read_b128 v[56:59], v130 offset:6144
    ds_read_b128 v[60:63], v130 offset:7168
    s_waitcnt lgkmcnt(0)
    v_add_f32 v64, v64, v32
    v_add_f32 v65, v65, v33
    v_add_f32 v66, v66, v34
    v_add_f32 v67, v67, v35
    v_add_f32 v68, v68, v36
    v_add_f32 v69, v69, v37
    v_add_f32 v70, v70, v38
    v_add_f32 v71, v71, v39
    v_add_f32 v72, v72, v40
    v_add_f32 v73, v73, v41
    v_add_f32 v74, v74, v42
    v_add_f32 v75, v75, v43
    v_add_f32 v76, v76, v44
    v_add_f32 v77, v77, v45
    v_add_f32 v78, v78, v46
    v_add_f32 v79, v79, v47
    v_add_f32 v80, v80, v48
    v_add_f32 v81, v81, v49
    v_add_f32 v82, v82, v50
    v_add_f32 v83, v83, v51
    v_add_f32 v84, v84, v52
    v_add_f32 v85, v85, v53
    v_add_f32 v86, v86, v54
    v_add_f32 v87, v87, v55
    v_add_f32 v88, v88, v56
    v_add_f32 v89, v89, v57
    v_add_f32 v90, v90, v58
    v_add_f32 v91, v91, v59
    v_add_f32 v92, v92, v60
    v_add_f32 v93, v93, v61
    v_add_f32 v94, v94, v62
    v_add_f32 v95, v95, v63
    s_nop 0
    s_waitcnt vmcnt(4)
    v_mfma_f32_16x16x32_bf16 v[68:71], v[138:141], v[162:165], v[68:71]
    v_mfma_f32_16x16x32_bf16 v[76:79], v[138:141], v[190:193], v[76:79]
    v_mfma_f32_16x16x32_bf16 v[84:87], v[138:141], v[218:221], v[84:87]
    v_mfma_f32_16x16x32_bf16 v[92:95], v[138:141], v[246:249], v[92:95]
    s_waitcnt vmcnt(0)
    v_mfma_f32_16x16x32_bf16 v[64:67], v[138:141], v[166:169], v[64:67]
    v_mfma_f32_16x16x32_bf16 v[72:75], v[138:141], v[194:197], v[72:75]
    v_mfma_f32_16x16x32_bf16 v[80:83], v[138:141], v[222:225], v[80:83]
    v_mfma_f32_16x16x32_bf16 v[88:91], v[138:141], v[250:253], v[88:91]
    v_mfma_f32_16x16x32_bf16 v[68:71], v[136:139], v[168:171], v[68:71]
    v_mfma_f32_16x16x32_bf16 v[76:79], v[136:139], v[196:199], v[76:79]
    v_mfma_f32_16x16x32_bf16 v[84:87], v[136:139], v[224:227], v[84:87]
    v_mfma_f32_16x16x32_bf16 v[92:95], v[136:139], v[252:255], v[92:95]
    s_nop 1
    v_cvt_pk_bf16_f32 v64, v64, v65
    v_cvt_pk_bf16_f32 v65, v66, v67
    ds_write_b64 v10, v[64:65] offset:0
    v_cvt_pk_bf16_f32 v68, v68, v69
    v_cvt_pk_bf16_f32 v69, v70, v71
    ds_write_b64 v11, v[68:69] offset:0
    v_cvt_pk_bf16_f32 v72, v72, v73
    v_cvt_pk_bf16_f32 v73, v74, v75
    ds_write_b64 v12, v[72:73] offset:0
    v_cvt_pk_bf16_f32 v76, v76, v77
    v_cvt_pk_bf16_f32 v77, v78, v79
    ds_write_b64 v13, v[76:77] offset:0
    ds_read_b128 v[144:147], v133 offset:0
    ds_read_b128 v[148:151], v133 offset:1024
    v_cvt_pk_bf16_f32 v80, v80, v81
    v_cvt_pk_bf16_f32 v81, v82, v83
    ds_write_b64 v10, v[80:81] offset:2048
    v_cvt_pk_bf16_f32 v84, v84, v85
    v_cvt_pk_bf16_f32 v85, v86, v87
    ds_write_b64 v11, v[84:85] offset:2048
    v_cvt_pk_bf16_f32 v88, v88, v89
    v_cvt_pk_bf16_f32 v89, v90, v91
    ds_write_b64 v12, v[88:89] offset:2048
    v_cvt_pk_bf16_f32 v92, v92, v93
    v_cvt_pk_bf16_f32 v93, v94, v95
    ds_write_b64 v13, v[92:93] offset:2048
    ds_read_b128 v[152:155], v133 offset:2048
    ds_read_b128 v[156:159], v133 offset:3072
    s_waitcnt lgkmcnt(7)
    buffer_store_dwordx4 v[144:147], v132, s[68:71], 0 offen sc1
    s_waitcnt lgkmcnt(6)
    buffer_store_dwordx4 v[148:151], v132, s[68:71], s37 offen sc1
    s_waitcnt lgkmcnt(1)
    buffer_store_dwordx4 v[152:155], v132, s[68:71], s38 offen sc1
    s_waitcnt lgkmcnt(0)
    buffer_store_dwordx4 v[156:159], v132, s[68:71], s39 offen sc1
    s_endpgm
L_B1:
    v_lshrrev_b32 v32, 4, v0
    v_and_b32 v33, 15, v0
    v_lshlrev_b32 v34, 1, v32
    v_xor_b32 v34, v34, v33
    v_xor_b32 v35, 8, v34
    s_lshl_b32 s73, s72, 17
    v_lshl_add_u32 v36, v32, 13, s73
    v_lshl_add_u32 v10, v34, 4, v36
    v_lshl_add_u32 v11, v35, 4, v36
    v_add_u32 v11, 31744, v11
    v_lshl_add_u32 v12, v34, 4, v36
    v_add_u32 v12, 63488, v12
    v_lshl_add_u32 v13, v35, 4, v36
    v_add_u32 v13, 95232, v13
    s_lshl_b32 s73, s72, 12
    v_lshl_add_u32 v36, v32, 8, s73
    v_add_u32 v37, 0, v32
    v_xor_b32 v37, v37, v33
    v_lshl_add_u32 v4, v37, 4, v36
    v_add_u32 v37, 4, v32
    v_xor_b32 v37, v37, v33
    v_lshl_add_u32 v5, v37, 4, v36
    v_add_u32 v37, 8, v32
    v_xor_b32 v37, v37, v33
    v_lshl_add_u32 v6, v37, 4, v36
    v_add_u32 v37, 12, v32
    v_xor_b32 v37, v37, v33
    v_lshl_add_u32 v7, v37, 4, v36
    v_lshl_add_u32 v8, v34, 4, v36
    v_lshl_add_u32 v9, v35, 4, v36
    s_lshl_b32 s73, s72, 14
    v_lshl_add_u32 v36, v32, 10, s73
    v_lshrrev_b32 v37, 3, v34
    v_lshl_add_u32 v14, v37, 16, v36
    v_and_b32 v37, 7, v34
    v_lshl_add_u32 v14, v37, 4, v14
    v_lshrrev_b32 v37, 3, v35
    v_lshl_add_u32 v15, v37, 16, v36
    v_and_b32 v37, 7, v35
    v_lshl_add_u32 v15, v37, 4, v15
    v_add_u32 v15, 3072, v15
    v_add_u32 v16, 6144, v14
    v_add_u32 v17, 6144, v15
    v_lshrrev_b32 v28, 2, v0
    v_and_b32 v29, 7, v28
    v_lshlrev_b32 v28, 8, v28
    v_lshl_add_u32 v28, v29, 5, v28
    v_and_b32 v29, 3, v0
    v_lshl_add_u32 v28, v29, 3, v28
    v_add_u32 v28, 0x10000, v28
    v_xor_b32 v18, 0x0, v28
    v_xor_b32 v19, 0x20, v28
    v_xor_b32 v20, 0x40, v28
    v_xor_b32 v21, 0x60, v28
    v_xor_b32 v22, 0x80, v28
    v_xor_b32 v23, 0xa0, v28
    v_xor_b32 v24, 0xc0, v28
    v_xor_b32 v25, 0xe0, v28
    v_and_b32 v1, 15, v0
    v_lshrrev_b32 v2, 5, v0
    v_bfe_u32 v3, v0, 4, 1
    v_xor_b32 v28, v2, v1
    v_lshlrev_b32 v28, 4, v28
    v_lshl_add_u32 v28, v1, 8, v28
    v_lshl_add_u32 v28, v3, 3, v28
    v_add_u32 v26, s85, v28
    v_add_u32 v31, 0x20000, v26
    s_add_u32 s73, s85, 131072
    v_lshl_add_u32 v27, v2, 8, s73
    v_lshl_add_u32 v27, v1, 4, v27
    v_lshl_add_u32 v27, v3, 3, v27
    s_mov_b32 s92, 0x3e0293ee
    s_mov_b32 s93, 0x3e0293ee
    s_xor_b32 s78, s95, 524544
    s_and_b32 s82, s3, 0x60000
    s_xor_b32 s77, s3, 16384
    s_waitcnt lgkmcnt(0)
    s_cmp_lg_u32 s90, 0
    s_cselect_b32 s40, s16, s6
    s_cselect_b32 s41, s17, s7
    s_cselect_b32 s44, s18, s8
    s_cselect_b32 s45, s19, s9
    s_cselect_b32 s48, s20, s10
    s_cselect_b32 s49, s21, s11
    s_cselect_b32 s52, s22, s12
    s_cselect_b32 s53, s23, s13
    s_lshl_b32 s73, s89, 3
    s_add_u32 s73, s73, s80
    s_lshl_b32 s73, s73, 19
    s_add_u32 s40, s40, s73
    s_addc_u32 s41, s41, 0
    s_mov_b32 s42, 524288
    s_mov_b32 s43, 0x20000
    s_lshl_b32 s73, s89, 3
    s_add_u32 s73, s73, s80
    s_lshl_b32 s73, s73, 19
    s_add_u32 s44, s44, s73
    s_addc_u32 s45, s45, 0
    s_mov_b32 s46, 524288
    s_mov_b32 s47, 0x20000
    s_lshl_b32 s73, s80, 10
    s_sub_u32 s50, 0x400000, s73
    s_add_u32 s48, s48, s73
    s_addc_u32 s49, s49, 0
    s_mov_b32 s51, 0x20000
    s_lshl_b32 s73, s80, 19
    s_add_u32 s52, s52, s73
    s_addc_u32 s53, s53, 0
    s_mov_b32 s54, 524288
    s_mov_b32 s55, 0x20000
    s_lshl_b32 s73, s91, 20
    s_add_u32 s56, s24, s73
    s_addc_u32 s57, s25, 0
    s_mov_b32 s58, 1048576
    s_mov_b32 s59, 0x20000
    s_lshl_b32 s73, s91, 10
    s_add_u32 s73, s73, 33554432
    s_add_u32 s60, s24, s73
    s_addc_u32 s61, s25, 0
    s_mov_b32 s62, 1024
    s_mov_b32 s63, 0x20000
    s_lshl_b32 s73, s91, 2
    s_add_u32 s64, s34, s73
    s_addc_u32 s65, s35, 0
    s_mov_b32 s66, 4
    s_mov_b32 s67, 0x20000
    s_mul_i32 s73, s89, 229376
    s_add_u32 s68, s32, s73
    s_addc_u32 s69, s33, 0
    s_mov_b32 s70, 229376
    s_mov_b32 s71, 0x20000
    s_barrier
    v_xor_b32 v28, 0x0, v31
    ds_read_b64 v[128:129], v28 offset:0
    v_xor_b32 v29, 0x20, v31
    ds_read_b64 v[130:131], v29 offset:0
    ds_read_b64_tr_b16 v[32:33], v18 offset:0
    ds_read_b64_tr_b16 v[34:35], v18 offset:4096
    ds_read_b64_tr_b16 v[36:37], v19 offset:0
    ds_read_b64_tr_b16 v[38:39], v19 offset:4096
    v_xor_b32 v28, 0x40, v31
    ds_read_b64 v[132:133], v28 offset:0
    v_xor_b32 v29, 0x60, v31
    ds_read_b64 v[134:135], v29 offset:0
    ds_read_b64_tr_b16 v[40:41], v20 offset:0
    ds_read_b64_tr_b16 v[42:43], v20 offset:4096
    ds_read_b64_tr_b16 v[44:45], v21 offset:0
    ds_read_b64_tr_b16 v[46:47], v21 offset:4096
    v_xor_b32 v28, 0x80, v31
    ds_read_b64 v[136:137], v28 offset:0
    v_xor_b32 v29, 0xa0, v31
    ds_read_b64 v[138:139], v29 offset:0
    ds_read_b64_tr_b16 v[48:49], v22 offset:0
    ds_read_b64_tr_b16 v[50:51], v22 offset:4096
    ds_read_b64_tr_b16 v[52:53], v23 offset:0
    ds_read_b64_tr_b16 v[54:55], v23 offset:4096
    v_xor_b32 v28, 0xc0, v31
    ds_read_b64 v[140:141], v28 offset:0
    v_xor_b32 v29, 0xe0, v31
    ds_read_b64 v[142:143], v29 offset:0
    ds_read_b64_tr_b16 v[56:57], v24 offset:0
    ds_read_b64_tr_b16 v[58:59], v24 offset:4096
    s_waitcnt lgkmcnt(14)
    v_mfma_f32_16x16x32_bf16 v[64:67], v[32:35], v[128:131], 0
    ds_read_b64_tr_b16 v[60:61], v25 offset:0
    ds_read_b64_tr_b16 v[62:63], v25 offset:4096
    s_waitcnt lgkmcnt(14)
    v_mfma_f32_16x16x32_bf16 v[68:71], v[36:39], v[128:131], 0
    ds_read_b64_tr_b16 v[32:33], v18 offset:8192
    ds_read_b64_tr_b16 v[34:35], v18 offset:12288
    v_mfma_f32_16x16x32_bf16 v[72:75], v[40:43], v[128:131], 0
    ds_read_b64_tr_b16 v[36:37], v19 offset:8192
    ds_read_b64_tr_b16 v[38:39], v19 offset:12288
    s_waitcnt lgkmcnt(12)
    v_mfma_f32_16x16x32_bf16 v[76:79], v[44:47], v[128:131], 0
    ds_read_b64_tr_b16 v[40:41], v20 offset:8192
    ds_read_b64_tr_b16 v[42:43], v20 offset:12288
    v_mfma_f32_16x16x32_bf16 v[80:83], v[48:51], v[128:131], 0
    ds_read_b64_tr_b16 v[44:45], v21 offset:8192
    ds_read_b64_tr_b16 v[46:47], v21 offset:12288
    s_waitcnt lgkmcnt(10)
    v_mfma_f32_16x16x32_bf16 v[84:87], v[52:55], v[128:131], 0
    ds_read_b64_tr_b16 v[48:49], v22 offset:8192
    ds_read_b64_tr_b16 v[50:51], v22 offset:12288
    v_mfma_f32_16x16x32_bf16 v[88:91], v[56:59], v[128:131], 0
    ds_read_b64_tr_b16 v[52:53], v23 offset:8192
    ds_read_b64_tr_b16 v[54:55], v23 offset:12288
    s_waitcnt lgkmcnt(10)
    v_mfma_f32_16x16x32_bf16 v[92:95], v[60:63], v[128:131], 0
    ds_read_b64_tr_b16 v[56:57], v24 offset:8192
    ds_read_b64_tr_b16 v[58:59], v24 offset:12288
    v_mfma_f32_16x16x32_bf16 v[64:67], v[32:35], v[132:135], v[64:67]
    ds_read_b64_tr_b16 v[60:61], v25 offset:8192
    ds_read_b64_tr_b16 v[62:63], v25 offset:12288
    s_waitcnt lgkmcnt(10)
    v_mfma_f32_16x16x32_bf16 v[68:71], v[36:39], v[132:135], v[68:71]
    s_barrier
    ds_read_b64_tr_b16 v[32:33], v18 offset:16384
    ds_read_b64_tr_b16 v[34:35], v18 offset:20480
    v_mfma_f32_16x16x32_bf16 v[72:75], v[40:43], v[132:135], v[72:75]
    ds_read_b64_tr_b16 v[36:37], v19 offset:16384
    ds_read_b64_tr_b16 v[38:39], v19 offset:20480
    s_waitcnt lgkmcnt(10)
    v_mfma_f32_16x16x32_bf16 v[76:79], v[44:47], v[132:135], v[76:79]
    ds_read_b64_tr_b16 v[40:41], v20 offset:16384
    ds_read_b64_tr_b16 v[42:43], v20 offset:20480
    v_mfma_f32_16x16x32_bf16 v[80:83], v[48:51], v[132:135], v[80:83]
    ds_read_b64_tr_b16 v[44:45], v21 offset:16384
    ds_read_b64_tr_b16 v[46:47], v21 offset:20480
    s_waitcnt lgkmcnt(10)
    v_mfma_f32_16x16x32_bf16 v[84:87], v[52:55], v[132:135], v[84:87]
    ds_read_b64_tr_b16 v[48:49], v22 offset:16384
    ds_read_b64_tr_b16 v[50:51], v22 offset:20480
    v_mfma_f32_16x16x32_bf16 v[88:91], v[56:59], v[132:135], v[88:91]
    ds_read_b64_tr_b16 v[52:53], v23 offset:16384
    ds_read_b64_tr_b16 v[54:55], v23 offset:20480
    s_waitcnt lgkmcnt(10)
    v_mfma_f32_16x16x32_bf16 v[92:95], v[60:63], v[132:135], v[92:95]
    ds_read_b64_tr_b16 v[56:57], v24 offset:16384
    ds_read_b64_tr_b16 v[58:59], v24 offset:20480
    v_mfma_f32_16x16x32_bf16 v[64:67], v[32:35], v[136:139], v[64:67]
    ds_read_b64_tr_b16 v[60:61], v25 offset:16384
    ds_read_b64_tr_b16 v[62:63], v25 offset:20480
    s_waitcnt lgkmcnt(10)
    v_mfma_f32_16x16x32_bf16 v[68:71], v[36:39], v[136:139], v[68:71]
    ds_read_b64_tr_b16 v[32:33], v18 offset:24576
    ds_read_b64_tr_b16 v[34:35], v18 offset:28672
    v_mfma_f32_16x16x32_bf16 v[72:75], v[40:43], v[136:139], v[72:75]
    ds_read_b64_tr_b16 v[36:37], v19 offset:24576
    ds_read_b64_tr_b16 v[38:39], v19 offset:28672
    s_waitcnt lgkmcnt(10)
    v_mfma_f32_16x16x32_bf16 v[76:79], v[44:47], v[136:139], v[76:79]
    ds_read_b64_tr_b16 v[40:41], v20 offset:24576
    ds_read_b64_tr_b16 v[42:43], v20 offset:28672
    v_mfma_f32_16x16x32_bf16 v[80:83], v[48:51], v[136:139], v[80:83]
    ds_read_b64_tr_b16 v[44:45], v21 offset:24576
    ds_read_b64_tr_b16 v[46:47], v21 offset:28672
    s_waitcnt lgkmcnt(10)
    v_mfma_f32_16x16x32_bf16 v[84:87], v[52:55], v[136:139], v[84:87]
    ds_read_b64_tr_b16 v[48:49], v22 offset:24576
    ds_read_b64_tr_b16 v[50:51], v22 offset:28672
    v_mfma_f32_16x16x32_bf16 v[88:91], v[56:59], v[136:139], v[88:91]
    ds_read_b64_tr_b16 v[52:53], v23 offset:24576
    ds_read_b64_tr_b16 v[54:55], v23 offset:28672
    s_waitcnt lgkmcnt(10)
    v_mfma_f32_16x16x32_bf16 v[92:95], v[60:63], v[136:139], v[92:95]
    ds_read_b64_tr_b16 v[56:57], v24 offset:24576
    ds_read_b64_tr_b16 v[58:59], v24 offset:28672
    v_mfma_f32_16x16x32_bf16 v[64:67], v[32:35], v[140:143], v[64:67]
    ds_read_b64_tr_b16 v[60:61], v25 offset:24576
    ds_read_b64_tr_b16 v[62:63], v25 offset:28672
    s_waitcnt lgkmcnt(10)
    v_mfma_f32_16x16x32_bf16 v[68:71], v[36:39], v[140:143], v[68:71]
    s_barrier
    v_xor_b32 v28, 0x0, v26
    ds_read_b64 v[144:145], v28 offset:0
    v_xor_b32 v29, 0x20, v26
    ds_read_b64 v[146:147], v29 offset:0
    ds_read_b64_tr_b16 v[32:33], v18 offset:32768
    ds_read_b64_tr_b16 v[34:35], v18 offset:36864
    v_mfma_f32_16x16x32_bf16 v[72:75], v[40:43], v[140:143], v[72:75]
    ds_read_b64_tr_b16 v[36:37], v19 offset:32768
    ds_read_b64_tr_b16 v[38:39], v19 offset:36864
    s_waitcnt lgkmcnt(12)
    v_mfma_f32_16x16x32_bf16 v[76:79], v[44:47], v[140:143], v[76:79]
    v_xor_b32 v28, 0x40, v26
    ds_read_b64 v[148:149], v28 offset:0
    v_xor_b32 v29, 0x60, v26
    ds_read_b64 v[150:151], v29 offset:0
    ds_read_b64_tr_b16 v[40:41], v20 offset:32768
    ds_read_b64_tr_b16 v[42:43], v20 offset:36864
    v_mfma_f32_16x16x32_bf16 v[80:83], v[48:51], v[140:143], v[80:83]
    ds_read_b64_tr_b16 v[44:45], v21 offset:32768
    ds_read_b64_tr_b16 v[46:47], v21 offset:36864
    s_waitcnt lgkmcnt(14)
    v_mfma_f32_16x16x32_bf16 v[84:87], v[52:55], v[140:143], v[84:87]
    v_xor_b32 v28, 0x80, v26
    ds_read_b64 v[152:153], v28 offset:0
    v_xor_b32 v29, 0xa0, v26
    ds_read_b64 v[154:155], v29 offset:0
    ds_read_b64_tr_b16 v[48:49], v22 offset:32768
    ds_read_b64_tr_b16 v[50:51], v22 offset:36864
    v_mfma_f32_16x16x32_bf16 v[88:91], v[56:59], v[140:143], v[88:91]
    ds_read_b64_tr_b16 v[52:53], v23 offset:32768
    ds_read_b64_tr_b16 v[54:55], v23 offset:36864
    s_waitcnt lgkmcnt(14)
    v_mfma_f32_16x16x32_bf16 v[92:95], v[60:63], v[140:143], v[92:95]
    v_xor_b32 v28, 0xc0, v26
    ds_read_b64 v[156:157], v28 offset:0
    v_xor_b32 v29, 0xe0, v26
    ds_read_b64 v[158:159], v29 offset:0
    ds_read_b64_tr_b16 v[56:57], v24 offset:32768
    ds_read_b64_tr_b16 v[58:59], v24 offset:36864
    v_mfma_f32_16x16x32_bf16 v[64:67], v[32:35], v[144:147], v[64:67]
    ds_read_b64_tr_b16 v[60:61], v25 offset:32768
    ds_read_b64_tr_b16 v[62:63], v25 offset:36864
    s_waitcnt lgkmcnt(14)
    v_mfma_f32_16x16x32_bf16 v[68:71], v[36:39], v[144:147], v[68:71]
    ds_read_b64_tr_b16 v[32:33], v18 offset:40960
    ds_read_b64_tr_b16 v[34:35], v18 offset:45056
    v_mfma_f32_16x16x32_bf16 v[72:75], v[40:43], v[144:147], v[72:75]
    ds_read_b64_tr_b16 v[36:37], v19 offset:40960
    ds_read_b64_tr_b16 v[38:39], v19 offset:45056
    s_waitcnt lgkmcnt(12)
    v_mfma_f32_16x16x32_bf16 v[76:79], v[44:47], v[144:147], v[76:79]
    ds_read_b64_tr_b16 v[40:41], v20 offset:40960
    ds_read_b64_tr_b16 v[42:43], v20 offset:45056
    v_mfma_f32_16x16x32_bf16 v[80:83], v[48:51], v[144:147], v[80:83]
    ds_read_b64_tr_b16 v[44:45], v21 offset:40960
    ds_read_b64_tr_b16 v[46:47], v21 offset:45056
    s_waitcnt lgkmcnt(10)
    v_mfma_f32_16x16x32_bf16 v[84:87], v[52:55], v[144:147], v[84:87]
    ds_read_b64_tr_b16 v[48:49], v22 offset:40960
    ds_read_b64_tr_b16 v[50:51], v22 offset:45056
    v_mfma_f32_16x16x32_bf16 v[88:91], v[56:59], v[144:147], v[88:91]
    ds_read_b64_tr_b16 v[52:53], v23 offset:40960
    ds_read_b64_tr_b16 v[54:55], v23 offset:45056
    s_waitcnt lgkmcnt(10)
    v_mfma_f32_16x16x32_bf16 v[92:95], v[60:63], v[144:147], v[92:95]
    ds_read_b64_tr_b16 v[56:57], v24 offset:40960
    ds_read_b64_tr_b16 v[58:59], v24 offset:45056
    v_mfma_f32_16x16x32_bf16 v[64:67], v[32:35], v[148:151], v[64:67]
    ds_read_b64_tr_b16 v[60:61], v25 offset:40960
    ds_read_b64_tr_b16 v[62:63], v25 offset:45056
    s_waitcnt lgkmcnt(10)
    v_mfma_f32_16x16x32_bf16 v[68:71], v[36:39], v[148:151], v[68:71]
    s_barrier
    ds_read_b64_tr_b16 v[32:33], v18 offset:49152
    ds_read_b64_tr_b16 v[34:35], v18 offset:53248
    v_mfma_f32_16x16x32_bf16 v[72:75], v[40:43], v[148:151], v[72:75]
    ds_read_b64_tr_b16 v[36:37], v19 offset:49152
    ds_read_b64_tr_b16 v[38:39], v19 offset:53248
    s_waitcnt lgkmcnt(10)
    v_mfma_f32_16x16x32_bf16 v[76:79], v[44:47], v[148:151], v[76:79]
    ds_read_b64_tr_b16 v[40:41], v20 offset:49152
    ds_read_b64_tr_b16 v[42:43], v20 offset:53248
    v_mfma_f32_16x16x32_bf16 v[80:83], v[48:51], v[148:151], v[80:83]
    ds_read_b64_tr_b16 v[44:45], v21 offset:49152
    ds_read_b64_tr_b16 v[46:47], v21 offset:53248
    s_waitcnt lgkmcnt(10)
    v_mfma_f32_16x16x32_bf16 v[84:87], v[52:55], v[148:151], v[84:87]
    ds_read_b64_tr_b16 v[48:49], v22 offset:49152
    ds_read_b64_tr_b16 v[50:51], v22 offset:53248
    v_mfma_f32_16x16x32_bf16 v[88:91], v[56:59], v[148:151], v[88:91]
    ds_read_b64_tr_b16 v[52:53], v23 offset:49152
    ds_read_b64_tr_b16 v[54:55], v23 offset:53248
    s_waitcnt lgkmcnt(10)
    v_mfma_f32_16x16x32_bf16 v[92:95], v[60:63], v[148:151], v[92:95]
    ds_read_b64_tr_b16 v[56:57], v24 offset:49152
    ds_read_b64_tr_b16 v[58:59], v24 offset:53248
    v_mfma_f32_16x16x32_bf16 v[64:67], v[32:35], v[152:155], v[64:67]
    ds_read_b64_tr_b16 v[60:61], v25 offset:49152
    ds_read_b64_tr_b16 v[62:63], v25 offset:53248
    s_waitcnt lgkmcnt(10)
    v_mfma_f32_16x16x32_bf16 v[68:71], v[36:39], v[152:155], v[68:71]
    ds_read_b64_tr_b16 v[32:33], v18 offset:57344
    ds_read_b64_tr_b16 v[34:35], v18 offset:61440
    v_mfma_f32_16x16x32_bf16 v[72:75], v[40:43], v[152:155], v[72:75]
    ds_read_b64_tr_b16 v[36:37], v19 offset:57344
    ds_read_b64_tr_b16 v[38:39], v19 offset:61440
    s_waitcnt lgkmcnt(10)
    v_mfma_f32_16x16x32_bf16 v[76:79], v[44:47], v[152:155], v[76:79]
    ds_read_b64_tr_b16 v[40:41], v20 offset:57344
    ds_read_b64_tr_b16 v[42:43], v20 offset:61440
    v_mfma_f32_16x16x32_bf16 v[80:83], v[48:51], v[152:155], v[80:83]
    ds_read_b64_tr_b16 v[44:45], v21 offset:57344
    ds_read_b64_tr_b16 v[46:47], v21 offset:61440
    s_waitcnt lgkmcnt(10)
    v_mfma_f32_16x16x32_bf16 v[84:87], v[52:55], v[152:155], v[84:87]
    ds_read_b64_tr_b16 v[48:49], v22 offset:57344
    ds_read_b64_tr_b16 v[50:51], v22 offset:61440
    v_mfma_f32_16x16x32_bf16 v[88:91], v[56:59], v[152:155], v[88:91]
    ds_read_b64_tr_b16 v[52:53], v23 offset:57344
    ds_read_b64_tr_b16 v[54:55], v23 offset:61440
    s_waitcnt lgkmcnt(10)
    v_mfma_f32_16x16x32_bf16 v[92:95], v[60:63], v[152:155], v[92:95]
    ds_read_b64_tr_b16 v[56:57], v24 offset:57344
    ds_read_b64_tr_b16 v[58:59], v24 offset:61440
    v_mfma_f32_16x16x32_bf16 v[64:67], v[32:35], v[156:159], v[64:67]
    ds_read_b64_tr_b16 v[60:61], v25 offset:57344
    ds_read_b64_tr_b16 v[62:63], v25 offset:61440
    s_waitcnt lgkmcnt(10)
    v_mfma_f32_16x16x32_bf16 v[68:71], v[36:39], v[156:159], v[68:71]
    s_barrier
    v_xor_b32 v28, 0x0, v26
    ds_read_b64 v[160:161], v28 offset:32768
    v_xor_b32 v29, 0x20, v26
    ds_read_b64 v[162:163], v29 offset:32768
    ds_read_b64_tr_b16 v[32:33], v18 offset:0
    ds_read_b64_tr_b16 v[34:35], v18 offset:4096
    v_mfma_f32_16x16x32_bf16 v[72:75], v[40:43], v[156:159], v[72:75]
    ds_read_b64_tr_b16 v[36:37], v19 offset:0
    ds_read_b64_tr_b16 v[38:39], v19 offset:4096
    s_waitcnt lgkmcnt(12)
    v_mfma_f32_16x16x32_bf16 v[76:79], v[44:47], v[156:159], v[76:79]
    v_xor_b32 v28, 0x40, v26
    ds_read_b64 v[164:165], v28 offset:32768
    v_xor_b32 v29, 0x60, v26
    ds_read_b64 v[166:167], v29 offset:32768
    ds_read_b64_tr_b16 v[40:41], v20 offset:0
    ds_read_b64_tr_b16 v[42:43], v20 offset:4096
    v_mfma_f32_16x16x32_bf16 v[80:83], v[48:51], v[156:159], v[80:83]
    ds_read_b64_tr_b16 v[44:45], v21 offset:0
    ds_read_b64_tr_b16 v[46:47], v21 offset:4096
    s_waitcnt lgkmcnt(14)
    v_mfma_f32_16x16x32_bf16 v[84:87], v[52:55], v[156:159], v[84:87]
    v_xor_b32 v28, 0x80, v26
    ds_read_b64 v[168:169], v28 offset:32768
    v_xor_b32 v29, 0xa0, v26
    ds_read_b64 v[170:171], v29 offset:32768
    ds_read_b64_tr_b16 v[48:49], v22 offset:0
    ds_read_b64_tr_b16 v[50:51], v22 offset:4096
    v_mfma_f32_16x16x32_bf16 v[88:91], v[56:59], v[156:159], v[88:91]
    ds_read_b64_tr_b16 v[52:53], v23 offset:0
    ds_read_b64_tr_b16 v[54:55], v23 offset:4096
    s_waitcnt lgkmcnt(14)
    v_mfma_f32_16x16x32_bf16 v[92:95], v[60:63], v[156:159], v[92:95]
    v_xor_b32 v28, 0xc0, v26
    ds_read_b64 v[172:173], v28 offset:32768
    v_xor_b32 v29, 0xe0, v26
    ds_read_b64 v[174:175], v29 offset:32768
    ds_read_b64_tr_b16 v[56:57], v24 offset:0
    ds_read_b64_tr_b16 v[58:59], v24 offset:4096
    v_mfma_f32_16x16x32_bf16 v[64:67], v[32:35], v[160:163], v[64:67]
    ds_read_b64_tr_b16 v[60:61], v25 offset:0
    ds_read_b64_tr_b16 v[62:63], v25 offset:4096
    s_waitcnt lgkmcnt(14)
    v_mfma_f32_16x16x32_bf16 v[68:71], v[36:39], v[160:163], v[68:71]
    ds_read_b64_tr_b16 v[32:33], v18 offset:8192
    ds_read_b64_tr_b16 v[34:35], v18 offset:12288
    v_mfma_f32_16x16x32_bf16 v[72:75], v[40:43], v[160:163], v[72:75]
    ds_read_b64_tr_b16 v[36:37], v19 offset:8192
    ds_read_b64_tr_b16 v[38:39], v19 offset:12288
    s_waitcnt lgkmcnt(12)
    v_mfma_f32_16x16x32_bf16 v[76:79], v[44:47], v[160:163], v[76:79]
    ds_read_b64_tr_b16 v[40:41], v20 offset:8192
    ds_read_b64_tr_b16 v[42:43], v20 offset:12288
    v_mfma_f32_16x16x32_bf16 v[80:83], v[48:51], v[160:163], v[80:83]
    ds_read_b64_tr_b16 v[44:45], v21 offset:8192
    ds_read_b64_tr_b16 v[46:47], v21 offset:12288
    s_waitcnt lgkmcnt(10)
    v_mfma_f32_16x16x32_bf16 v[84:87], v[52:55], v[160:163], v[84:87]
    ds_read_b64_tr_b16 v[48:49], v22 offset:8192
    ds_read_b64_tr_b16 v[50:51], v22 offset:12288
    v_mfma_f32_16x16x32_bf16 v[88:91], v[56:59], v[160:163], v[88:91]
    ds_read_b64_tr_b16 v[52:53], v23 offset:8192
    ds_read_b64_tr_b16 v[54:55], v23 offset:12288
    s_waitcnt lgkmcnt(10)
    v_mfma_f32_16x16x32_bf16 v[92:95], v[60:63], v[160:163], v[92:95]
    ds_read_b64_tr_b16 v[56:57], v24 offset:8192
    ds_read_b64_tr_b16 v[58:59], v24 offset:12288
    v_mfma_f32_16x16x32_bf16 v[64:67], v[32:35], v[164:167], v[64:67]
    ds_read_b64_tr_b16 v[60:61], v25 offset:8192
    ds_read_b64_tr_b16 v[62:63], v25 offset:12288
    s_waitcnt lgkmcnt(10)
    v_mfma_f32_16x16x32_bf16 v[68:71], v[36:39], v[164:167], v[68:71]
    s_barrier
    ds_read_b64_tr_b16 v[32:33], v18 offset:16384
    ds_read_b64_tr_b16 v[34:35], v18 offset:20480
    v_mfma_f32_16x16x32_bf16 v[72:75], v[40:43], v[164:167], v[72:75]
    ds_read_b64_tr_b16 v[36:37], v19 offset:16384
    ds_read_b64_tr_b16 v[38:39], v19 offset:20480
    s_waitcnt lgkmcnt(10)
    v_mfma_f32_16x16x32_bf16 v[76:79], v[44:47], v[164:167], v[76:79]
    ds_read_b64_tr_b16 v[40:41], v20 offset:16384
    ds_read_b64_tr_b16 v[42:43], v20 offset:20480
    v_mfma_f32_16x16x32_bf16 v[80:83], v[48:51], v[164:167], v[80:83]
    ds_read_b64_tr_b16 v[44:45], v21 offset:16384
    ds_read_b64_tr_b16 v[46:47], v21 offset:20480
    s_waitcnt lgkmcnt(10)
    v_mfma_f32_16x16x32_bf16 v[84:87], v[52:55], v[164:167], v[84:87]
    ds_read_b64_tr_b16 v[48:49], v22 offset:16384
    ds_read_b64_tr_b16 v[50:51], v22 offset:20480
    v_mfma_f32_16x16x32_bf16 v[88:91], v[56:59], v[164:167], v[88:91]
    ds_read_b64_tr_b16 v[52:53], v23 offset:16384
    ds_read_b64_tr_b16 v[54:55], v23 offset:20480
    s_waitcnt lgkmcnt(10)
    v_mfma_f32_16x16x32_bf16 v[92:95], v[60:63], v[164:167], v[92:95]
    ds_read_b64_tr_b16 v[56:57], v24 offset:16384
    ds_read_b64_tr_b16 v[58:59], v24 offset:20480
    v_mfma_f32_16x16x32_bf16 v[64:67], v[32:35], v[168:171], v[64:67]
    ds_read_b64_tr_b16 v[60:61], v25 offset:16384
    ds_read_b64_tr_b16 v[62:63], v25 offset:20480
    s_waitcnt lgkmcnt(10)
    v_mfma_f32_16x16x32_bf16 v[68:71], v[36:39], v[168:171], v[68:71]
    ds_read_b64_tr_b16 v[32:33], v18 offset:24576
    ds_read_b64_tr_b16 v[34:35], v18 offset:28672
    v_mfma_f32_16x16x32_bf16 v[72:75], v[40:43], v[168:171], v[72:75]
    ds_read_b64_tr_b16 v[36:37], v19 offset:24576
    ds_read_b64_tr_b16 v[38:39], v19 offset:28672
    s_waitcnt lgkmcnt(10)
    v_mfma_f32_16x16x32_bf16 v[76:79], v[44:47], v[168:171], v[76:79]
    ds_read_b64_tr_b16 v[40:41], v20 offset:24576
    ds_read_b64_tr_b16 v[42:43], v20 offset:28672
    v_mfma_f32_16x16x32_bf16 v[80:83], v[48:51], v[168:171], v[80:83]
    ds_read_b64_tr_b16 v[44:45], v21 offset:24576
    ds_read_b64_tr_b16 v[46:47], v21 offset:28672
    s_waitcnt lgkmcnt(10)
    v_mfma_f32_16x16x32_bf16 v[84:87], v[52:55], v[168:171], v[84:87]
    ds_read_b64_tr_b16 v[48:49], v22 offset:24576
    ds_read_b64_tr_b16 v[50:51], v22 offset:28672
    v_mfma_f32_16x16x32_bf16 v[88:91], v[56:59], v[168:171], v[88:91]
    ds_read_b64_tr_b16 v[52:53], v23 offset:24576
    ds_read_b64_tr_b16 v[54:55], v23 offset:28672
    s_waitcnt lgkmcnt(10)
    v_mfma_f32_16x16x32_bf16 v[92:95], v[60:63], v[168:171], v[92:95]
    ds_read_b64_tr_b16 v[56:57], v24 offset:24576
    ds_read_b64_tr_b16 v[58:59], v24 offset:28672
    v_mfma_f32_16x16x32_bf16 v[64:67], v[32:35], v[172:175], v[64:67]
    ds_read_b64_tr_b16 v[60:61], v25 offset:24576
    ds_read_b64_tr_b16 v[62:63], v25 offset:28672
    s_waitcnt lgkmcnt(10)
    v_mfma_f32_16x16x32_bf16 v[68:71], v[36:39], v[172:175], v[68:71]
    s_barrier
    v_xor_b32 v28, 0x0, v31
    ds_read_b64 v[176:177], v28 offset:0
    v_xor_b32 v29, 0x20, v31
    ds_read_b64 v[178:179], v29 offset:0
    ds_read_b64_tr_b16 v[32:33], v18 offset:32768
    ds_read_b64_tr_b16 v[34:35], v18 offset:36864
    v_mfma_f32_16x16x32_bf16 v[72:75], v[40:43], v[172:175], v[72:75]
    ds_read_b64_tr_b16 v[36:37], v19 offset:32768
    ds_read_b64_tr_b16 v[38:39], v19 offset:36864
    s_waitcnt lgkmcnt(12)
    v_mfma_f32_16x16x32_bf16 v[76:79], v[44:47], v[172:175], v[76:79]
    v_xor_b32 v28, 0x40, v31
    ds_read_b64 v[180:181], v28 offset:0
    v_xor_b32 v29, 0x60, v31
    ds_read_b64 v[182:183], v29 offset:0
    ds_read_b64_tr_b16 v[40:41], v20 offset:32768
    ds_read_b64_tr_b16 v[42:43], v20 offset:36864
    v_mfma_f32_16x16x32_bf16 v[80:83], v[48:51], v[172:175], v[80:83]
    ds_read_b64_tr_b16 v[44:45], v21 offset:32768
    ds_read_b64_tr_b16 v[46:47], v21 offset:36864
    s_waitcnt lgkmcnt(14)
    v_mfma_f32_16x16x32_bf16 v[84:87], v[52:55], v[172:175], v[84:87]
    v_xor_b32 v28, 0x80, v31
    ds_read_b64 v[184:185], v28 offset:0
    v_xor_b32 v29, 0xa0, v31
    ds_read_b64 v[186:187], v29 offset:0
    ds_read_b64_tr_b16 v[48:49], v22 offset:32768
    ds_read_b64_tr_b16 v[50:51], v22 offset:36864
    v_mfma_f32_16x16x32_bf16 v[88:91], v[56:59], v[172:175], v[88:91]
    ds_read_b64_tr_b16 v[52:53], v23 offset:32768
    ds_read_b64_tr_b16 v[54:55], v23 offset:36864
    s_waitcnt lgkmcnt(14)
    v_mfma_f32_16x16x32_bf16 v[92:95], v[60:63], v[172:175], v[92:95]
    v_xor_b32 v28, 0xc0, v31
    ds_read_b64 v[188:189], v28 offset:0
    v_xor_b32 v29, 0xe0, v31
    ds_read_b64 v[190:191], v29 offset:0
    ds_read_b64_tr_b16 v[56:57], v24 offset:32768
    ds_read_b64_tr_b16 v[58:59], v24 offset:36864
    v_mfma_f32_16x16x32_bf16 v[64:67], v[32:35], v[176:179], v[64:67]
    ds_read_b64_tr_b16 v[60:61], v25 offset:32768
    ds_read_b64_tr_b16 v[62:63], v25 offset:36864
    s_waitcnt lgkmcnt(14)
    v_mfma_f32_16x16x32_bf16 v[68:71], v[36:39], v[176:179], v[68:71]
    ds_read_b64_tr_b16 v[32:33], v18 offset:40960
    ds_read_b64_tr_b16 v[34:35], v18 offset:45056
    v_mfma_f32_16x16x32_bf16 v[72:75], v[40:43], v[176:179], v[72:75]
    ds_read_b64_tr_b16 v[36:37], v19 offset:40960
    ds_read_b64_tr_b16 v[38:39], v19 offset:45056
    s_waitcnt lgkmcnt(12)
    v_mfma_f32_16x16x32_bf16 v[76:79], v[44:47], v[176:179], v[76:79]
    ds_read_b64_tr_b16 v[40:41], v20 offset:40960
    ds_read_b64_tr_b16 v[42:43], v20 offset:45056
    v_mfma_f32_16x16x32_bf16 v[80:83], v[48:51], v[176:179], v[80:83]
    ds_read_b64_tr_b16 v[44:45], v21 offset:40960
    ds_read_b64_tr_b16 v[46:47], v21 offset:45056
    s_waitcnt lgkmcnt(10)
    v_mfma_f32_16x16x32_bf16 v[84:87], v[52:55], v[176:179], v[84:87]
    ds_read_b64_tr_b16 v[48:49], v22 offset:40960
    ds_read_b64_tr_b16 v[50:51], v22 offset:45056
    v_mfma_f32_16x16x32_bf16 v[88:91], v[56:59], v[176:179], v[88:91]
    ds_read_b64_tr_b16 v[52:53], v23 offset:40960
    ds_read_b64_tr_b16 v[54:55], v23 offset:45056
    s_waitcnt lgkmcnt(10)
    v_mfma_f32_16x16x32_bf16 v[92:95], v[60:63], v[176:179], v[92:95]
    ds_read_b64_tr_b16 v[56:57], v24 offset:40960
    ds_read_b64_tr_b16 v[58:59], v24 offset:45056
    v_mfma_f32_16x16x32_bf16 v[64:67], v[32:35], v[180:183], v[64:67]
    ds_read_b64_tr_b16 v[60:61], v25 offset:40960
    ds_read_b64_tr_b16 v[62:63], v25 offset:45056
    s_waitcnt lgkmcnt(10)
    v_mfma_f32_16x16x32_bf16 v[68:71], v[36:39], v[180:183], v[68:71]
    s_barrier
    ds_read_b64_tr_b16 v[32:33], v18 offset:49152
    ds_read_b64_tr_b16 v[34:35], v18 offset:53248
    v_mfma_f32_16x16x32_bf16 v[72:75], v[40:43], v[180:183], v[72:75]
    ds_read_b64_tr_b16 v[36:37], v19 offset:49152
    ds_read_b64_tr_b16 v[38:39], v19 offset:53248
    s_waitcnt lgkmcnt(10)
    v_mfma_f32_16x16x32_bf16 v[76:79], v[44:47], v[180:183], v[76:79]
    ds_read_b64_tr_b16 v[40:41], v20 offset:49152
    ds_read_b64_tr_b16 v[42:43], v20 offset:53248
    v_mfma_f32_16x16x32_bf16 v[80:83], v[48:51], v[180:183], v[80:83]
    ds_read_b64_tr_b16 v[44:45], v21 offset:49152
    ds_read_b64_tr_b16 v[46:47], v21 offset:53248
    s_waitcnt lgkmcnt(10)
    v_mfma_f32_16x16x32_bf16 v[84:87], v[52:55], v[180:183], v[84:87]
    ds_read_b64_tr_b16 v[48:49], v22 offset:49152
    ds_read_b64_tr_b16 v[50:51], v22 offset:53248
    v_mfma_f32_16x16x32_bf16 v[88:91], v[56:59], v[180:183], v[88:91]
    ds_read_b64_tr_b16 v[52:53], v23 offset:49152
    ds_read_b64_tr_b16 v[54:55], v23 offset:53248
    s_waitcnt lgkmcnt(10)
    v_mfma_f32_16x16x32_bf16 v[92:95], v[60:63], v[180:183], v[92:95]
    ds_read_b64_tr_b16 v[56:57], v24 offset:49152
    ds_read_b64_tr_b16 v[58:59], v24 offset:53248
    v_mfma_f32_16x16x32_bf16 v[64:67], v[32:35], v[184:187], v[64:67]
    ds_read_b64_tr_b16 v[60:61], v25 offset:49152
    ds_read_b64_tr_b16 v[62:63], v25 offset:53248
    s_waitcnt lgkmcnt(10)
    v_mfma_f32_16x16x32_bf16 v[68:71], v[36:39], v[184:187], v[68:71]
    ds_read_b64_tr_b16 v[32:33], v18 offset:57344
    ds_read_b64_tr_b16 v[34:35], v18 offset:61440
    v_mfma_f32_16x16x32_bf16 v[72:75], v[40:43], v[184:187], v[72:75]
    ds_read_b64_tr_b16 v[36:37], v19 offset:57344
    ds_read_b64_tr_b16 v[38:39], v19 offset:61440
    s_waitcnt lgkmcnt(10)
    v_mfma_f32_16x16x32_bf16 v[76:79], v[44:47], v[184:187], v[76:79]
    ds_read_b64_tr_b16 v[40:41], v20 offset:57344
    ds_read_b64_tr_b16 v[42:43], v20 offset:61440
    v_mfma_f32_16x16x32_bf16 v[80:83], v[48:51], v[184:187], v[80:83]
    ds_read_b64_tr_b16 v[44:45], v21 offset:57344
    ds_read_b64_tr_b16 v[46:47], v21 offset:61440
    s_waitcnt lgkmcnt(10)
    v_mfma_f32_16x16x32_bf16 v[84:87], v[52:55], v[184:187], v[84:87]
    ds_read_b64_tr_b16 v[48:49], v22 offset:57344
    ds_read_b64_tr_b16 v[50:51], v22 offset:61440
    v_mfma_f32_16x16x32_bf16 v[88:91], v[56:59], v[184:187], v[88:91]
    ds_read_b64_tr_b16 v[52:53], v23 offset:57344
    ds_read_b64_tr_b16 v[54:55], v23 offset:61440
    s_waitcnt lgkmcnt(10)
    v_mfma_f32_16x16x32_bf16 v[92:95], v[60:63], v[184:187], v[92:95]
    ds_read_b64_tr_b16 v[56:57], v24 offset:57344
    ds_read_b64_tr_b16 v[58:59], v24 offset:61440
    v_mfma_f32_16x16x32_bf16 v[64:67], v[32:35], v[188:191], v[64:67]
    ds_read_b64_tr_b16 v[60:61], v25 offset:57344
    ds_read_b64_tr_b16 v[62:63], v25 offset:61440
    s_waitcnt lgkmcnt(10)
    v_mfma_f32_16x16x32_bf16 v[68:71], v[36:39], v[188:191], v[68:71]
    v_mfma_f32_16x16x32_bf16 v[72:75], v[40:43], v[188:191], v[72:75]
    s_waitcnt lgkmcnt(6)
    v_mfma_f32_16x16x32_bf16 v[76:79], v[44:47], v[188:191], v[76:79]
    v_mfma_f32_16x16x32_bf16 v[80:83], v[48:51], v[188:191], v[80:83]
    s_waitcnt lgkmcnt(2)
    v_mfma_f32_16x16x32_bf16 v[84:87], v[52:55], v[188:191], v[84:87]
    v_mfma_f32_16x16x32_bf16 v[88:91], v[56:59], v[188:191], v[88:91]
    s_waitcnt lgkmcnt(0)
    v_mfma_f32_16x16x32_bf16 v[92:95], v[60:63], v[188:191], v[92:95]
    s_nop 3
    s_add_u32 m0, s79, 81920
    s_nop 0
    buffer_load_dwordx4 v10, s[48:51], s78 offen offset:0  lds
    v_pk_mul_f32 v[64:65], s[92:93], v[64:65]
    v_pk_mul_f32 v[66:67], s[92:93], v[66:67]
    v_cvt_pk_bf16_f32 v32, v64, v65
    v_cvt_pk_bf16_f32 v33, v66, v67
    ds_write_b64 v27, v[32:33] offset:0
    v_pk_mul_f32 v[68:69], s[92:93], v[68:69]
    v_pk_mul_f32 v[70:71], s[92:93], v[70:71]
    v_cvt_pk_bf16_f32 v34, v68, v69
    v_cvt_pk_bf16_f32 v35, v70, v71
    ds_write_b64 v27, v[34:35] offset:512
    buffer_load_dwordx4 v11, s[48:51], s78 offen offset:1024  lds
    v_pk_mul_f32 v[72:73], s[92:93], v[72:73]
    v_pk_mul_f32 v[74:75], s[92:93], v[74:75]
    v_cvt_pk_bf16_f32 v36, v72, v73
    v_cvt_pk_bf16_f32 v37, v74, v75
    ds_write_b64 v27, v[36:37] offset:1024
    v_pk_mul_f32 v[76:77], s[92:93], v[76:77]
    v_pk_mul_f32 v[78:79], s[92:93], v[78:79]
    v_cvt_pk_bf16_f32 v38, v76, v77
    v_cvt_pk_bf16_f32 v39, v78, v79
    ds_write_b64 v27, v[38:39] offset:1536
    s_add_u32 m0, s79, 32768
    s_nop 0
    buffer_load_dwordx4 v4, s[40:43], s77 offen offset:0 nt lds
    v_pk_mul_f32 v[80:81], s[92:93], v[80:81]
    v_pk_mul_f32 v[82:83], s[92:93], v[82:83]
    v_cvt_pk_bf16_f32 v40, v80, v81
    v_cvt_pk_bf16_f32 v41, v82, v83
    ds_write_b64 v27, v[40:41] offset:2048
    v_pk_mul_f32 v[84:85], s[92:93], v[84:85]
    v_pk_mul_f32 v[86:87], s[92:93], v[86:87]
    v_cvt_pk_bf16_f32 v42, v84, v85
    v_cvt_pk_bf16_f32 v43, v86, v87
    ds_write_b64 v27, v[42:43] offset:2560
    buffer_load_dwordx4 v5, s[40:43], s77 offen offset:1024 nt lds
    v_pk_mul_f32 v[88:89], s[92:93], v[88:89]
    v_pk_mul_f32 v[90:91], s[92:93], v[90:91]
    v_cvt_pk_bf16_f32 v44, v88, v89
    v_cvt_pk_bf16_f32 v45, v90, v91
    ds_write_b64 v27, v[44:45] offset:3072
    v_pk_mul_f32 v[92:93], s[92:93], v[92:93]
    v_pk_mul_f32 v[94:95], s[92:93], v[94:95]
    v_cvt_pk_bf16_f32 v46, v92, v93
    v_cvt_pk_bf16_f32 v47, v94, v95
    ds_write_b64 v27, v[46:47] offset:3584
    s_waitcnt lgkmcnt(0)
    s_waitcnt vmcnt(4)
    s_barrier
    s_waitcnt vmcnt(7)
    buffer_load_dwordx4 v6, s[40:43], s77 offen offset:2048 nt lds
    s_waitcnt vmcnt(7)
    buffer_load_dwordx4 v7, s[40:43], s77 offen offset:3072 nt lds
    s_add_u32 m0, s79, 81920
    s_waitcnt vmcnt(7)
    buffer_load_dwordx4 v12, s[48:51], s78 offen offset:2048  lds
    ds_read_b64_tr_b16 v[32:33], v18 offset:0
    ds_read_b64_tr_b16 v[34:35], v18 offset:4096
    ds_read_b64_tr_b16 v[36:37], v19 offset:0
    ds_read_b64_tr_b16 v[38:39], v19 offset:4096
    ds_read_b64_tr_b16 v[40:41], v20 offset:0
    ds_read_b64_tr_b16 v[42:43], v20 offset:4096
    ds_read_b64_tr_b16 v[44:45], v21 offset:0
    ds_read_b64_tr_b16 v[46:47], v21 offset:4096
    ds_read_b64_tr_b16 v[48:49], v22 offset:0
    ds_read_b64_tr_b16 v[50:51], v22 offset:4096
    ds_read_b64_tr_b16 v[52:53], v23 offset:0
    ds_read_b64_tr_b16 v[54:55], v23 offset:4096
    ds_read_b64_tr_b16 v[56:57], v24 offset:0
    ds_read_b64_tr_b16 v[58:59], v24 offset:4096
    s_waitcnt lgkmcnt(12)
    v_mfma_f32_16x16x32_bf16 v[64:67], v[32:35], v[128:131], 0
    ds_read_b64_tr_b16 v[60:61], v25 offset:0
    ds_read_b64_tr_b16 v[62:63], v25 offset:4096
    s_waitcnt lgkmcnt(10)
    v_mfma_f32_16x16x32_bf16 v[68:71], v[36:39], v[128:131], 0
    ds_read_b64_tr_b16 v[32:33], v18 offset:8192
    ds_read_b64_tr_b16 v[34:35], v18 offset:12288
    s_waitcnt vmcnt(7)
    buffer_load_dwordx4 v13, s[48:51], s78 offen offset:3072  lds
    s_xor_b32 s78, s95, 1048832
    v_mfma_f32_16x16x32_bf16 v[72:75], v[40:43], v[128:131], 0
    ds_read_b64_tr_b16 v[36:37], v19 offset:8192
    ds_read_b64_tr_b16 v[38:39], v19 offset:12288
    s_waitcnt lgkmcnt(10)
    v_mfma_f32_16x16x32_bf16 v[76:79], v[44:47], v[128:131], 0
    ds_read_b64_tr_b16 v[40:41], v20 offset:8192
    ds_read_b64_tr_b16 v[42:43], v20 offset:12288
    v_mfma_f32_16x16x32_bf16 v[80:83], v[48:51], v[128:131], 0
    ds_read_b64_tr_b16 v[44:45], v21 offset:8192
    ds_read_b64_tr_b16 v[46:47], v21 offset:12288
    s_add_u32 m0, s79, 49152
    s_waitcnt vmcnt(7)
    buffer_load_dwordx4 v8, s[44:47], s77 offen offset:0 nt lds
    s_waitcnt lgkmcnt(10)
    v_mfma_f32_16x16x32_bf16 v[84:87], v[52:55], v[128:131], 0
    ds_read_b64_tr_b16 v[48:49], v22 offset:8192
    ds_read_b64_tr_b16 v[50:51], v22 offset:12288
    v_mfma_f32_16x16x32_bf16 v[88:91], v[56:59], v[128:131], 0
    ds_read_b64_tr_b16 v[52:53], v23 offset:8192
    ds_read_b64_tr_b16 v[54:55], v23 offset:12288
    s_waitcnt lgkmcnt(10)
    v_mfma_f32_16x16x32_bf16 v[92:95], v[60:63], v[128:131], 0
    ds_read_b64_tr_b16 v[56:57], v24 offset:8192
    ds_read_b64_tr_b16 v[58:59], v24 offset:12288
    s_waitcnt vmcnt(7)
    buffer_load_dwordx4 v9, s[44:47], s77 offen offset:1024 nt lds
    v_mfma_f32_16x16x32_bf16 v[64:67], v[32:35], v[132:135], v[64:67]
    ds_read_b64_tr_b16 v[60:61], v25 offset:8192
    ds_read_b64_tr_b16 v[62:63], v25 offset:12288
    s_waitcnt lgkmcnt(10)
    v_mfma_f32_16x16x32_bf16 v[68:71], v[36:39], v[132:135], v[68:71]
    s_waitcnt vmcnt(7)
    buffer_load_dwordx4 v8, s[44:47], s77 offen offset:2048 nt lds
    v_mfma_f32_16x16x32_bf16 v[72:75], v[40:43], v[132:135], v[72:75]
    s_waitcnt lgkmcnt(6)
    v_mfma_f32_16x16x32_bf16 v[76:79], v[44:47], v[132:135], v[76:79]
    v_mfma_f32_16x16x32_bf16 v[80:83], v[48:51], v[132:135], v[80:83]
    s_waitcnt vmcnt(7)
    buffer_load_dwordx4 v9, s[44:47], s77 offen offset:3072 nt lds
    s_xor_b32 s77, s3, 32768
    s_waitcnt lgkmcnt(2)
    v_mfma_f32_16x16x32_bf16 v[84:87], v[52:55], v[132:135], v[84:87]
    v_mfma_f32_16x16x32_bf16 v[88:91], v[56:59], v[132:135], v[88:91]
    s_waitcnt lgkmcnt(0)
    v_mfma_f32_16x16x32_bf16 v[92:95], v[60:63], v[132:135], v[92:95]
    s_add_u32 m0, s79, 98304
    s_waitcnt vmcnt(7)
    buffer_load_dwordx4 v10, s[48:51], s78 offen offset:0  lds
    s_waitcnt vmcnt(13)
    s_barrier
    s_waitcnt vmcnt(7)
    buffer_load_dwordx4 v11, s[48:51], s78 offen offset:1024  lds
    s_add_u32 m0, s79, 0
    s_waitcnt vmcnt(7)
    buffer_load_dwordx4 v4, s[40:43], s77 offen offset:0 nt lds
    s_waitcnt vmcnt(7)
    buffer_load_dwordx4 v5, s[40:43], s77 offen offset:1024 nt lds
    s_waitcnt vmcnt(7)
    buffer_load_dwordx4 v6, s[40:43], s77 offen offset:2048 nt lds
    s_waitcnt vmcnt(9)
    s_barrier
    s_waitcnt vmcnt(7)
    buffer_load_dwordx4 v7, s[40:43], s77 offen offset:3072 nt lds
    s_add_u32 m0, s79, 98304
    s_waitcnt vmcnt(7)
    buffer_load_dwordx4 v12, s[48:51], s78 offen offset:2048  lds
    s_waitcnt vmcnt(7)
    buffer_load_dwordx4 v13, s[48:51], s78 offen offset:3072  lds
    s_xor_b32 s78, s95, 1573120
    s_add_u32 m0, s79, 16384
    s_waitcnt vmcnt(7)
    buffer_load_dwordx4 v8, s[44:47], s77 offen offset:0 nt lds
    ds_read_b64_tr_b16 v[32:33], v18 offset:16384
    ds_read_b64_tr_b16 v[34:35], v18 offset:20480
    ds_read_b64_tr_b16 v[36:37], v19 offset:16384
    ds_read_b64_tr_b16 v[38:39], v19 offset:20480
    ds_read_b64_tr_b16 v[40:41], v20 offset:16384
    ds_read_b64_tr_b16 v[42:43], v20 offset:20480
    ds_read_b64_tr_b16 v[44:45], v21 offset:16384
    ds_read_b64_tr_b16 v[46:47], v21 offset:20480
    ds_read_b64_tr_b16 v[48:49], v22 offset:16384
    ds_read_b64_tr_b16 v[50:51], v22 offset:20480
    ds_read_b64_tr_b16 v[52:53], v23 offset:16384
    ds_read_b64_tr_b16 v[54:55], v23 offset:20480
    ds_read_b64_tr_b16 v[56:57], v24 offset:16384
    ds_read_b64_tr_b16 v[58:59], v24 offset:20480
    s_waitcnt lgkmcnt(12)
    v_mfma_f32_16x16x32_bf16 v[64:67], v[32:35], v[136:139], v[64:67]
    ds_read_b64_tr_b16 v[60:61], v25 offset:16384
    ds_read_b64_tr_b16 v[62:63], v25 offset:20480
    s_waitcnt lgkmcnt(10)
    v_mfma_f32_16x16x32_bf16 v[68:71], v[36:39], v[136:139], v[68:71]
    ds_read_b64_tr_b16 v[32:33], v18 offset:24576
    ds_read_b64_tr_b16 v[34:35], v18 offset:28672
    v_mfma_f32_16x16x32_bf16 v[72:75], v[40:43], v[136:139], v[72:75]
    ds_read_b64_tr_b16 v[36:37], v19 offset:24576
    ds_read_b64_tr_b16 v[38:39], v19 offset:28672
    s_waitcnt lgkmcnt(10)
    v_mfma_f32_16x16x32_bf16 v[76:79], v[44:47], v[136:139], v[76:79]
    ds_read_b64_tr_b16 v[40:41], v20 offset:24576
    ds_read_b64_tr_b16 v[42:43], v20 offset:28672
    s_waitcnt vmcnt(7)
    buffer_load_dwordx4 v9, s[44:47], s77 offen offset:1024 nt lds
    v_mfma_f32_16x16x32_bf16 v[80:83], v[48:51], v[136:139], v[80:83]
    ds_read_b64_tr_b16 v[44:45], v21 offset:24576
    ds_read_b64_tr_b16 v[46:47], v21 offset:28672
    s_waitcnt lgkmcnt(10)
    v_mfma_f32_16x16x32_bf16 v[84:87], v[52:55], v[136:139], v[84:87]
    ds_read_b64_tr_b16 v[48:49], v22 offset:24576
    ds_read_b64_tr_b16 v[50:51], v22 offset:28672
    v_mfma_f32_16x16x32_bf16 v[88:91], v[56:59], v[136:139], v[88:91]
    ds_read_b64_tr_b16 v[52:53], v23 offset:24576
    ds_read_b64_tr_b16 v[54:55], v23 offset:28672
    s_waitcnt lgkmcnt(10)
    v_mfma_f32_16x16x32_bf16 v[92:95], v[60:63], v[136:139], v[92:95]
    ds_read_b64_tr_b16 v[56:57], v24 offset:24576
    ds_read_b64_tr_b16 v[58:59], v24 offset:28672
    s_waitcnt vmcnt(7)
    buffer_load_dwordx4 v8, s[44:47], s77 offen offset:2048 nt lds
    v_mfma_f32_16x16x32_bf16 v[64:67], v[32:35], v[140:143], v[64:67]
    ds_read_b64_tr_b16 v[60:61], v25 offset:24576
    ds_read_b64_tr_b16 v[62:63], v25 offset:28672
    s_waitcnt lgkmcnt(10)
    v_mfma_f32_16x16x32_bf16 v[68:71], v[36:39], v[140:143], v[68:71]
    v_mfma_f32_16x16x32_bf16 v[72:75], v[40:43], v[140:143], v[72:75]
    s_waitcnt lgkmcnt(6)
    v_mfma_f32_16x16x32_bf16 v[76:79], v[44:47], v[140:143], v[76:79]
    s_waitcnt vmcnt(7)
    buffer_load_dwordx4 v9, s[44:47], s77 offen offset:3072 nt lds
    s_xor_b32 s77, s3, 49152
    v_mfma_f32_16x16x32_bf16 v[80:83], v[48:51], v[140:143], v[80:83]
    s_waitcnt lgkmcnt(2)
    v_mfma_f32_16x16x32_bf16 v[84:87], v[52:55], v[140:143], v[84:87]
    v_mfma_f32_16x16x32_bf16 v[88:91], v[56:59], v[140:143], v[88:91]
    s_waitcnt lgkmcnt(0)
    v_mfma_f32_16x16x32_bf16 v[92:95], v[60:63], v[140:143], v[92:95]
    s_add_u32 m0, s79, 114688
    s_waitcnt vmcnt(7)
    buffer_load_dwordx4 v10, s[48:51], s78 offen offset:0  lds
    s_waitcnt vmcnt(13)
    s_barrier
    s_waitcnt vmcnt(7)
    buffer_load_dwordx4 v11, s[48:51], s78 offen offset:1024  lds
    s_add_u32 m0, s79, 32768
    s_waitcnt vmcnt(7)
    buffer_load_dwordx4 v4, s[40:43], s77 offen offset:0 nt lds
    s_waitcnt vmcnt(7)
    buffer_load_dwordx4 v5, s[40:43], s77 offen offset:1024 nt lds
    s_waitcnt vmcnt(7)
    buffer_load_dwordx4 v6, s[40:43], s77 offen offset:2048 nt lds
    s_waitcnt vmcnt(9)
    s_barrier
    s_waitcnt vmcnt(7)
    buffer_load_dwordx4 v7, s[40:43], s77 offen offset:3072 nt lds
    s_add_u32 m0, s79, 114688
    s_waitcnt vmcnt(7)
    buffer_load_dwordx4 v12, s[48:51], s78 offen offset:2048  lds
    s_waitcnt vmcnt(7)
    buffer_load_dwordx4 v13, s[48:51], s78 offen offset:3072  lds
    s_xor_b32 s78, s95, 2097408
    s_add_u32 m0, s79, 49152
    s_waitcnt vmcnt(7)
    buffer_load_dwordx4 v8, s[44:47], s77 offen offset:0 nt lds
    ds_read_b64_tr_b16 v[32:33], v18 offset:32768
    ds_read_b64_tr_b16 v[34:35], v18 offset:36864
    ds_read_b64_tr_b16 v[36:37], v19 offset:32768
    ds_read_b64_tr_b16 v[38:39], v19 offset:36864
    ds_read_b64_tr_b16 v[40:41], v20 offset:32768
    ds_read_b64_tr_b16 v[42:43], v20 offset:36864
    ds_read_b64_tr_b16 v[44:45], v21 offset:32768
    ds_read_b64_tr_b16 v[46:47], v21 offset:36864
    ds_read_b64_tr_b16 v[48:49], v22 offset:32768
    ds_read_b64_tr_b16 v[50:51], v22 offset:36864
    ds_read_b64_tr_b16 v[52:53], v23 offset:32768
    ds_read_b64_tr_b16 v[54:55], v23 offset:36864
    ds_read_b64_tr_b16 v[56:57], v24 offset:32768
    ds_read_b64_tr_b16 v[58:59], v24 offset:36864
    s_waitcnt lgkmcnt(12)
    v_mfma_f32_16x16x32_bf16 v[64:67], v[32:35], v[144:147], v[64:67]
    ds_read_b64_tr_b16 v[60:61], v25 offset:32768
    ds_read_b64_tr_b16 v[62:63], v25 offset:36864
    s_waitcnt lgkmcnt(10)
    v_mfma_f32_16x16x32_bf16 v[68:71], v[36:39], v[144:147], v[68:71]
    ds_read_b64_tr_b16 v[32:33], v18 offset:40960
    ds_read_b64_tr_b16 v[34:35], v18 offset:45056
    v_mfma_f32_16x16x32_bf16 v[72:75], v[40:43], v[144:147], v[72:75]
    ds_read_b64_tr_b16 v[36:37], v19 offset:40960
    ds_read_b64_tr_b16 v[38:39], v19 offset:45056
    s_waitcnt lgkmcnt(10)
    v_mfma_f32_16x16x32_bf16 v[76:79], v[44:47], v[144:147], v[76:79]
    ds_read_b64_tr_b16 v[40:41], v20 offset:40960
    ds_read_b64_tr_b16 v[42:43], v20 offset:45056
    s_waitcnt vmcnt(7)
    buffer_load_dwordx4 v9, s[44:47], s77 offen offset:1024 nt lds
    v_mfma_f32_16x16x32_bf16 v[80:83], v[48:51], v[144:147], v[80:83]
    ds_read_b64_tr_b16 v[44:45], v21 offset:40960
    ds_read_b64_tr_b16 v[46:47], v21 offset:45056
    s_waitcnt lgkmcnt(10)
    v_mfma_f32_16x16x32_bf16 v[84:87], v[52:55], v[144:147], v[84:87]
    ds_read_b64_tr_b16 v[48:49], v22 offset:40960
    ds_read_b64_tr_b16 v[50:51], v22 offset:45056
    v_mfma_f32_16x16x32_bf16 v[88:91], v[56:59], v[144:147], v[88:91]
    ds_read_b64_tr_b16 v[52:53], v23 offset:40960
    ds_read_b64_tr_b16 v[54:55], v23 offset:45056
    s_waitcnt lgkmcnt(10)
    v_mfma_f32_16x16x32_bf16 v[92:95], v[60:63], v[144:147], v[92:95]
    ds_read_b64_tr_b16 v[56:57], v24 offset:40960
    ds_read_b64_tr_b16 v[58:59], v24 offset:45056
    s_waitcnt vmcnt(7)
    buffer_load_dwordx4 v8, s[44:47], s77 offen offset:2048 nt lds
    v_mfma_f32_16x16x32_bf16 v[64:67], v[32:35], v[148:151], v[64:67]
    ds_read_b64_tr_b16 v[60:61], v25 offset:40960
    ds_read_b64_tr_b16 v[62:63], v25 offset:45056
    s_waitcnt lgkmcnt(10)
    v_mfma_f32_16x16x32_bf16 v[68:71], v[36:39], v[148:151], v[68:71]
    v_mfma_f32_16x16x32_bf16 v[72:75], v[40:43], v[148:151], v[72:75]
    s_waitcnt lgkmcnt(6)
    v_mfma_f32_16x16x32_bf16 v[76:79], v[44:47], v[148:151], v[76:79]
    s_waitcnt vmcnt(7)
    buffer_load_dwordx4 v9, s[44:47], s77 offen offset:3072 nt lds
    s_xor_b32 s77, s3, 65536
    v_mfma_f32_16x16x32_bf16 v[80:83], v[48:51], v[148:151], v[80:83]
    s_waitcnt lgkmcnt(2)
    v_mfma_f32_16x16x32_bf16 v[84:87], v[52:55], v[148:151], v[84:87]
    v_mfma_f32_16x16x32_bf16 v[88:91], v[56:59], v[148:151], v[88:91]
    s_waitcnt lgkmcnt(0)
    v_mfma_f32_16x16x32_bf16 v[92:95], v[60:63], v[148:151], v[92:95]
    s_add_u32 m0, s79, 65536
    s_waitcnt vmcnt(7)
    buffer_load_dwordx4 v10, s[48:51], s78 offen offset:0  lds
    s_waitcnt vmcnt(13)
    s_barrier
    s_waitcnt vmcnt(7)
    buffer_load_dwordx4 v11, s[48:51], s78 offen offset:1024  lds
    s_add_u32 m0, s79, 0
    s_waitcnt vmcnt(7)
    buffer_load_dwordx4 v4, s[40:43], s77 offen offset:0 nt lds
    s_waitcnt vmcnt(7)
    buffer_load_dwordx4 v5, s[40:43], s77 offen offset:1024 nt lds
    s_waitcnt vmcnt(7)
    buffer_load_dwordx4 v6, s[40:43], s77 offen offset:2048 nt lds
    s_waitcnt vmcnt(9)
    s_barrier
    s_waitcnt vmcnt(7)
    buffer_load_dwordx4 v7, s[40:43], s77 offen offset:3072 nt lds
    s_add_u32 m0, s79, 65536
    s_waitcnt vmcnt(7)
    buffer_load_dwordx4 v12, s[48:51], s78 offen offset:2048  lds
    s_waitcnt vmcnt(7)
    buffer_load_dwordx4 v13, s[48:51], s78 offen offset:3072  lds
    s_xor_b32 s78, s95, 2621696
    s_add_u32 m0, s79, 16384
    s_waitcnt vmcnt(7)
    buffer_load_dwordx4 v8, s[44:47], s77 offen offset:0 nt lds
    ds_read_b64_tr_b16 v[32:33], v18 offset:49152
    ds_read_b64_tr_b16 v[34:35], v18 offset:53248
    ds_read_b64_tr_b16 v[36:37], v19 offset:49152
    ds_read_b64_tr_b16 v[38:39], v19 offset:53248
    ds_read_b64_tr_b16 v[40:41], v20 offset:49152
    ds_read_b64_tr_b16 v[42:43], v20 offset:53248
    ds_read_b64_tr_b16 v[44:45], v21 offset:49152
    ds_read_b64_tr_b16 v[46:47], v21 offset:53248
    ds_read_b64_tr_b16 v[48:49], v22 offset:49152
    ds_read_b64_tr_b16 v[50:51], v22 offset:53248
    ds_read_b64_tr_b16 v[52:53], v23 offset:49152
    ds_read_b64_tr_b16 v[54:55], v23 offset:53248
    ds_read_b64_tr_b16 v[56:57], v24 offset:49152
    ds_read_b64_tr_b16 v[58:59], v24 offset:53248
    s_waitcnt lgkmcnt(12)
    v_mfma_f32_16x16x32_bf16 v[64:67], v[32:35], v[152:155], v[64:67]
    ds_read_b64_tr_b16 v[60:61], v25 offset:49152
    ds_read_b64_tr_b16 v[62:63], v25 offset:53248
    s_waitcnt lgkmcnt(10)
    v_mfma_f32_16x16x32_bf16 v[68:71], v[36:39], v[152:155], v[68:71]
    ds_read_b64_tr_b16 v[32:33], v18 offset:57344
    ds_read_b64_tr_b16 v[34:35], v18 offset:61440
    v_mfma_f32_16x16x32_bf16 v[72:75], v[40:43], v[152:155], v[72:75]
    ds_read_b64_tr_b16 v[36:37], v19 offset:57344
    ds_read_b64_tr_b16 v[38:39], v19 offset:61440
    s_waitcnt lgkmcnt(10)
    v_mfma_f32_16x16x32_bf16 v[76:79], v[44:47], v[152:155], v[76:79]
    ds_read_b64_tr_b16 v[40:41], v20 offset:57344
    ds_read_b64_tr_b16 v[42:43], v20 offset:61440
    v_mfma_f32_16x16x32_bf16 v[80:83], v[48:51], v[152:155], v[80:83]
    ds_read_b64_tr_b16 v[44:45], v21 offset:57344
    ds_read_b64_tr_b16 v[46:47], v21 offset:61440
    s_waitcnt vmcnt(7)
    buffer_load_dwordx4 v9, s[44:47], s77 offen offset:1024 nt lds
    s_waitcnt lgkmcnt(10)
    v_mfma_f32_16x16x32_bf16 v[84:87], v[52:55], v[152:155], v[84:87]
    ds_read_b64_tr_b16 v[48:49], v22 offset:57344
    ds_read_b64_tr_b16 v[50:51], v22 offset:61440
    v_mfma_f32_16x16x32_bf16 v[88:91], v[56:59], v[152:155], v[88:91]
    ds_read_b64_tr_b16 v[52:53], v23 offset:57344
    ds_read_b64_tr_b16 v[54:55], v23 offset:61440
    s_waitcnt lgkmcnt(10)
    v_mfma_f32_16x16x32_bf16 v[92:95], v[60:63], v[152:155], v[92:95]
    ds_read_b64_tr_b16 v[56:57], v24 offset:57344
    ds_read_b64_tr_b16 v[58:59], v24 offset:61440
    v_mfma_f32_16x16x32_bf16 v[64:67], v[32:35], v[156:159], v[64:67]
    ds_read_b64_tr_b16 v[60:61], v25 offset:57344
    ds_read_b64_tr_b16 v[62:63], v25 offset:61440
    s_waitcnt lgkmcnt(10)
    v_mfma_f32_16x16x32_bf16 v[68:71], v[36:39], v[156:159], v[68:71]
    s_waitcnt vmcnt(7)
    buffer_load_dwordx4 v8, s[44:47], s77 offen offset:2048 nt lds
    v_mfma_f32_16x16x32_bf16 v[72:75], v[40:43], v[156:159], v[72:75]
    s_waitcnt lgkmcnt(6)
    v_mfma_f32_16x16x32_bf16 v[76:79], v[44:47], v[156:159], v[76:79]
    v_mfma_f32_16x16x32_bf16 v[80:83], v[48:51], v[156:159], v[80:83]
    s_waitcnt lgkmcnt(2)
    v_mfma_f32_16x16x32_bf16 v[84:87], v[52:55], v[156:159], v[84:87]
    v_mfma_f32_16x16x32_bf16 v[88:91], v[56:59], v[156:159], v[88:91]
    s_waitcnt lgkmcnt(0)
    v_mfma_f32_16x16x32_bf16 v[92:95], v[60:63], v[156:159], v[92:95]
    s_waitcnt vmcnt(7)
    buffer_load_dwordx4 v9, s[44:47], s77 offen offset:3072 nt lds
    s_xor_b32 s77, s3, 81920
    s_waitcnt vmcnt(12)
    s_barrier
    s_add_u32 m0, s79, 81920
    s_waitcnt vmcnt(7)
    buffer_load_dwordx4 v10, s[48:51], s78 offen offset:0  lds
    s_waitcnt vmcnt(7)
    buffer_load_dwordx4 v11, s[48:51], s78 offen offset:1024  lds
    s_add_u32 m0, s79, 32768
    s_waitcnt vmcnt(7)
    buffer_load_dwordx4 v4, s[40:43], s77 offen offset:0 nt lds
    s_waitcnt vmcnt(7)
    buffer_load_dwordx4 v5, s[40:43], s77 offen offset:1024 nt lds
    s_waitcnt vmcnt(8)
    s_barrier
    s_waitcnt vmcnt(7)
    buffer_load_dwordx4 v6, s[40:43], s77 offen offset:2048 nt lds
    s_waitcnt vmcnt(7)
    buffer_load_dwordx4 v7, s[40:43], s77 offen offset:3072 nt lds
    s_add_u32 m0, s79, 81920
    s_waitcnt vmcnt(7)
    buffer_load_dwordx4 v12, s[48:51], s78 offen offset:2048  lds
    s_waitcnt vmcnt(7)
    buffer_load_dwordx4 v13, s[48:51], s78 offen offset:3072  lds
    s_xor_b32 s78, s95, 3145984
    ds_read_b64_tr_b16 v[32:33], v18 offset:0
    ds_read_b64_tr_b16 v[34:35], v18 offset:4096
    ds_read_b64_tr_b16 v[36:37], v19 offset:0
    ds_read_b64_tr_b16 v[38:39], v19 offset:4096
    ds_read_b64_tr_b16 v[40:41], v20 offset:0
    ds_read_b64_tr_b16 v[42:43], v20 offset:4096
    ds_read_b64_tr_b16 v[44:45], v21 offset:0
    ds_read_b64_tr_b16 v[46:47], v21 offset:4096
    ds_read_b64_tr_b16 v[48:49], v22 offset:0
    ds_read_b64_tr_b16 v[50:51], v22 offset:4096
    ds_read_b64_tr_b16 v[52:53], v23 offset:0
    ds_read_b64_tr_b16 v[54:55], v23 offset:4096
    ds_read_b64_tr_b16 v[56:57], v24 offset:0
    ds_read_b64_tr_b16 v[58:59], v24 offset:4096
    s_waitcnt lgkmcnt(12)
    v_mfma_f32_16x16x32_bf16 v[64:67], v[32:35], v[160:163], v[64:67]
    ds_read_b64_tr_b16 v[60:61], v25 offset:0
    ds_read_b64_tr_b16 v[62:63], v25 offset:4096
    s_waitcnt lgkmcnt(10)
    v_mfma_f32_16x16x32_bf16 v[68:71], v[36:39], v[160:163], v[68:71]
    ds_read_b64_tr_b16 v[32:33], v18 offset:8192
    ds_read_b64_tr_b16 v[34:35], v18 offset:12288
    v_mfma_f32_16x16x32_bf16 v[72:75], v[40:43], v[160:163], v[72:75]
    ds_read_b64_tr_b16 v[36:37], v19 offset:8192
    ds_read_b64_tr_b16 v[38:39], v19 offset:12288
    s_waitcnt lgkmcnt(10)
    v_mfma_f32_16x16x32_bf16 v[76:79], v[44:47], v[160:163], v[76:79]
    ds_read_b64_tr_b16 v[40:41], v20 offset:8192
    ds_read_b64_tr_b16 v[42:43], v20 offset:12288
    s_add_u32 m0, s79, 49152
    s_waitcnt vmcnt(7)
    buffer_load_dwordx4 v8, s[44:47], s77 offen offset:0 nt lds
    v_mfma_f32_16x16x32_bf16 v[80:83], v[48:51], v[160:163], v[80:83]
    ds_read_b64_tr_b16 v[44:45], v21 offset:8192
    ds_read_b64_tr_b16 v[46:47], v21 offset:12288
    s_waitcnt lgkmcnt(10)
    v_mfma_f32_16x16x32_bf16 v[84:87], v[52:55], v[160:163], v[84:87]
    ds_read_b64_tr_b16 v[48:49], v22 offset:8192
    ds_read_b64_tr_b16 v[50:51], v22 offset:12288
    v_mfma_f32_16x16x32_bf16 v[88:91], v[56:59], v[160:163], v[88:91]
    ds_read_b64_tr_b16 v[52:53], v23 offset:8192
    ds_read_b64_tr_b16 v[54:55], v23 offset:12288
    s_waitcnt lgkmcnt(10)
    v_mfma_f32_16x16x32_bf16 v[92:95], v[60:63], v[160:163], v[92:95]
    ds_read_b64_tr_b16 v[56:57], v24 offset:8192
    ds_read_b64_tr_b16 v[58:59], v24 offset:12288
    s_waitcnt vmcnt(7)
    buffer_load_dwordx4 v9, s[44:47], s77 offen offset:1024 nt lds
    v_mfma_f32_16x16x32_bf16 v[64:67], v[32:35], v[164:167], v[64:67]
    ds_read_b64_tr_b16 v[60:61], v25 offset:8192
    ds_read_b64_tr_b16 v[62:63], v25 offset:12288
    s_waitcnt lgkmcnt(10)
    v_mfma_f32_16x16x32_bf16 v[68:71], v[36:39], v[164:167], v[68:71]
    v_mfma_f32_16x16x32_bf16 v[72:75], v[40:43], v[164:167], v[72:75]
    s_waitcnt lgkmcnt(6)
    v_mfma_f32_16x16x32_bf16 v[76:79], v[44:47], v[164:167], v[76:79]
    s_waitcnt vmcnt(7)
    buffer_load_dwordx4 v8, s[44:47], s77 offen offset:2048 nt lds
    v_mfma_f32_16x16x32_bf16 v[80:83], v[48:51], v[164:167], v[80:83]
    s_waitcnt lgkmcnt(2)
    v_mfma_f32_16x16x32_bf16 v[84:87], v[52:55], v[164:167], v[84:87]
    v_mfma_f32_16x16x32_bf16 v[88:91], v[56:59], v[164:167], v[88:91]
    s_waitcnt lgkmcnt(0)
    v_mfma_f32_16x16x32_bf16 v[92:95], v[60:63], v[164:167], v[92:95]
    s_waitcnt vmcnt(7)
    buffer_load_dwordx4 v9, s[44:47], s77 offen offset:3072 nt lds
    s_xor_b32 s77, s3, 98304
    s_waitcnt vmcnt(12)
    s_barrier
    s_add_u32 m0, s79, 98304
    s_waitcnt vmcnt(7)
    buffer_load_dwordx4 v10, s[48:51], s78 offen offset:0  lds
    s_waitcnt vmcnt(7)
    buffer_load_dwordx4 v11, s[48:51], s78 offen offset:1024  lds
    s_add_u32 m0, s79, 0
    s_waitcnt vmcnt(7)
    buffer_load_dwordx4 v4, s[40:43], s77 offen offset:0 nt lds
    s_waitcnt vmcnt(7)
    buffer_load_dwordx4 v5, s[40:43], s77 offen offset:1024 nt lds
    s_waitcnt vmcnt(8)
    s_barrier
    s_waitcnt vmcnt(7)
    buffer_load_dwordx4 v6, s[40:43], s77 offen offset:2048 nt lds
    s_waitcnt vmcnt(7)
    buffer_load_dwordx4 v7, s[40:43], s77 offen offset:3072 nt lds
    s_add_u32 m0, s79, 98304
    s_waitcnt vmcnt(7)
    buffer_load_dwordx4 v12, s[48:51], s78 offen offset:2048  lds
    s_waitcnt vmcnt(7)
    buffer_load_dwordx4 v13, s[48:51], s78 offen offset:3072  lds
    s_xor_b32 s78, s95, 3670272
    ds_read_b64_tr_b16 v[32:33], v18 offset:16384
    ds_read_b64_tr_b16 v[34:35], v18 offset:20480
    ds_read_b64_tr_b16 v[36:37], v19 offset:16384
    ds_read_b64_tr_b16 v[38:39], v19 offset:20480
    ds_read_b64_tr_b16 v[40:41], v20 offset:16384
    ds_read_b64_tr_b16 v[42:43], v20 offset:20480
    ds_read_b64_tr_b16 v[44:45], v21 offset:16384
    ds_read_b64_tr_b16 v[46:47], v21 offset:20480
    ds_read_b64_tr_b16 v[48:49], v22 offset:16384
    ds_read_b64_tr_b16 v[50:51], v22 offset:20480
    ds_read_b64_tr_b16 v[52:53], v23 offset:16384
    ds_read_b64_tr_b16 v[54:55], v23 offset:20480
    ds_read_b64_tr_b16 v[56:57], v24 offset:16384
    ds_read_b64_tr_b16 v[58:59], v24 offset:20480
    s_waitcnt lgkmcnt(12)
    v_mfma_f32_16x16x32_bf16 v[64:67], v[32:35], v[168:171], v[64:67]
    ds_read_b64_tr_b16 v[60:61], v25 offset:16384
    ds_read_b64_tr_b16 v[62:63], v25 offset:20480
    s_waitcnt lgkmcnt(10)
    v_mfma_f32_16x16x32_bf16 v[68:71], v[36:39], v[168:171], v[68:71]
    ds_read_b64_tr_b16 v[32:33], v18 offset:24576
    ds_read_b64_tr_b16 v[34:35], v18 offset:28672
    v_mfma_f32_16x16x32_bf16 v[72:75], v[40:43], v[168:171], v[72:75]
    ds_read_b64_tr_b16 v[36:37], v19 offset:24576
    ds_read_b64_tr_b16 v[38:39], v19 offset:28672
    s_waitcnt lgkmcnt(10)
    v_mfma_f32_16x16x32_bf16 v[76:79], v[44:47], v[168:171], v[76:79]
    ds_read_b64_tr_b16 v[40:41], v20 offset:24576
    ds_read_b64_tr_b16 v[42:43], v20 offset:28672
    s_add_u32 m0, s79, 16384
    s_waitcnt vmcnt(7)
    buffer_load_dwordx4 v8, s[44:47], s77 offen offset:0 nt lds
    v_mfma_f32_16x16x32_bf16 v[80:83], v[48:51], v[168:171], v[80:83]
    ds_read_b64_tr_b16 v[44:45], v21 offset:24576
    ds_read_b64_tr_b16 v[46:47], v21 offset:28672
    s_waitcnt lgkmcnt(10)
    v_mfma_f32_16x16x32_bf16 v[84:87], v[52:55], v[168:171], v[84:87]
    ds_read_b64_tr_b16 v[48:49], v22 offset:24576
    ds_read_b64_tr_b16 v[50:51], v22 offset:28672
    v_mfma_f32_16x16x32_bf16 v[88:91], v[56:59], v[168:171], v[88:91]
    ds_read_b64_tr_b16 v[52:53], v23 offset:24576
    ds_read_b64_tr_b16 v[54:55], v23 offset:28672
    s_waitcnt lgkmcnt(10)
    v_mfma_f32_16x16x32_bf16 v[92:95], v[60:63], v[168:171], v[92:95]
    ds_read_b64_tr_b16 v[56:57], v24 offset:24576
    ds_read_b64_tr_b16 v[58:59], v24 offset:28672
    s_waitcnt vmcnt(7)
    buffer_load_dwordx4 v9, s[44:47], s77 offen offset:1024 nt lds
    v_mfma_f32_16x16x32_bf16 v[64:67], v[32:35], v[172:175], v[64:67]
    ds_read_b64_tr_b16 v[60:61], v25 offset:24576
    ds_read_b64_tr_b16 v[62:63], v25 offset:28672
    s_waitcnt lgkmcnt(10)
    v_mfma_f32_16x16x32_bf16 v[68:71], v[36:39], v[172:175], v[68:71]
    v_mfma_f32_16x16x32_bf16 v[72:75], v[40:43], v[172:175], v[72:75]
    s_waitcnt lgkmcnt(6)
    v_mfma_f32_16x16x32_bf16 v[76:79], v[44:47], v[172:175], v[76:79]
    s_waitcnt vmcnt(7)
    buffer_load_dwordx4 v8, s[44:47], s77 offen offset:2048 nt lds
    v_mfma_f32_16x16x32_bf16 v[80:83], v[48:51], v[172:175], v[80:83]
    s_waitcnt lgkmcnt(2)
    v_mfma_f32_16x16x32_bf16 v[84:87], v[52:55], v[172:175], v[84:87]
    v_mfma_f32_16x16x32_bf16 v[88:91], v[56:59], v[172:175], v[88:91]
    s_waitcnt lgkmcnt(0)
    v_mfma_f32_16x16x32_bf16 v[92:95], v[60:63], v[172:175], v[92:95]
    s_waitcnt vmcnt(7)
    buffer_load_dwordx4 v9, s[44:47], s77 offen offset:3072 nt lds
    s_xor_b32 s77, s3, 114688
    s_waitcnt vmcnt(12)
    s_barrier
    s_add_u32 m0, s79, 114688
    s_waitcnt vmcnt(7)
    buffer_load_dwordx4 v10, s[48:51], s78 offen offset:0  lds
    s_waitcnt vmcnt(7)
    buffer_load_dwordx4 v11, s[48:51], s78 offen offset:1024  lds
    s_add_u32 m0, s79, 32768
    s_waitcnt vmcnt(7)
    buffer_load_dwordx4 v4, s[40:43], s77 offen offset:0 nt lds
    s_waitcnt vmcnt(7)
    buffer_load_dwordx4 v5, s[40:43], s77 offen offset:1024 nt lds
    s_waitcnt vmcnt(8)
    s_barrier
    s_waitcnt vmcnt(7)
    buffer_load_dwordx4 v6, s[40:43], s77 offen offset:2048 nt lds
    s_waitcnt vmcnt(7)
    buffer_load_dwordx4 v7, s[40:43], s77 offen offset:3072 nt lds
    s_add_u32 m0, s79, 114688
    s_waitcnt vmcnt(7)
    buffer_load_dwordx4 v12, s[48:51], s78 offen offset:2048  lds
    s_waitcnt vmcnt(7)
    buffer_load_dwordx4 v13, s[48:51], s78 offen offset:3072  lds
    s_xor_b32 s78, s95, 512
    ds_read_b64_tr_b16 v[32:33], v18 offset:32768
    ds_read_b64_tr_b16 v[34:35], v18 offset:36864
    ds_read_b64_tr_b16 v[36:37], v19 offset:32768
    ds_read_b64_tr_b16 v[38:39], v19 offset:36864
    ds_read_b64_tr_b16 v[40:41], v20 offset:32768
    ds_read_b64_tr_b16 v[42:43], v20 offset:36864
    ds_read_b64_tr_b16 v[44:45], v21 offset:32768
    ds_read_b64_tr_b16 v[46:47], v21 offset:36864
    ds_read_b64_tr_b16 v[48:49], v22 offset:32768
    ds_read_b64_tr_b16 v[50:51], v22 offset:36864
    ds_read_b64_tr_b16 v[52:53], v23 offset:32768
    ds_read_b64_tr_b16 v[54:55], v23 offset:36864
    ds_read_b64_tr_b16 v[56:57], v24 offset:32768
    ds_read_b64_tr_b16 v[58:59], v24 offset:36864
    s_waitcnt lgkmcnt(12)
    v_mfma_f32_16x16x32_bf16 v[64:67], v[32:35], v[176:179], v[64:67]
    ds_read_b64_tr_b16 v[60:61], v25 offset:32768
    ds_read_b64_tr_b16 v[62:63], v25 offset:36864
    s_waitcnt lgkmcnt(10)
    v_mfma_f32_16x16x32_bf16 v[68:71], v[36:39], v[176:179], v[68:71]
    ds_read_b64_tr_b16 v[32:33], v18 offset:40960
    ds_read_b64_tr_b16 v[34:35], v18 offset:45056
    v_mfma_f32_16x16x32_bf16 v[72:75], v[40:43], v[176:179], v[72:75]
    ds_read_b64_tr_b16 v[36:37], v19 offset:40960
    ds_read_b64_tr_b16 v[38:39], v19 offset:45056
    s_waitcnt lgkmcnt(10)
    v_mfma_f32_16x16x32_bf16 v[76:79], v[44:47], v[176:179], v[76:79]
    ds_read_b64_tr_b16 v[40:41], v20 offset:40960
    ds_read_b64_tr_b16 v[42:43], v20 offset:45056
    s_add_u32 m0, s79, 49152
    s_waitcnt vmcnt(7)
    buffer_load_dwordx4 v8, s[44:47], s77 offen offset:0 nt lds
    v_mfma_f32_16x16x32_bf16 v[80:83], v[48:51], v[176:179], v[80:83]
    ds_read_b64_tr_b16 v[44:45], v21 offset:40960
    ds_read_b64_tr_b16 v[46:47], v21 offset:45056
    s_waitcnt lgkmcnt(10)
    v_mfma_f32_16x16x32_bf16 v[84:87], v[52:55], v[176:179], v[84:87]
    ds_read_b64_tr_b16 v[48:49], v22 offset:40960
    ds_read_b64_tr_b16 v[50:51], v22 offset:45056
    v_mfma_f32_16x16x32_bf16 v[88:91], v[56:59], v[176:179], v[88:91]
    ds_read_b64_tr_b16 v[52:53], v23 offset:40960
    ds_read_b64_tr_b16 v[54:55], v23 offset:45056
    s_waitcnt lgkmcnt(10)
    v_mfma_f32_16x16x32_bf16 v[92:95], v[60:63], v[176:179], v[92:95]
    ds_read_b64_tr_b16 v[56:57], v24 offset:40960
    ds_read_b64_tr_b16 v[58:59], v24 offset:45056
    s_waitcnt vmcnt(7)
    buffer_load_dwordx4 v9, s[44:47], s77 offen offset:1024 nt lds
    v_mfma_f32_16x16x32_bf16 v[64:67], v[32:35], v[180:183], v[64:67]
    ds_read_b64_tr_b16 v[60:61], v25 offset:40960
    ds_read_b64_tr_b16 v[62:63], v25 offset:45056
    s_waitcnt lgkmcnt(10)
    v_mfma_f32_16x16x32_bf16 v[68:71], v[36:39], v[180:183], v[68:71]
    v_mfma_f32_16x16x32_bf16 v[72:75], v[40:43], v[180:183], v[72:75]
    s_waitcnt lgkmcnt(6)
    v_mfma_f32_16x16x32_bf16 v[76:79], v[44:47], v[180:183], v[76:79]
    s_waitcnt vmcnt(7)
    buffer_load_dwordx4 v8, s[44:47], s77 offen offset:2048 nt lds
    v_mfma_f32_16x16x32_bf16 v[80:83], v[48:51], v[180:183], v[80:83]
    s_waitcnt lgkmcnt(2)
    v_mfma_f32_16x16x32_bf16 v[84:87], v[52:55], v[180:183], v[84:87]
    v_mfma_f32_16x16x32_bf16 v[88:91], v[56:59], v[180:183], v[88:91]
    s_waitcnt lgkmcnt(0)
    v_mfma_f32_16x16x32_bf16 v[92:95], v[60:63], v[180:183], v[92:95]
    s_waitcnt vmcnt(7)
    buffer_load_dwordx4 v9, s[44:47], s77 offen offset:3072 nt lds
    s_xor_b32 s77, s3, 131072
    s_waitcnt vmcnt(12)
    s_barrier
    s_add_u32 m0, s79, 65536
    s_waitcnt vmcnt(7)
    buffer_load_dwordx4 v10, s[48:51], s78 offen offset:0  lds
    s_waitcnt vmcnt(7)
    buffer_load_dwordx4 v11, s[48:51], s78 offen offset:1024  lds
    s_add_u32 m0, s79, 0
    s_waitcnt vmcnt(7)
    buffer_load_dwordx4 v4, s[40:43], s77 offen offset:0 nt lds
    s_waitcnt vmcnt(7)
    buffer_load_dwordx4 v5, s[40:43], s77 offen offset:1024 nt lds
    s_waitcnt vmcnt(8)
    s_barrier
    s_waitcnt vmcnt(7)
    buffer_load_dwordx4 v6, s[40:43], s77 offen offset:2048 nt lds
    s_waitcnt vmcnt(7)
    buffer_load_dwordx4 v7, s[40:43], s77 offen offset:3072 nt lds
    s_add_u32 m0, s79, 65536
    s_waitcnt vmcnt(7)
    buffer_load_dwordx4 v12, s[48:51], s78 offen offset:2048  lds
    s_waitcnt vmcnt(7)
    buffer_load_dwordx4 v13, s[48:51], s78 offen offset:3072  lds
    s_xor_b32 s78, s95, 524800
    ds_read_b64_tr_b16 v[32:33], v18 offset:49152
    ds_read_b64_tr_b16 v[34:35], v18 offset:53248
    ds_read_b64_tr_b16 v[36:37], v19 offset:49152
    ds_read_b64_tr_b16 v[38:39], v19 offset:53248
    ds_read_b64_tr_b16 v[40:41], v20 offset:49152
    ds_read_b64_tr_b16 v[42:43], v20 offset:53248
    ds_read_b64_tr_b16 v[44:45], v21 offset:49152
    ds_read_b64_tr_b16 v[46:47], v21 offset:53248
    ds_read_b64_tr_b16 v[48:49], v22 offset:49152
    ds_read_b64_tr_b16 v[50:51], v22 offset:53248
    ds_read_b64_tr_b16 v[52:53], v23 offset:49152
    ds_read_b64_tr_b16 v[54:55], v23 offset:53248
    ds_read_b64_tr_b16 v[56:57], v24 offset:49152
    ds_read_b64_tr_b16 v[58:59], v24 offset:53248
    s_waitcnt lgkmcnt(12)
    v_mfma_f32_16x16x32_bf16 v[64:67], v[32:35], v[184:187], v[64:67]
    ds_read_b64_tr_b16 v[60:61], v25 offset:49152
    ds_read_b64_tr_b16 v[62:63], v25 offset:53248
    s_waitcnt lgkmcnt(10)
    v_mfma_f32_16x16x32_bf16 v[68:71], v[36:39], v[184:187], v[68:71]
    ds_read_b64_tr_b16 v[32:33], v18 offset:57344
    ds_read_b64_tr_b16 v[34:35], v18 offset:61440
    v_mfma_f32_16x16x32_bf16 v[72:75], v[40:43], v[184:187], v[72:75]
    ds_read_b64_tr_b16 v[36:37], v19 offset:57344
    ds_read_b64_tr_b16 v[38:39], v19 offset:61440
    s_waitcnt lgkmcnt(10)
    v_mfma_f32_16x16x32_bf16 v[76:79], v[44:47], v[184:187], v[76:79]
    ds_read_b64_tr_b16 v[40:41], v20 offset:57344
    ds_read_b64_tr_b16 v[42:43], v20 offset:61440
    v_mfma_f32_16x16x32_bf16 v[80:83], v[48:51], v[184:187], v[80:83]
    ds_read_b64_tr_b16 v[44:45], v21 offset:57344
    ds_read_b64_tr_b16 v[46:47], v21 offset:61440
    s_waitcnt lgkmcnt(10)
    v_mfma_f32_16x16x32_bf16 v[84:87], v[52:55], v[184:187], v[84:87]
    ds_read_b64_tr_b16 v[48:49], v22 offset:57344
    ds_read_b64_tr_b16 v[50:51], v22 offset:61440
    v_mfma_f32_16x16x32_bf16 v[88:91], v[56:59], v[184:187], v[88:91]
    ds_read_b64_tr_b16 v[52:53], v23 offset:57344
    ds_read_b64_tr_b16 v[54:55], v23 offset:61440
    s_waitcnt lgkmcnt(10)
    v_mfma_f32_16x16x32_bf16 v[92:95], v[60:63], v[184:187], v[92:95]
    ds_read_b64_tr_b16 v[56:57], v24 offset:57344
    ds_read_b64_tr_b16 v[58:59], v24 offset:61440
    s_add_u32 m0, s79, 16384
    s_waitcnt vmcnt(7)
    buffer_load_dwordx4 v8, s[44:47], s77 offen offset:0 nt lds
    v_mfma_f32_16x16x32_bf16 v[64:67], v[32:35], v[188:191], v[64:67]
    ds_read_b64_tr_b16 v[60:61], v25 offset:57344
    ds_read_b64_tr_b16 v[62:63], v25 offset:61440
    s_waitcnt lgkmcnt(10)
    v_mfma_f32_16x16x32_bf16 v[68:71], v[36:39], v[188:191], v[68:71]
    v_mfma_f32_16x16x32_bf16 v[72:75], v[40:43], v[188:191], v[72:75]
    s_waitcnt lgkmcnt(6)
    v_mfma_f32_16x16x32_bf16 v[76:79], v[44:47], v[188:191], v[76:79]
    v_mfma_f32_16x16x32_bf16 v[80:83], v[48:51], v[188:191], v[80:83]
    s_waitcnt lgkmcnt(2)
    v_mfma_f32_16x16x32_bf16 v[84:87], v[52:55], v[188:191], v[84:87]
    v_mfma_f32_16x16x32_bf16 v[88:91], v[56:59], v[188:191], v[88:91]
    s_waitcnt lgkmcnt(0)
    v_mfma_f32_16x16x32_bf16 v[92:95], v[60:63], v[188:191], v[92:95]
    s_waitcnt vmcnt(7)
    buffer_load_dwordx4 v9, s[44:47], s77 offen offset:1024 nt lds
    s_waitcnt vmcnt(10)
    s_barrier
    s_setprio 1
    s_waitcnt vmcnt(7)
    buffer_load_dwordx4 v8, s[44:47], s77 offen offset:2048 nt lds
    v_mul_f32 v64, s92, v64
    v_mul_f32 v65, s92, v65
    v_mul_f32 v66, s92, v66
    v_mul_f32 v67, s92, v67
    v_cvt_pk_bf16_f32 v32, v64, v65
    v_cvt_pk_bf16_f32 v33, v66, v67
    ds_write_b64 v27, v[32:33] offset:0
    v_mul_f32 v68, s92, v68
    v_mul_f32 v69, s92, v69
    v_mul_f32 v70, s92, v70
    v_mul_f32 v71, s92, v71
    v_cvt_pk_bf16_f32 v34, v68, v69
    v_cvt_pk_bf16_f32 v35, v70, v71
    ds_write_b64 v27, v[34:35] offset:512
    s_waitcnt vmcnt(7)
    buffer_load_dwordx4 v9, s[44:47], s77 offen offset:3072 nt lds
    s_xor_b32 s77, s3, 147456
    v_mul_f32 v72, s92, v72
    v_mul_f32 v73, s92, v73
    v_mul_f32 v74, s92, v74
    v_mul_f32 v75, s92, v75
    v_cvt_pk_bf16_f32 v36, v72, v73
    v_cvt_pk_bf16_f32 v37, v74, v75
    ds_write_b64 v27, v[36:37] offset:1024
    v_mul_f32 v76, s92, v76
    v_mul_f32 v77, s92, v77
    v_mul_f32 v78, s92, v78
    v_mul_f32 v79, s92, v79
    v_cvt_pk_bf16_f32 v38, v76, v77
    v_cvt_pk_bf16_f32 v39, v78, v79
    ds_write_b64 v27, v[38:39] offset:1536
    s_add_u32 m0, s79, 81920
    s_waitcnt vmcnt(7)
    buffer_load_dwordx4 v10, s[48:51], s78 offen offset:0  lds
    v_mul_f32 v80, s92, v80
    v_mul_f32 v81, s92, v81
    v_mul_f32 v82, s92, v82
    v_mul_f32 v83, s92, v83
    v_cvt_pk_bf16_f32 v40, v80, v81
    v_cvt_pk_bf16_f32 v41, v82, v83
    ds_write_b64 v27, v[40:41] offset:2048
    v_mul_f32 v84, s92, v84
    v_mul_f32 v85, s92, v85
    v_mul_f32 v86, s92, v86
    v_mul_f32 v87, s92, v87
    v_cvt_pk_bf16_f32 v42, v84, v85
    v_cvt_pk_bf16_f32 v43, v86, v87
    ds_write_b64 v27, v[42:43] offset:2560
    s_waitcnt vmcnt(7)
    buffer_load_dwordx4 v11, s[48:51], s78 offen offset:1024  lds
    v_mul_f32 v88, s92, v88
    v_mul_f32 v89, s92, v89
    v_mul_f32 v90, s92, v90
    v_mul_f32 v91, s92, v91
    v_cvt_pk_bf16_f32 v44, v88, v89
    v_cvt_pk_bf16_f32 v45, v90, v91
    ds_write_b64 v27, v[44:45] offset:3072
    v_mul_f32 v92, s92, v92
    v_mul_f32 v93, s92, v93
    v_mul_f32 v94, s92, v94
    v_mul_f32 v95, s92, v95
    v_cvt_pk_bf16_f32 v46, v92, v93
    v_cvt_pk_bf16_f32 v47, v94, v95
    ds_write_b64 v27, v[46:47] offset:3584
    s_add_u32 m0, s79, 32768
    s_waitcnt vmcnt(7)
    buffer_load_dwordx4 v4, s[40:43], s77 offen offset:0 nt lds
    s_waitcnt vmcnt(7)
    buffer_load_dwordx4 v5, s[40:43], s77 offen offset:1024 nt lds
    s_setprio 0
    s_waitcnt lgkmcnt(0)
    s_waitcnt vmcnt(8)
    s_barrier
    s_waitcnt vmcnt(6)
    buffer_load_dwordx4 v6, s[40:43], s77 offen offset:2048 nt lds
    s_waitcnt vmcnt(6)
    buffer_load_dwordx4 v7, s[40:43], s77 offen offset:3072 nt lds
    s_add_u32 m0, s79, 81920
    s_waitcnt vmcnt(6)
    buffer_load_dwordx4 v12, s[48:51], s78 offen offset:2048  lds
    ds_read_b64_tr_b16 v[32:33], v18 offset:0
    ds_read_b64_tr_b16 v[34:35], v18 offset:4096
    ds_read_b64_tr_b16 v[36:37], v19 offset:0
    ds_read_b64_tr_b16 v[38:39], v19 offset:4096
    ds_read_b64_tr_b16 v[40:41], v20 offset:0
    ds_read_b64_tr_b16 v[42:43], v20 offset:4096
    ds_read_b64_tr_b16 v[44:45], v21 offset:0
    ds_read_b64_tr_b16 v[46:47], v21 offset:4096
    ds_read_b64_tr_b16 v[48:49], v22 offset:0
    ds_read_b64_tr_b16 v[50:51], v22 offset:4096
    ds_read_b64_tr_b16 v[52:53], v23 offset:0
    ds_read_b64_tr_b16 v[54:55], v23 offset:4096
    ds_read_b64_tr_b16 v[56:57], v24 offset:0
    ds_read_b64_tr_b16 v[58:59], v24 offset:4096
    s_waitcnt lgkmcnt(12)
    v_mfma_f32_16x16x32_bf16 v[64:67], v[32:35], v[128:131], 0
    ds_read_b64_tr_b16 v[60:61], v25 offset:0
    ds_read_b64_tr_b16 v[62:63], v25 offset:4096
    s_waitcnt lgkmcnt(10)
    v_mfma_f32_16x16x32_bf16 v[68:71], v[36:39], v[128:131], 0
    ds_read_b64_tr_b16 v[32:33], v18 offset:8192
    ds_read_b64_tr_b16 v[34:35], v18 offset:12288
    s_waitcnt vmcnt(6)
    buffer_load_dwordx4 v13, s[48:51], s78 offen offset:3072  lds
    s_xor_b32 s78, s95, 1049088
    v_mfma_f32_16x16x32_bf16 v[72:75], v[40:43], v[128:131], 0
    ds_read_b64_tr_b16 v[36:37], v19 offset:8192
    ds_read_b64_tr_b16 v[38:39], v19 offset:12288
    s_waitcnt lgkmcnt(10)
    v_mfma_f32_16x16x32_bf16 v[76:79], v[44:47], v[128:131], 0
    ds_read_b64_tr_b16 v[40:41], v20 offset:8192
    ds_read_b64_tr_b16 v[42:43], v20 offset:12288
    v_mfma_f32_16x16x32_bf16 v[80:83], v[48:51], v[128:131], 0
    ds_read_b64_tr_b16 v[44:45], v21 offset:8192
    ds_read_b64_tr_b16 v[46:47], v21 offset:12288
    s_add_u32 m0, s79, 49152
    s_waitcnt vmcnt(6)
    buffer_load_dwordx4 v8, s[44:47], s77 offen offset:0 nt lds
    s_waitcnt lgkmcnt(10)
    v_mfma_f32_16x16x32_bf16 v[84:87], v[52:55], v[128:131], 0
    ds_read_b64_tr_b16 v[48:49], v22 offset:8192
    ds_read_b64_tr_b16 v[50:51], v22 offset:12288
    v_mfma_f32_16x16x32_bf16 v[88:91], v[56:59], v[128:131], 0
    ds_read_b64_tr_b16 v[52:53], v23 offset:8192
    ds_read_b64_tr_b16 v[54:55], v23 offset:12288
    s_waitcnt lgkmcnt(10)
    v_mfma_f32_16x16x32_bf16 v[92:95], v[60:63], v[128:131], 0
    ds_read_b64_tr_b16 v[56:57], v24 offset:8192
    ds_read_b64_tr_b16 v[58:59], v24 offset:12288
    s_waitcnt vmcnt(6)
    buffer_load_dwordx4 v9, s[44:47], s77 offen offset:1024 nt lds
    v_mfma_f32_16x16x32_bf16 v[64:67], v[32:35], v[132:135], v[64:67]
    ds_read_b64_tr_b16 v[60:61], v25 offset:8192
    ds_read_b64_tr_b16 v[62:63], v25 offset:12288
    s_waitcnt lgkmcnt(10)
    v_mfma_f32_16x16x32_bf16 v[68:71], v[36:39], v[132:135], v[68:71]
    s_waitcnt vmcnt(6)
    buffer_load_dwordx4 v8, s[44:47], s77 offen offset:2048 nt lds
    v_mfma_f32_16x16x32_bf16 v[72:75], v[40:43], v[132:135], v[72:75]
    s_waitcnt lgkmcnt(6)
    v_mfma_f32_16x16x32_bf16 v[76:79], v[44:47], v[132:135], v[76:79]
    v_mfma_f32_16x16x32_bf16 v[80:83], v[48:51], v[132:135], v[80:83]
    s_waitcnt vmcnt(6)
    buffer_load_dwordx4 v9, s[44:47], s77 offen offset:3072 nt lds
    s_xor_b32 s77, s3, 163840
    s_waitcnt lgkmcnt(2)
    v_mfma_f32_16x16x32_bf16 v[84:87], v[52:55], v[132:135], v[84:87]
    v_mfma_f32_16x16x32_bf16 v[88:91], v[56:59], v[132:135], v[88:91]
    s_waitcnt lgkmcnt(0)
    v_mfma_f32_16x16x32_bf16 v[92:95], v[60:63], v[132:135], v[92:95]
    s_add_u32 m0, s79, 98304
    s_waitcnt vmcnt(6)
    buffer_load_dwordx4 v10, s[48:51], s78 offen offset:0  lds
    s_waitcnt vmcnt(13)
    s_barrier
    s_waitcnt vmcnt(6)
    buffer_load_dwordx4 v11, s[48:51], s78 offen offset:1024  lds
    s_add_u32 m0, s79, 0
    s_waitcnt vmcnt(6)
    buffer_load_dwordx4 v4, s[40:43], s77 offen offset:0 nt lds
    s_waitcnt vmcnt(6)
    buffer_load_dwordx4 v5, s[40:43], s77 offen offset:1024 nt lds
    s_waitcnt vmcnt(6)
    buffer_load_dwordx4 v6, s[40:43], s77 offen offset:2048 nt lds
    s_waitcnt vmcnt(9)
    s_barrier
    s_waitcnt vmcnt(6)
    buffer_load_dwordx4 v7, s[40:43], s77 offen offset:3072 nt lds
    s_add_u32 m0, s79, 98304
    s_waitcnt vmcnt(6)
    buffer_load_dwordx4 v12, s[48:51], s78 offen offset:2048  lds
    s_waitcnt vmcnt(6)
    buffer_load_dwordx4 v13, s[48:51], s78 offen offset:3072  lds
    s_xor_b32 s78, s95, 1573376
    s_add_u32 m0, s79, 16384
    s_waitcnt vmcnt(6)
    buffer_load_dwordx4 v8, s[44:47], s77 offen offset:0 nt lds
    ds_read_b64_tr_b16 v[32:33], v18 offset:16384
    ds_read_b64_tr_b16 v[34:35], v18 offset:20480
    ds_read_b64_tr_b16 v[36:37], v19 offset:16384
    ds_read_b64_tr_b16 v[38:39], v19 offset:20480
    ds_read_b64_tr_b16 v[40:41], v20 offset:16384
    ds_read_b64_tr_b16 v[42:43], v20 offset:20480
    ds_read_b64_tr_b16 v[44:45], v21 offset:16384
    ds_read_b64_tr_b16 v[46:47], v21 offset:20480
    ds_read_b64_tr_b16 v[48:49], v22 offset:16384
    ds_read_b64_tr_b16 v[50:51], v22 offset:20480
    ds_read_b64_tr_b16 v[52:53], v23 offset:16384
    ds_read_b64_tr_b16 v[54:55], v23 offset:20480
    ds_read_b64_tr_b16 v[56:57], v24 offset:16384
    ds_read_b64_tr_b16 v[58:59], v24 offset:20480
    s_waitcnt lgkmcnt(12)
    v_mfma_f32_16x16x32_bf16 v[64:67], v[32:35], v[136:139], v[64:67]
    ds_read_b64_tr_b16 v[60:61], v25 offset:16384
    ds_read_b64_tr_b16 v[62:63], v25 offset:20480
    s_waitcnt lgkmcnt(10)
    v_mfma_f32_16x16x32_bf16 v[68:71], v[36:39], v[136:139], v[68:71]
    ds_read_b64_tr_b16 v[32:33], v18 offset:24576
    ds_read_b64_tr_b16 v[34:35], v18 offset:28672
    v_mfma_f32_16x16x32_bf16 v[72:75], v[40:43], v[136:139], v[72:75]
    ds_read_b64_tr_b16 v[36:37], v19 offset:24576
    ds_read_b64_tr_b16 v[38:39], v19 offset:28672
    s_waitcnt lgkmcnt(10)
    v_mfma_f32_16x16x32_bf16 v[76:79], v[44:47], v[136:139], v[76:79]
    ds_read_b64_tr_b16 v[40:41], v20 offset:24576
    ds_read_b64_tr_b16 v[42:43], v20 offset:28672
    s_waitcnt vmcnt(6)
    buffer_load_dwordx4 v9, s[44:47], s77 offen offset:1024 nt lds
    v_mfma_f32_16x16x32_bf16 v[80:83], v[48:51], v[136:139], v[80:83]
    ds_read_b64_tr_b16 v[44:45], v21 offset:24576
    ds_read_b64_tr_b16 v[46:47], v21 offset:28672
    s_waitcnt lgkmcnt(10)
    v_mfma_f32_16x16x32_bf16 v[84:87], v[52:55], v[136:139], v[84:87]
    ds_read_b64_tr_b16 v[48:49], v22 offset:24576
    ds_read_b64_tr_b16 v[50:51], v22 offset:28672
    v_mfma_f32_16x16x32_bf16 v[88:91], v[56:59], v[136:139], v[88:91]
    ds_read_b64_tr_b16 v[52:53], v23 offset:24576
    ds_read_b64_tr_b16 v[54:55], v23 offset:28672
    s_waitcnt lgkmcnt(10)
    v_mfma_f32_16x16x32_bf16 v[92:95], v[60:63], v[136:139], v[92:95]
    ds_read_b64_tr_b16 v[56:57], v24 offset:24576
    ds_read_b64_tr_b16 v[58:59], v24 offset:28672
    s_waitcnt vmcnt(6)
    buffer_load_dwordx4 v8, s[44:47], s77 offen offset:2048 nt lds
    v_mfma_f32_16x16x32_bf16 v[64:67], v[32:35], v[140:143], v[64:67]
    ds_read_b64_tr_b16 v[60:61], v25 offset:24576
    ds_read_b64_tr_b16 v[62:63], v25 offset:28672
    s_waitcnt lgkmcnt(10)
    v_mfma_f32_16x16x32_bf16 v[68:71], v[36:39], v[140:143], v[68:71]
    v_mfma_f32_16x16x32_bf16 v[72:75], v[40:43], v[140:143], v[72:75]
    s_waitcnt lgkmcnt(6)
    v_mfma_f32_16x16x32_bf16 v[76:79], v[44:47], v[140:143], v[76:79]
    s_waitcnt vmcnt(6)
    buffer_load_dwordx4 v9, s[44:47], s77 offen offset:3072 nt lds
    s_xor_b32 s77, s3, 180224
    v_mfma_f32_16x16x32_bf16 v[80:83], v[48:51], v[140:143], v[80:83]
    s_waitcnt lgkmcnt(2)
    v_mfma_f32_16x16x32_bf16 v[84:87], v[52:55], v[140:143], v[84:87]
    v_mfma_f32_16x16x32_bf16 v[88:91], v[56:59], v[140:143], v[88:91]
    s_waitcnt lgkmcnt(0)
    v_mfma_f32_16x16x32_bf16 v[92:95], v[60:63], v[140:143], v[92:95]
    s_add_u32 m0, s79, 114688
    s_waitcnt vmcnt(6)
    buffer_load_dwordx4 v10, s[48:51], s78 offen offset:0  lds
    s_waitcnt vmcnt(13)
    s_barrier
    s_waitcnt vmcnt(6)
    buffer_load_dwordx4 v11, s[48:51], s78 offen offset:1024  lds
    s_add_u32 m0, s79, 32768
    s_waitcnt vmcnt(6)
    buffer_load_dwordx4 v4, s[40:43], s77 offen offset:0 nt lds
    s_waitcnt vmcnt(6)
    buffer_load_dwordx4 v5, s[40:43], s77 offen offset:1024 nt lds
    s_waitcnt vmcnt(6)
    buffer_load_dwordx4 v6, s[40:43], s77 offen offset:2048 nt lds
    s_waitcnt vmcnt(9)
    s_barrier
    s_waitcnt vmcnt(6)
    buffer_load_dwordx4 v7, s[40:43], s77 offen offset:3072 nt lds
    s_add_u32 m0, s79, 114688
    s_waitcnt vmcnt(6)
    buffer_load_dwordx4 v12, s[48:51], s78 offen offset:2048  lds
    s_waitcnt vmcnt(6)
    buffer_load_dwordx4 v13, s[48:51], s78 offen offset:3072  lds
    s_xor_b32 s78, s95, 2097664
    s_add_u32 m0, s79, 49152
    s_waitcnt vmcnt(6)
    buffer_load_dwordx4 v8, s[44:47], s77 offen offset:0 nt lds
    ds_read_b64_tr_b16 v[32:33], v18 offset:32768
    ds_read_b64_tr_b16 v[34:35], v18 offset:36864
    ds_read_b64_tr_b16 v[36:37], v19 offset:32768
    ds_read_b64_tr_b16 v[38:39], v19 offset:36864
    ds_read_b64_tr_b16 v[40:41], v20 offset:32768
    ds_read_b64_tr_b16 v[42:43], v20 offset:36864
    ds_read_b64_tr_b16 v[44:45], v21 offset:32768
    ds_read_b64_tr_b16 v[46:47], v21 offset:36864
    ds_read_b64_tr_b16 v[48:49], v22 offset:32768
    ds_read_b64_tr_b16 v[50:51], v22 offset:36864
    ds_read_b64_tr_b16 v[52:53], v23 offset:32768
    ds_read_b64_tr_b16 v[54:55], v23 offset:36864
    ds_read_b64_tr_b16 v[56:57], v24 offset:32768
    ds_read_b64_tr_b16 v[58:59], v24 offset:36864
    s_waitcnt lgkmcnt(12)
    v_mfma_f32_16x16x32_bf16 v[64:67], v[32:35], v[144:147], v[64:67]
    ds_read_b64_tr_b16 v[60:61], v25 offset:32768
    ds_read_b64_tr_b16 v[62:63], v25 offset:36864
    s_waitcnt lgkmcnt(10)
    v_mfma_f32_16x16x32_bf16 v[68:71], v[36:39], v[144:147], v[68:71]
    ds_read_b64_tr_b16 v[32:33], v18 offset:40960
    ds_read_b64_tr_b16 v[34:35], v18 offset:45056
    v_mfma_f32_16x16x32_bf16 v[72:75], v[40:43], v[144:147], v[72:75]
    ds_read_b64_tr_b16 v[36:37], v19 offset:40960
    ds_read_b64_tr_b16 v[38:39], v19 offset:45056
    s_waitcnt lgkmcnt(10)
    v_mfma_f32_16x16x32_bf16 v[76:79], v[44:47], v[144:147], v[76:79]
    ds_read_b64_tr_b16 v[40:41], v20 offset:40960
    ds_read_b64_tr_b16 v[42:43], v20 offset:45056
    s_waitcnt vmcnt(6)
    buffer_load_dwordx4 v9, s[44:47], s77 offen offset:1024 nt lds
    v_mfma_f32_16x16x32_bf16 v[80:83], v[48:51], v[144:147], v[80:83]
    ds_read_b64_tr_b16 v[44:45], v21 offset:40960
    ds_read_b64_tr_b16 v[46:47], v21 offset:45056
    s_waitcnt lgkmcnt(10)
    v_mfma_f32_16x16x32_bf16 v[84:87], v[52:55], v[144:147], v[84:87]
    ds_read_b64_tr_b16 v[48:49], v22 offset:40960
    ds_read_b64_tr_b16 v[50:51], v22 offset:45056
    v_mfma_f32_16x16x32_bf16 v[88:91], v[56:59], v[144:147], v[88:91]
    ds_read_b64_tr_b16 v[52:53], v23 offset:40960
    ds_read_b64_tr_b16 v[54:55], v23 offset:45056
    s_waitcnt lgkmcnt(10)
    v_mfma_f32_16x16x32_bf16 v[92:95], v[60:63], v[144:147], v[92:95]
    ds_read_b64_tr_b16 v[56:57], v24 offset:40960
    ds_read_b64_tr_b16 v[58:59], v24 offset:45056
    s_waitcnt vmcnt(6)
    buffer_load_dwordx4 v8, s[44:47], s77 offen offset:2048 nt lds
    v_mfma_f32_16x16x32_bf16 v[64:67], v[32:35], v[148:151], v[64:67]
    ds_read_b64_tr_b16 v[60:61], v25 offset:40960
    ds_read_b64_tr_b16 v[62:63], v25 offset:45056
    s_waitcnt lgkmcnt(10)
    v_mfma_f32_16x16x32_bf16 v[68:71], v[36:39], v[148:151], v[68:71]
    v_mfma_f32_16x16x32_bf16 v[72:75], v[40:43], v[148:151], v[72:75]
    s_waitcnt lgkmcnt(6)
    v_mfma_f32_16x16x32_bf16 v[76:79], v[44:47], v[148:151], v[76:79]
    s_waitcnt vmcnt(6)
    buffer_load_dwordx4 v9, s[44:47], s77 offen offset:3072 nt lds
    s_xor_b32 s77, s3, 196608
    v_mfma_f32_16x16x32_bf16 v[80:83], v[48:51], v[148:151], v[80:83]
    s_waitcnt lgkmcnt(2)
    v_mfma_f32_16x16x32_bf16 v[84:87], v[52:55], v[148:151], v[84:87]
    v_mfma_f32_16x16x32_bf16 v[88:91], v[56:59], v[148:151], v[88:91]
    s_waitcnt lgkmcnt(0)
    v_mfma_f32_16x16x32_bf16 v[92:95], v[60:63], v[148:151], v[92:95]
    s_add_u32 m0, s79, 65536
    s_waitcnt vmcnt(6)
    buffer_load_dwordx4 v10, s[48:51], s78 offen offset:0  lds
    s_waitcnt vmcnt(13)
    s_barrier
    s_waitcnt vmcnt(6)
    buffer_load_dwordx4 v11, s[48:51], s78 offen offset:1024  lds
    s_add_u32 m0, s79, 0
    s_waitcnt vmcnt(6)
    buffer_load_dwordx4 v4, s[40:43], s77 offen offset:0 nt lds
    s_waitcnt vmcnt(6)
    buffer_load_dwordx4 v5, s[40:43], s77 offen offset:1024 nt lds
    s_waitcnt vmcnt(6)
    buffer_load_dwordx4 v6, s[40:43], s77 offen offset:2048 nt lds
    s_waitcnt vmcnt(9)
    s_barrier
    s_waitcnt vmcnt(6)
    buffer_load_dwordx4 v7, s[40:43], s77 offen offset:3072 nt lds
    s_add_u32 m0, s79, 65536
    s_waitcnt vmcnt(6)
    buffer_load_dwordx4 v12, s[48:51], s78 offen offset:2048  lds
    s_waitcnt vmcnt(6)
    buffer_load_dwordx4 v13, s[48:51], s78 offen offset:3072  lds
    s_xor_b32 s78, s95, 2621952
    s_add_u32 m0, s79, 16384
    s_waitcnt vmcnt(6)
    buffer_load_dwordx4 v8, s[44:47], s77 offen offset:0 nt lds
    ds_read_b64_tr_b16 v[32:33], v18 offset:49152
    ds_read_b64_tr_b16 v[34:35], v18 offset:53248
    ds_read_b64_tr_b16 v[36:37], v19 offset:49152
    ds_read_b64_tr_b16 v[38:39], v19 offset:53248
    ds_read_b64_tr_b16 v[40:41], v20 offset:49152
    ds_read_b64_tr_b16 v[42:43], v20 offset:53248
    ds_read_b64_tr_b16 v[44:45], v21 offset:49152
    ds_read_b64_tr_b16 v[46:47], v21 offset:53248
    ds_read_b64_tr_b16 v[48:49], v22 offset:49152
    ds_read_b64_tr_b16 v[50:51], v22 offset:53248
    ds_read_b64_tr_b16 v[52:53], v23 offset:49152
    ds_read_b64_tr_b16 v[54:55], v23 offset:53248
    ds_read_b64_tr_b16 v[56:57], v24 offset:49152
    ds_read_b64_tr_b16 v[58:59], v24 offset:53248
    s_waitcnt lgkmcnt(12)
    v_mfma_f32_16x16x32_bf16 v[64:67], v[32:35], v[152:155], v[64:67]
    ds_read_b64_tr_b16 v[60:61], v25 offset:49152
    ds_read_b64_tr_b16 v[62:63], v25 offset:53248
    s_waitcnt lgkmcnt(10)
    v_mfma_f32_16x16x32_bf16 v[68:71], v[36:39], v[152:155], v[68:71]
    ds_read_b64_tr_b16 v[32:33], v18 offset:57344
    ds_read_b64_tr_b16 v[34:35], v18 offset:61440
    v_mfma_f32_16x16x32_bf16 v[72:75], v[40:43], v[152:155], v[72:75]
    ds_read_b64_tr_b16 v[36:37], v19 offset:57344
    ds_read_b64_tr_b16 v[38:39], v19 offset:61440
    s_waitcnt lgkmcnt(10)
    v_mfma_f32_16x16x32_bf16 v[76:79], v[44:47], v[152:155], v[76:79]
    ds_read_b64_tr_b16 v[40:41], v20 offset:57344
    ds_read_b64_tr_b16 v[42:43], v20 offset:61440
    v_mfma_f32_16x16x32_bf16 v[80:83], v[48:51], v[152:155], v[80:83]
    ds_read_b64_tr_b16 v[44:45], v21 offset:57344
    ds_read_b64_tr_b16 v[46:47], v21 offset:61440
    s_waitcnt vmcnt(6)
    buffer_load_dwordx4 v9, s[44:47], s77 offen offset:1024 nt lds
    s_waitcnt lgkmcnt(10)
    v_mfma_f32_16x16x32_bf16 v[84:87], v[52:55], v[152:155], v[84:87]
    ds_read_b64_tr_b16 v[48:49], v22 offset:57344
    ds_read_b64_tr_b16 v[50:51], v22 offset:61440
    v_mfma_f32_16x16x32_bf16 v[88:91], v[56:59], v[152:155], v[88:91]
    ds_read_b64_tr_b16 v[52:53], v23 offset:57344
    ds_read_b64_tr_b16 v[54:55], v23 offset:61440
    s_waitcnt lgkmcnt(10)
    v_mfma_f32_16x16x32_bf16 v[92:95], v[60:63], v[152:155], v[92:95]
    ds_read_b64_tr_b16 v[56:57], v24 offset:57344
    ds_read_b64_tr_b16 v[58:59], v24 offset:61440
    v_mfma_f32_16x16x32_bf16 v[64:67], v[32:35], v[156:159], v[64:67]
    ds_read_b64_tr_b16 v[60:61], v25 offset:57344
    ds_read_b64_tr_b16 v[62:63], v25 offset:61440
    s_waitcnt lgkmcnt(10)
    v_mfma_f32_16x16x32_bf16 v[68:71], v[36:39], v[156:159], v[68:71]
    s_waitcnt vmcnt(6)
    buffer_load_dwordx4 v8, s[44:47], s77 offen offset:2048 nt lds
    v_mfma_f32_16x16x32_bf16 v[72:75], v[40:43], v[156:159], v[72:75]
    s_waitcnt lgkmcnt(6)
    v_mfma_f32_16x16x32_bf16 v[76:79], v[44:47], v[156:159], v[76:79]
    v_mfma_f32_16x16x32_bf16 v[80:83], v[48:51], v[156:159], v[80:83]
    s_waitcnt lgkmcnt(2)
    v_mfma_f32_16x16x32_bf16 v[84:87], v[52:55], v[156:159], v[84:87]
    v_mfma_f32_16x16x32_bf16 v[88:91], v[56:59], v[156:159], v[88:91]
    s_waitcnt lgkmcnt(0)
    v_mfma_f32_16x16x32_bf16 v[92:95], v[60:63], v[156:159], v[92:95]
    s_waitcnt vmcnt(6)
    buffer_load_dwordx4 v9, s[44:47], s77 offen offset:3072 nt lds
    s_xor_b32 s77, s3, 212992
    s_waitcnt vmcnt(12)
    s_barrier
    s_add_u32 m0, s79, 81920
    s_waitcnt vmcnt(6)
    buffer_load_dwordx4 v10, s[48:51], s78 offen offset:0  lds
    s_waitcnt vmcnt(6)
    buffer_load_dwordx4 v11, s[48:51], s78 offen offset:1024  lds
    s_add_u32 m0, s79, 32768
    s_waitcnt vmcnt(6)
    buffer_load_dwordx4 v4, s[40:43], s77 offen offset:0 nt lds
    s_waitcnt vmcnt(6)
    buffer_load_dwordx4 v5, s[40:43], s77 offen offset:1024 nt lds
    s_waitcnt vmcnt(8)
    s_barrier
    s_waitcnt vmcnt(6)
    buffer_load_dwordx4 v6, s[40:43], s77 offen offset:2048 nt lds
    s_waitcnt vmcnt(6)
    buffer_load_dwordx4 v7, s[40:43], s77 offen offset:3072 nt lds
    s_add_u32 m0, s79, 81920
    s_waitcnt vmcnt(6)
    buffer_load_dwordx4 v12, s[48:51], s78 offen offset:2048  lds
    s_waitcnt vmcnt(6)
    buffer_load_dwordx4 v13, s[48:51], s78 offen offset:3072  lds
    s_xor_b32 s78, s95, 3146240
    ds_read_b64_tr_b16 v[32:33], v18 offset:0
    ds_read_b64_tr_b16 v[34:35], v18 offset:4096
    ds_read_b64_tr_b16 v[36:37], v19 offset:0
    ds_read_b64_tr_b16 v[38:39], v19 offset:4096
    ds_read_b64_tr_b16 v[40:41], v20 offset:0
    ds_read_b64_tr_b16 v[42:43], v20 offset:4096
    ds_read_b64_tr_b16 v[44:45], v21 offset:0
    ds_read_b64_tr_b16 v[46:47], v21 offset:4096
    ds_read_b64_tr_b16 v[48:49], v22 offset:0
    ds_read_b64_tr_b16 v[50:51], v22 offset:4096
    ds_read_b64_tr_b16 v[52:53], v23 offset:0
    ds_read_b64_tr_b16 v[54:55], v23 offset:4096
    ds_read_b64_tr_b16 v[56:57], v24 offset:0
    ds_read_b64_tr_b16 v[58:59], v24 offset:4096
    s_waitcnt lgkmcnt(12)
    v_mfma_f32_16x16x32_bf16 v[64:67], v[32:35], v[160:163], v[64:67]
    ds_read_b64_tr_b16 v[60:61], v25 offset:0
    ds_read_b64_tr_b16 v[62:63], v25 offset:4096
    s_waitcnt lgkmcnt(10)
    v_mfma_f32_16x16x32_bf16 v[68:71], v[36:39], v[160:163], v[68:71]
    ds_read_b64_tr_b16 v[32:33], v18 offset:8192
    ds_read_b64_tr_b16 v[34:35], v18 offset:12288
    v_mfma_f32_16x16x32_bf16 v[72:75], v[40:43], v[160:163], v[72:75]
    ds_read_b64_tr_b16 v[36:37], v19 offset:8192
    ds_read_b64_tr_b16 v[38:39], v19 offset:12288
    s_waitcnt lgkmcnt(10)
    v_mfma_f32_16x16x32_bf16 v[76:79], v[44:47], v[160:163], v[76:79]
    ds_read_b64_tr_b16 v[40:41], v20 offset:8192
    ds_read_b64_tr_b16 v[42:43], v20 offset:12288
    s_add_u32 m0, s79, 49152
    s_waitcnt vmcnt(6)
    buffer_load_dwordx4 v8, s[44:47], s77 offen offset:0 nt lds
    v_mfma_f32_16x16x32_bf16 v[80:83], v[48:51], v[160:163], v[80:83]
    ds_read_b64_tr_b16 v[44:45], v21 offset:8192
    ds_read_b64_tr_b16 v[46:47], v21 offset:12288
    s_waitcnt lgkmcnt(10)
    v_mfma_f32_16x16x32_bf16 v[84:87], v[52:55], v[160:163], v[84:87]
    ds_read_b64_tr_b16 v[48:49], v22 offset:8192
    ds_read_b64_tr_b16 v[50:51], v22 offset:12288
    v_mfma_f32_16x16x32_bf16 v[88:91], v[56:59], v[160:163], v[88:91]
    ds_read_b64_tr_b16 v[52:53], v23 offset:8192
    ds_read_b64_tr_b16 v[54:55], v23 offset:12288
    s_waitcnt lgkmcnt(10)
    v_mfma_f32_16x16x32_bf16 v[92:95], v[60:63], v[160:163], v[92:95]
    ds_read_b64_tr_b16 v[56:57], v24 offset:8192
    ds_read_b64_tr_b16 v[58:59], v24 offset:12288
    s_waitcnt vmcnt(6)
    buffer_load_dwordx4 v9, s[44:47], s77 offen offset:1024 nt lds
    v_mfma_f32_16x16x32_bf16 v[64:67], v[32:35], v[164:167], v[64:67]
    ds_read_b64_tr_b16 v[60:61], v25 offset:8192
    ds_read_b64_tr_b16 v[62:63], v25 offset:12288
    s_waitcnt lgkmcnt(10)
    v_mfma_f32_16x16x32_bf16 v[68:71], v[36:39], v[164:167], v[68:71]
    v_mfma_f32_16x16x32_bf16 v[72:75], v[40:43], v[164:167], v[72:75]
    s_waitcnt lgkmcnt(6)
    v_mfma_f32_16x16x32_bf16 v[76:79], v[44:47], v[164:167], v[76:79]
    s_waitcnt vmcnt(6)
    buffer_load_dwordx4 v8, s[44:47], s77 offen offset:2048 nt lds
    v_mfma_f32_16x16x32_bf16 v[80:83], v[48:51], v[164:167], v[80:83]
    s_waitcnt lgkmcnt(2)
    v_mfma_f32_16x16x32_bf16 v[84:87], v[52:55], v[164:167], v[84:87]
    v_mfma_f32_16x16x32_bf16 v[88:91], v[56:59], v[164:167], v[88:91]
    s_waitcnt lgkmcnt(0)
    v_mfma_f32_16x16x32_bf16 v[92:95], v[60:63], v[164:167], v[92:95]
    s_waitcnt vmcnt(6)
    buffer_load_dwordx4 v9, s[44:47], s77 offen offset:3072 nt lds
    s_xor_b32 s77, s3, 229376
    s_waitcnt vmcnt(12)
    s_barrier
    s_add_u32 m0, s79, 98304
    s_waitcnt vmcnt(6)
    buffer_load_dwordx4 v10, s[48:51], s78 offen offset:0  lds
    s_waitcnt vmcnt(6)
    buffer_load_dwordx4 v11, s[48:51], s78 offen offset:1024  lds
    s_add_u32 m0, s79, 0
    s_waitcnt vmcnt(6)
    buffer_load_dwordx4 v4, s[40:43], s77 offen offset:0 nt lds
    s_waitcnt vmcnt(6)
    buffer_load_dwordx4 v5, s[40:43], s77 offen offset:1024 nt lds
    s_waitcnt vmcnt(8)
    s_barrier
    s_waitcnt vmcnt(6)
    buffer_load_dwordx4 v6, s[40:43], s77 offen offset:2048 nt lds
    s_waitcnt vmcnt(6)
    buffer_load_dwordx4 v7, s[40:43], s77 offen offset:3072 nt lds
    s_add_u32 m0, s79, 98304
    s_waitcnt vmcnt(6)
    buffer_load_dwordx4 v12, s[48:51], s78 offen offset:2048  lds
    s_waitcnt vmcnt(6)
    buffer_load_dwordx4 v13, s[48:51], s78 offen offset:3072  lds
    s_xor_b32 s78, s95, 3670528
    ds_read_b64_tr_b16 v[32:33], v18 offset:16384
    ds_read_b64_tr_b16 v[34:35], v18 offset:20480
    ds_read_b64_tr_b16 v[36:37], v19 offset:16384
    ds_read_b64_tr_b16 v[38:39], v19 offset:20480
    ds_read_b64_tr_b16 v[40:41], v20 offset:16384
    ds_read_b64_tr_b16 v[42:43], v20 offset:20480
    ds_read_b64_tr_b16 v[44:45], v21 offset:16384
    ds_read_b64_tr_b16 v[46:47], v21 offset:20480
    ds_read_b64_tr_b16 v[48:49], v22 offset:16384
    ds_read_b64_tr_b16 v[50:51], v22 offset:20480
    ds_read_b64_tr_b16 v[52:53], v23 offset:16384
    ds_read_b64_tr_b16 v[54:55], v23 offset:20480
    ds_read_b64_tr_b16 v[56:57], v24 offset:16384
    ds_read_b64_tr_b16 v[58:59], v24 offset:20480
    s_waitcnt lgkmcnt(12)
    v_mfma_f32_16x16x32_bf16 v[64:67], v[32:35], v[168:171], v[64:67]
    ds_read_b64_tr_b16 v[60:61], v25 offset:16384
    ds_read_b64_tr_b16 v[62:63], v25 offset:20480
    s_waitcnt lgkmcnt(10)
    v_mfma_f32_16x16x32_bf16 v[68:71], v[36:39], v[168:171], v[68:71]
    ds_read_b64_tr_b16 v[32:33], v18 offset:24576
    ds_read_b64_tr_b16 v[34:35], v18 offset:28672
    v_mfma_f32_16x16x32_bf16 v[72:75], v[40:43], v[168:171], v[72:75]
    ds_read_b64_tr_b16 v[36:37], v19 offset:24576
    ds_read_b64_tr_b16 v[38:39], v19 offset:28672
    s_waitcnt lgkmcnt(10)
    v_mfma_f32_16x16x32_bf16 v[76:79], v[44:47], v[168:171], v[76:79]
    ds_read_b64_tr_b16 v[40:41], v20 offset:24576
    ds_read_b64_tr_b16 v[42:43], v20 offset:28672
    s_add_u32 m0, s79, 16384
    s_waitcnt vmcnt(6)
    buffer_load_dwordx4 v8, s[44:47], s77 offen offset:0 nt lds
    v_mfma_f32_16x16x32_bf16 v[80:83], v[48:51], v[168:171], v[80:83]
    ds_read_b64_tr_b16 v[44:45], v21 offset:24576
    ds_read_b64_tr_b16 v[46:47], v21 offset:28672
    s_waitcnt lgkmcnt(10)
    v_mfma_f32_16x16x32_bf16 v[84:87], v[52:55], v[168:171], v[84:87]
    ds_read_b64_tr_b16 v[48:49], v22 offset:24576
    ds_read_b64_tr_b16 v[50:51], v22 offset:28672
    v_mfma_f32_16x16x32_bf16 v[88:91], v[56:59], v[168:171], v[88:91]
    ds_read_b64_tr_b16 v[52:53], v23 offset:24576
    ds_read_b64_tr_b16 v[54:55], v23 offset:28672
    s_waitcnt lgkmcnt(10)
    v_mfma_f32_16x16x32_bf16 v[92:95], v[60:63], v[168:171], v[92:95]
    ds_read_b64_tr_b16 v[56:57], v24 offset:24576
    ds_read_b64_tr_b16 v[58:59], v24 offset:28672
    s_waitcnt vmcnt(6)
    buffer_load_dwordx4 v9, s[44:47], s77 offen offset:1024 nt lds
    v_mfma_f32_16x16x32_bf16 v[64:67], v[32:35], v[172:175], v[64:67]
    ds_read_b64_tr_b16 v[60:61], v25 offset:24576
    ds_read_b64_tr_b16 v[62:63], v25 offset:28672
    s_waitcnt lgkmcnt(10)
    v_mfma_f32_16x16x32_bf16 v[68:71], v[36:39], v[172:175], v[68:71]
    v_mfma_f32_16x16x32_bf16 v[72:75], v[40:43], v[172:175], v[72:75]
    s_waitcnt lgkmcnt(6)
    v_mfma_f32_16x16x32_bf16 v[76:79], v[44:47], v[172:175], v[76:79]
    s_waitcnt vmcnt(6)
    buffer_load_dwordx4 v8, s[44:47], s77 offen offset:2048 nt lds
    v_mfma_f32_16x16x32_bf16 v[80:83], v[48:51], v[172:175], v[80:83]
    s_waitcnt lgkmcnt(2)
    v_mfma_f32_16x16x32_bf16 v[84:87], v[52:55], v[172:175], v[84:87]
    v_mfma_f32_16x16x32_bf16 v[88:91], v[56:59], v[172:175], v[88:91]
    s_waitcnt lgkmcnt(0)
    v_mfma_f32_16x16x32_bf16 v[92:95], v[60:63], v[172:175], v[92:95]
    s_waitcnt vmcnt(6)
    buffer_load_dwordx4 v9, s[44:47], s77 offen offset:3072 nt lds
    s_xor_b32 s77, s3, 245760
    s_waitcnt vmcnt(12)
    s_barrier
    s_add_u32 m0, s79, 114688
    s_waitcnt vmcnt(6)
    buffer_load_dwordx4 v10, s[48:51], s78 offen offset:0  lds
    s_waitcnt vmcnt(6)
    buffer_load_dwordx4 v11, s[48:51], s78 offen offset:1024  lds
    s_add_u32 m0, s79, 32768
    s_waitcnt vmcnt(6)
    buffer_load_dwordx4 v4, s[40:43], s77 offen offset:0 nt lds
    s_waitcnt vmcnt(6)
    buffer_load_dwordx4 v5, s[40:43], s77 offen offset:1024 nt lds
    s_waitcnt vmcnt(8)
    s_barrier
    s_waitcnt vmcnt(6)
    buffer_load_dwordx4 v6, s[40:43], s77 offen offset:2048 nt lds
    s_waitcnt vmcnt(6)
    buffer_load_dwordx4 v7, s[40:43], s77 offen offset:3072 nt lds
    s_add_u32 m0, s79, 114688
    s_waitcnt vmcnt(6)
    buffer_load_dwordx4 v12, s[48:51], s78 offen offset:2048  lds
    s_waitcnt vmcnt(6)
    buffer_load_dwordx4 v13, s[48:51], s78 offen offset:3072  lds
    s_xor_b32 s78, s95, 768
    ds_read_b64_tr_b16 v[32:33], v18 offset:32768
    ds_read_b64_tr_b16 v[34:35], v18 offset:36864
    ds_read_b64_tr_b16 v[36:37], v19 offset:32768
    ds_read_b64_tr_b16 v[38:39], v19 offset:36864
    ds_read_b64_tr_b16 v[40:41], v20 offset:32768
    ds_read_b64_tr_b16 v[42:43], v20 offset:36864
    ds_read_b64_tr_b16 v[44:45], v21 offset:32768
    ds_read_b64_tr_b16 v[46:47], v21 offset:36864
    ds_read_b64_tr_b16 v[48:49], v22 offset:32768
    ds_read_b64_tr_b16 v[50:51], v22 offset:36864
    ds_read_b64_tr_b16 v[52:53], v23 offset:32768
    ds_read_b64_tr_b16 v[54:55], v23 offset:36864
    ds_read_b64_tr_b16 v[56:57], v24 offset:32768
    ds_read_b64_tr_b16 v[58:59], v24 offset:36864
    s_waitcnt lgkmcnt(12)
    v_mfma_f32_16x16x32_bf16 v[64:67], v[32:35], v[176:179], v[64:67]
    ds_read_b64_tr_b16 v[60:61], v25 offset:32768
    ds_read_b64_tr_b16 v[62:63], v25 offset:36864
    s_waitcnt lgkmcnt(10)
    v_mfma_f32_16x16x32_bf16 v[68:71], v[36:39], v[176:179], v[68:71]
    ds_read_b64_tr_b16 v[32:33], v18 offset:40960
    ds_read_b64_tr_b16 v[34:35], v18 offset:45056
    v_mfma_f32_16x16x32_bf16 v[72:75], v[40:43], v[176:179], v[72:75]
    ds_read_b64_tr_b16 v[36:37], v19 offset:40960
    ds_read_b64_tr_b16 v[38:39], v19 offset:45056
    s_waitcnt lgkmcnt(10)
    v_mfma_f32_16x16x32_bf16 v[76:79], v[44:47], v[176:179], v[76:79]
    ds_read_b64_tr_b16 v[40:41], v20 offset:40960
    ds_read_b64_tr_b16 v[42:43], v20 offset:45056
    s_add_u32 m0, s79, 49152
    s_waitcnt vmcnt(6)
    buffer_load_dwordx4 v8, s[44:47], s77 offen offset:0 nt lds
    v_mfma_f32_16x16x32_bf16 v[80:83], v[48:51], v[176:179], v[80:83]
    ds_read_b64_tr_b16 v[44:45], v21 offset:40960
    ds_read_b64_tr_b16 v[46:47], v21 offset:45056
    s_waitcnt lgkmcnt(10)
    v_mfma_f32_16x16x32_bf16 v[84:87], v[52:55], v[176:179], v[84:87]
    ds_read_b64_tr_b16 v[48:49], v22 offset:40960
    ds_read_b64_tr_b16 v[50:51], v22 offset:45056
    v_mfma_f32_16x16x32_bf16 v[88:91], v[56:59], v[176:179], v[88:91]
    ds_read_b64_tr_b16 v[52:53], v23 offset:40960
    ds_read_b64_tr_b16 v[54:55], v23 offset:45056
    s_waitcnt lgkmcnt(10)
    v_mfma_f32_16x16x32_bf16 v[92:95], v[60:63], v[176:179], v[92:95]
    ds_read_b64_tr_b16 v[56:57], v24 offset:40960
    ds_read_b64_tr_b16 v[58:59], v24 offset:45056
    s_waitcnt vmcnt(6)
    buffer_load_dwordx4 v9, s[44:47], s77 offen offset:1024 nt lds
    v_mfma_f32_16x16x32_bf16 v[64:67], v[32:35], v[180:183], v[64:67]
    ds_read_b64_tr_b16 v[60:61], v25 offset:40960
    ds_read_b64_tr_b16 v[62:63], v25 offset:45056
    s_waitcnt lgkmcnt(10)
    v_mfma_f32_16x16x32_bf16 v[68:71], v[36:39], v[180:183], v[68:71]
    v_mfma_f32_16x16x32_bf16 v[72:75], v[40:43], v[180:183], v[72:75]
    s_waitcnt lgkmcnt(6)
    v_mfma_f32_16x16x32_bf16 v[76:79], v[44:47], v[180:183], v[76:79]
    s_waitcnt vmcnt(6)
    buffer_load_dwordx4 v8, s[44:47], s77 offen offset:2048 nt lds
    v_mfma_f32_16x16x32_bf16 v[80:83], v[48:51], v[180:183], v[80:83]
    s_waitcnt lgkmcnt(2)
    v_mfma_f32_16x16x32_bf16 v[84:87], v[52:55], v[180:183], v[84:87]
    v_mfma_f32_16x16x32_bf16 v[88:91], v[56:59], v[180:183], v[88:91]
    s_waitcnt lgkmcnt(0)
    v_mfma_f32_16x16x32_bf16 v[92:95], v[60:63], v[180:183], v[92:95]
    s_waitcnt vmcnt(6)
    buffer_load_dwordx4 v9, s[44:47], s77 offen offset:3072 nt lds
    s_xor_b32 s77, s3, 262144
    s_waitcnt vmcnt(12)
    s_barrier
    s_add_u32 m0, s79, 65536
    s_waitcnt vmcnt(6)
    buffer_load_dwordx4 v10, s[48:51], s78 offen offset:0  lds
    s_waitcnt vmcnt(6)
    buffer_load_dwordx4 v11, s[48:51], s78 offen offset:1024  lds
    s_add_u32 m0, s79, 0
    s_waitcnt vmcnt(6)
    buffer_load_dwordx4 v4, s[40:43], s77 offen offset:0 nt lds
    s_waitcnt vmcnt(6)
    buffer_load_dwordx4 v5, s[40:43], s77 offen offset:1024 nt lds
    s_waitcnt vmcnt(8)
    s_barrier
    s_waitcnt vmcnt(6)
    buffer_load_dwordx4 v6, s[40:43], s77 offen offset:2048 nt lds
    s_waitcnt vmcnt(6)
    buffer_load_dwordx4 v7, s[40:43], s77 offen offset:3072 nt lds
    s_add_u32 m0, s79, 65536
    s_waitcnt vmcnt(6)
    buffer_load_dwordx4 v12, s[48:51], s78 offen offset:2048  lds
    s_waitcnt vmcnt(6)
    buffer_load_dwordx4 v13, s[48:51], s78 offen offset:3072  lds
    s_xor_b32 s78, s95, 525056
    ds_read_b64_tr_b16 v[32:33], v18 offset:49152
    ds_read_b64_tr_b16 v[34:35], v18 offset:53248
    ds_read_b64_tr_b16 v[36:37], v19 offset:49152
    ds_read_b64_tr_b16 v[38:39], v19 offset:53248
    ds_read_b64_tr_b16 v[40:41], v20 offset:49152
    ds_read_b64_tr_b16 v[42:43], v20 offset:53248
    ds_read_b64_tr_b16 v[44:45], v21 offset:49152
    ds_read_b64_tr_b16 v[46:47], v21 offset:53248
    ds_read_b64_tr_b16 v[48:49], v22 offset:49152
    ds_read_b64_tr_b16 v[50:51], v22 offset:53248
    ds_read_b64_tr_b16 v[52:53], v23 offset:49152
    ds_read_b64_tr_b16 v[54:55], v23 offset:53248
    ds_read_b64_tr_b16 v[56:57], v24 offset:49152
    ds_read_b64_tr_b16 v[58:59], v24 offset:53248
    s_waitcnt lgkmcnt(12)
    v_mfma_f32_16x16x32_bf16 v[64:67], v[32:35], v[184:187], v[64:67]
    ds_read_b64_tr_b16 v[60:61], v25 offset:49152
    ds_read_b64_tr_b16 v[62:63], v25 offset:53248
    s_waitcnt lgkmcnt(10)
    v_mfma_f32_16x16x32_bf16 v[68:71], v[36:39], v[184:187], v[68:71]
    ds_read_b64_tr_b16 v[32:33], v18 offset:57344
    ds_read_b64_tr_b16 v[34:35], v18 offset:61440
    v_mfma_f32_16x16x32_bf16 v[72:75], v[40:43], v[184:187], v[72:75]
    ds_read_b64_tr_b16 v[36:37], v19 offset:57344
    ds_read_b64_tr_b16 v[38:39], v19 offset:61440
    s_waitcnt lgkmcnt(10)
    v_mfma_f32_16x16x32_bf16 v[76:79], v[44:47], v[184:187], v[76:79]
    ds_read_b64_tr_b16 v[40:41], v20 offset:57344
    ds_read_b64_tr_b16 v[42:43], v20 offset:61440
    v_mfma_f32_16x16x32_bf16 v[80:83], v[48:51], v[184:187], v[80:83]
    ds_read_b64_tr_b16 v[44:45], v21 offset:57344
    ds_read_b64_tr_b16 v[46:47], v21 offset:61440
    s_waitcnt lgkmcnt(10)
    v_mfma_f32_16x16x32_bf16 v[84:87], v[52:55], v[184:187], v[84:87]
    ds_read_b64_tr_b16 v[48:49], v22 offset:57344
    ds_read_b64_tr_b16 v[50:51], v22 offset:61440
    v_mfma_f32_16x16x32_bf16 v[88:91], v[56:59], v[184:187], v[88:91]
    ds_read_b64_tr_b16 v[52:53], v23 offset:57344
    ds_read_b64_tr_b16 v[54:55], v23 offset:61440
    s_waitcnt lgkmcnt(10)
    v_mfma_f32_16x16x32_bf16 v[92:95], v[60:63], v[184:187], v[92:95]
    ds_read_b64_tr_b16 v[56:57], v24 offset:57344
    ds_read_b64_tr_b16 v[58:59], v24 offset:61440
    s_add_u32 m0, s79, 16384
    s_waitcnt vmcnt(6)
    buffer_load_dwordx4 v8, s[44:47], s77 offen offset:0 nt lds
    v_mfma_f32_16x16x32_bf16 v[64:67], v[32:35], v[188:191], v[64:67]
    ds_read_b64_tr_b16 v[60:61], v25 offset:57344
    ds_read_b64_tr_b16 v[62:63], v25 offset:61440
    s_waitcnt lgkmcnt(10)
    v_mfma_f32_16x16x32_bf16 v[68:71], v[36:39], v[188:191], v[68:71]
    v_mfma_f32_16x16x32_bf16 v[72:75], v[40:43], v[188:191], v[72:75]
    s_waitcnt lgkmcnt(6)
    v_mfma_f32_16x16x32_bf16 v[76:79], v[44:47], v[188:191], v[76:79]
    v_mfma_f32_16x16x32_bf16 v[80:83], v[48:51], v[188:191], v[80:83]
    s_waitcnt lgkmcnt(2)
    v_mfma_f32_16x16x32_bf16 v[84:87], v[52:55], v[188:191], v[84:87]
    v_mfma_f32_16x16x32_bf16 v[88:91], v[56:59], v[188:191], v[88:91]
    s_waitcnt lgkmcnt(0)
    v_mfma_f32_16x16x32_bf16 v[92:95], v[60:63], v[188:191], v[92:95]
    s_waitcnt vmcnt(6)
    buffer_load_dwordx4 v9, s[44:47], s77 offen offset:1024 nt lds
    s_waitcnt vmcnt(10)
    s_barrier
    s_setprio 1
    s_waitcnt vmcnt(6)
    buffer_load_dwordx4 v8, s[44:47], s77 offen offset:2048 nt lds
    v_mul_f32 v64, s92, v64
    v_mul_f32 v65, s92, v65
    v_mul_f32 v66, s92, v66
    v_mul_f32 v67, s92, v67
    v_cvt_pk_bf16_f32 v32, v64, v65
    v_cvt_pk_bf16_f32 v33, v66, v67
    ds_write_b64 v27, v[32:33] offset:0
    v_mul_f32 v68, s92, v68
    v_mul_f32 v69, s92, v69
    v_mul_f32 v70, s92, v70
    v_mul_f32 v71, s92, v71
    v_cvt_pk_bf16_f32 v34, v68, v69
    v_cvt_pk_bf16_f32 v35, v70, v71
    ds_write_b64 v27, v[34:35] offset:512
    s_waitcnt vmcnt(6)
    buffer_load_dwordx4 v9, s[44:47], s77 offen offset:3072 nt lds
    s_xor_b32 s77, s3, 278528
    v_mul_f32 v72, s92, v72
    v_mul_f32 v73, s92, v73
    v_mul_f32 v74, s92, v74
    v_mul_f32 v75, s92, v75
    v_cvt_pk_bf16_f32 v36, v72, v73
    v_cvt_pk_bf16_f32 v37, v74, v75
    ds_write_b64 v27, v[36:37] offset:1024
    v_mul_f32 v76, s92, v76
    v_mul_f32 v77, s92, v77
    v_mul_f32 v78, s92, v78
    v_mul_f32 v79, s92, v79
    v_cvt_pk_bf16_f32 v38, v76, v77
    v_cvt_pk_bf16_f32 v39, v78, v79
    ds_write_b64 v27, v[38:39] offset:1536
    s_add_u32 m0, s79, 81920
    s_waitcnt vmcnt(6)
    buffer_load_dwordx4 v10, s[48:51], s78 offen offset:0  lds
    v_mul_f32 v80, s92, v80
    v_mul_f32 v81, s92, v81
    v_mul_f32 v82, s92, v82
    v_mul_f32 v83, s92, v83
    v_cvt_pk_bf16_f32 v40, v80, v81
    v_cvt_pk_bf16_f32 v41, v82, v83
    ds_write_b64 v27, v[40:41] offset:2048
    v_mul_f32 v84, s92, v84
    v_mul_f32 v85, s92, v85
    v_mul_f32 v86, s92, v86
    v_mul_f32 v87, s92, v87
    v_cvt_pk_bf16_f32 v42, v84, v85
    v_cvt_pk_bf16_f32 v43, v86, v87
    ds_write_b64 v27, v[42:43] offset:2560
    s_waitcnt vmcnt(6)
    buffer_load_dwordx4 v11, s[48:51], s78 offen offset:1024  lds
    v_mul_f32 v88, s92, v88
    v_mul_f32 v89, s92, v89
    v_mul_f32 v90, s92, v90
    v_mul_f32 v91, s92, v91
    v_cvt_pk_bf16_f32 v44, v88, v89
    v_cvt_pk_bf16_f32 v45, v90, v91
    ds_write_b64 v27, v[44:45] offset:3072
    v_mul_f32 v92, s92, v92
    v_mul_f32 v93, s92, v93
    v_mul_f32 v94, s92, v94
    v_mul_f32 v95, s92, v95
    v_cvt_pk_bf16_f32 v46, v92, v93
    v_cvt_pk_bf16_f32 v47, v94, v95
    ds_write_b64 v27, v[46:47] offset:3584
    s_add_u32 m0, s79, 32768
    s_waitcnt vmcnt(6)
    buffer_load_dwordx4 v4, s[40:43], s77 offen offset:0 nt lds
    s_waitcnt vmcnt(6)
    buffer_load_dwordx4 v5, s[40:43], s77 offen offset:1024 nt lds
    s_setprio 0
    s_waitcnt lgkmcnt(0)
    s_waitcnt vmcnt(8)
    s_barrier
    s_waitcnt vmcnt(6)
    buffer_load_dwordx4 v6, s[40:43], s77 offen offset:2048 nt lds
    s_waitcnt vmcnt(6)
    buffer_load_dwordx4 v7, s[40:43], s77 offen offset:3072 nt lds
    s_add_u32 m0, s79, 81920
    s_waitcnt vmcnt(6)
    buffer_load_dwordx4 v12, s[48:51], s78 offen offset:2048  lds
    ds_read_b64_tr_b16 v[32:33], v18 offset:0
    ds_read_b64_tr_b16 v[34:35], v18 offset:4096
    ds_read_b64_tr_b16 v[36:37], v19 offset:0
    ds_read_b64_tr_b16 v[38:39], v19 offset:4096
    ds_read_b64_tr_b16 v[40:41], v20 offset:0
    ds_read_b64_tr_b16 v[42:43], v20 offset:4096
    ds_read_b64_tr_b16 v[44:45], v21 offset:0
    ds_read_b64_tr_b16 v[46:47], v21 offset:4096
    ds_read_b64_tr_b16 v[48:49], v22 offset:0
    ds_read_b64_tr_b16 v[50:51], v22 offset:4096
    ds_read_b64_tr_b16 v[52:53], v23 offset:0
    ds_read_b64_tr_b16 v[54:55], v23 offset:4096
    ds_read_b64_tr_b16 v[56:57], v24 offset:0
    ds_read_b64_tr_b16 v[58:59], v24 offset:4096
    s_waitcnt lgkmcnt(12)
    v_mfma_f32_16x16x32_bf16 v[64:67], v[32:35], v[128:131], 0
    ds_read_b64_tr_b16 v[60:61], v25 offset:0
    ds_read_b64_tr_b16 v[62:63], v25 offset:4096
    s_waitcnt lgkmcnt(10)
    v_mfma_f32_16x16x32_bf16 v[68:71], v[36:39], v[128:131], 0
    ds_read_b64_tr_b16 v[32:33], v18 offset:8192
    ds_read_b64_tr_b16 v[34:35], v18 offset:12288
    s_waitcnt vmcnt(6)
    buffer_load_dwordx4 v13, s[48:51], s78 offen offset:3072  lds
    s_xor_b32 s78, s95, 1049344
    v_mfma_f32_16x16x32_bf16 v[72:75], v[40:43], v[128:131], 0
    ds_read_b64_tr_b16 v[36:37], v19 offset:8192
    ds_read_b64_tr_b16 v[38:39], v19 offset:12288
    s_waitcnt lgkmcnt(10)
    v_mfma_f32_16x16x32_bf16 v[76:79], v[44:47], v[128:131], 0
    ds_read_b64_tr_b16 v[40:41], v20 offset:8192
    ds_read_b64_tr_b16 v[42:43], v20 offset:12288
    v_mfma_f32_16x16x32_bf16 v[80:83], v[48:51], v[128:131], 0
    ds_read_b64_tr_b16 v[44:45], v21 offset:8192
    ds_read_b64_tr_b16 v[46:47], v21 offset:12288
    s_add_u32 m0, s79, 49152
    s_waitcnt vmcnt(6)
    buffer_load_dwordx4 v8, s[44:47], s77 offen offset:0 nt lds
    s_waitcnt lgkmcnt(10)
    v_mfma_f32_16x16x32_bf16 v[84:87], v[52:55], v[128:131], 0
    ds_read_b64_tr_b16 v[48:49], v22 offset:8192
    ds_read_b64_tr_b16 v[50:51], v22 offset:12288
    v_mfma_f32_16x16x32_bf16 v[88:91], v[56:59], v[128:131], 0
    ds_read_b64_tr_b16 v[52:53], v23 offset:8192
    ds_read_b64_tr_b16 v[54:55], v23 offset:12288
    s_waitcnt lgkmcnt(10)
    v_mfma_f32_16x16x32_bf16 v[92:95], v[60:63], v[128:131], 0
    ds_read_b64_tr_b16 v[56:57], v24 offset:8192
    ds_read_b64_tr_b16 v[58:59], v24 offset:12288
    s_waitcnt vmcnt(6)
    buffer_load_dwordx4 v9, s[44:47], s77 offen offset:1024 nt lds
    v_mfma_f32_16x16x32_bf16 v[64:67], v[32:35], v[132:135], v[64:67]
    ds_read_b64_tr_b16 v[60:61], v25 offset:8192
    ds_read_b64_tr_b16 v[62:63], v25 offset:12288
    s_waitcnt lgkmcnt(10)
    v_mfma_f32_16x16x32_bf16 v[68:71], v[36:39], v[132:135], v[68:71]
    s_waitcnt vmcnt(6)
    buffer_load_dwordx4 v8, s[44:47], s77 offen offset:2048 nt lds
    v_mfma_f32_16x16x32_bf16 v[72:75], v[40:43], v[132:135], v[72:75]
    s_waitcnt lgkmcnt(6)
    v_mfma_f32_16x16x32_bf16 v[76:79], v[44:47], v[132:135], v[76:79]
    v_mfma_f32_16x16x32_bf16 v[80:83], v[48:51], v[132:135], v[80:83]
    s_waitcnt vmcnt(6)
    buffer_load_dwordx4 v9, s[44:47], s77 offen offset:3072 nt lds
    s_xor_b32 s77, s3, 294912
    s_waitcnt lgkmcnt(2)
    v_mfma_f32_16x16x32_bf16 v[84:87], v[52:55], v[132:135], v[84:87]
    v_mfma_f32_16x16x32_bf16 v[88:91], v[56:59], v[132:135], v[88:91]
    s_waitcnt lgkmcnt(0)
    v_mfma_f32_16x16x32_bf16 v[92:95], v[60:63], v[132:135], v[92:95]
    s_add_u32 m0, s79, 98304
    s_waitcnt vmcnt(6)
    buffer_load_dwordx4 v10, s[48:51], s78 offen offset:0  lds
    s_waitcnt vmcnt(13)
    s_barrier
    s_waitcnt vmcnt(6)
    buffer_load_dwordx4 v11, s[48:51], s78 offen offset:1024  lds
    s_add_u32 m0, s79, 0
    s_waitcnt vmcnt(6)
    buffer_load_dwordx4 v4, s[40:43], s77 offen offset:0 nt lds
    s_waitcnt vmcnt(6)
    buffer_load_dwordx4 v5, s[40:43], s77 offen offset:1024 nt lds
    s_waitcnt vmcnt(6)
    buffer_load_dwordx4 v6, s[40:43], s77 offen offset:2048 nt lds
    s_waitcnt vmcnt(9)
    s_barrier
    s_waitcnt vmcnt(6)
    buffer_load_dwordx4 v7, s[40:43], s77 offen offset:3072 nt lds
    s_add_u32 m0, s79, 98304
    s_waitcnt vmcnt(6)
    buffer_load_dwordx4 v12, s[48:51], s78 offen offset:2048  lds
    s_waitcnt vmcnt(6)
    buffer_load_dwordx4 v13, s[48:51], s78 offen offset:3072  lds
    s_xor_b32 s78, s95, 1573632
    s_add_u32 m0, s79, 16384
    s_waitcnt vmcnt(6)
    buffer_load_dwordx4 v8, s[44:47], s77 offen offset:0 nt lds
    ds_read_b64_tr_b16 v[32:33], v18 offset:16384
    ds_read_b64_tr_b16 v[34:35], v18 offset:20480
    ds_read_b64_tr_b16 v[36:37], v19 offset:16384
    ds_read_b64_tr_b16 v[38:39], v19 offset:20480
    ds_read_b64_tr_b16 v[40:41], v20 offset:16384
    ds_read_b64_tr_b16 v[42:43], v20 offset:20480
    ds_read_b64_tr_b16 v[44:45], v21 offset:16384
    ds_read_b64_tr_b16 v[46:47], v21 offset:20480
    ds_read_b64_tr_b16 v[48:49], v22 offset:16384
    ds_read_b64_tr_b16 v[50:51], v22 offset:20480
    ds_read_b64_tr_b16 v[52:53], v23 offset:16384
    ds_read_b64_tr_b16 v[54:55], v23 offset:20480
    ds_read_b64_tr_b16 v[56:57], v24 offset:16384
    ds_read_b64_tr_b16 v[58:59], v24 offset:20480
    s_waitcnt lgkmcnt(12)
    v_mfma_f32_16x16x32_bf16 v[64:67], v[32:35], v[136:139], v[64:67]
    ds_read_b64_tr_b16 v[60:61], v25 offset:16384
    ds_read_b64_tr_b16 v[62:63], v25 offset:20480
    s_waitcnt lgkmcnt(10)
    v_mfma_f32_16x16x32_bf16 v[68:71], v[36:39], v[136:139], v[68:71]
    ds_read_b64_tr_b16 v[32:33], v18 offset:24576
    ds_read_b64_tr_b16 v[34:35], v18 offset:28672
    v_mfma_f32_16x16x32_bf16 v[72:75], v[40:43], v[136:139], v[72:75]
    ds_read_b64_tr_b16 v[36:37], v19 offset:24576
    ds_read_b64_tr_b16 v[38:39], v19 offset:28672
    s_waitcnt lgkmcnt(10)
    v_mfma_f32_16x16x32_bf16 v[76:79], v[44:47], v[136:139], v[76:79]
    ds_read_b64_tr_b16 v[40:41], v20 offset:24576
    ds_read_b64_tr_b16 v[42:43], v20 offset:28672
    s_waitcnt vmcnt(6)
    buffer_load_dwordx4 v9, s[44:47], s77 offen offset:1024 nt lds
    v_mfma_f32_16x16x32_bf16 v[80:83], v[48:51], v[136:139], v[80:83]
    ds_read_b64_tr_b16 v[44:45], v21 offset:24576
    ds_read_b64_tr_b16 v[46:47], v21 offset:28672
    s_waitcnt lgkmcnt(10)
    v_mfma_f32_16x16x32_bf16 v[84:87], v[52:55], v[136:139], v[84:87]
    ds_read_b64_tr_b16 v[48:49], v22 offset:24576
    ds_read_b64_tr_b16 v[50:51], v22 offset:28672
    v_mfma_f32_16x16x32_bf16 v[88:91], v[56:59], v[136:139], v[88:91]
    ds_read_b64_tr_b16 v[52:53], v23 offset:24576
    ds_read_b64_tr_b16 v[54:55], v23 offset:28672
    s_waitcnt lgkmcnt(10)
    v_mfma_f32_16x16x32_bf16 v[92:95], v[60:63], v[136:139], v[92:95]
    ds_read_b64_tr_b16 v[56:57], v24 offset:24576
    ds_read_b64_tr_b16 v[58:59], v24 offset:28672
    s_waitcnt vmcnt(6)
    buffer_load_dwordx4 v8, s[44:47], s77 offen offset:2048 nt lds
    v_mfma_f32_16x16x32_bf16 v[64:67], v[32:35], v[140:143], v[64:67]
    ds_read_b64_tr_b16 v[60:61], v25 offset:24576
    ds_read_b64_tr_b16 v[62:63], v25 offset:28672
    s_waitcnt lgkmcnt(10)
    v_mfma_f32_16x16x32_bf16 v[68:71], v[36:39], v[140:143], v[68:71]
    v_mfma_f32_16x16x32_bf16 v[72:75], v[40:43], v[140:143], v[72:75]
    s_waitcnt lgkmcnt(6)
    v_mfma_f32_16x16x32_bf16 v[76:79], v[44:47], v[140:143], v[76:79]
    s_waitcnt vmcnt(6)
    buffer_load_dwordx4 v9, s[44:47], s77 offen offset:3072 nt lds
    s_xor_b32 s77, s3, 311296
    v_mfma_f32_16x16x32_bf16 v[80:83], v[48:51], v[140:143], v[80:83]
    s_waitcnt lgkmcnt(2)
    v_mfma_f32_16x16x32_bf16 v[84:87], v[52:55], v[140:143], v[84:87]
    v_mfma_f32_16x16x32_bf16 v[88:91], v[56:59], v[140:143], v[88:91]
    s_waitcnt lgkmcnt(0)
    v_mfma_f32_16x16x32_bf16 v[92:95], v[60:63], v[140:143], v[92:95]
    s_add_u32 m0, s79, 114688
    s_waitcnt vmcnt(6)
    buffer_load_dwordx4 v10, s[48:51], s78 offen offset:0  lds
    s_waitcnt vmcnt(13)
    s_barrier
    s_waitcnt vmcnt(6)
    buffer_load_dwordx4 v11, s[48:51], s78 offen offset:1024  lds
    s_add_u32 m0, s79, 32768
    s_waitcnt vmcnt(6)
    buffer_load_dwordx4 v4, s[40:43], s77 offen offset:0 nt lds
    s_waitcnt vmcnt(6)
    buffer_load_dwordx4 v5, s[40:43], s77 offen offset:1024 nt lds
    s_waitcnt vmcnt(6)
    buffer_load_dwordx4 v6, s[40:43], s77 offen offset:2048 nt lds
    s_waitcnt vmcnt(9)
    s_barrier
    s_waitcnt vmcnt(6)
    buffer_load_dwordx4 v7, s[40:43], s77 offen offset:3072 nt lds
    s_add_u32 m0, s79, 114688
    s_waitcnt vmcnt(6)
    buffer_load_dwordx4 v12, s[48:51], s78 offen offset:2048  lds
    s_waitcnt vmcnt(6)
    buffer_load_dwordx4 v13, s[48:51], s78 offen offset:3072  lds
    s_xor_b32 s78, s95, 2097920
    s_add_u32 m0, s79, 49152
    s_waitcnt vmcnt(6)
    buffer_load_dwordx4 v8, s[44:47], s77 offen offset:0 nt lds
    ds_read_b64_tr_b16 v[32:33], v18 offset:32768
    ds_read_b64_tr_b16 v[34:35], v18 offset:36864
    ds_read_b64_tr_b16 v[36:37], v19 offset:32768
    ds_read_b64_tr_b16 v[38:39], v19 offset:36864
    ds_read_b64_tr_b16 v[40:41], v20 offset:32768
    ds_read_b64_tr_b16 v[42:43], v20 offset:36864
    ds_read_b64_tr_b16 v[44:45], v21 offset:32768
    ds_read_b64_tr_b16 v[46:47], v21 offset:36864
    ds_read_b64_tr_b16 v[48:49], v22 offset:32768
    ds_read_b64_tr_b16 v[50:51], v22 offset:36864
    ds_read_b64_tr_b16 v[52:53], v23 offset:32768
    ds_read_b64_tr_b16 v[54:55], v23 offset:36864
    ds_read_b64_tr_b16 v[56:57], v24 offset:32768
    ds_read_b64_tr_b16 v[58:59], v24 offset:36864
    s_waitcnt lgkmcnt(12)
    v_mfma_f32_16x16x32_bf16 v[64:67], v[32:35], v[144:147], v[64:67]
    ds_read_b64_tr_b16 v[60:61], v25 offset:32768
    ds_read_b64_tr_b16 v[62:63], v25 offset:36864
    s_waitcnt lgkmcnt(10)
    v_mfma_f32_16x16x32_bf16 v[68:71], v[36:39], v[144:147], v[68:71]
    ds_read_b64_tr_b16 v[32:33], v18 offset:40960
    ds_read_b64_tr_b16 v[34:35], v18 offset:45056
    v_mfma_f32_16x16x32_bf16 v[72:75], v[40:43], v[144:147], v[72:75]
    ds_read_b64_tr_b16 v[36:37], v19 offset:40960
    ds_read_b64_tr_b16 v[38:39], v19 offset:45056
    s_waitcnt lgkmcnt(10)
    v_mfma_f32_16x16x32_bf16 v[76:79], v[44:47], v[144:147], v[76:79]
    ds_read_b64_tr_b16 v[40:41], v20 offset:40960
    ds_read_b64_tr_b16 v[42:43], v20 offset:45056
    s_waitcnt vmcnt(6)
    buffer_load_dwordx4 v9, s[44:47], s77 offen offset:1024 nt lds
    v_mfma_f32_16x16x32_bf16 v[80:83], v[48:51], v[144:147], v[80:83]
    ds_read_b64_tr_b16 v[44:45], v21 offset:40960
    ds_read_b64_tr_b16 v[46:47], v21 offset:45056
    s_waitcnt lgkmcnt(10)
    v_mfma_f32_16x16x32_bf16 v[84:87], v[52:55], v[144:147], v[84:87]
    ds_read_b64_tr_b16 v[48:49], v22 offset:40960
    ds_read_b64_tr_b16 v[50:51], v22 offset:45056
    v_mfma_f32_16x16x32_bf16 v[88:91], v[56:59], v[144:147], v[88:91]
    ds_read_b64_tr_b16 v[52:53], v23 offset:40960
    ds_read_b64_tr_b16 v[54:55], v23 offset:45056
    s_waitcnt lgkmcnt(10)
    v_mfma_f32_16x16x32_bf16 v[92:95], v[60:63], v[144:147], v[92:95]
    ds_read_b64_tr_b16 v[56:57], v24 offset:40960
    ds_read_b64_tr_b16 v[58:59], v24 offset:45056
    s_waitcnt vmcnt(6)
    buffer_load_dwordx4 v8, s[44:47], s77 offen offset:2048 nt lds
    v_mfma_f32_16x16x32_bf16 v[64:67], v[32:35], v[148:151], v[64:67]
    ds_read_b64_tr_b16 v[60:61], v25 offset:40960
    ds_read_b64_tr_b16 v[62:63], v25 offset:45056
    s_waitcnt lgkmcnt(10)
    v_mfma_f32_16x16x32_bf16 v[68:71], v[36:39], v[148:151], v[68:71]
    v_mfma_f32_16x16x32_bf16 v[72:75], v[40:43], v[148:151], v[72:75]
    s_waitcnt lgkmcnt(6)
    v_mfma_f32_16x16x32_bf16 v[76:79], v[44:47], v[148:151], v[76:79]
    s_waitcnt vmcnt(6)
    buffer_load_dwordx4 v9, s[44:47], s77 offen offset:3072 nt lds
    s_xor_b32 s77, s3, 327680
    v_mfma_f32_16x16x32_bf16 v[80:83], v[48:51], v[148:151], v[80:83]
    s_waitcnt lgkmcnt(2)
    v_mfma_f32_16x16x32_bf16 v[84:87], v[52:55], v[148:151], v[84:87]
    v_mfma_f32_16x16x32_bf16 v[88:91], v[56:59], v[148:151], v[88:91]
    s_waitcnt lgkmcnt(0)
    v_mfma_f32_16x16x32_bf16 v[92:95], v[60:63], v[148:151], v[92:95]
    s_add_u32 m0, s79, 65536
    s_waitcnt vmcnt(6)
    buffer_load_dwordx4 v10, s[48:51], s78 offen offset:0  lds
    s_waitcnt vmcnt(13)
    s_barrier
    s_waitcnt vmcnt(6)
    buffer_load_dwordx4 v11, s[48:51], s78 offen offset:1024  lds
    s_add_u32 m0, s79, 0
    s_waitcnt vmcnt(6)
    buffer_load_dwordx4 v4, s[40:43], s77 offen offset:0 nt lds
    s_waitcnt vmcnt(6)
    buffer_load_dwordx4 v5, s[40:43], s77 offen offset:1024 nt lds
    s_waitcnt vmcnt(6)
    buffer_load_dwordx4 v6, s[40:43], s77 offen offset:2048 nt lds
    s_waitcnt vmcnt(9)
    s_barrier
    s_waitcnt vmcnt(6)
    buffer_load_dwordx4 v7, s[40:43], s77 offen offset:3072 nt lds
    s_add_u32 m0, s79, 65536
    s_waitcnt vmcnt(6)
    buffer_load_dwordx4 v12, s[48:51], s78 offen offset:2048  lds
    s_waitcnt vmcnt(6)
    buffer_load_dwordx4 v13, s[48:51], s78 offen offset:3072  lds
    s_xor_b32 s78, s95, 2622208
    s_add_u32 m0, s79, 16384
    s_waitcnt vmcnt(6)
    buffer_load_dwordx4 v8, s[44:47], s77 offen offset:0 nt lds
    ds_read_b64_tr_b16 v[32:33], v18 offset:49152
    ds_read_b64_tr_b16 v[34:35], v18 offset:53248
    ds_read_b64_tr_b16 v[36:37], v19 offset:49152
    ds_read_b64_tr_b16 v[38:39], v19 offset:53248
    ds_read_b64_tr_b16 v[40:41], v20 offset:49152
    ds_read_b64_tr_b16 v[42:43], v20 offset:53248
    ds_read_b64_tr_b16 v[44:45], v21 offset:49152
    ds_read_b64_tr_b16 v[46:47], v21 offset:53248
    ds_read_b64_tr_b16 v[48:49], v22 offset:49152
    ds_read_b64_tr_b16 v[50:51], v22 offset:53248
    ds_read_b64_tr_b16 v[52:53], v23 offset:49152
    ds_read_b64_tr_b16 v[54:55], v23 offset:53248
    ds_read_b64_tr_b16 v[56:57], v24 offset:49152
    ds_read_b64_tr_b16 v[58:59], v24 offset:53248
    s_waitcnt lgkmcnt(12)
    v_mfma_f32_16x16x32_bf16 v[64:67], v[32:35], v[152:155], v[64:67]
    ds_read_b64_tr_b16 v[60:61], v25 offset:49152
    ds_read_b64_tr_b16 v[62:63], v25 offset:53248
    s_waitcnt lgkmcnt(10)
    v_mfma_f32_16x16x32_bf16 v[68:71], v[36:39], v[152:155], v[68:71]
    ds_read_b64_tr_b16 v[32:33], v18 offset:57344
    ds_read_b64_tr_b16 v[34:35], v18 offset:61440
    v_mfma_f32_16x16x32_bf16 v[72:75], v[40:43], v[152:155], v[72:75]
    ds_read_b64_tr_b16 v[36:37], v19 offset:57344
    ds_read_b64_tr_b16 v[38:39], v19 offset:61440
    s_waitcnt lgkmcnt(10)
    v_mfma_f32_16x16x32_bf16 v[76:79], v[44:47], v[152:155], v[76:79]
    ds_read_b64_tr_b16 v[40:41], v20 offset:57344
    ds_read_b64_tr_b16 v[42:43], v20 offset:61440
    v_mfma_f32_16x16x32_bf16 v[80:83], v[48:51], v[152:155], v[80:83]
    ds_read_b64_tr_b16 v[44:45], v21 offset:57344
    ds_read_b64_tr_b16 v[46:47], v21 offset:61440
    s_waitcnt vmcnt(6)
    buffer_load_dwordx4 v9, s[44:47], s77 offen offset:1024 nt lds
    s_waitcnt lgkmcnt(10)
    v_mfma_f32_16x16x32_bf16 v[84:87], v[52:55], v[152:155], v[84:87]
    ds_read_b64_tr_b16 v[48:49], v22 offset:57344
    ds_read_b64_tr_b16 v[50:51], v22 offset:61440
    v_mfma_f32_16x16x32_bf16 v[88:91], v[56:59], v[152:155], v[88:91]
    ds_read_b64_tr_b16 v[52:53], v23 offset:57344
    ds_read_b64_tr_b16 v[54:55], v23 offset:61440
    s_waitcnt lgkmcnt(10)
    v_mfma_f32_16x16x32_bf16 v[92:95], v[60:63], v[152:155], v[92:95]
    ds_read_b64_tr_b16 v[56:57], v24 offset:57344
    ds_read_b64_tr_b16 v[58:59], v24 offset:61440
    v_mfma_f32_16x16x32_bf16 v[64:67], v[32:35], v[156:159], v[64:67]
    ds_read_b64_tr_b16 v[60:61], v25 offset:57344
    ds_read_b64_tr_b16 v[62:63], v25 offset:61440
    s_waitcnt lgkmcnt(10)
    v_mfma_f32_16x16x32_bf16 v[68:71], v[36:39], v[156:159], v[68:71]
    s_waitcnt vmcnt(6)
    buffer_load_dwordx4 v8, s[44:47], s77 offen offset:2048 nt lds
    v_mfma_f32_16x16x32_bf16 v[72:75], v[40:43], v[156:159], v[72:75]
    s_waitcnt lgkmcnt(6)
    v_mfma_f32_16x16x32_bf16 v[76:79], v[44:47], v[156:159], v[76:79]
    v_mfma_f32_16x16x32_bf16 v[80:83], v[48:51], v[156:159], v[80:83]
    s_waitcnt lgkmcnt(2)
    v_mfma_f32_16x16x32_bf16 v[84:87], v[52:55], v[156:159], v[84:87]
    v_mfma_f32_16x16x32_bf16 v[88:91], v[56:59], v[156:159], v[88:91]
    s_waitcnt lgkmcnt(0)
    v_mfma_f32_16x16x32_bf16 v[92:95], v[60:63], v[156:159], v[92:95]
    s_waitcnt vmcnt(6)
    buffer_load_dwordx4 v9, s[44:47], s77 offen offset:3072 nt lds
    s_xor_b32 s77, s3, 344064
    s_waitcnt vmcnt(12)
    s_barrier
    s_add_u32 m0, s79, 81920
    s_waitcnt vmcnt(6)
    buffer_load_dwordx4 v10, s[48:51], s78 offen offset:0  lds
    s_waitcnt vmcnt(6)
    buffer_load_dwordx4 v11, s[48:51], s78 offen offset:1024  lds
    s_add_u32 m0, s79, 32768
    s_waitcnt vmcnt(6)
    buffer_load_dwordx4 v4, s[40:43], s77 offen offset:0 nt lds
    s_waitcnt vmcnt(6)
    buffer_load_dwordx4 v5, s[40:43], s77 offen offset:1024 nt lds
    s_waitcnt vmcnt(8)
    s_barrier
    s_waitcnt vmcnt(6)
    buffer_load_dwordx4 v6, s[40:43], s77 offen offset:2048 nt lds
    s_waitcnt vmcnt(6)
    buffer_load_dwordx4 v7, s[40:43], s77 offen offset:3072 nt lds
    s_add_u32 m0, s79, 81920
    s_waitcnt vmcnt(6)
    buffer_load_dwordx4 v12, s[48:51], s78 offen offset:2048  lds
    s_waitcnt vmcnt(6)
    buffer_load_dwordx4 v13, s[48:51], s78 offen offset:3072  lds
    s_xor_b32 s78, s95, 3146496
    ds_read_b64_tr_b16 v[32:33], v18 offset:0
    ds_read_b64_tr_b16 v[34:35], v18 offset:4096
    ds_read_b64_tr_b16 v[36:37], v19 offset:0
    ds_read_b64_tr_b16 v[38:39], v19 offset:4096
    ds_read_b64_tr_b16 v[40:41], v20 offset:0
    ds_read_b64_tr_b16 v[42:43], v20 offset:4096
    ds_read_b64_tr_b16 v[44:45], v21 offset:0
    ds_read_b64_tr_b16 v[46:47], v21 offset:4096
    ds_read_b64_tr_b16 v[48:49], v22 offset:0
    ds_read_b64_tr_b16 v[50:51], v22 offset:4096
    ds_read_b64_tr_b16 v[52:53], v23 offset:0
    ds_read_b64_tr_b16 v[54:55], v23 offset:4096
    ds_read_b64_tr_b16 v[56:57], v24 offset:0
    ds_read_b64_tr_b16 v[58:59], v24 offset:4096
    s_waitcnt lgkmcnt(12)
    v_mfma_f32_16x16x32_bf16 v[64:67], v[32:35], v[160:163], v[64:67]
    ds_read_b64_tr_b16 v[60:61], v25 offset:0
    ds_read_b64_tr_b16 v[62:63], v25 offset:4096
    s_waitcnt lgkmcnt(10)
    v_mfma_f32_16x16x32_bf16 v[68:71], v[36:39], v[160:163], v[68:71]
    ds_read_b64_tr_b16 v[32:33], v18 offset:8192
    ds_read_b64_tr_b16 v[34:35], v18 offset:12288
    v_mfma_f32_16x16x32_bf16 v[72:75], v[40:43], v[160:163], v[72:75]
    ds_read_b64_tr_b16 v[36:37], v19 offset:8192
    ds_read_b64_tr_b16 v[38:39], v19 offset:12288
    s_waitcnt lgkmcnt(10)
    v_mfma_f32_16x16x32_bf16 v[76:79], v[44:47], v[160:163], v[76:79]
    ds_read_b64_tr_b16 v[40:41], v20 offset:8192
    ds_read_b64_tr_b16 v[42:43], v20 offset:12288
    s_add_u32 m0, s79, 49152
    s_waitcnt vmcnt(6)
    buffer_load_dwordx4 v8, s[44:47], s77 offen offset:0 nt lds
    v_mfma_f32_16x16x32_bf16 v[80:83], v[48:51], v[160:163], v[80:83]
    ds_read_b64_tr_b16 v[44:45], v21 offset:8192
    ds_read_b64_tr_b16 v[46:47], v21 offset:12288
    s_waitcnt lgkmcnt(10)
    v_mfma_f32_16x16x32_bf16 v[84:87], v[52:55], v[160:163], v[84:87]
    ds_read_b64_tr_b16 v[48:49], v22 offset:8192
    ds_read_b64_tr_b16 v[50:51], v22 offset:12288
    v_mfma_f32_16x16x32_bf16 v[88:91], v[56:59], v[160:163], v[88:91]
    ds_read_b64_tr_b16 v[52:53], v23 offset:8192
    ds_read_b64_tr_b16 v[54:55], v23 offset:12288
    s_waitcnt lgkmcnt(10)
    v_mfma_f32_16x16x32_bf16 v[92:95], v[60:63], v[160:163], v[92:95]
    ds_read_b64_tr_b16 v[56:57], v24 offset:8192
    ds_read_b64_tr_b16 v[58:59], v24 offset:12288
    s_waitcnt vmcnt(6)
    buffer_load_dwordx4 v9, s[44:47], s77 offen offset:1024 nt lds
    v_mfma_f32_16x16x32_bf16 v[64:67], v[32:35], v[164:167], v[64:67]
    ds_read_b64_tr_b16 v[60:61], v25 offset:8192
    ds_read_b64_tr_b16 v[62:63], v25 offset:12288
    s_waitcnt lgkmcnt(10)
    v_mfma_f32_16x16x32_bf16 v[68:71], v[36:39], v[164:167], v[68:71]
    v_mfma_f32_16x16x32_bf16 v[72:75], v[40:43], v[164:167], v[72:75]
    s_waitcnt lgkmcnt(6)
    v_mfma_f32_16x16x32_bf16 v[76:79], v[44:47], v[164:167], v[76:79]
    s_waitcnt vmcnt(6)
    buffer_load_dwordx4 v8, s[44:47], s77 offen offset:2048 nt lds
    v_mfma_f32_16x16x32_bf16 v[80:83], v[48:51], v[164:167], v[80:83]
    s_waitcnt lgkmcnt(2)
    v_mfma_f32_16x16x32_bf16 v[84:87], v[52:55], v[164:167], v[84:87]
    v_mfma_f32_16x16x32_bf16 v[88:91], v[56:59], v[164:167], v[88:91]
    s_waitcnt lgkmcnt(0)
    v_mfma_f32_16x16x32_bf16 v[92:95], v[60:63], v[164:167], v[92:95]
    s_waitcnt vmcnt(6)
    buffer_load_dwordx4 v9, s[44:47], s77 offen offset:3072 nt lds
    s_xor_b32 s77, s3, 360448
    s_waitcnt vmcnt(12)
    s_barrier
    s_add_u32 m0, s79, 98304
    s_waitcnt vmcnt(6)
    buffer_load_dwordx4 v10, s[48:51], s78 offen offset:0  lds
    s_waitcnt vmcnt(6)
    buffer_load_dwordx4 v11, s[48:51], s78 offen offset:1024  lds
    s_add_u32 m0, s79, 0
    s_waitcnt vmcnt(6)
    buffer_load_dwordx4 v4, s[40:43], s77 offen offset:0 nt lds
    s_waitcnt vmcnt(6)
    buffer_load_dwordx4 v5, s[40:43], s77 offen offset:1024 nt lds
    s_waitcnt vmcnt(8)
    s_barrier
    s_waitcnt vmcnt(6)
    buffer_load_dwordx4 v6, s[40:43], s77 offen offset:2048 nt lds
    s_waitcnt vmcnt(6)
    buffer_load_dwordx4 v7, s[40:43], s77 offen offset:3072 nt lds
    s_add_u32 m0, s79, 98304
    s_waitcnt vmcnt(6)
    buffer_load_dwordx4 v12, s[48:51], s78 offen offset:2048  lds
    s_waitcnt vmcnt(6)
    buffer_load_dwordx4 v13, s[48:51], s78 offen offset:3072  lds
    s_xor_b32 s78, s95, 3670784
    ds_read_b64_tr_b16 v[32:33], v18 offset:16384
    ds_read_b64_tr_b16 v[34:35], v18 offset:20480
    ds_read_b64_tr_b16 v[36:37], v19 offset:16384
    ds_read_b64_tr_b16 v[38:39], v19 offset:20480
    ds_read_b64_tr_b16 v[40:41], v20 offset:16384
    ds_read_b64_tr_b16 v[42:43], v20 offset:20480
    ds_read_b64_tr_b16 v[44:45], v21 offset:16384
    ds_read_b64_tr_b16 v[46:47], v21 offset:20480
    ds_read_b64_tr_b16 v[48:49], v22 offset:16384
    ds_read_b64_tr_b16 v[50:51], v22 offset:20480
    ds_read_b64_tr_b16 v[52:53], v23 offset:16384
    ds_read_b64_tr_b16 v[54:55], v23 offset:20480
    ds_read_b64_tr_b16 v[56:57], v24 offset:16384
    ds_read_b64_tr_b16 v[58:59], v24 offset:20480
    s_waitcnt lgkmcnt(12)
    v_mfma_f32_16x16x32_bf16 v[64:67], v[32:35], v[168:171], v[64:67]
    ds_read_b64_tr_b16 v[60:61], v25 offset:16384
    ds_read_b64_tr_b16 v[62:63], v25 offset:20480
    s_waitcnt lgkmcnt(10)
    v_mfma_f32_16x16x32_bf16 v[68:71], v[36:39], v[168:171], v[68:71]
    ds_read_b64_tr_b16 v[32:33], v18 offset:24576
    ds_read_b64_tr_b16 v[34:35], v18 offset:28672
    v_mfma_f32_16x16x32_bf16 v[72:75], v[40:43], v[168:171], v[72:75]
    ds_read_b64_tr_b16 v[36:37], v19 offset:24576
    ds_read_b64_tr_b16 v[38:39], v19 offset:28672
    s_waitcnt lgkmcnt(10)
    v_mfma_f32_16x16x32_bf16 v[76:79], v[44:47], v[168:171], v[76:79]
    ds_read_b64_tr_b16 v[40:41], v20 offset:24576
    ds_read_b64_tr_b16 v[42:43], v20 offset:28672
    s_add_u32 m0, s79, 16384
    s_waitcnt vmcnt(6)
    buffer_load_dwordx4 v8, s[44:47], s77 offen offset:0 nt lds
    v_mfma_f32_16x16x32_bf16 v[80:83], v[48:51], v[168:171], v[80:83]
    ds_read_b64_tr_b16 v[44:45], v21 offset:24576
    ds_read_b64_tr_b16 v[46:47], v21 offset:28672
    s_waitcnt lgkmcnt(10)
    v_mfma_f32_16x16x32_bf16 v[84:87], v[52:55], v[168:171], v[84:87]
    ds_read_b64_tr_b16 v[48:49], v22 offset:24576
    ds_read_b64_tr_b16 v[50:51], v22 offset:28672
    v_mfma_f32_16x16x32_bf16 v[88:91], v[56:59], v[168:171], v[88:91]
    ds_read_b64_tr_b16 v[52:53], v23 offset:24576
    ds_read_b64_tr_b16 v[54:55], v23 offset:28672
    s_waitcnt lgkmcnt(10)
    v_mfma_f32_16x16x32_bf16 v[92:95], v[60:63], v[168:171], v[92:95]
    ds_read_b64_tr_b16 v[56:57], v24 offset:24576
    ds_read_b64_tr_b16 v[58:59], v24 offset:28672
    s_waitcnt vmcnt(6)
    buffer_load_dwordx4 v9, s[44:47], s77 offen offset:1024 nt lds
    v_mfma_f32_16x16x32_bf16 v[64:67], v[32:35], v[172:175], v[64:67]
    ds_read_b64_tr_b16 v[60:61], v25 offset:24576
    ds_read_b64_tr_b16 v[62:63], v25 offset:28672
    s_waitcnt lgkmcnt(10)
    v_mfma_f32_16x16x32_bf16 v[68:71], v[36:39], v[172:175], v[68:71]
    v_mfma_f32_16x16x32_bf16 v[72:75], v[40:43], v[172:175], v[72:75]
    s_waitcnt lgkmcnt(6)
    v_mfma_f32_16x16x32_bf16 v[76:79], v[44:47], v[172:175], v[76:79]
    s_waitcnt vmcnt(6)
    buffer_load_dwordx4 v8, s[44:47], s77 offen offset:2048 nt lds
    v_mfma_f32_16x16x32_bf16 v[80:83], v[48:51], v[172:175], v[80:83]
    s_waitcnt lgkmcnt(2)
    v_mfma_f32_16x16x32_bf16 v[84:87], v[52:55], v[172:175], v[84:87]
    v_mfma_f32_16x16x32_bf16 v[88:91], v[56:59], v[172:175], v[88:91]
    s_waitcnt lgkmcnt(0)
    v_mfma_f32_16x16x32_bf16 v[92:95], v[60:63], v[172:175], v[92:95]
    s_waitcnt vmcnt(6)
    buffer_load_dwordx4 v9, s[44:47], s77 offen offset:3072 nt lds
    s_xor_b32 s77, s3, 376832
    s_waitcnt vmcnt(12)
    s_barrier
    s_add_u32 m0, s79, 114688
    s_waitcnt vmcnt(6)
    buffer_load_dwordx4 v10, s[48:51], s78 offen offset:0  lds
    s_waitcnt vmcnt(6)
    buffer_load_dwordx4 v11, s[48:51], s78 offen offset:1024  lds
    s_add_u32 m0, s79, 32768
    s_waitcnt vmcnt(6)
    buffer_load_dwordx4 v4, s[40:43], s77 offen offset:0 nt lds
    s_waitcnt vmcnt(6)
    buffer_load_dwordx4 v5, s[40:43], s77 offen offset:1024 nt lds
    s_waitcnt vmcnt(8)
    s_barrier
    s_waitcnt vmcnt(5)
    buffer_load_dwordx4 v6, s[40:43], s77 offen offset:2048 nt lds
    s_waitcnt vmcnt(5)
    buffer_load_dwordx4 v7, s[40:43], s77 offen offset:3072 nt lds
    s_add_u32 m0, s79, 114688
    s_waitcnt vmcnt(5)
    buffer_load_dwordx4 v12, s[48:51], s78 offen offset:2048  lds
    s_waitcnt vmcnt(5)
    buffer_load_dwordx4 v13, s[48:51], s78 offen offset:3072  lds
    s_xor_b32 s78, s95, 0
    ds_read_b64_tr_b16 v[32:33], v18 offset:32768
    ds_read_b64_tr_b16 v[34:35], v18 offset:36864
    ds_read_b64_tr_b16 v[36:37], v19 offset:32768
    ds_read_b64_tr_b16 v[38:39], v19 offset:36864
    ds_read_b64_tr_b16 v[40:41], v20 offset:32768
    ds_read_b64_tr_b16 v[42:43], v20 offset:36864
    ds_read_b64_tr_b16 v[44:45], v21 offset:32768
    ds_read_b64_tr_b16 v[46:47], v21 offset:36864
    ds_read_b64_tr_b16 v[48:49], v22 offset:32768
    ds_read_b64_tr_b16 v[50:51], v22 offset:36864
    ds_read_b64_tr_b16 v[52:53], v23 offset:32768
    ds_read_b64_tr_b16 v[54:55], v23 offset:36864
    ds_read_b64_tr_b16 v[56:57], v24 offset:32768
    ds_read_b64_tr_b16 v[58:59], v24 offset:36864
    s_waitcnt lgkmcnt(12)
    v_mfma_f32_16x16x32_bf16 v[64:67], v[32:35], v[176:179], v[64:67]
    ds_read_b64_tr_b16 v[60:61], v25 offset:32768
    ds_read_b64_tr_b16 v[62:63], v25 offset:36864
    s_waitcnt lgkmcnt(10)
    v_mfma_f32_16x16x32_bf16 v[68:71], v[36:39], v[176:179], v[68:71]
    ds_read_b64_tr_b16 v[32:33], v18 offset:40960
    ds_read_b64_tr_b16 v[34:35], v18 offset:45056
    v_mfma_f32_16x16x32_bf16 v[72:75], v[40:43], v[176:179], v[72:75]
    ds_read_b64_tr_b16 v[36:37], v19 offset:40960
    ds_read_b64_tr_b16 v[38:39], v19 offset:45056
    s_waitcnt lgkmcnt(10)
    v_mfma_f32_16x16x32_bf16 v[76:79], v[44:47], v[176:179], v[76:79]
    ds_read_b64_tr_b16 v[40:41], v20 offset:40960
    ds_read_b64_tr_b16 v[42:43], v20 offset:45056
    v_mfma_f32_16x16x32_bf16 v[80:83], v[48:51], v[176:179], v[80:83]
    ds_read_b64_tr_b16 v[44:45], v21 offset:40960
    ds_read_b64_tr_b16 v[46:47], v21 offset:45056
    s_waitcnt lgkmcnt(10)
    v_mfma_f32_16x16x32_bf16 v[84:87], v[52:55], v[176:179], v[84:87]
    ds_read_b64_tr_b16 v[48:49], v22 offset:40960
    ds_read_b64_tr_b16 v[50:51], v22 offset:45056
    v_mfma_f32_16x16x32_bf16 v[88:91], v[56:59], v[176:179], v[88:91]
    ds_read_b64_tr_b16 v[52:53], v23 offset:40960
    ds_read_b64_tr_b16 v[54:55], v23 offset:45056
    s_waitcnt lgkmcnt(10)
    v_mfma_f32_16x16x32_bf16 v[92:95], v[60:63], v[176:179], v[92:95]
    ds_read_b64_tr_b16 v[56:57], v24 offset:40960
    ds_read_b64_tr_b16 v[58:59], v24 offset:45056
    s_add_u32 m0, s79, 49152
    s_waitcnt vmcnt(5)
    buffer_load_dwordx4 v8, s[44:47], s77 offen offset:0 nt lds
    v_mfma_f32_16x16x32_bf16 v[64:67], v[32:35], v[180:183], v[64:67]
    ds_read_b64_tr_b16 v[60:61], v25 offset:40960
    ds_read_b64_tr_b16 v[62:63], v25 offset:45056
    s_waitcnt lgkmcnt(10)
    v_mfma_f32_16x16x32_bf16 v[68:71], v[36:39], v[180:183], v[68:71]
    v_mfma_f32_16x16x32_bf16 v[72:75], v[40:43], v[180:183], v[72:75]
    s_waitcnt lgkmcnt(6)
    v_mfma_f32_16x16x32_bf16 v[76:79], v[44:47], v[180:183], v[76:79]
    v_mfma_f32_16x16x32_bf16 v[80:83], v[48:51], v[180:183], v[80:83]
    s_waitcnt lgkmcnt(2)
    v_mfma_f32_16x16x32_bf16 v[84:87], v[52:55], v[180:183], v[84:87]
    v_mfma_f32_16x16x32_bf16 v[88:91], v[56:59], v[180:183], v[88:91]
    s_waitcnt lgkmcnt(0)
    v_mfma_f32_16x16x32_bf16 v[92:95], v[60:63], v[180:183], v[92:95]
    s_waitcnt vmcnt(5)
    buffer_load_dwordx4 v9, s[44:47], s77 offen offset:1024 nt lds
    s_waitcnt vmcnt(10)
    s_barrier
    s_waitcnt vmcnt(5)
    buffer_load_dwordx4 v8, s[44:47], s77 offen offset:2048 nt lds
    s_waitcnt vmcnt(5)
    buffer_load_dwordx4 v9, s[44:47], s77 offen offset:3072 nt lds
    s_xor_b32 s77, s3, 393216
    s_add_u32 m0, s79, 0
    s_waitcnt vmcnt(5)
    buffer_load_dwordx4 v4, s[40:43], s77 offen offset:0 nt lds
    s_waitcnt vmcnt(5)
    buffer_load_dwordx4 v5, s[40:43], s77 offen offset:1024 nt lds
    s_waitcnt vmcnt(6)
    s_barrier
    s_waitcnt vmcnt(5)
    buffer_load_dwordx4 v6, s[40:43], s77 offen offset:2048 nt lds
    s_waitcnt vmcnt(5)
    buffer_load_dwordx4 v7, s[40:43], s77 offen offset:3072 nt lds
    s_add_u32 s74, s80, 1
    s_and_b32 s74, s74, 7
    s_lshl_b32 s74, s74, 7
    s_or_b32 s74, s74, s82
    s_xor_b32 s74, s74, 0
    s_add_u32 m0, s79, 65536
    s_waitcnt vmcnt(5)
    buffer_load_dwordx4 v14, s[52:55], s74 offen offset:0  lds
    s_add_u32 m0, s79, 16384
    s_waitcnt vmcnt(5)
    buffer_load_dwordx4 v8, s[44:47], s77 offen offset:0 nt lds
    ds_read_b64_tr_b16 v[32:33], v18 offset:49152
    ds_read_b64_tr_b16 v[34:35], v18 offset:53248
    ds_read_b64_tr_b16 v[36:37], v19 offset:49152
    ds_read_b64_tr_b16 v[38:39], v19 offset:53248
    ds_read_b64_tr_b16 v[40:41], v20 offset:49152
    ds_read_b64_tr_b16 v[42:43], v20 offset:53248
    ds_read_b64_tr_b16 v[44:45], v21 offset:49152
    ds_read_b64_tr_b16 v[46:47], v21 offset:53248
    ds_read_b64_tr_b16 v[48:49], v22 offset:49152
    ds_read_b64_tr_b16 v[50:51], v22 offset:53248
    ds_read_b64_tr_b16 v[52:53], v23 offset:49152
    ds_read_b64_tr_b16 v[54:55], v23 offset:53248
    ds_read_b64_tr_b16 v[56:57], v24 offset:49152
    ds_read_b64_tr_b16 v[58:59], v24 offset:53248
    s_waitcnt lgkmcnt(12)
    v_mfma_f32_16x16x32_bf16 v[64:67], v[32:35], v[184:187], v[64:67]
    ds_read_b64_tr_b16 v[60:61], v25 offset:49152
    ds_read_b64_tr_b16 v[62:63], v25 offset:53248
    s_waitcnt lgkmcnt(10)
    v_mfma_f32_16x16x32_bf16 v[68:71], v[36:39], v[184:187], v[68:71]
    ds_read_b64_tr_b16 v[32:33], v18 offset:57344
    ds_read_b64_tr_b16 v[34:35], v18 offset:61440
    v_mfma_f32_16x16x32_bf16 v[72:75], v[40:43], v[184:187], v[72:75]
    ds_read_b64_tr_b16 v[36:37], v19 offset:57344
    ds_read_b64_tr_b16 v[38:39], v19 offset:61440
    s_waitcnt lgkmcnt(10)
    v_mfma_f32_16x16x32_bf16 v[76:79], v[44:47], v[184:187], v[76:79]
    ds_read_b64_tr_b16 v[40:41], v20 offset:57344
    ds_read_b64_tr_b16 v[42:43], v20 offset:61440
    v_mfma_f32_16x16x32_bf16 v[80:83], v[48:51], v[184:187], v[80:83]
    ds_read_b64_tr_b16 v[44:45], v21 offset:57344
    ds_read_b64_tr_b16 v[46:47], v21 offset:61440
    s_waitcnt lgkmcnt(10)
    v_mfma_f32_16x16x32_bf16 v[84:87], v[52:55], v[184:187], v[84:87]
    ds_read_b64_tr_b16 v[48:49], v22 offset:57344
    ds_read_b64_tr_b16 v[50:51], v22 offset:61440
    v_mfma_f32_16x16x32_bf16 v[88:91], v[56:59], v[184:187], v[88:91]
    ds_read_b64_tr_b16 v[52:53], v23 offset:57344
    ds_read_b64_tr_b16 v[54:55], v23 offset:61440
    s_waitcnt lgkmcnt(10)
    v_mfma_f32_16x16x32_bf16 v[92:95], v[60:63], v[184:187], v[92:95]
    ds_read_b64_tr_b16 v[56:57], v24 offset:57344
    ds_read_b64_tr_b16 v[58:59], v24 offset:61440
    s_waitcnt vmcnt(5)
    buffer_load_dwordx4 v9, s[44:47], s77 offen offset:1024 nt lds
    v_mfma_f32_16x16x32_bf16 v[64:67], v[32:35], v[188:191], v[64:67]
    ds_read_b64_tr_b16 v[60:61], v25 offset:57344
    ds_read_b64_tr_b16 v[62:63], v25 offset:61440
    s_waitcnt lgkmcnt(10)
    v_mfma_f32_16x16x32_bf16 v[68:71], v[36:39], v[188:191], v[68:71]
    v_mfma_f32_16x16x32_bf16 v[72:75], v[40:43], v[188:191], v[72:75]
    s_waitcnt lgkmcnt(6)
    v_mfma_f32_16x16x32_bf16 v[76:79], v[44:47], v[188:191], v[76:79]
    v_mfma_f32_16x16x32_bf16 v[80:83], v[48:51], v[188:191], v[80:83]
    s_waitcnt lgkmcnt(2)
    v_mfma_f32_16x16x32_bf16 v[84:87], v[52:55], v[188:191], v[84:87]
    v_mfma_f32_16x16x32_bf16 v[88:91], v[56:59], v[188:191], v[88:91]
    s_waitcnt lgkmcnt(0)
    v_mfma_f32_16x16x32_bf16 v[92:95], v[60:63], v[188:191], v[92:95]
    s_waitcnt vmcnt(5)
    buffer_load_dwordx4 v8, s[44:47], s77 offen offset:2048 nt lds
    s_waitcnt vmcnt(8)
    s_barrier
    s_setprio 1
    s_waitcnt vmcnt(5)
    buffer_load_dwordx4 v9, s[44:47], s77 offen offset:3072 nt lds
    s_xor_b32 s77, s3, 409600
    v_mul_f32 v64, s92, v64
    v_mul_f32 v65, s92, v65
    v_mul_f32 v66, s92, v66
    v_mul_f32 v67, s92, v67
    v_cvt_pk_bf16_f32 v32, v64, v65
    v_cvt_pk_bf16_f32 v33, v66, v67
    ds_write_b64 v27, v[32:33] offset:0
    v_mul_f32 v68, s92, v68
    v_mul_f32 v69, s92, v69
    v_mul_f32 v70, s92, v70
    v_mul_f32 v71, s92, v71
    v_cvt_pk_bf16_f32 v34, v68, v69
    v_cvt_pk_bf16_f32 v35, v70, v71
    ds_write_b64 v27, v[34:35] offset:512
    v_mul_f32 v72, s92, v72
    v_mul_f32 v73, s92, v73
    v_mul_f32 v74, s92, v74
    v_mul_f32 v75, s92, v75
    v_cvt_pk_bf16_f32 v36, v72, v73
    v_cvt_pk_bf16_f32 v37, v74, v75
    ds_write_b64 v27, v[36:37] offset:1024
    v_mul_f32 v76, s92, v76
    v_mul_f32 v77, s92, v77
    v_mul_f32 v78, s92, v78
    v_mul_f32 v79, s92, v79
    v_cvt_pk_bf16_f32 v38, v76, v77
    v_cvt_pk_bf16_f32 v39, v78, v79
    ds_write_b64 v27, v[38:39] offset:1536
    s_add_u32 m0, s79, 65536
    s_waitcnt vmcnt(5)
    buffer_load_dwordx4 v15, s[52:55], s74 offen offset:1024  lds
    v_mul_f32 v80, s92, v80
    v_mul_f32 v81, s92, v81
    v_mul_f32 v82, s92, v82
    v_mul_f32 v83, s92, v83
    v_cvt_pk_bf16_f32 v40, v80, v81
    v_cvt_pk_bf16_f32 v41, v82, v83
    ds_write_b64 v27, v[40:41] offset:2048
    v_mul_f32 v84, s92, v84
    v_mul_f32 v85, s92, v85
    v_mul_f32 v86, s92, v86
    v_mul_f32 v87, s92, v87
    v_cvt_pk_bf16_f32 v42, v84, v85
    v_cvt_pk_bf16_f32 v43, v86, v87
    ds_write_b64 v27, v[42:43] offset:2560
    v_mul_f32 v88, s92, v88
    v_mul_f32 v89, s92, v89
    v_mul_f32 v90, s92, v90
    v_mul_f32 v91, s92, v91
    v_cvt_pk_bf16_f32 v44, v88, v89
    v_cvt_pk_bf16_f32 v45, v90, v91
    ds_write_b64 v27, v[44:45] offset:3072
    v_mul_f32 v92, s92, v92
    v_mul_f32 v93, s92, v93
    v_mul_f32 v94, s92, v94
    v_mul_f32 v95, s92, v95
    v_cvt_pk_bf16_f32 v46, v92, v93
    v_cvt_pk_bf16_f32 v47, v94, v95
    ds_write_b64 v27, v[46:47] offset:3584
    s_add_u32 m0, s79, 32768
    s_waitcnt vmcnt(5)
    buffer_load_dwordx4 v4, s[40:43], s77 offen offset:0 nt lds
    s_waitcnt vmcnt(5)
    buffer_load_dwordx4 v5, s[40:43], s77 offen offset:1024 nt lds
    s_setprio 0
    s_waitcnt lgkmcnt(0)
    s_waitcnt vmcnt(8)
    s_barrier
    v_lshlrev_b32 v128, 24, v0
    s_mov_b32 s81, 0x40000
    v_lshl_add_u32 v129, v0, 4, s79
    s_add_u32 s73, s85, 131072
    v_lshl_add_u32 v130, v0, 4, s73
    s_lshl_b32 s83, s80, 17
    s_lshl_b32 s73, s72, 16
    s_lshl_b32 s75, s90, 10
    s_add_u32 s73, s73, s75
    s_lshl_b32 s75, s80, 7
    s_add_u32 s73, s73, s75
    v_lshrrev_b32 v1, 3, v0
    v_and_b32 v2, 7, v0
    v_lshl_add_u32 v132, v1, 11, s73
    v_lshl_add_u32 v132, v2, 4, v132
    s_add_u32 s73, s85, 131072
    v_xor_b32 v3, v1, v2
    v_lshl_add_u32 v133, v1, 7, s73
    v_lshl_add_u32 v133, v3, 4, v133
    v_and_b32 v1, 15, v0
    v_lshl_add_u32 v10, v1, 7, s73
    v_lshrrev_b32 v3, 5, v0
    v_xor_b32 v3, v3, v2
    v_lshl_add_u32 v10, v3, 4, v10
    v_bfe_u32 v1, v0, 4, 1
    v_lshl_add_u32 v10, v1, 3, v10
    v_xor_b32 v11, 32, v10
    v_xor_b32 v12, 64, v10
    v_xor_b32 v13, 96, v10
    s_mov_b32 s37, 16384
    s_mov_b32 s38, 32768
    s_mov_b32 s39, 49152
    v_bfe_u32 v1, v0, 2, 2
    v_lshrrev_b32 v2, 4, v0
    v_and_b32 v3, 1, v0
    v_lshlrev_b32 v3, 4, v3
    v_mov_b32 v28, 0x3f80
    v_lshlrev_b32 v3, v3, v28
    v_cmp_eq_u32 vcc, v1, v2
    v_bfe_u32 v1, v0, 1, 1
    v_mov_b32 v136, 0
    v_cndmask_b32 v3, 0, v3, vcc
    v_cmp_eq_u32 vcc, 0, v1
    v_mov_b32 v137, 0
    v_mov_b32 v142, 0
    v_cndmask_b32 v138, 0, v3, vcc
    v_mov_b32 v143, 0
    v_sub_u32 v139, v3, v138
    v_mov_b32 v140, v138
    v_mov_b32 v141, v139
    v_mov_b32 v28, -1
    v_mov_b32 v29, -1
    v_mov_b32 v30, -1
    v_mov_b32 v31, -1
    s_waitcnt vmcnt(6)
    buffer_load_dwordx4 v6, s[40:43], s77 offen offset:2048 nt lds
    s_waitcnt vmcnt(6)
    buffer_load_dwordx4 v7, s[40:43], s77 offen offset:3072 nt lds
    s_add_u32 m0, s79, 65536
    s_waitcnt vmcnt(6)
    buffer_load_dwordx4 v16, s[52:55], s74 offen offset:2048  lds
    s_add_u32 m0, s79, 49152
    s_waitcnt vmcnt(6)
    buffer_load_dwordx4 v8, s[44:47], s77 offen offset:0 nt lds
    s_waitcnt vmcnt(6)
    buffer_load_dwordx4 v9, s[44:47], s77 offen offset:1024 nt lds
    s_waitcnt vmcnt(6)
    buffer_load_dwordx4 v8, s[44:47], s77 offen offset:2048 nt lds
    s_waitcnt vmcnt(6)
    buffer_load_dwordx4 v9, s[44:47], s77 offen offset:3072 nt lds
    s_xor_b32 s77, s3, 425984
    s_add_u32 m0, s79, 65536
    s_waitcnt vmcnt(6)
    buffer_load_dwordx4 v17, s[52:55], s74 offen offset:3072  lds
    s_waitcnt vmcnt(11)
    s_barrier
    s_add_u32 m0, s79, 0
    s_waitcnt vmcnt(6)
    buffer_load_dwordx4 v4, s[40:43], s77 offen offset:0 nt lds
    s_waitcnt vmcnt(6)
    buffer_load_dwordx4 v5, s[40:43], s77 offen offset:1024 nt lds
    s_waitcnt vmcnt(6)
    buffer_load_dwordx4 v6, s[40:43], s77 offen offset:2048 nt lds
    s_waitcnt vmcnt(9)
    s_barrier
    s_waitcnt vmcnt(6)
    buffer_load_dwordx4 v7, s[40:43], s77 offen offset:3072 nt lds
    s_add_u32 s74, s80, 1
    s_and_b32 s74, s74, 7
    s_lshl_b32 s74, s74, 7
    s_or_b32 s74, s74, s82
    s_xor_b32 s74, s74, 131072
    s_add_u32 m0, s79, 81920
    s_waitcnt vmcnt(6)
    buffer_load_dwordx4 v14, s[52:55], s74 offen offset:0  lds
    s_add_u32 m0, s79, 16384
    s_waitcnt vmcnt(6)
    buffer_load_dwordx4 v8, s[44:47], s77 offen offset:0 nt lds
    s_waitcnt vmcnt(6)
    buffer_load_dwordx4 v9, s[44:47], s77 offen offset:1024 nt lds
    s_waitcnt vmcnt(6)
    buffer_load_dwordx4 v8, s[44:47], s77 offen offset:2048 nt lds
    s_waitcnt vmcnt(9)
    s_barrier
    s_waitcnt vmcnt(6)
    buffer_load_dwordx4 v9, s[44:47], s77 offen offset:3072 nt lds
    s_xor_b32 s77, s3, 442368
    s_add_u32 m0, s79, 81920
    s_waitcnt vmcnt(6)
    buffer_load_dwordx4 v15, s[52:55], s74 offen offset:1024  lds
    s_add_u32 m0, s79, 32768
    s_waitcnt vmcnt(6)
    buffer_load_dwordx4 v4, s[40:43], s77 offen offset:0 nt lds
    s_waitcnt vmcnt(6)
    buffer_load_dwordx4 v5, s[40:43], s77 offen offset:1024 nt lds
    s_waitcnt vmcnt(8)
    s_barrier
    s_waitcnt vmcnt(6)
    buffer_load_dwordx4 v6, s[40:43], s77 offen offset:2048 nt lds
    s_waitcnt vmcnt(6)
    buffer_load_dwordx4 v7, s[40:43], s77 offen offset:3072 nt lds
    s_add_u32 m0, s79, 81920
    s_waitcnt vmcnt(6)
    buffer_load_dwordx4 v16, s[52:55], s74 offen offset:2048  lds
    s_add_u32 m0, s79, 49152
    s_waitcnt vmcnt(6)
    buffer_load_dwordx4 v8, s[44:47], s77 offen offset:0 nt lds
    s_waitcnt vmcnt(6)
    buffer_load_dwordx4 v9, s[44:47], s77 offen offset:1024 nt lds
    s_waitcnt vmcnt(8)
    s_barrier
    s_waitcnt vmcnt(6)
    buffer_load_dwordx4 v8, s[44:47], s77 offen offset:2048 nt lds
    s_waitcnt vmcnt(6)
    buffer_load_dwordx4 v9, s[44:47], s77 offen offset:3072 nt lds
    s_xor_b32 s77, s3, 458752
    s_add_u32 m0, s79, 81920
    s_waitcnt vmcnt(6)
    buffer_load_dwordx4 v17, s[52:55], s74 offen offset:3072  lds
    s_add_u32 m0, s79, 0
    s_waitcnt vmcnt(6)
    buffer_load_dwordx4 v4, s[40:43], s77 offen offset:0 nt lds
    s_waitcnt vmcnt(7)
    s_barrier
    s_waitcnt vmcnt(6)
    buffer_load_dwordx4 v5, s[40:43], s77 offen offset:1024 nt lds
    s_waitcnt vmcnt(6)
    buffer_load_dwordx4 v6, s[40:43], s77 offen offset:2048 nt lds
    s_waitcnt vmcnt(6)
    buffer_load_dwordx4 v7, s[40:43], s77 offen offset:3072 nt lds
    s_add_u32 s74, s80, 1
    s_and_b32 s74, s74, 7
    s_lshl_b32 s74, s74, 7
    s_or_b32 s74, s74, s82
    s_xor_b32 s74, s74, 262144
    s_add_u32 m0, s79, 98304
    s_waitcnt vmcnt(6)
    buffer_load_dwordx4 v14, s[52:55], s74 offen offset:0  lds
    s_add_u32 m0, s79, 16384
    s_waitcnt vmcnt(6)
    buffer_load_dwordx4 v8, s[44:47], s77 offen offset:0 nt lds
    s_waitcnt vmcnt(7)
    s_barrier
    s_waitcnt vmcnt(6)
    buffer_load_dwordx4 v9, s[44:47], s77 offen offset:1024 nt lds
    s_waitcnt vmcnt(6)
    buffer_load_dwordx4 v8, s[44:47], s77 offen offset:2048 nt lds
    s_waitcnt vmcnt(6)
    buffer_load_dwordx4 v9, s[44:47], s77 offen offset:3072 nt lds
    s_xor_b32 s77, s3, 475136
    s_add_u32 m0, s79, 98304
    s_waitcnt vmcnt(6)
    buffer_load_dwordx4 v15, s[52:55], s74 offen offset:1024  lds
    s_waitcnt vmcnt(6)
    s_barrier
    s_add_u32 m0, s79, 32768
    s_waitcnt vmcnt(6)
    buffer_load_dwordx4 v4, s[40:43], s77 offen offset:0 nt lds
    s_waitcnt vmcnt(6)
    buffer_load_dwordx4 v5, s[40:43], s77 offen offset:1024 nt lds
    s_waitcnt vmcnt(6)
    buffer_load_dwordx4 v6, s[40:43], s77 offen offset:2048 nt lds
    s_waitcnt vmcnt(6)
    buffer_load_dwordx4 v7, s[40:43], s77 offen offset:3072 nt lds
    s_add_u32 m0, s79, 98304
    s_waitcnt vmcnt(6)
    buffer_load_dwordx4 v16, s[52:55], s74 offen offset:2048  lds
    s_waitcnt vmcnt(6)
    s_barrier
    s_add_u32 m0, s79, 49152
    s_waitcnt vmcnt(6)
    buffer_load_dwordx4 v8, s[44:47], s77 offen offset:0 nt lds
    s_waitcnt vmcnt(6)
    buffer_load_dwordx4 v9, s[44:47], s77 offen offset:1024 nt lds
    s_waitcnt vmcnt(6)
    buffer_load_dwordx4 v8, s[44:47], s77 offen offset:2048 nt lds
    s_waitcnt vmcnt(6)
    buffer_load_dwordx4 v9, s[44:47], s77 offen offset:3072 nt lds
    s_xor_b32 s77, s3, 491520
    s_waitcnt vmcnt(5)
    s_barrier
    s_add_u32 m0, s79, 98304
    s_waitcnt vmcnt(6)
    buffer_load_dwordx4 v17, s[52:55], s74 offen offset:3072  lds
    s_add_u32 m0, s79, 0
    s_waitcnt vmcnt(6)
    buffer_load_dwordx4 v4, s[40:43], s77 offen offset:0 nt lds
    s_waitcnt vmcnt(6)
    buffer_load_dwordx4 v5, s[40:43], s77 offen offset:1024 nt lds
    s_waitcnt vmcnt(6)
    buffer_load_dwordx4 v6, s[40:43], s77 offen offset:2048 nt lds
    s_waitcnt vmcnt(6)
    buffer_load_dwordx4 v7, s[40:43], s77 offen offset:3072 nt lds
    s_add_u32 s74, s80, 1
    s_and_b32 s74, s74, 7
    s_lshl_b32 s74, s74, 7
    s_or_b32 s74, s74, s82
    s_xor_b32 s74, s74, 393216
    s_add_u32 m0, s79, 114688
    s_waitcnt vmcnt(6)
    buffer_load_dwordx4 v14, s[52:55], s74 offen offset:0  lds
    s_waitcnt vmcnt(6)
    s_barrier
    s_add_u32 m0, s79, 16384
    s_waitcnt vmcnt(6)
    buffer_load_dwordx4 v8, s[44:47], s77 offen offset:0 nt lds
    s_waitcnt vmcnt(6)
    buffer_load_dwordx4 v9, s[44:47], s77 offen offset:1024 nt lds
    s_waitcnt vmcnt(6)
    buffer_load_dwordx4 v8, s[44:47], s77 offen offset:2048 nt lds
    s_waitcnt vmcnt(6)
    buffer_load_dwordx4 v9, s[44:47], s77 offen offset:3072 nt lds
    s_xor_b32 s77, s3, 507904
    s_waitcnt vmcnt(5)
    s_barrier
    s_add_u32 m0, s79, 114688
    s_waitcnt vmcnt(6)
    buffer_load_dwordx4 v15, s[52:55], s74 offen offset:1024  lds
    s_add_u32 m0, s79, 32768
    s_waitcnt vmcnt(6)
    buffer_load_dwordx4 v4, s[40:43], s77 offen offset:0 nt lds
    s_waitcnt vmcnt(6)
    buffer_load_dwordx4 v5, s[40:43], s77 offen offset:1024 nt lds
    s_waitcnt vmcnt(6)
    buffer_load_dwordx4 v6, s[40:43], s77 offen offset:2048 nt lds
    s_waitcnt vmcnt(6)
    buffer_load_dwordx4 v7, s[40:43], s77 offen offset:3072 nt lds
    s_add_u32 m0, s79, 114688
    s_waitcnt vmcnt(6)
    buffer_load_dwordx4 v16, s[52:55], s74 offen offset:2048  lds
    s_waitcnt vmcnt(6)
    s_barrier
    s_add_u32 m0, s79, 49152
    s_waitcnt vmcnt(6)
    buffer_load_dwordx4 v8, s[44:47], s77 offen offset:0 nt lds
    s_waitcnt vmcnt(6)
    buffer_load_dwordx4 v9, s[44:47], s77 offen offset:1024 nt lds
    s_waitcnt vmcnt(6)
    buffer_load_dwordx4 v8, s[44:47], s77 offen offset:2048 nt lds
    s_waitcnt vmcnt(6)
    buffer_load_dwordx4 v9, s[44:47], s77 offen offset:3072 nt lds
    s_xor_b32 s77, s3, 524288
    s_add_u32 m0, s79, 114688
    s_waitcnt vmcnt(6)
    buffer_load_dwordx4 v17, s[52:55], s74 offen offset:3072  lds
    s_waitcnt vmcnt(6)
    s_barrier
    s_add_u32 s74, s80, 2
    s_and_b32 s74, s74, 7
    s_lshl_b32 s74, s74, 7
    s_or_b32 s74, s74, s82
    s_xor_b32 s74, s74, 0
    s_add_u32 m0, s79, 0
    s_nop 0
    buffer_load_dwordx4 v14, s[52:55], s74 offen offset:0  lds
    buffer_load_dwordx4 v15, s[52:55], s74 offen offset:1024  lds
    buffer_load_dwordx4 v16, s[52:55], s74 offen offset:2048  lds
    buffer_load_dwordx4 v17, s[52:55], s74 offen offset:3072  lds
    s_add_u32 s74, s80, 2
    s_and_b32 s74, s74, 7
    s_lshl_b32 s74, s74, 7
    s_or_b32 s74, s74, s82
    s_xor_b32 s74, s74, 131072
    s_add_u32 m0, s79, 16384
    s_nop 0
    buffer_load_dwordx4 v14, s[52:55], s74 offen offset:0  lds
    buffer_load_dwordx4 v15, s[52:55], s74 offen offset:1024  lds
    buffer_load_dwordx4 v16, s[52:55], s74 offen offset:2048  lds
    buffer_load_dwordx4 v17, s[52:55], s74 offen offset:3072  lds
    s_xor_b32 s75, s89, 0
    s_lshl_b32 s75, s75, 15
    s_add_u32 s75, s75, s85
    v_lshlrev_b32 v1, 7, v0
    buffer_load_dword v2, v1, s[52:55], s75 offen
    s_waitcnt vmcnt(10)
    s_barrier
    s_add_u32 s74, s80, 2
    s_and_b32 s74, s74, 7
    s_lshl_b32 s74, s74, 7
    s_or_b32 s74, s74, s82
    s_xor_b32 s74, s74, 262144
    s_add_u32 m0, s79, 32768
    s_nop 0
    buffer_load_dwordx4 v14, s[52:55], s74 offen offset:0  lds
    buffer_load_dwordx4 v15, s[52:55], s74 offen offset:1024  lds
    buffer_load_dwordx4 v16, s[52:55], s74 offen offset:2048  lds
    buffer_load_dwordx4 v17, s[52:55], s74 offen offset:3072  lds
    s_waitcnt vmcnt(14)
    s_barrier
    s_add_u32 s74, s80, 2
    s_and_b32 s74, s74, 7
    s_lshl_b32 s74, s74, 7
    s_or_b32 s74, s74, s82
    s_xor_b32 s74, s74, 393216
    s_add_u32 m0, s79, 49152
    s_nop 0
    buffer_load_dwordx4 v14, s[52:55], s74 offen offset:0  lds
    buffer_load_dwordx4 v15, s[52:55], s74 offen offset:1024  lds
    buffer_load_dwordx4 v16, s[52:55], s74 offen offset:2048  lds
    buffer_load_dwordx4 v17, s[52:55], s74 offen offset:3072  lds
    buffer_load_dword v134, v128, s[64:67], 0 offen sc1
    s_waitcnt vmcnt(19)
    s_barrier
    s_add_u32 s74, s80, 3
    s_and_b32 s74, s74, 7
    s_lshl_b32 s74, s74, 7
    s_or_b32 s74, s74, s82
    s_xor_b32 s74, s74, 0
    s_add_u32 m0, s79, 65536
    s_nop 0
    buffer_load_dwordx4 v14, s[52:55], s74 offen offset:0  lds
    buffer_load_dwordx4 v15, s[52:55], s74 offen offset:1024  lds
    buffer_load_dwordx4 v16, s[52:55], s74 offen offset:2048  lds
    buffer_load_dwordx4 v17, s[52:55], s74 offen offset:3072  lds
    s_waitcnt vmcnt(22)
    s_barrier
    s_add_u32 s74, s80, 3
    s_and_b32 s74, s74, 7
    s_lshl_b32 s74, s74, 7
    s_or_b32 s74, s74, s82
    s_xor_b32 s74, s74, 131072
    s_add_u32 m0, s79, 81920
    s_nop 0
    buffer_load_dwordx4 v14, s[52:55], s74 offen offset:0  lds
    buffer_load_dwordx4 v15, s[52:55], s74 offen offset:1024  lds
    buffer_load_dwordx4 v16, s[52:55], s74 offen offset:2048  lds
    buffer_load_dwordx4 v17, s[52:55], s74 offen offset:3072  lds
    s_waitcnt vmcnt(22)
    s_barrier
    s_add_u32 s74, s80, 3
    s_and_b32 s74, s74, 7
    s_lshl_b32 s74, s74, 7
    s_or_b32 s74, s74, s82
    s_xor_b32 s74, s74, 262144
    s_add_u32 m0, s79, 98304
    s_nop 0
    buffer_load_dwordx4 v14, s[52:55], s74 offen offset:0  lds
    buffer_load_dwordx4 v15, s[52:55], s74 offen offset:1024  lds
    buffer_load_dwordx4 v16, s[52:55], s74 offen offset:2048  lds
    buffer_load_dwordx4 v17, s[52:55], s74 offen offset:3072  lds
    s_waitcnt vmcnt(22)
    s_barrier
    s_add_u32 s74, s80, 3
    s_and_b32 s74, s74, 7
    s_lshl_b32 s74, s74, 7
    s_or_b32 s74, s74, s82
    s_xor_b32 s74, s74, 393216
    s_add_u32 m0, s79, 114688
    s_nop 0
    buffer_load_dwordx4 v14, s[52:55], s74 offen offset:0  lds
    buffer_load_dwordx4 v15, s[52:55], s74 offen offset:1024  lds
    buffer_load_dwordx4 v16, s[52:55], s74 offen offset:2048  lds
    buffer_load_dwordx4 v17, s[52:55], s74 offen offset:3072  lds
    s_waitcnt vmcnt(16)
L_B1_poll0_0:
    v_readfirstlane_b32 s73, v134
    s_cmp_ge_u32 s73, 8
    s_cbranch_scc1 L_B1_poll0_0_ok
    buffer_load_dword v134, v128, s[64:67], 0 offen sc1
    s_waitcnt vmcnt(0)
    s_sub_u32 s81, s81, 1
    s_cbranch_scc0 L_B1_poll0_0
    s_mov_b32 s81, 0
L_B1_poll0_0_ok:
    s_waitcnt vmcnt(21)
    s_barrier
    s_add_u32 s74, s80, 4
    s_and_b32 s74, s74, 7
    s_lshl_b32 s74, s74, 7
    s_or_b32 s74, s74, s82
    s_xor_b32 s74, s74, 0
    s_add_u32 m0, s79, 0
    s_nop 0
    buffer_load_dwordx4 v14, s[52:55], s74 offen offset:0  lds
    buffer_load_dwordx4 v15, s[52:55], s74 offen offset:1024  lds
    buffer_load_dwordx4 v16, s[52:55], s74 offen offset:2048  lds
    buffer_load_dwordx4 v17, s[52:55], s74 offen offset:3072  lds
    s_waitcnt vmcnt(21)
    s_barrier
    s_add_u32 s74, s80, 4
    s_and_b32 s74, s74, 7
    s_lshl_b32 s74, s74, 7
    s_or_b32 s74, s74, s82
    s_xor_b32 s74, s74, 131072
    s_add_u32 m0, s79, 16384
    s_nop 0
    buffer_load_dwordx4 v14, s[52:55], s74 offen offset:0  lds
    buffer_load_dwordx4 v15, s[52:55], s74 offen offset:1024  lds
    buffer_load_dwordx4 v16, s[52:55], s74 offen offset:2048  lds
    buffer_load_dwordx4 v17, s[52:55], s74 offen offset:3072  lds
    s_waitcnt vmcnt(20)
    s_barrier
    s_add_u32 s74, s80, 4
    s_and_b32 s74, s74, 7
    s_lshl_b32 s74, s74, 7
    s_or_b32 s74, s74, s82
    s_xor_b32 s74, s74, 262144
    s_add_u32 m0, s79, 32768
    s_nop 0
    buffer_load_dwordx4 v14, s[52:55], s74 offen offset:0  lds
    buffer_load_dwordx4 v15, s[52:55], s74 offen offset:1024  lds
    buffer_load_dwordx4 v16, s[52:55], s74 offen offset:2048  lds
    buffer_load_dwordx4 v17, s[52:55], s74 offen offset:3072  lds
    s_waitcnt vmcnt(20)
    s_barrier
    s_add_u32 s74, s80, 4
    s_and_b32 s74, s74, 7
    s_lshl_b32 s74, s74, 7
    s_or_b32 s74, s74, s82
    s_xor_b32 s74, s74, 393216
    s_add_u32 m0, s79, 49152
    s_nop 0
    buffer_load_dwordx4 v14, s[52:55], s74 offen offset:0  lds
    buffer_load_dwordx4 v15, s[52:55], s74 offen offset:1024  lds
    buffer_load_dwordx4 v16, s[52:55], s74 offen offset:2048  lds
    buffer_load_dwordx4 v17, s[52:55], s74 offen offset:3072  lds
    s_waitcnt vmcnt(20)
    s_barrier
    s_add_u32 s74, s80, 5
    s_and_b32 s74, s74, 7
    s_lshl_b32 s74, s74, 7
    s_or_b32 s74, s74, s82
    s_xor_b32 s74, s74, 0
    s_add_u32 m0, s79, 65536
    s_nop 0
    buffer_load_dwordx4 v14, s[52:55], s74 offen offset:0  lds
    buffer_load_dwordx4 v15, s[52:55], s74 offen offset:1024  lds
    buffer_load_dwordx4 v16, s[52:55], s74 offen offset:2048  lds
    buffer_load_dwordx4 v17, s[52:55], s74 offen offset:3072  lds
    s_sub_u32 s76, s80, 1
    s_and_b32 s76, s76, 7
    s_lshl_b32 s76, s76, 7
    buffer_load_dword v134, v128, s[60:63], s76 offen sc1
    s_waitcnt vmcnt(21)
    s_barrier
    s_add_u32 s74, s80, 5
    s_and_b32 s74, s74, 7
    s_lshl_b32 s74, s74, 7
    s_or_b32 s74, s74, s82
    s_xor_b32 s74, s74, 131072
    s_add_u32 m0, s79, 81920
    s_nop 0
    buffer_load_dwordx4 v14, s[52:55], s74 offen offset:0  lds
    buffer_load_dwordx4 v15, s[52:55], s74 offen offset:1024  lds
    buffer_load_dwordx4 v16, s[52:55], s74 offen offset:2048  lds
    buffer_load_dwordx4 v17, s[52:55], s74 offen offset:3072  lds
    s_waitcnt vmcnt(21)
    s_barrier
    s_add_u32 s74, s80, 5
    s_and_b32 s74, s74, 7
    s_lshl_b32 s74, s74, 7
    s_or_b32 s74, s74, s82
    s_xor_b32 s74, s74, 262144
    s_add_u32 m0, s79, 98304
    s_nop 0
    buffer_load_dwordx4 v14, s[52:55], s74 offen offset:0  lds
    buffer_load_dwordx4 v15, s[52:55], s74 offen offset:1024  lds
    buffer_load_dwordx4 v16, s[52:55], s74 offen offset:2048  lds
    buffer_load_dwordx4 v17, s[52:55], s74 offen offset:3072  lds
    s_waitcnt vmcnt(21)
    s_barrier
    s_add_u32 s74, s80, 5
    s_and_b32 s74, s74, 7
    s_lshl_b32 s74, s74, 7
    s_or_b32 s74, s74, s82
    s_xor_b32 s74, s74, 393216
    s_add_u32 m0, s79, 114688
    s_nop 0
    buffer_load_dwordx4 v14, s[52:55], s74 offen offset:0  lds
    buffer_load_dwordx4 v15, s[52:55], s74 offen offset:1024  lds
    buffer_load_dwordx4 v16, s[52:55], s74 offen offset:2048  lds
    buffer_load_dwordx4 v17, s[52:55], s74 offen offset:3072  lds
    s_waitcnt vmcnt(12)
L_B1_poll1_0:
    v_readfirstlane_b32 s73, v134
    s_cmp_ge_u32 s73, 1
    s_cbranch_scc1 L_B1_poll1_0_ok
    buffer_load_dword v134, v128, s[60:63], s76 offen sc1
    s_waitcnt vmcnt(0)
    s_sub_u32 s81, s81, 1
    s_cbranch_scc0 L_B1_poll1_0
    s_mov_b32 s81, 0
L_B1_poll1_0_ok:
    s_waitcnt vmcnt(21)
    s_barrier
    s_add_u32 s74, s80, 6
    s_and_b32 s74, s74, 7
    s_lshl_b32 s74, s74, 7
    s_or_b32 s74, s74, s82
    s_xor_b32 s74, s74, 0
    s_add_u32 m0, s79, 0
    s_nop 0
    buffer_load_dwordx4 v14, s[52:55], s74 offen offset:0  lds
    buffer_load_dwordx4 v15, s[52:55], s74 offen offset:1024  lds
    buffer_load_dwordx4 v16, s[52:55], s74 offen offset:2048  lds
    buffer_load_dwordx4 v17, s[52:55], s74 offen offset:3072  lds
    s_sub_u32 s75, s80, 1
    s_and_b32 s75, s75, 7
    s_lshl_b32 s75, s75, 14
    s_add_u32 s75, s75, s83
    buffer_load_dwordx4 v[144:147], v129, s[56:59], s75 offen offset:0 sc1
    buffer_load_dwordx4 v[172:175], v129, s[56:59], s75 offen offset:1024 sc1
    s_sub_u32 s76, s80, 2
    s_and_b32 s76, s76, 7
    s_lshl_b32 s76, s76, 7
    buffer_load_dword v134, v128, s[60:63], s76 offen sc1
    s_waitcnt vmcnt(24)
    s_barrier
    s_add_u32 s74, s80, 6
    s_and_b32 s74, s74, 7
    s_lshl_b32 s74, s74, 7
    s_or_b32 s74, s74, s82
    s_xor_b32 s74, s74, 131072
    s_add_u32 m0, s79, 16384
    s_nop 0
    buffer_load_dwordx4 v14, s[52:55], s74 offen offset:0  lds
    buffer_load_dwordx4 v15, s[52:55], s74 offen offset:1024  lds
    buffer_load_dwordx4 v16, s[52:55], s74 offen offset:2048  lds
    buffer_load_dwordx4 v17, s[52:55], s74 offen offset:3072  lds
    s_waitcnt vmcnt(24)
    s_barrier
    s_add_u32 s74, s80, 6
    s_and_b32 s74, s74, 7
    s_lshl_b32 s74, s74, 7
    s_or_b32 s74, s74, s82
    s_xor_b32 s74, s74, 262144
    s_add_u32 m0, s79, 32768
    s_nop 0
    buffer_load_dwordx4 v14, s[52:55], s74 offen offset:0  lds
    buffer_load_dwordx4 v15, s[52:55], s74 offen offset:1024  lds
    buffer_load_dwordx4 v16, s[52:55], s74 offen offset:2048  lds
    buffer_load_dwordx4 v17, s[52:55], s74 offen offset:3072  lds
    s_waitcnt vmcnt(23)
    s_barrier
    s_add_u32 s74, s80, 6
    s_and_b32 s74, s74, 7
    s_lshl_b32 s74, s74, 7
    s_or_b32 s74, s74, s82
    s_xor_b32 s74, s74, 393216
    s_add_u32 m0, s79, 49152
    s_nop 0
    buffer_load_dwordx4 v14, s[52:55], s74 offen offset:0  lds
    buffer_load_dwordx4 v15, s[52:55], s74 offen offset:1024  lds
    buffer_load_dwordx4 v16, s[52:55], s74 offen offset:2048  lds
    buffer_load_dwordx4 v17, s[52:55], s74 offen offset:3072  lds
    s_waitcnt vmcnt(12)
L_B1_poll2_0:
    v_readfirstlane_b32 s73, v134
    s_cmp_ge_u32 s73, 2
    s_cbranch_scc1 L_B1_poll2_0_ok
    buffer_load_dword v134, v128, s[60:63], s76 offen sc1
    s_waitcnt vmcnt(0)
    s_sub_u32 s81, s81, 1
    s_cbranch_scc0 L_B1_poll2_0
    s_mov_b32 s81, 0
L_B1_poll2_0_ok:
    s_waitcnt vmcnt(23)
    s_barrier
    s_add_u32 s74, s80, 7
    s_and_b32 s74, s74, 7
    s_lshl_b32 s74, s74, 7
    s_or_b32 s74, s74, s82
    s_xor_b32 s74, s74, 0
    s_add_u32 m0, s79, 65536
    s_nop 0
    buffer_load_dwordx4 v14, s[52:55], s74 offen offset:0  lds
    buffer_load_dwordx4 v15, s[52:55], s74 offen offset:1024  lds
    buffer_load_dwordx4 v16, s[52:55], s74 offen offset:2048  lds
    buffer_load_dwordx4 v17, s[52:55], s74 offen offset:3072  lds
    s_sub_u32 s75, s80, 2
    s_and_b32 s75, s75, 7
    s_lshl_b32 s75, s75, 14
    s_add_u32 s75, s75, s83
    buffer_load_dwordx4 v[148:151], v129, s[56:59], s75 offen offset:0 sc1
    buffer_load_dwordx4 v[176:179], v129, s[56:59], s75 offen offset:1024 sc1
    s_sub_u32 s76, s80, 3
    s_and_b32 s76, s76, 7
    s_lshl_b32 s76, s76, 7
    buffer_load_dword v134, v128, s[60:63], s76 offen sc1
    s_waitcnt vmcnt(26)
    s_barrier
    s_add_u32 s74, s80, 7
    s_and_b32 s74, s74, 7
    s_lshl_b32 s74, s74, 7
    s_or_b32 s74, s74, s82
    s_xor_b32 s74, s74, 131072
    s_add_u32 m0, s79, 81920
    s_nop 0
    buffer_load_dwordx4 v14, s[52:55], s74 offen offset:0  lds
    buffer_load_dwordx4 v15, s[52:55], s74 offen offset:1024  lds
    buffer_load_dwordx4 v16, s[52:55], s74 offen offset:2048  lds
    buffer_load_dwordx4 v17, s[52:55], s74 offen offset:3072  lds
    s_waitcnt vmcnt(26)
    s_barrier
    s_add_u32 s74, s80, 7
    s_and_b32 s74, s74, 7
    s_lshl_b32 s74, s74, 7
    s_or_b32 s74, s74, s82
    s_xor_b32 s74, s74, 262144
    s_add_u32 m0, s79, 98304
    s_nop 0
    buffer_load_dwordx4 v14, s[52:55], s74 offen offset:0  lds
    buffer_load_dwordx4 v15, s[52:55], s74 offen offset:1024  lds
    buffer_load_dwordx4 v16, s[52:55], s74 offen offset:2048  lds
    buffer_load_dwordx4 v17, s[52:55], s74 offen offset:3072  lds
    s_waitcnt vmcnt(23)
    s_barrier
    s_add_u32 s74, s80, 7
    s_and_b32 s74, s74, 7
    s_lshl_b32 s74, s74, 7
    s_or_b32 s74, s74, s82
    s_xor_b32 s74, s74, 393216
    s_add_u32 m0, s79, 114688
    s_nop 0
    buffer_load_dwordx4 v14, s[52:55], s74 offen offset:0  lds
    buffer_load_dwordx4 v15, s[52:55], s74 offen offset:1024  lds
    buffer_load_dwordx4 v16, s[52:55], s74 offen offset:2048  lds
    buffer_load_dwordx4 v17, s[52:55], s74 offen offset:3072  lds
    s_waitcnt vmcnt(12)
L_B1_poll3_0:
    v_readfirstlane_b32 s73, v134
    s_cmp_ge_u32 s73, 3
    s_cbranch_scc1 L_B1_poll3_0_ok
    buffer_load_dword v134, v128, s[60:63], s76 offen sc1
    s_waitcnt vmcnt(0)
    s_sub_u32 s81, s81, 1
    s_cbranch_scc0 L_B1_poll3_0
    s_mov_b32 s81, 0
L_B1_poll3_0_ok:
    s_waitcnt vmcnt(23)
    s_barrier
    s_add_u32 s74, s80, 8
    s_and_b32 s74, s74, 7
    s_lshl_b32 s74, s74, 7
    s_or_b32 s74, s74, s82
    s_xor_b32 s74, s74, 0
    s_add_u32 m0, s79, 0
    s_nop 0
    buffer_load_dwordx4 v14, s[52:55], s74 offen offset:0  lds
    buffer_load_dwordx4 v15, s[52:55], s74 offen offset:1024  lds
    buffer_load_dwordx4 v16, s[52:55], s74 offen offset:2048  lds
    buffer_load_dwordx4 v17, s[52:55], s74 offen offset:3072  lds
    s_sub_u32 s75, s80, 3
    s_and_b32 s75, s75, 7
    s_lshl_b32 s75, s75, 14
    s_add_u32 s75, s75, s83
    buffer_load_dwordx4 v[152:155], v129, s[56:59], s75 offen offset:0 sc1
    buffer_load_dwordx4 v[180:183], v129, s[56:59], s75 offen offset:1024 sc1
    s_sub_u32 s76, s80, 4
    s_and_b32 s76, s76, 7
    s_lshl_b32 s76, s76, 7
    buffer_load_dword v134, v128, s[60:63], s76 offen sc1
    s_waitcnt vmcnt(26)
    s_barrier
    s_add_u32 s74, s80, 8
    s_and_b32 s74, s74, 7
    s_lshl_b32 s74, s74, 7
    s_or_b32 s74, s74, s82
    s_xor_b32 s74, s74, 131072
    s_add_u32 m0, s79, 16384
    s_nop 0
    buffer_load_dwordx4 v14, s[52:55], s74 offen offset:0  lds
    buffer_load_dwordx4 v15, s[52:55], s74 offen offset:1024  lds
    buffer_load_dwordx4 v16, s[52:55], s74 offen offset:2048  lds
    buffer_load_dwordx4 v17, s[52:55], s74 offen offset:3072  lds
    s_waitcnt vmcnt(26)
    s_barrier
    s_add_u32 s74, s80, 8
    s_and_b32 s74, s74, 7
    s_lshl_b32 s74, s74, 7
    s_or_b32 s74, s74, s82
    s_xor_b32 s74, s74, 262144
    s_add_u32 m0, s79, 32768
    s_nop 0
    buffer_load_dwordx4 v14, s[52:55], s74 offen offset:0  lds
    buffer_load_dwordx4 v15, s[52:55], s74 offen offset:1024  lds
    buffer_load_dwordx4 v16, s[52:55], s74 offen offset:2048  lds
    buffer_load_dwordx4 v17, s[52:55], s74 offen offset:3072  lds
    s_waitcnt vmcnt(23)
    s_barrier
    s_add_u32 s74, s80, 8
    s_and_b32 s74, s74, 7
    s_lshl_b32 s74, s74, 7
    s_or_b32 s74, s74, s82
    s_xor_b32 s74, s74, 393216
    s_add_u32 m0, s79, 49152
    s_nop 0
    buffer_load_dwordx4 v14, s[52:55], s74 offen offset:0  lds
    buffer_load_dwordx4 v15, s[52:55], s74 offen offset:1024  lds
    buffer_load_dwordx4 v16, s[52:55], s74 offen offset:2048  lds
    buffer_load_dwordx4 v17, s[52:55], s74 offen offset:3072  lds
    s_waitcnt vmcnt(12)
L_B1_poll4_0:
    v_readfirstlane_b32 s73, v134
    s_cmp_ge_u32 s73, 4
    s_cbranch_scc1 L_B1_poll4_0_ok
    buffer_load_dword v134, v128, s[60:63], s76 offen sc1
    s_waitcnt vmcnt(0)
    s_sub_u32 s81, s81, 1
    s_cbranch_scc0 L_B1_poll4_0
    s_mov_b32 s81, 0
L_B1_poll4_0_ok:
    s_waitcnt vmcnt(23)
    s_barrier
    s_sub_u32 s75, s80, 4
    s_and_b32 s75, s75, 7
    s_lshl_b32 s75, s75, 14
    s_add_u32 s75, s75, s83
    buffer_load_dwordx4 v[156:159], v129, s[56:59], s75 offen offset:0 sc1
    buffer_load_dwordx4 v[184:187], v129, s[56:59], s75 offen offset:1024 sc1
    s_sub_u32 s76, s80, 5
    s_and_b32 s76, s76, 7
    s_lshl_b32 s76, s76, 7
    buffer_load_dword v134, v128, s[60:63], s76 offen sc1
    s_waitcnt vmcnt(22)
    s_barrier
    s_waitcnt vmcnt(18)
    s_barrier
    s_waitcnt vmcnt(11)
    s_barrier
    s_waitcnt vmcnt(0)
L_B1_poll5_0:
    v_readfirstlane_b32 s73, v134
    s_cmp_ge_u32 s73, 5
    s_cbranch_scc1 L_B1_poll5_0_ok
    buffer_load_dword v134, v128, s[60:63], s76 offen sc1
    s_waitcnt vmcnt(0)
    s_sub_u32 s81, s81, 1
    s_cbranch_scc0 L_B1_poll5_0
    s_mov_b32 s81, 0
L_B1_poll5_0_ok:
    s_waitcnt vmcnt(7)
    s_barrier
    s_sub_u32 s75, s80, 5
    s_and_b32 s75, s75, 7
    s_lshl_b32 s75, s75, 14
    s_add_u32 s75, s75, s83
    buffer_load_dwordx4 v[160:163], v129, s[56:59], s75 offen offset:0 sc1
    buffer_load_dwordx4 v[188:191], v129, s[56:59], s75 offen offset:1024 sc1
    s_sub_u32 s76, s80, 6
    s_and_b32 s76, s76, 7
    s_lshl_b32 s76, s76, 7
    buffer_load_dword v134, v128, s[60:63], s76 offen sc1
    s_waitcnt vmcnt(6)
    s_barrier
    s_waitcnt vmcnt(6)
    s_barrier
    s_waitcnt vmcnt(0)
L_B1_poll6_0:
    v_readfirstlane_b32 s73, v134
    s_cmp_ge_u32 s73, 6
    s_cbranch_scc1 L_B1_poll6_0_ok
    buffer_load_dword v134, v128, s[60:63], s76 offen sc1
    s_waitcnt vmcnt(0)
    s_sub_u32 s81, s81, 1
    s_cbranch_scc0 L_B1_poll6_0
    s_mov_b32 s81, 0
L_B1_poll6_0_ok:
    s_waitcnt vmcnt(6)
    s_barrier
    s_sub_u32 s76, s80, 7
    s_and_b32 s76, s76, 7
    s_lshl_b32 s76, s76, 7
    buffer_load_dword v134, v128, s[60:63], s76 offen sc1
    s_sub_u32 s75, s80, 6
    s_and_b32 s75, s75, 7
    s_lshl_b32 s75, s75, 14
    s_add_u32 s75, s75, s83
    buffer_load_dwordx4 v[164:167], v129, s[56:59], s75 offen offset:0 sc1
    buffer_load_dwordx4 v[192:195], v129, s[56:59], s75 offen offset:1024 sc1
    s_waitcnt vmcnt(4)
    v_mfma_f32_16x16x32_bf16 v[64:67], v[140:143], v[144:147], 0
    v_mfma_f32_16x16x32_bf16 v[72:75], v[140:143], v[172:175], 0
    v_mfma_f32_16x16x32_bf16 v[68:71], v[138:141], v[146:149], 0
    v_mfma_f32_16x16x32_bf16 v[76:79], v[138:141], v[174:177], 0
    v_mfma_f32_16x16x32_bf16 v[64:67], v[138:141], v[150:153], v[64:67]
    v_mfma_f32_16x16x32_bf16 v[72:75], v[138:141], v[178:181], v[72:75]
    v_mfma_f32_16x16x32_bf16 v[68:71], v[138:141], v[154:157], v[68:71]
    v_mfma_f32_16x16x32_bf16 v[76:79], v[138:141], v[182:185], v[76:79]
    v_mfma_f32_16x16x32_bf16 v[64:67], v[138:141], v[158:161], v[64:67]
    v_mfma_f32_16x16x32_bf16 v[72:75], v[138:141], v[186:189], v[72:75]
    s_waitcnt vmcnt(2)
L_B1_poll7_0:
    v_readfirstlane_b32 s73, v134
    s_cmp_ge_u32 s73, 7
    s_cbranch_scc1 L_B1_poll7_0_ok
    buffer_load_dword v134, v128, s[60:63], s76 offen sc1
    s_waitcnt vmcnt(0)
    s_sub_u32 s81, s81, 1
    s_cbranch_scc0 L_B1_poll7_0
    s_mov_b32 s81, 0
L_B1_poll7_0_ok:
    s_barrier
    s_sub_u32 s75, s80, 7
    s_and_b32 s75, s75, 7
    s_lshl_b32 s75, s75, 14
    s_add_u32 s75, s75, s83
    buffer_load_dwordx4 v[168:171], v129, s[56:59], s75 offen offset:0 sc1
    buffer_load_dwordx4 v[196:199], v129, s[56:59], s75 offen offset:1024 sc1
    ds_read_b128 v[32:35], v130 offset:0
    ds_read_b128 v[36:39], v130 offset:1024
    ds_read_b128 v[40:43], v130 offset:2048
    ds_read_b128 v[44:47], v130 offset:3072
    s_waitcnt lgkmcnt(0)
    v_add_f32 v64, v64, v32
    v_add_f32 v65, v65, v33
    v_add_f32 v66, v66, v34
    v_add_f32 v67, v67, v35
    v_add_f32 v68, v68, v36
    v_add_f32 v69, v69, v37
    v_add_f32 v70, v70, v38
    v_add_f32 v71, v71, v39
    v_add_f32 v72, v72, v40
    v_add_f32 v73, v73, v41
    v_add_f32 v74, v74, v42
    v_add_f32 v75, v75, v43
    v_add_f32 v76, v76, v44
    v_add_f32 v77, v77, v45
    v_add_f32 v78, v78, v46
    v_add_f32 v79, v79, v47
    s_nop 0
    s_waitcnt vmcnt(2)
    v_mfma_f32_16x16x32_bf16 v[68:71], v[138:141], v[162:165], v[68:71]
    v_mfma_f32_16x16x32_bf16 v[76:79], v[138:141], v[190:193], v[76:79]
    s_waitcnt vmcnt(0)
    v_mfma_f32_16x16x32_bf16 v[64:67], v[138:141], v[166:169], v[64:67]
    v_mfma_f32_16x16x32_bf16 v[72:75], v[138:141], v[194:197], v[72:75]
    v_mfma_f32_16x16x32_bf16 v[68:71], v[136:139], v[168:171], v[68:71]
    v_mfma_f32_16x16x32_bf16 v[76:79], v[136:139], v[196:199], v[76:79]
    s_nop 4
    v_cvt_pk_bf16_f32 v64, v64, v65
    v_cvt_pk_bf16_f32 v65, v66, v67
    ds_write_b64 v10, v[64:65] offset:0
    v_cvt_pk_bf16_f32 v68, v68, v69
    v_cvt_pk_bf16_f32 v69, v70, v71
    ds_write_b64 v11, v[68:69] offset:0
    v_cvt_pk_bf16_f32 v72, v72, v73
    v_cvt_pk_bf16_f32 v73, v74, v75
    ds_write_b64 v12, v[72:73] offset:0
    v_cvt_pk_bf16_f32 v76, v76, v77
    v_cvt_pk_bf16_f32 v77, v78, v79
    ds_write_b64 v13, v[76:77] offset:0
    ds_read_b128 v[144:147], v133 offset:0
    ds_read_b128 v[148:151], v133 offset:1024
    s_waitcnt lgkmcnt(1)
    buffer_store_dwordx4 v[144:147], v132, s[68:71], 0 offen sc1
    s_waitcnt lgkmcnt(0)
    buffer_store_dwordx4 v[148:151], v132, s[68:71], s37 offen sc1
    s_endpgm
L_end:
    s_endpgm
.section .rodata,"a"
.p2align 6
.amdhsa_kernel concat_heads__mha_block_cached__mha_block_cached__near_ridge_kernel
  .amdhsa_next_free_vgpr 256
  .amdhsa_next_free_sgpr 102
  .amdhsa_accum_offset 256
  .amdhsa_group_segment_fixed_size 0
  .amdhsa_kernarg_size 104
  .amdhsa_user_sgpr_count 2
  .amdhsa_user_sgpr_kernarg_segment_ptr 1
  .amdhsa_system_sgpr_workgroup_id_x 1
.end_amdhsa_kernel
```
